```python
import torch

def _softmax(x, axis=-1):
    return torch.softmax(x, dim=axis)

def _gelu(x):
    return torch.nn.functional.gelu(x, approximate='tanh')

def _silu(x):
    return torch.nn.functional.silu(x)

def _sigmoid(x):
    return torch.sigmoid(x)

def _layernorm(x, axis=-1, eps=1e-05):
    m = x.mean(dim=axis, keepdim=True)
    v = x.var(dim=axis, keepdim=True, unbiased=False)
    return (x - m) / torch.sqrt(v + eps)

def _scatter_add(tgt, idx, src, axis=0):
    return tgt.clone().index_add_(axis, idx, src)

def _segment_sum(src, seg, n):
    out = torch.zeros((n,) + src.shape[1:], dtype=src.dtype)
    return out.index_add_(0, seg, src)

def _pad(x, pw):
    flat = tuple((v for pair in reversed(pw) for v in pair))
    return torch.nn.functional.pad(x, flat)
kernel_name = 'adaLN_cond__gqa_block_cached__mixer_s_mlp__prompt'

def setup_inputs():

    _w = lambda a: (lambda t: t.to(torch.bfloat16) if t.is_floating_point() else t)(torch.as_tensor(a))

    def _A_setup():
        B, Sq, D = (1, 2048, 448)
        Hq, Hkv, Sk, Dh = (16, 8, 2048, 256)
        assert Hq % Hkv == 0, (Hq, Hkv)
        return {'x': _w((lambda *s: torch.randn(*s, dtype=torch.bfloat16) * 0.05)(B, Sq, D)), 'k_cache': _w((lambda *s: torch.randn(*s, dtype=torch.bfloat16) * 3.2)(B, Hkv, Sk, Dh)), 'v_cache': _w((lambda *s: torch.randn(*s, dtype=torch.bfloat16) * 0.4)(B, Hkv, Sk, Dh)), 'wq': _w((lambda *s: torch.randn(*s, dtype=torch.bfloat16) * 3.2)(D, Hq * Dh) * D ** (-0.5)), 'wo': _w((lambda *s: torch.randn(*s, dtype=torch.bfloat16) * 0.4)(Hq * Dh, D) * (Hq * Dh) ** (-0.5))}
    _A_in = _A_setup()

    def _B_setup():
        B, S, D, F = (1, 2048, 448, 1792)
        return {'x': _w((lambda *s: torch.randn(*s, dtype=torch.bfloat16) * 0.05)(B, S, D)), 'w1': _w((lambda *s: torch.randn(*s, dtype=torch.bfloat16) * 3.2)(D, D) * D ** (-0.5)), 'w2': _w((lambda *s: torch.randn(*s, dtype=torch.bfloat16) * 3.2)(D, D) * D ** (-0.5)), 'w3': _w((lambda *s: torch.randn(*s, dtype=torch.bfloat16) * 3.2)(D, F) * D ** (-0.5)), 'w4': _w((lambda *s: torch.randn(*s, dtype=torch.bfloat16) * 3.2)(F, D) * F ** (-0.5))}
    _B_in = _B_setup()
    return {'A_x': _A_in['x'], 'A_k_cache': _A_in['k_cache'], 'A_v_cache': _A_in['v_cache'], 'A_wq': _A_in['wq'], 'A_wo': _A_in['wo'], 'B_x': _B_in['x'], 'B_w1': _B_in['w1'], 'B_w2': _B_in['w2'], 'B_w3': _B_in['w3'], 'B_w4': _B_in['w4'], 'c': _w((lambda *s: torch.randn(*s, dtype=torch.bfloat16) * 0.1)(1, 448) * 8.0), 'w_mod': _w((lambda *s: torch.randn(*s, dtype=torch.bfloat16) * 0.1)(448, 6 * 448) * 448 ** (-0.5) * 8.0)}

def reference(A_x, A_k_cache, A_v_cache, A_wq, A_wo, B_x, B_w1, B_w2, B_w3, B_w4, c, w_mod):

    def _A_ref(x, k_cache, v_cache, wq, wo):
        B, Sq, D = x.shape
        Hq, Dh = (16, 256)
        Hkv = k_cache.shape[1]
        rep = Hq // Hkv
        q = (lambda x, *d: x.permute(*d))((x @ wq).reshape(B, Sq, Hq, Dh), 0, 2, 1, 3)
        k = (lambda x, n, axis: torch.repeat_interleave(x, n, dim=axis))(k_cache, rep, axis=1)
        v = (lambda x, n, axis: torch.repeat_interleave(x, n, dim=axis))(v_cache, rep, axis=1)
        scores = torch.einsum('bhqd,bhkd->bhqk', q, k) * Dh ** (-0.5)
        p = _softmax(scores, axis=-1)
        o = torch.einsum('bhqk,bhkd->bhqd', p, v)
        return (lambda x, *d: x.permute(*d))(o, 0, 2, 1, 3).reshape(B, Sq, Hq * Dh) @ wo

    def _B_ref(x, w1, w2, w3, w4):
        B, S, D = x.shape
        h = _gelu(_layernorm(x, axis=-1) @ w1)
        c = D // 4
        g0 = _pad(h[:, :, 0 * c:1 * c], ((0, 0), (1, 0), (0, 0)))[:, :S, :]
        g1 = _pad(h[:, :, 1 * c:2 * c], ((0, 0), (0, 1), (0, 0)))[:, 1:, :]
        g2 = _pad(h[:, :, 2 * c:3 * c], ((0, 0), (2, 0), (0, 0)))[:, :S, :]
        g3 = _pad(h[:, :, 3 * c:], ((0, 0), (0, 2), (0, 0)))[:, 2:, :]
        hs = torch.concatenate([g0, g1, g2, g3], axis=-1) @ w2
        x1 = x + hs
        h2 = _gelu(_layernorm(x1, axis=-1) @ w3) @ w4
        return x1 + h2
    x = A_x
    mod = (_silu(c) @ w_mod).reshape(c.shape[0], 6, 1, -1)
    sa, ca, ga, sb, cb, gb = (mod[:, 0].clone(), mod[:, 1].clone(), mod[:, 2].clone(), mod[:, 3].clone(), mod[:, 4].clone(), mod[:, 5].clone())
    h = _layernorm(x, axis=-1) * (1 + ca) + sa
    x = x + ga * _A_ref(h, A_k_cache, A_v_cache, A_wq, A_wo)
    h = _layernorm(x, axis=-1) * (1 + cb) + sb
    x = x + gb * _B_ref(h, B_w1, B_w2, B_w3, B_w4)
    return x
```

```asm
; @launch grid=(256,1,1) block=(256,1,1) lds=163840
.amdgcn_target "amdgcn-amd-amdhsa--gfx950"
.text
.globl adaLN_cond__gqa_block_cached__mixer_s_mlp__prompt_kernel
.p2align 8
.type adaLN_cond__gqa_block_cached__mixer_s_mlp__prompt_kernel,@function
adaLN_cond__gqa_block_cached__mixer_s_mlp__prompt_kernel:
KB_entry:
    s_cmp_ge_u32 s2, 256
    s_cbranch_scc1 KB_done
    s_load_dwordx4 s[4:7], s[0:1], 80
    s_load_dwordx2 s[64:65], s[0:1], 0
    s_load_dwordx4 s[44:47], s[0:1], 8
    s_load_dwordx4 s[48:51], s[0:1], 24
    s_load_dwordx4 s[52:55], s[0:1], 104
    s_load_dwordx4 s[56:59], s[0:1], 48
    s_load_dwordx4 s[60:63], s[0:1], 64
    v_mov_b32 v255, v0
    v_lshrrev_b32 v201, 6, v0
    v_and_b32 v202, 63, v0
    v_lshrrev_b32 v206, 2, v0
    v_and_b32 v207, 3, v0
    v_mul_u32_u24 v208, 5376, v206
    v_lshl_add_u32 v208, v207, 4, v208
    v_lshlrev_b32 v206, 1, v206
    v_readfirstlane_b32 s24, v201
    s_lshl_b32 s43, s2, 6
    s_waitcnt lgkmcnt(0)
    s_mov_b32 s8, s4
    s_mov_b32 s9, s5
    s_mov_b32 s10, 896
    s_mov_b32 s11, 0x20000
    s_mov_b32 s4, s6
    s_mov_b32 s5, s7
    s_mov_b32 s6, 2408448
    s_mov_b32 s7, 0x20000
    s_cmp_ge_u32 s2, 84
    s_cbranch_scc1 KB_p1
    buffer_load_ushort v56, v206, s[8:11], 0 offen offset:0
    buffer_load_ushort v57, v206, s[8:11], 0 offen offset:128
    buffer_load_ushort v58, v206, s[8:11], 0 offen offset:256
    buffer_load_ushort v59, v206, s[8:11], 0 offen offset:384
    buffer_load_ushort v60, v206, s[8:11], 0 offen offset:512
    buffer_load_ushort v61, v206, s[8:11], 0 offen offset:640
    buffer_load_ushort v62, v206, s[8:11], 0 offen offset:768
    buffer_load_dwordx4 v[64:67], v208, s[4:7], s43 offen
    s_add_u32 s43, s43, 344064
    buffer_load_dwordx4 v[68:71], v208, s[4:7], s43 offen
    s_add_u32 s43, s43, 344064
    buffer_load_dwordx4 v[72:75], v208, s[4:7], s43 offen
    s_add_u32 s43, s43, 344064
    buffer_load_dwordx4 v[76:79], v208, s[4:7], s43 offen
    s_add_u32 s43, s43, 344064
    buffer_load_dwordx4 v[80:83], v208, s[4:7], s43 offen
    s_add_u32 s43, s43, 344064
    buffer_load_dwordx4 v[84:87], v208, s[4:7], s43 offen
    s_add_u32 s43, s43, 344064
    buffer_load_dwordx4 v[88:91], v208, s[4:7], s43 offen
KB_p1:
    s_mov_b32 s12, s52
    s_mov_b32 s13, s53
    s_mov_b32 s14, 256
    s_mov_b32 s15, 0x20000
    s_mov_b32 s20, s54
    s_mov_b32 s21, s55
    s_mov_b32 s22, 67108864
    s_mov_b32 s23, 0x20000
    s_lshl_b32 s3, s2, 2
    s_or_b32 s3, s3, s24
    s_cmp_lg_u32 s3, 1012
    s_cbranch_scc1 KB_p0
    s_mov_b32 s66, 57344
    buffer_load_dword v1, off, s[20:23], s66 sc1
KB_p0:
    s_cmp_lg_u32 s24, 3
    s_cbranch_scc1 KB_cp1
    s_getpc_b64 s[72:73]
KB_cp_pc:
    s_add_u32 s72, s72, KB_entry-KB_cp_pc
    s_addc_u32 s73, s73, -1
    s_mov_b32 s74, KB_exit-KB_entry
    s_mov_b32 s75, 0x20000
    s_lshr_b32 s76, s2, 3
    s_mul_i32 s76, s76, 896
    v_min_u32 v3, 6, v202
    v_lshlrev_b32 v3, 7, v3
    buffer_load_dword a255, v3, s[72:75], s76 offen
KB_cp1:
    s_and_b32 s25, s2, 7
    s_lshr_b32 s26, s2, 3
    s_and_b32 s27, s24, 1
    v_and_b32 v203, 15, v202
    v_lshrrev_b32 v204, 4, v202
    v_lshlrev_b32 v205, 4, v202
    v_mov_b32 v254, 1073741824
    v_lshrrev_b32 v201, 1, v204
    s_lshl_b32 s30, s25, 10
    v_cmp_gt_u32 vcc, 56, v202
    s_nop 1
    v_cndmask_b32 v209, v254, v205, vcc
    s_mov_b32 s16, s48
    s_mov_b32 s17, s49
    s_mov_b32 s18, 3670016
    s_mov_b32 s19, 0x20000
    s_mul_i32 s40, s26, 3
    s_mul_i32 s41, s24, 1
    s_add_u32 s40, s40, s41
    s_add_u32 s40, s40, 0
    s_lshl_b32 s40, s40, 13
    s_add_u32 s40, s40, s30
    v_lshrrev_b32 v192, 3, v202
    v_lshlrev_b32 v192, 13, v192
    v_and_b32 v193, 7, v202
    v_lshl_add_u32 v192, v193, 7, v192
    v_cmp_gt_u32 vcc, 8, v202
    s_nop 1
    v_cndmask_b32 v192, v254, v192, vcc
    buffer_load_dword a255, v192, s[16:19], s40 offen
    s_lshl_b32 s42, s26, 2
    s_add_u32 s42, s42, s24
    s_mul_i32 s42, s42, 16*896
    s_mov_b32 s68, s64
    s_mov_b32 s69, s65
    s_mov_b32 s70, 1835008
    s_mov_b32 s71, 0x20000
    s_lshl_b32 s40, s24, 8
    s_add_u32 s28, s30, s40
    s_add_u32 s29, s28, 65536
    s_mul_i32 s32, s24, 8448
    v_and_b32 v207, 1, v204
    v_lshlrev_b32 v207, 15, v207
    v_lshl_add_u32 v207, v201, 17, v207
    v_lshl_add_u32 v230, v203, 4, v207
    v_add_u32 v231, 7136, v230
    v_add_u32 v232, 14272, v230
    v_add_u32 v233, 21408, v230
    s_mul_i32 s40, s27, 16640
    v_mul_u32_u24 v192, 1040, v203
    v_and_b32 v193, 1, v204
    v_lshlrev_b32 v193, 8, v193
    v_lshl_add_u32 v242, v201, 4, v193
    v_add3_u32 v224, v192, v242, s40
    v_and_b32 v193, 1, v204
    v_bfe_u32 v194, v202, 2, 2
    v_lshl_add_u32 v192, v193, 2, v194
    v_mul_u32_u24 v192, 1056, v192
    v_and_b32 v195, 3, v202
    v_lshlrev_b32 v195, 3, v195
    v_lshl_add_u32 v196, v201, 9, v195
    v_add_u32 v196, v196, v192
    s_mul_i32 s40, s27, 17152
    s_add_u32 s40, s40, 66560
    v_add_u32 v225, s40, v196
    s_mul_i32 s40, s27, 16640
    s_sub_u32 s40, 83456, s40
    v_add_u32 v226, s40, v196
    v_add_u32 v238, s32, v196
    s_lshl_b32 s40, s24, 12
    s_add_u32 s40, s40, 134144
    v_lshrrev_b32 v192, 1, v205
    v_add_u32 v227, s40, v192
    s_xor_b32 s40, s40, 4096
    v_add_u32 v228, s40, v192
    v_lshrrev_b32 v192, 5, v202
    v_and_b32 v193, 31, v202
    v_lshlrev_b32 v193, 4, v193
    v_lshl_add_u32 v194, v192, 12, v193
    v_add_u32 v234, 1632, v194
    v_add_u32 v235, 1088, v194
    v_add_u32 v236, 544, v194
    v_add_u32 v237, 0, v194
    v_xor_b32 v192, v203, v204
    v_lshlrev_b32 v192, 4, v192
    v_lshl_add_u32 v192, v204, 8, v192
    v_add_u32 v239, 101376, v192
    v_and_b32 v192, 7, v202
    v_lshlrev_b32 v192, 4, v192
    v_lshl_add_u32 v192, v202, 8, v192
    s_mul_i32 s40, s24, 14336
    s_add_u32 s40, s40, 101376
    v_add_u32 v192, s40, v192
    v_cmp_gt_u32 vcc, 56, v202
    v_and_b32 v193, 0x70, v192
    v_add_u32 v193, 159744, v193
    v_cndmask_b32 v240, v193, v192, vcc
    v_min_u32 v241, 55, v202
    v_lshlrev_b32 v241, 4, v241
    s_mul_i32 s40, s27, 0x3000
    v_add_u32 v241, s40, v241
    v_mov_b32 v245, v203
    v_mov_b32 v246, v204
    s_mul_i32 s33, s24, 8448
    s_mov_b32 s35, 0x3db8aa3b
    s_mov_b32 s36, 0x42cc0000
    s_mov_b32 s38, 0
    s_cmp_ge_u32 s2, 84
    s_cbranch_scc1 KB_np
    s_waitcnt vmcnt(1)
    s_cmp_lg_u32 s24, 0
    s_cbranch_scc1 KB_px
    buffer_load_dword v193, off, s[12:15], 0 offset:112 sc1
    s_branch KB_py
KB_px:
    buffer_load_dwordx4 v[128:131], v209, s[68:71], s42 offen offset:0
    buffer_load_dwordx4 v[132:135], v209, s[68:71], s42 offen offset:896
    buffer_load_dwordx4 v[136:139], v209, s[68:71], s42 offen offset:1792
    buffer_load_dwordx4 v[140:143], v209, s[68:71], s42 offen offset:2688
    s_add_u32 s42, s42, 4*896
    buffer_load_dwordx4 v[144:147], v209, s[68:71], s42 offen offset:0
    buffer_load_dwordx4 v[148:151], v209, s[68:71], s42 offen offset:896
    buffer_load_dwordx4 v[152:155], v209, s[68:71], s42 offen offset:1792
    buffer_load_dwordx4 v[156:159], v209, s[68:71], s42 offen offset:2688
    s_add_u32 s42, s42, 4*896
    buffer_load_dwordx4 v[160:163], v209, s[68:71], s42 offen offset:0
    buffer_load_dwordx4 v[164:167], v209, s[68:71], s42 offen offset:896
    buffer_load_dwordx4 v[168:171], v209, s[68:71], s42 offen offset:1792
    buffer_load_dwordx4 v[172:175], v209, s[68:71], s42 offen offset:2688
    s_add_u32 s42, s42, 4*896
    buffer_load_dwordx4 v[176:179], v209, s[68:71], s42 offen offset:0
    buffer_load_dwordx4 v[180:183], v209, s[68:71], s42 offen offset:896
    buffer_load_dwordx4 v[184:187], v209, s[68:71], s42 offen offset:1792
    buffer_load_dwordx4 v[188:191], v209, s[68:71], s42 offen offset:2688
KB_py:
    s_mov_b32 s40, 0xbfb8aa3b
    s_mov_b32 s41, 0xffff0000
    v_lshlrev_b32 v56, 16, v56
    v_lshlrev_b32 v57, 16, v57
    v_lshlrev_b32 v58, 16, v58
    v_lshlrev_b32 v59, 16, v59
    v_lshlrev_b32 v60, 16, v60
    v_lshlrev_b32 v61, 16, v61
    v_lshlrev_b32 v62, 16, v62
    v_mul_f32 v0, s40, v56
    v_mul_f32 v1, s40, v57
    v_mul_f32 v2, s40, v58
    v_mul_f32 v3, s40, v59
    v_mul_f32 v4, s40, v60
    v_mul_f32 v5, s40, v61
    v_mul_f32 v6, s40, v62
    v_exp_f32 v0, v0
    v_exp_f32 v1, v1
    v_exp_f32 v2, v2
    v_exp_f32 v3, v3
    v_exp_f32 v4, v4
    v_exp_f32 v5, v5
    v_exp_f32 v6, v6
    v_add_f32 v0, 1.0, v0
    v_add_f32 v1, 1.0, v1
    v_add_f32 v2, 1.0, v2
    v_add_f32 v3, 1.0, v3
    v_add_f32 v4, 1.0, v4
    v_add_f32 v5, 1.0, v5
    v_add_f32 v6, 1.0, v6
    v_rcp_f32 v0, v0
    v_rcp_f32 v1, v1
    v_rcp_f32 v2, v2
    v_rcp_f32 v3, v3
    v_rcp_f32 v4, v4
    v_rcp_f32 v5, v5
    v_rcp_f32 v6, v6
    v_mul_f32 v8, v0, v56
    v_mul_f32 v10, v1, v57
    v_mul_f32 v12, v2, v58
    v_mul_f32 v14, v3, v59
    v_mul_f32 v16, v4, v60
    v_mul_f32 v18, v5, v61
    v_mul_f32 v20, v6, v62
    v_lshlrev_b32 v32, 16, v64
    v_and_b32 v33, s41, v64
    v_lshlrev_b32 v34, 16, v65
    v_and_b32 v35, s41, v65
    v_lshlrev_b32 v36, 16, v66
    v_and_b32 v37, s41, v66
    v_lshlrev_b32 v38, 16, v67
    v_and_b32 v39, s41, v67
    v_pk_mul_f32 v[24:25], v[32:33], v[8:9] op_sel_hi:[1,0]
    v_pk_mul_f32 v[26:27], v[34:35], v[8:9] op_sel_hi:[1,0]
    v_pk_mul_f32 v[28:29], v[36:37], v[8:9] op_sel_hi:[1,0]
    v_pk_mul_f32 v[30:31], v[38:39], v[8:9] op_sel_hi:[1,0]
    v_lshlrev_b32 v32, 16, v68
    v_and_b32 v33, s41, v68
    v_lshlrev_b32 v34, 16, v69
    v_and_b32 v35, s41, v69
    v_lshlrev_b32 v36, 16, v70
    v_and_b32 v37, s41, v70
    v_lshlrev_b32 v38, 16, v71
    v_and_b32 v39, s41, v71
    v_pk_fma_f32 v[24:25], v[32:33], v[10:11], v[24:25] op_sel_hi:[1,0,1]
    v_pk_fma_f32 v[26:27], v[34:35], v[10:11], v[26:27] op_sel_hi:[1,0,1]
    v_pk_fma_f32 v[28:29], v[36:37], v[10:11], v[28:29] op_sel_hi:[1,0,1]
    v_pk_fma_f32 v[30:31], v[38:39], v[10:11], v[30:31] op_sel_hi:[1,0,1]
    v_lshlrev_b32 v32, 16, v72
    v_and_b32 v33, s41, v72
    v_lshlrev_b32 v34, 16, v73
    v_and_b32 v35, s41, v73
    v_lshlrev_b32 v36, 16, v74
    v_and_b32 v37, s41, v74
    v_lshlrev_b32 v38, 16, v75
    v_and_b32 v39, s41, v75
    v_pk_fma_f32 v[24:25], v[32:33], v[12:13], v[24:25] op_sel_hi:[1,0,1]
    v_pk_fma_f32 v[26:27], v[34:35], v[12:13], v[26:27] op_sel_hi:[1,0,1]
    v_pk_fma_f32 v[28:29], v[36:37], v[12:13], v[28:29] op_sel_hi:[1,0,1]
    v_pk_fma_f32 v[30:31], v[38:39], v[12:13], v[30:31] op_sel_hi:[1,0,1]
    v_lshlrev_b32 v32, 16, v76
    v_and_b32 v33, s41, v76
    v_lshlrev_b32 v34, 16, v77
    v_and_b32 v35, s41, v77
    v_lshlrev_b32 v36, 16, v78
    v_and_b32 v37, s41, v78
    v_lshlrev_b32 v38, 16, v79
    v_and_b32 v39, s41, v79
    v_pk_fma_f32 v[24:25], v[32:33], v[14:15], v[24:25] op_sel_hi:[1,0,1]
    v_pk_fma_f32 v[26:27], v[34:35], v[14:15], v[26:27] op_sel_hi:[1,0,1]
    v_pk_fma_f32 v[28:29], v[36:37], v[14:15], v[28:29] op_sel_hi:[1,0,1]
    v_pk_fma_f32 v[30:31], v[38:39], v[14:15], v[30:31] op_sel_hi:[1,0,1]
    v_lshlrev_b32 v32, 16, v80
    v_and_b32 v33, s41, v80
    v_lshlrev_b32 v34, 16, v81
    v_and_b32 v35, s41, v81
    v_lshlrev_b32 v36, 16, v82
    v_and_b32 v37, s41, v82
    v_lshlrev_b32 v38, 16, v83
    v_and_b32 v39, s41, v83
    v_pk_fma_f32 v[24:25], v[32:33], v[16:17], v[24:25] op_sel_hi:[1,0,1]
    v_pk_fma_f32 v[26:27], v[34:35], v[16:17], v[26:27] op_sel_hi:[1,0,1]
    v_pk_fma_f32 v[28:29], v[36:37], v[16:17], v[28:29] op_sel_hi:[1,0,1]
    v_pk_fma_f32 v[30:31], v[38:39], v[16:17], v[30:31] op_sel_hi:[1,0,1]
    v_lshlrev_b32 v32, 16, v84
    v_and_b32 v33, s41, v84
    v_lshlrev_b32 v34, 16, v85
    v_and_b32 v35, s41, v85
    v_lshlrev_b32 v36, 16, v86
    v_and_b32 v37, s41, v86
    v_lshlrev_b32 v38, 16, v87
    v_and_b32 v39, s41, v87
    v_pk_fma_f32 v[24:25], v[32:33], v[18:19], v[24:25] op_sel_hi:[1,0,1]
    v_pk_fma_f32 v[26:27], v[34:35], v[18:19], v[26:27] op_sel_hi:[1,0,1]
    v_pk_fma_f32 v[28:29], v[36:37], v[18:19], v[28:29] op_sel_hi:[1,0,1]
    v_pk_fma_f32 v[30:31], v[38:39], v[18:19], v[30:31] op_sel_hi:[1,0,1]
    v_lshlrev_b32 v32, 16, v88
    v_and_b32 v33, s41, v88
    v_lshlrev_b32 v34, 16, v89
    v_and_b32 v35, s41, v89
    v_lshlrev_b32 v36, 16, v90
    v_and_b32 v37, s41, v90
    v_lshlrev_b32 v38, 16, v91
    v_and_b32 v39, s41, v91
    v_pk_fma_f32 v[24:25], v[32:33], v[20:21], v[24:25] op_sel_hi:[1,0,1]
    v_pk_fma_f32 v[26:27], v[34:35], v[20:21], v[26:27] op_sel_hi:[1,0,1]
    v_pk_fma_f32 v[28:29], v[36:37], v[20:21], v[28:29] op_sel_hi:[1,0,1]
    v_pk_fma_f32 v[30:31], v[38:39], v[20:21], v[30:31] op_sel_hi:[1,0,1]
    s_nop 0
    v_permlane32_swap_b32 v24, v28
    v_permlane32_swap_b32 v25, v29
    v_permlane32_swap_b32 v26, v30
    v_permlane32_swap_b32 v27, v31
    v_add_f32 v24, v24, v28
    v_add_f32 v25, v25, v29
    v_add_f32 v26, v26, v30
    v_add_f32 v27, v27, v31
    s_nop 0
    v_permlane16_swap_b32 v24, v26
    v_permlane16_swap_b32 v25, v27
    v_add_f32 v24, v24, v26
    v_add_f32 v25, v25, v27
    s_nop 0
    v_add_f32_dpp v24, v24, v24 row_ror:8 row_mask:0xf bank_mask:0xf
    v_add_f32_dpp v25, v25, v25 row_ror:8 row_mask:0xf bank_mask:0xf
    s_nop 0
    v_add_f32_dpp v24, v24, v24 row_ror:4 row_mask:0xf bank_mask:0xf
    v_add_f32_dpp v25, v25, v25 row_ror:4 row_mask:0xf bank_mask:0xf
    v_and_b32 v0, 3, v202
    v_lshlrev_b32 v0, 5, v0
    v_lshl_add_u32 v0, v204, 3, v0
    s_lshl_b32 s40, s24, 7
    s_add_u32 s40, s40, 158720
    v_add_u32 v0, s40, v0
    ds_write_b64 v0, v[24:25]
    s_waitcnt lgkmcnt(0)
    s_barrier
    s_cmp_lg_u32 s24, 0
    s_cbranch_scc1 KB_pa_e
    v_and_b32 v0, 31, v202
    v_lshlrev_b32 v0, 2, v0
    v_add_u32 v1, 158720, v0
    ds_read_b32 v4, v1 offset:0
    ds_read_b32 v5, v1 offset:128
    ds_read_b32 v6, v1 offset:256
    ds_read_b32 v7, v1 offset:384
    s_sub_u32 s40, s2, 14
    s_cmp_lt_u32 s40, 14
    s_cselect_b32 s41, 1.0, 0
    s_sub_u32 s40, s2, 56
    s_cmp_lt_u32 s40, 14
    s_cselect_b32 s41, 1.0, s41
    s_mul_i32 s40, s2, 4682
    s_lshr_b32 s40, s40, 16
    s_mul_i32 s40, s40, 896
    s_lshl_b32 s43, s2, 6
    s_add_u32 s40, s40, s43
    v_bfe_u32 v0, v202, 1, 1
    v_lshlrev_b32 v0, 3, v0
    v_bfe_u32 v2, v202, 2, 1
    v_mul_u32_u24 v2, 896, v2
    v_bfe_u32 v3, v202, 3, 2
    v_lshl_add_u32 v0, v3, 4, v0
    v_lshrrev_b32 v3, 5, v202
    v_mul_u32_u24 v3, 0x3000, v3
    v_add3_u32 v0, v0, v2, v3
    s_waitcnt lgkmcnt(0)
    v_add_f32 v4, v4, v5
    v_add_f32 v6, v6, v7
    v_add_f32 v4, v4, v6
    v_add_f32 v4, s41, v4
    s_nop 1
    v_mov_b32_dpp v5, v4 quad_perm:[1,1,3,3] row_mask:0xf bank_mask:0xf
    v_cvt_pk_bf16_f32 v4, v4, v5
    s_mov_b32 s43, 0x8000
    s_waitcnt vmcnt(0)
KB_ta:
    v_readfirstlane_b32 s3, v193
    s_sub_u32 s43, s43, 1
    s_nop 2
    s_cmp_lg_u32 s3, 0
    s_cbranch_scc1 KB_ta_e
    s_cmp_eq_u32 s43, 0
    s_cbranch_scc1 KB_ta_e
    buffer_load_dword v193, off, s[12:15], 0 offset:112 sc1
    s_waitcnt vmcnt(0)
    s_branch KB_ta
KB_ta_e:
    v_mov_b32 v5, s3
    s_mov_b32 exec_lo, 0x55555555
    s_mov_b32 exec_hi, 0x55555555
    buffer_store_dwordx2 v[4:5], v0, s[20:23], s40 offen sc1
    s_mov_b64 exec, -1
    s_branch KB_nq
KB_np:
    s_cmp_lg_u32 s3, 1012
    s_cbranch_scc1 KB_nq
    s_waitcnt vmcnt(1)
    v_add_u32 v1, 2, v1
    v_or_b32 v1, 0xffc00001, v1
    s_mov_b64 exec, 1
    buffer_store_dword v1, off, s[12:15], 0 offset:112 sc1
    buffer_store_dword v1, off, s[20:23], s66 sc1
    s_mov_b64 exec, -1
KB_nq:
    buffer_load_dwordx4 v[128:131], v209, s[68:71], s42 offen offset:0
    buffer_load_dwordx4 v[132:135], v209, s[68:71], s42 offen offset:896
    buffer_load_dwordx4 v[136:139], v209, s[68:71], s42 offen offset:1792
    buffer_load_dwordx4 v[140:143], v209, s[68:71], s42 offen offset:2688
    s_add_u32 s42, s42, 4*896
    buffer_load_dwordx4 v[144:147], v209, s[68:71], s42 offen offset:0
    buffer_load_dwordx4 v[148:151], v209, s[68:71], s42 offen offset:896
    buffer_load_dwordx4 v[152:155], v209, s[68:71], s42 offen offset:1792
    buffer_load_dwordx4 v[156:159], v209, s[68:71], s42 offen offset:2688
    s_add_u32 s42, s42, 4*896
    buffer_load_dwordx4 v[160:163], v209, s[68:71], s42 offen offset:0
    buffer_load_dwordx4 v[164:167], v209, s[68:71], s42 offen offset:896
    buffer_load_dwordx4 v[168:171], v209, s[68:71], s42 offen offset:1792
    buffer_load_dwordx4 v[172:175], v209, s[68:71], s42 offen offset:2688
    s_add_u32 s42, s42, 4*896
    buffer_load_dwordx4 v[176:179], v209, s[68:71], s42 offen offset:0
    buffer_load_dwordx4 v[180:183], v209, s[68:71], s42 offen offset:896
    buffer_load_dwordx4 v[184:187], v209, s[68:71], s42 offen offset:1792
    buffer_load_dwordx4 v[188:191], v209, s[68:71], s42 offen offset:2688
KB_pa_e:
    s_waitcnt vmcnt(0)
    buffer_load_dword v193, off, s[12:15], 0 offset:112 sc1
    s_mov_b32 s40, 0xffff0000
    s_mov_b32 s41, 0xbb124925
    v_mov_b32 v200, 0x3727c5ac
    v_lshlrev_b32 v0, 16, v128
    v_and_b32 v1, s40, v128
    v_lshlrev_b32 v2, 16, v129
    v_and_b32 v3, s40, v129
    v_lshlrev_b32 v4, 16, v130
    v_and_b32 v5, s40, v130
    v_lshlrev_b32 v6, 16, v131
    v_and_b32 v7, s40, v131
    v_pk_add_f32 v[196:197], v[0:1], v[2:3]
    v_pk_add_f32 v[198:199], v[4:5], v[6:7]
    v_pk_add_f32 v[196:197], v[196:197], v[198:199]
    v_add_f32 v206, v196, v197
    v_lshlrev_b32 v8, 16, v132
    v_and_b32 v9, s40, v132
    v_lshlrev_b32 v10, 16, v133
    v_and_b32 v11, s40, v133
    v_lshlrev_b32 v12, 16, v134
    v_and_b32 v13, s40, v134
    v_lshlrev_b32 v14, 16, v135
    v_and_b32 v15, s40, v135
    v_pk_add_f32 v[196:197], v[8:9], v[10:11]
    v_pk_add_f32 v[198:199], v[12:13], v[14:15]
    v_pk_add_f32 v[196:197], v[196:197], v[198:199]
    v_add_f32 v207, v196, v197
    v_lshlrev_b32 v16, 16, v136
    v_and_b32 v17, s40, v136
    v_lshlrev_b32 v18, 16, v137
    v_and_b32 v19, s40, v137
    v_lshlrev_b32 v20, 16, v138
    v_and_b32 v21, s40, v138
    v_lshlrev_b32 v22, 16, v139
    v_and_b32 v23, s40, v139
    v_pk_add_f32 v[196:197], v[16:17], v[18:19]
    v_pk_add_f32 v[198:199], v[20:21], v[22:23]
    v_pk_add_f32 v[196:197], v[196:197], v[198:199]
    v_add_f32 v208, v196, v197
    v_lshlrev_b32 v24, 16, v140
    v_and_b32 v25, s40, v140
    v_lshlrev_b32 v26, 16, v141
    v_and_b32 v27, s40, v141
    v_lshlrev_b32 v28, 16, v142
    v_and_b32 v29, s40, v142
    v_lshlrev_b32 v30, 16, v143
    v_and_b32 v31, s40, v143
    v_pk_add_f32 v[196:197], v[24:25], v[26:27]
    v_pk_add_f32 v[198:199], v[28:29], v[30:31]
    v_pk_add_f32 v[196:197], v[196:197], v[198:199]
    v_add_f32 v209, v196, v197
    v_lshlrev_b32 v32, 16, v144
    v_and_b32 v33, s40, v144
    v_lshlrev_b32 v34, 16, v145
    v_and_b32 v35, s40, v145
    v_lshlrev_b32 v36, 16, v146
    v_and_b32 v37, s40, v146
    v_lshlrev_b32 v38, 16, v147
    v_and_b32 v39, s40, v147
    v_pk_add_f32 v[196:197], v[32:33], v[34:35]
    v_pk_add_f32 v[198:199], v[36:37], v[38:39]
    v_pk_add_f32 v[196:197], v[196:197], v[198:199]
    v_add_f32 v210, v196, v197
    v_lshlrev_b32 v40, 16, v148
    v_and_b32 v41, s40, v148
    v_lshlrev_b32 v42, 16, v149
    v_and_b32 v43, s40, v149
    v_lshlrev_b32 v44, 16, v150
    v_and_b32 v45, s40, v150
    v_lshlrev_b32 v46, 16, v151
    v_and_b32 v47, s40, v151
    v_pk_add_f32 v[196:197], v[40:41], v[42:43]
    v_pk_add_f32 v[198:199], v[44:45], v[46:47]
    v_pk_add_f32 v[196:197], v[196:197], v[198:199]
    v_add_f32 v211, v196, v197
    v_lshlrev_b32 v48, 16, v152
    v_and_b32 v49, s40, v152
    v_lshlrev_b32 v50, 16, v153
    v_and_b32 v51, s40, v153
    v_lshlrev_b32 v52, 16, v154
    v_and_b32 v53, s40, v154
    v_lshlrev_b32 v54, 16, v155
    v_and_b32 v55, s40, v155
    v_pk_add_f32 v[196:197], v[48:49], v[50:51]
    v_pk_add_f32 v[198:199], v[52:53], v[54:55]
    v_pk_add_f32 v[196:197], v[196:197], v[198:199]
    v_add_f32 v212, v196, v197
    v_lshlrev_b32 v56, 16, v156
    v_and_b32 v57, s40, v156
    v_lshlrev_b32 v58, 16, v157
    v_and_b32 v59, s40, v157
    v_lshlrev_b32 v60, 16, v158
    v_and_b32 v61, s40, v158
    v_lshlrev_b32 v62, 16, v159
    v_and_b32 v63, s40, v159
    v_pk_add_f32 v[196:197], v[56:57], v[58:59]
    v_pk_add_f32 v[198:199], v[60:61], v[62:63]
    v_pk_add_f32 v[196:197], v[196:197], v[198:199]
    v_add_f32 v213, v196, v197
    v_lshlrev_b32 v64, 16, v160
    v_and_b32 v65, s40, v160
    v_lshlrev_b32 v66, 16, v161
    v_and_b32 v67, s40, v161
    v_lshlrev_b32 v68, 16, v162
    v_and_b32 v69, s40, v162
    v_lshlrev_b32 v70, 16, v163
    v_and_b32 v71, s40, v163
    v_pk_add_f32 v[196:197], v[64:65], v[66:67]
    v_pk_add_f32 v[198:199], v[68:69], v[70:71]
    v_pk_add_f32 v[196:197], v[196:197], v[198:199]
    v_add_f32 v214, v196, v197
    v_lshlrev_b32 v72, 16, v164
    v_and_b32 v73, s40, v164
    v_lshlrev_b32 v74, 16, v165
    v_and_b32 v75, s40, v165
    v_lshlrev_b32 v76, 16, v166
    v_and_b32 v77, s40, v166
    v_lshlrev_b32 v78, 16, v167
    v_and_b32 v79, s40, v167
    v_pk_add_f32 v[196:197], v[72:73], v[74:75]
    v_pk_add_f32 v[198:199], v[76:77], v[78:79]
    v_pk_add_f32 v[196:197], v[196:197], v[198:199]
    v_add_f32 v215, v196, v197
    v_lshlrev_b32 v80, 16, v168
    v_and_b32 v81, s40, v168
    v_lshlrev_b32 v82, 16, v169
    v_and_b32 v83, s40, v169
    v_lshlrev_b32 v84, 16, v170
    v_and_b32 v85, s40, v170
    v_lshlrev_b32 v86, 16, v171
    v_and_b32 v87, s40, v171
    v_pk_add_f32 v[196:197], v[80:81], v[82:83]
    v_pk_add_f32 v[198:199], v[84:85], v[86:87]
    v_pk_add_f32 v[196:197], v[196:197], v[198:199]
    v_add_f32 v216, v196, v197
    v_lshlrev_b32 v88, 16, v172
    v_and_b32 v89, s40, v172
    v_lshlrev_b32 v90, 16, v173
    v_and_b32 v91, s40, v173
    v_lshlrev_b32 v92, 16, v174
    v_and_b32 v93, s40, v174
    v_lshlrev_b32 v94, 16, v175
    v_and_b32 v95, s40, v175
    v_pk_add_f32 v[196:197], v[88:89], v[90:91]
    v_pk_add_f32 v[198:199], v[92:93], v[94:95]
    v_pk_add_f32 v[196:197], v[196:197], v[198:199]
    v_add_f32 v217, v196, v197
    v_lshlrev_b32 v96, 16, v176
    v_and_b32 v97, s40, v176
    v_lshlrev_b32 v98, 16, v177
    v_and_b32 v99, s40, v177
    v_lshlrev_b32 v100, 16, v178
    v_and_b32 v101, s40, v178
    v_lshlrev_b32 v102, 16, v179
    v_and_b32 v103, s40, v179
    v_pk_add_f32 v[196:197], v[96:97], v[98:99]
    v_pk_add_f32 v[198:199], v[100:101], v[102:103]
    v_pk_add_f32 v[196:197], v[196:197], v[198:199]
    v_add_f32 v218, v196, v197
    v_lshlrev_b32 v104, 16, v180
    v_and_b32 v105, s40, v180
    v_lshlrev_b32 v106, 16, v181
    v_and_b32 v107, s40, v181
    v_lshlrev_b32 v108, 16, v182
    v_and_b32 v109, s40, v182
    v_lshlrev_b32 v110, 16, v183
    v_and_b32 v111, s40, v183
    v_pk_add_f32 v[196:197], v[104:105], v[106:107]
    v_pk_add_f32 v[198:199], v[108:109], v[110:111]
    v_pk_add_f32 v[196:197], v[196:197], v[198:199]
    v_add_f32 v219, v196, v197
    v_lshlrev_b32 v112, 16, v184
    v_and_b32 v113, s40, v184
    v_lshlrev_b32 v114, 16, v185
    v_and_b32 v115, s40, v185
    v_lshlrev_b32 v116, 16, v186
    v_and_b32 v117, s40, v186
    v_lshlrev_b32 v118, 16, v187
    v_and_b32 v119, s40, v187
    v_pk_add_f32 v[196:197], v[112:113], v[114:115]
    v_pk_add_f32 v[198:199], v[116:117], v[118:119]
    v_pk_add_f32 v[196:197], v[196:197], v[198:199]
    v_add_f32 v220, v196, v197
    v_lshlrev_b32 v120, 16, v188
    v_and_b32 v121, s40, v188
    v_lshlrev_b32 v122, 16, v189
    v_and_b32 v123, s40, v189
    v_lshlrev_b32 v124, 16, v190
    v_and_b32 v125, s40, v190
    v_lshlrev_b32 v126, 16, v191
    v_and_b32 v127, s40, v191
    v_pk_add_f32 v[196:197], v[120:121], v[122:123]
    v_pk_add_f32 v[198:199], v[124:125], v[126:127]
    v_pk_add_f32 v[196:197], v[196:197], v[198:199]
    v_add_f32 v221, v196, v197
    v_permlane32_swap_b32 v206, v214
    v_permlane32_swap_b32 v207, v215
    v_permlane32_swap_b32 v208, v216
    v_permlane32_swap_b32 v209, v217
    v_permlane32_swap_b32 v210, v218
    v_permlane32_swap_b32 v211, v219
    v_permlane32_swap_b32 v212, v220
    v_permlane32_swap_b32 v213, v221
    v_add_f32 v206, v206, v214
    v_add_f32 v207, v207, v215
    v_add_f32 v208, v208, v216
    v_add_f32 v209, v209, v217
    v_add_f32 v210, v210, v218
    v_add_f32 v211, v211, v219
    v_add_f32 v212, v212, v220
    v_add_f32 v213, v213, v221
    v_permlane16_swap_b32 v206, v210
    v_permlane16_swap_b32 v207, v211
    v_permlane16_swap_b32 v208, v212
    v_permlane16_swap_b32 v209, v213
    v_add_f32 v206, v206, v210
    v_add_f32 v207, v207, v211
    v_add_f32 v208, v208, v212
    v_add_f32 v209, v209, v213
    v_add_f32_dpp v206, v206, v206 row_ror:8 row_mask:0xf bank_mask:0xf
    v_add_f32_dpp v207, v207, v207 row_ror:8 row_mask:0xf bank_mask:0xf
    v_add_f32_dpp v208, v208, v208 row_ror:8 row_mask:0xf bank_mask:0xf
    v_add_f32_dpp v209, v209, v209 row_ror:8 row_mask:0xf bank_mask:0xf
    v_add_f32_dpp v206, v206, v206 row_ror:4 row_mask:0xf bank_mask:0xf
    v_add_f32_dpp v207, v207, v207 row_ror:4 row_mask:0xf bank_mask:0xf
    v_add_f32_dpp v208, v208, v208 row_ror:4 row_mask:0xf bank_mask:0xf
    v_add_f32_dpp v209, v209, v209 row_ror:4 row_mask:0xf bank_mask:0xf
    v_add_f32_dpp v206, v206, v206 row_ror:2 row_mask:0xf bank_mask:0xf
    v_add_f32_dpp v207, v207, v207 row_ror:2 row_mask:0xf bank_mask:0xf
    v_add_f32_dpp v208, v208, v208 row_ror:2 row_mask:0xf bank_mask:0xf
    v_add_f32_dpp v209, v209, v209 row_ror:2 row_mask:0xf bank_mask:0xf
    v_add_f32_dpp v206, v206, v206 row_ror:1 row_mask:0xf bank_mask:0xf
    v_add_f32_dpp v207, v207, v207 row_ror:1 row_mask:0xf bank_mask:0xf
    v_add_f32_dpp v208, v208, v208 row_ror:1 row_mask:0xf bank_mask:0xf
    v_add_f32_dpp v209, v209, v209 row_ror:1 row_mask:0xf bank_mask:0xf
    v_mul_f32 v206, s41, v206
    v_mul_f32 v207, s41, v207
    v_mul_f32 v208, s41, v208
    v_mul_f32 v209, s41, v209
    v_readlane_b32 s64, v206, 0
    v_readlane_b32 s65, v207, 0
    v_readlane_b32 s66, v208, 0
    v_readlane_b32 s67, v209, 0
    v_readlane_b32 s68, v206, 16
    v_readlane_b32 s69, v207, 16
    v_readlane_b32 s70, v208, 16
    v_readlane_b32 s71, v209, 16
    v_readlane_b32 s72, v206, 32
    v_readlane_b32 s73, v207, 32
    v_readlane_b32 s74, v208, 32
    v_readlane_b32 s75, v209, 32
    v_readlane_b32 s76, v206, 48
    v_readlane_b32 s77, v207, 48
    v_readlane_b32 s78, v208, 48
    v_readlane_b32 s79, v209, 48
    s_mov_b32 s43, 0x8000
    s_waitcnt vmcnt(0)
KB_tb:
    v_readfirstlane_b32 s3, v193
    s_sub_u32 s43, s43, 1
    s_nop 2
    s_cmp_lg_u32 s3, 0
    s_cbranch_scc1 KB_tb_e
    s_cmp_eq_u32 s43, 0
    s_cbranch_scc1 KB_tb_e
    buffer_load_dword v193, off, s[12:15], 0 offset:112 sc1
    s_waitcnt vmcnt(0)
    s_branch KB_tb
KB_tb_e:
    s_mul_i32 s40, s26, 11
    s_mul_i32 s41, s24, 3
    s_add_u32 s40, s40, s41
    s_add_u32 s40, s40, 96
    s_lshl_b32 s40, s40, 13
    s_add_u32 s40, s40, s30
    v_lshrrev_b32 v198, 3, v202
    v_lshlrev_b32 v198, 13, v198
    v_and_b32 v199, 7, v202
    v_lshl_add_u32 v198, v199, 7, v198
    v_cmp_gt_u32 vcc, 24, v202
    s_nop 1
    v_cndmask_b32 v198, v254, v198, vcc
    s_mov_b32 s42, 0x3b124925
    v_cmp_gt_u32 vcc, 56, v202
    v_pk_add_f32 v[0:1], v[0:1], s[64:65] op_sel_hi:[1,0]
    v_pk_add_f32 v[2:3], v[2:3], s[64:65] op_sel_hi:[1,0]
    v_pk_add_f32 v[4:5], v[4:5], s[64:65] op_sel_hi:[1,0]
    v_pk_add_f32 v[6:7], v[6:7], s[64:65] op_sel_hi:[1,0]
    v_pk_mul_f32 v[196:197], v[0:1], v[0:1]
    v_pk_fma_f32 v[196:197], v[2:3], v[2:3], v[196:197]
    v_pk_fma_f32 v[196:197], v[4:5], v[4:5], v[196:197]
    v_pk_fma_f32 v[196:197], v[6:7], v[6:7], v[196:197]
    v_add_f32 v196, v196, v197
    v_cndmask_b32 v206, 0, v196, vcc
    v_pk_add_f32 v[8:9], v[8:9], s[64:65] op_sel:[0,1] op_sel_hi:[1,1]
    s_add_u32 m0, s32, 0
    v_pk_add_f32 v[10:11], v[10:11], s[64:65] op_sel:[0,1] op_sel_hi:[1,1]
    v_pk_add_f32 v[12:13], v[12:13], s[64:65] op_sel:[0,1] op_sel_hi:[1,1]
    v_pk_add_f32 v[14:15], v[14:15], s[64:65] op_sel:[0,1] op_sel_hi:[1,1]
    v_pk_mul_f32 v[196:197], v[8:9], v[8:9]
    v_pk_fma_f32 v[196:197], v[10:11], v[10:11], v[196:197]
    v_pk_fma_f32 v[196:197], v[12:13], v[12:13], v[196:197]
    v_pk_fma_f32 v[196:197], v[14:15], v[14:15], v[196:197]
    v_add_f32 v196, v196, v197
    v_cndmask_b32 v207, 0, v196, vcc
    v_pk_add_f32 v[16:17], v[16:17], s[66:67] op_sel_hi:[1,0]
    v_pk_add_f32 v[18:19], v[18:19], s[66:67] op_sel_hi:[1,0]
    v_pk_add_f32 v[20:21], v[20:21], s[66:67] op_sel_hi:[1,0]
    buffer_load_dwordx4 v230, s[16:19], s28 offen offset:0 lds
    v_pk_add_f32 v[22:23], v[22:23], s[66:67] op_sel_hi:[1,0]
    v_pk_mul_f32 v[196:197], v[16:17], v[16:17]
    v_pk_fma_f32 v[196:197], v[18:19], v[18:19], v[196:197]
    v_pk_fma_f32 v[196:197], v[20:21], v[20:21], v[196:197]
    v_pk_fma_f32 v[196:197], v[22:23], v[22:23], v[196:197]
    v_add_f32 v196, v196, v197
    v_cndmask_b32 v208, 0, v196, vcc
    v_pk_add_f32 v[24:25], v[24:25], s[66:67] op_sel:[0,1] op_sel_hi:[1,1]
    v_pk_add_f32 v[26:27], v[26:27], s[66:67] op_sel:[0,1] op_sel_hi:[1,1]
    v_pk_add_f32 v[28:29], v[28:29], s[66:67] op_sel:[0,1] op_sel_hi:[1,1]
    v_pk_add_f32 v[30:31], v[30:31], s[66:67] op_sel:[0,1] op_sel_hi:[1,1]
    v_pk_mul_f32 v[196:197], v[24:25], v[24:25]
    buffer_load_dwordx4 v231, s[16:19], s28 offen offset:1056 lds
    v_pk_fma_f32 v[196:197], v[26:27], v[26:27], v[196:197]
    v_pk_fma_f32 v[196:197], v[28:29], v[28:29], v[196:197]
    v_pk_fma_f32 v[196:197], v[30:31], v[30:31], v[196:197]
    v_add_f32 v196, v196, v197
    v_cndmask_b32 v209, 0, v196, vcc
    v_pk_add_f32 v[32:33], v[32:33], s[68:69] op_sel_hi:[1,0]
    v_pk_add_f32 v[34:35], v[34:35], s[68:69] op_sel_hi:[1,0]
    v_pk_add_f32 v[36:37], v[36:37], s[68:69] op_sel_hi:[1,0]
    v_pk_add_f32 v[38:39], v[38:39], s[68:69] op_sel_hi:[1,0]
    v_pk_mul_f32 v[196:197], v[32:33], v[32:33]
    v_pk_fma_f32 v[196:197], v[34:35], v[34:35], v[196:197]
    v_pk_fma_f32 v[196:197], v[36:37], v[36:37], v[196:197]
    buffer_load_dwordx4 v232, s[16:19], s28 offen offset:2112 lds
    v_pk_fma_f32 v[196:197], v[38:39], v[38:39], v[196:197]
    v_add_f32 v196, v196, v197
    v_cndmask_b32 v210, 0, v196, vcc
    v_pk_add_f32 v[40:41], v[40:41], s[68:69] op_sel:[0,1] op_sel_hi:[1,1]
    v_pk_add_f32 v[42:43], v[42:43], s[68:69] op_sel:[0,1] op_sel_hi:[1,1]
    v_pk_add_f32 v[44:45], v[44:45], s[68:69] op_sel:[0,1] op_sel_hi:[1,1]
    v_pk_add_f32 v[46:47], v[46:47], s[68:69] op_sel:[0,1] op_sel_hi:[1,1]
    v_pk_mul_f32 v[196:197], v[40:41], v[40:41]
    v_pk_fma_f32 v[196:197], v[42:43], v[42:43], v[196:197]
    v_pk_fma_f32 v[196:197], v[44:45], v[44:45], v[196:197]
    v_pk_fma_f32 v[196:197], v[46:47], v[46:47], v[196:197]
    v_add_f32 v196, v196, v197
    buffer_load_dwordx4 v233, s[16:19], s28 offen offset:3168 lds
    v_cndmask_b32 v211, 0, v196, vcc
    v_pk_add_f32 v[48:49], v[48:49], s[70:71] op_sel_hi:[1,0]
    v_pk_add_f32 v[50:51], v[50:51], s[70:71] op_sel_hi:[1,0]
    v_pk_add_f32 v[52:53], v[52:53], s[70:71] op_sel_hi:[1,0]
    v_pk_add_f32 v[54:55], v[54:55], s[70:71] op_sel_hi:[1,0]
    v_pk_mul_f32 v[196:197], v[48:49], v[48:49]
    v_pk_fma_f32 v[196:197], v[50:51], v[50:51], v[196:197]
    v_pk_fma_f32 v[196:197], v[52:53], v[52:53], v[196:197]
    v_pk_fma_f32 v[196:197], v[54:55], v[54:55], v[196:197]
    v_add_f32 v196, v196, v197
    v_cndmask_b32 v212, 0, v196, vcc
    v_pk_add_f32 v[56:57], v[56:57], s[70:71] op_sel:[0,1] op_sel_hi:[1,1]
    s_add_u32 m0, s32, 4224
    v_pk_add_f32 v[58:59], v[58:59], s[70:71] op_sel:[0,1] op_sel_hi:[1,1]
    v_pk_add_f32 v[60:61], v[60:61], s[70:71] op_sel:[0,1] op_sel_hi:[1,1]
    v_pk_add_f32 v[62:63], v[62:63], s[70:71] op_sel:[0,1] op_sel_hi:[1,1]
    v_pk_mul_f32 v[196:197], v[56:57], v[56:57]
    v_pk_fma_f32 v[196:197], v[58:59], v[58:59], v[196:197]
    v_pk_fma_f32 v[196:197], v[60:61], v[60:61], v[196:197]
    v_pk_fma_f32 v[196:197], v[62:63], v[62:63], v[196:197]
    v_add_f32 v196, v196, v197
    v_cndmask_b32 v213, 0, v196, vcc
    v_pk_add_f32 v[64:65], v[64:65], s[72:73] op_sel_hi:[1,0]
    v_pk_add_f32 v[66:67], v[66:67], s[72:73] op_sel_hi:[1,0]
    v_pk_add_f32 v[68:69], v[68:69], s[72:73] op_sel_hi:[1,0]
    buffer_load_dwordx4 v230, s[16:19], s29 offen offset:0 lds
    v_pk_add_f32 v[70:71], v[70:71], s[72:73] op_sel_hi:[1,0]
    v_pk_mul_f32 v[196:197], v[64:65], v[64:65]
    v_pk_fma_f32 v[196:197], v[66:67], v[66:67], v[196:197]
    v_pk_fma_f32 v[196:197], v[68:69], v[68:69], v[196:197]
    v_pk_fma_f32 v[196:197], v[70:71], v[70:71], v[196:197]
    v_add_f32 v196, v196, v197
    v_cndmask_b32 v214, 0, v196, vcc
    v_pk_add_f32 v[72:73], v[72:73], s[72:73] op_sel:[0,1] op_sel_hi:[1,1]
    v_pk_add_f32 v[74:75], v[74:75], s[72:73] op_sel:[0,1] op_sel_hi:[1,1]
    v_pk_add_f32 v[76:77], v[76:77], s[72:73] op_sel:[0,1] op_sel_hi:[1,1]
    v_pk_add_f32 v[78:79], v[78:79], s[72:73] op_sel:[0,1] op_sel_hi:[1,1]
    v_pk_mul_f32 v[196:197], v[72:73], v[72:73]
    buffer_load_dwordx4 v231, s[16:19], s29 offen offset:1056 lds
    v_pk_fma_f32 v[196:197], v[74:75], v[74:75], v[196:197]
    v_pk_fma_f32 v[196:197], v[76:77], v[76:77], v[196:197]
    v_pk_fma_f32 v[196:197], v[78:79], v[78:79], v[196:197]
    v_add_f32 v196, v196, v197
    v_cndmask_b32 v215, 0, v196, vcc
    v_pk_add_f32 v[80:81], v[80:81], s[74:75] op_sel_hi:[1,0]
    v_pk_add_f32 v[82:83], v[82:83], s[74:75] op_sel_hi:[1,0]
    v_pk_add_f32 v[84:85], v[84:85], s[74:75] op_sel_hi:[1,0]
    v_pk_add_f32 v[86:87], v[86:87], s[74:75] op_sel_hi:[1,0]
    v_pk_mul_f32 v[196:197], v[80:81], v[80:81]
    v_pk_fma_f32 v[196:197], v[82:83], v[82:83], v[196:197]
    v_pk_fma_f32 v[196:197], v[84:85], v[84:85], v[196:197]
    buffer_load_dwordx4 v232, s[16:19], s29 offen offset:2112 lds
    v_pk_fma_f32 v[196:197], v[86:87], v[86:87], v[196:197]
    v_add_f32 v196, v196, v197
    v_cndmask_b32 v216, 0, v196, vcc
    v_pk_add_f32 v[88:89], v[88:89], s[74:75] op_sel:[0,1] op_sel_hi:[1,1]
    v_pk_add_f32 v[90:91], v[90:91], s[74:75] op_sel:[0,1] op_sel_hi:[1,1]
    v_pk_add_f32 v[92:93], v[92:93], s[74:75] op_sel:[0,1] op_sel_hi:[1,1]
    v_pk_add_f32 v[94:95], v[94:95], s[74:75] op_sel:[0,1] op_sel_hi:[1,1]
    v_pk_mul_f32 v[196:197], v[88:89], v[88:89]
    v_pk_fma_f32 v[196:197], v[90:91], v[90:91], v[196:197]
    v_pk_fma_f32 v[196:197], v[92:93], v[92:93], v[196:197]
    v_pk_fma_f32 v[196:197], v[94:95], v[94:95], v[196:197]
    v_add_f32 v196, v196, v197
    buffer_load_dwordx4 v233, s[16:19], s29 offen offset:3168 lds
    v_cndmask_b32 v217, 0, v196, vcc
    v_pk_add_f32 v[96:97], v[96:97], s[76:77] op_sel_hi:[1,0]
    v_pk_add_f32 v[98:99], v[98:99], s[76:77] op_sel_hi:[1,0]
    v_pk_add_f32 v[100:101], v[100:101], s[76:77] op_sel_hi:[1,0]
    v_pk_add_f32 v[102:103], v[102:103], s[76:77] op_sel_hi:[1,0]
    v_pk_mul_f32 v[196:197], v[96:97], v[96:97]
    v_pk_fma_f32 v[196:197], v[98:99], v[98:99], v[196:197]
    v_pk_fma_f32 v[196:197], v[100:101], v[100:101], v[196:197]
    v_pk_fma_f32 v[196:197], v[102:103], v[102:103], v[196:197]
    v_add_f32 v196, v196, v197
    v_cndmask_b32 v218, 0, v196, vcc
    v_pk_add_f32 v[104:105], v[104:105], s[76:77] op_sel:[0,1] op_sel_hi:[1,1]
    s_add_u32 s28, s28, 262144
    v_pk_add_f32 v[106:107], v[106:107], s[76:77] op_sel:[0,1] op_sel_hi:[1,1]
    v_pk_add_f32 v[108:109], v[108:109], s[76:77] op_sel:[0,1] op_sel_hi:[1,1]
    v_pk_add_f32 v[110:111], v[110:111], s[76:77] op_sel:[0,1] op_sel_hi:[1,1]
    v_pk_mul_f32 v[196:197], v[104:105], v[104:105]
    v_pk_fma_f32 v[196:197], v[106:107], v[106:107], v[196:197]
    v_pk_fma_f32 v[196:197], v[108:109], v[108:109], v[196:197]
    v_pk_fma_f32 v[196:197], v[110:111], v[110:111], v[196:197]
    v_add_f32 v196, v196, v197
    v_cndmask_b32 v219, 0, v196, vcc
    v_pk_add_f32 v[112:113], v[112:113], s[78:79] op_sel_hi:[1,0]
    v_pk_add_f32 v[114:115], v[114:115], s[78:79] op_sel_hi:[1,0]
    v_pk_add_f32 v[116:117], v[116:117], s[78:79] op_sel_hi:[1,0]
    s_add_u32 s29, s29, 262144
    v_pk_add_f32 v[118:119], v[118:119], s[78:79] op_sel_hi:[1,0]
    v_pk_mul_f32 v[196:197], v[112:113], v[112:113]
    v_pk_fma_f32 v[196:197], v[114:115], v[114:115], v[196:197]
    v_pk_fma_f32 v[196:197], v[116:117], v[116:117], v[196:197]
    v_pk_fma_f32 v[196:197], v[118:119], v[118:119], v[196:197]
    v_add_f32 v196, v196, v197
    v_cndmask_b32 v220, 0, v196, vcc
    v_pk_add_f32 v[120:121], v[120:121], s[78:79] op_sel:[0,1] op_sel_hi:[1,1]
    v_pk_add_f32 v[122:123], v[122:123], s[78:79] op_sel:[0,1] op_sel_hi:[1,1]
    v_pk_add_f32 v[124:125], v[124:125], s[78:79] op_sel:[0,1] op_sel_hi:[1,1]
    v_pk_add_f32 v[126:127], v[126:127], s[78:79] op_sel:[0,1] op_sel_hi:[1,1]
    v_pk_mul_f32 v[196:197], v[120:121], v[120:121]
    v_pk_fma_f32 v[196:197], v[122:123], v[122:123], v[196:197]
    s_add_u32 m0, s32, 33792
    v_pk_fma_f32 v[196:197], v[124:125], v[124:125], v[196:197]
    v_pk_fma_f32 v[196:197], v[126:127], v[126:127], v[196:197]
    v_add_f32 v196, v196, v197
    v_cndmask_b32 v221, 0, v196, vcc
    v_permlane32_swap_b32 v206, v214
    v_permlane32_swap_b32 v207, v215
    v_permlane32_swap_b32 v208, v216
    v_permlane32_swap_b32 v209, v217
    v_permlane32_swap_b32 v210, v218
    v_permlane32_swap_b32 v211, v219
    v_permlane32_swap_b32 v212, v220
    v_permlane32_swap_b32 v213, v221
    buffer_load_dwordx4 v230, s[16:19], s28 offen offset:0 lds
    v_add_f32 v206, v206, v214
    v_add_f32 v207, v207, v215
    v_add_f32 v208, v208, v216
    v_add_f32 v209, v209, v217
    v_add_f32 v210, v210, v218
    v_add_f32 v211, v211, v219
    v_add_f32 v212, v212, v220
    v_add_f32 v213, v213, v221
    v_permlane16_swap_b32 v206, v210
    v_permlane16_swap_b32 v207, v211
    v_permlane16_swap_b32 v208, v212
    v_permlane16_swap_b32 v209, v213
    buffer_load_dwordx4 v231, s[16:19], s28 offen offset:1056 lds
    v_add_f32 v206, v206, v210
    v_add_f32 v207, v207, v211
    v_add_f32 v208, v208, v212
    v_add_f32 v209, v209, v213
    v_add_f32_dpp v206, v206, v206 row_ror:8 row_mask:0xf bank_mask:0xf
    v_add_f32_dpp v207, v207, v207 row_ror:8 row_mask:0xf bank_mask:0xf
    v_add_f32_dpp v208, v208, v208 row_ror:8 row_mask:0xf bank_mask:0xf
    v_add_f32_dpp v209, v209, v209 row_ror:8 row_mask:0xf bank_mask:0xf
    v_add_f32_dpp v206, v206, v206 row_ror:4 row_mask:0xf bank_mask:0xf
    v_add_f32_dpp v207, v207, v207 row_ror:4 row_mask:0xf bank_mask:0xf
    v_add_f32_dpp v208, v208, v208 row_ror:4 row_mask:0xf bank_mask:0xf
    v_add_f32_dpp v209, v209, v209 row_ror:4 row_mask:0xf bank_mask:0xf
    buffer_load_dwordx4 v232, s[16:19], s28 offen offset:2112 lds
    v_add_f32_dpp v206, v206, v206 row_ror:2 row_mask:0xf bank_mask:0xf
    v_add_f32_dpp v207, v207, v207 row_ror:2 row_mask:0xf bank_mask:0xf
    v_add_f32_dpp v208, v208, v208 row_ror:2 row_mask:0xf bank_mask:0xf
    v_add_f32_dpp v209, v209, v209 row_ror:2 row_mask:0xf bank_mask:0xf
    v_add_f32_dpp v206, v206, v206 row_ror:1 row_mask:0xf bank_mask:0xf
    v_add_f32_dpp v207, v207, v207 row_ror:1 row_mask:0xf bank_mask:0xf
    v_add_f32_dpp v208, v208, v208 row_ror:1 row_mask:0xf bank_mask:0xf
    v_add_f32_dpp v209, v209, v209 row_ror:1 row_mask:0xf bank_mask:0xf
    v_fma_f32 v206, v206, s42, v200
    v_fma_f32 v207, v207, s42, v200
    v_fma_f32 v208, v208, s42, v200
    v_fma_f32 v209, v209, s42, v200
    buffer_load_dwordx4 v233, s[16:19], s28 offen offset:3168 lds
    v_rsq_f32 v206, v206
    v_rsq_f32 v207, v207
    v_rsq_f32 v208, v208
    v_rsq_f32 v209, v209
    v_readlane_b32 s80, v206, 0
    v_readlane_b32 s81, v207, 0
    v_readlane_b32 s82, v208, 0
    v_readlane_b32 s83, v209, 0
    v_readlane_b32 s84, v206, 16
    v_readlane_b32 s85, v207, 16
    v_readlane_b32 s86, v208, 16
    v_readlane_b32 s87, v209, 16
    s_add_u32 m0, s32, 38016
    v_readlane_b32 s88, v206, 32
    v_readlane_b32 s89, v207, 32
    v_readlane_b32 s90, v208, 32
    v_readlane_b32 s91, v209, 32
    v_readlane_b32 s92, v206, 48
    v_readlane_b32 s93, v207, 48
    v_readlane_b32 s94, v208, 48
    v_readlane_b32 s95, v209, 48
    v_pk_mul_f32 v[0:1], v[0:1], s[80:81] op_sel_hi:[1,0]
    v_pk_mul_f32 v[2:3], v[2:3], s[80:81] op_sel_hi:[1,0]
    v_pk_mul_f32 v[4:5], v[4:5], s[80:81] op_sel_hi:[1,0]
    v_pk_mul_f32 v[6:7], v[6:7], s[80:81] op_sel_hi:[1,0]
    buffer_load_dwordx4 v230, s[16:19], s29 offen offset:0 lds
    v_pk_mul_f32 v[8:9], v[8:9], s[80:81] op_sel:[0,1] op_sel_hi:[1,1]
    v_pk_mul_f32 v[10:11], v[10:11], s[80:81] op_sel:[0,1] op_sel_hi:[1,1]
    v_pk_mul_f32 v[12:13], v[12:13], s[80:81] op_sel:[0,1] op_sel_hi:[1,1]
    v_pk_mul_f32 v[14:15], v[14:15], s[80:81] op_sel:[0,1] op_sel_hi:[1,1]
    v_pk_mul_f32 v[16:17], v[16:17], s[82:83] op_sel_hi:[1,0]
    v_pk_mul_f32 v[18:19], v[18:19], s[82:83] op_sel_hi:[1,0]
    v_pk_mul_f32 v[20:21], v[20:21], s[82:83] op_sel_hi:[1,0]
    v_pk_mul_f32 v[22:23], v[22:23], s[82:83] op_sel_hi:[1,0]
    v_pk_mul_f32 v[24:25], v[24:25], s[82:83] op_sel:[0,1] op_sel_hi:[1,1]
    v_pk_mul_f32 v[26:27], v[26:27], s[82:83] op_sel:[0,1] op_sel_hi:[1,1]
    v_pk_mul_f32 v[28:29], v[28:29], s[82:83] op_sel:[0,1] op_sel_hi:[1,1]
    v_pk_mul_f32 v[30:31], v[30:31], s[82:83] op_sel:[0,1] op_sel_hi:[1,1]
    buffer_load_dwordx4 v231, s[16:19], s29 offen offset:1056 lds
    v_pk_mul_f32 v[32:33], v[32:33], s[84:85] op_sel_hi:[1,0]
    v_pk_mul_f32 v[34:35], v[34:35], s[84:85] op_sel_hi:[1,0]
    v_pk_mul_f32 v[36:37], v[36:37], s[84:85] op_sel_hi:[1,0]
    v_pk_mul_f32 v[38:39], v[38:39], s[84:85] op_sel_hi:[1,0]
    v_pk_mul_f32 v[40:41], v[40:41], s[84:85] op_sel:[0,1] op_sel_hi:[1,1]
    v_pk_mul_f32 v[42:43], v[42:43], s[84:85] op_sel:[0,1] op_sel_hi:[1,1]
    v_pk_mul_f32 v[44:45], v[44:45], s[84:85] op_sel:[0,1] op_sel_hi:[1,1]
    v_pk_mul_f32 v[46:47], v[46:47], s[84:85] op_sel:[0,1] op_sel_hi:[1,1]
    v_pk_mul_f32 v[48:49], v[48:49], s[86:87] op_sel_hi:[1,0]
    v_pk_mul_f32 v[50:51], v[50:51], s[86:87] op_sel_hi:[1,0]
    v_pk_mul_f32 v[52:53], v[52:53], s[86:87] op_sel_hi:[1,0]
    v_pk_mul_f32 v[54:55], v[54:55], s[86:87] op_sel_hi:[1,0]
    buffer_load_dwordx4 v232, s[16:19], s29 offen offset:2112 lds
    v_pk_mul_f32 v[56:57], v[56:57], s[86:87] op_sel:[0,1] op_sel_hi:[1,1]
    v_pk_mul_f32 v[58:59], v[58:59], s[86:87] op_sel:[0,1] op_sel_hi:[1,1]
    v_pk_mul_f32 v[60:61], v[60:61], s[86:87] op_sel:[0,1] op_sel_hi:[1,1]
    v_pk_mul_f32 v[62:63], v[62:63], s[86:87] op_sel:[0,1] op_sel_hi:[1,1]
    v_pk_mul_f32 v[64:65], v[64:65], s[88:89] op_sel_hi:[1,0]
    v_pk_mul_f32 v[66:67], v[66:67], s[88:89] op_sel_hi:[1,0]
    v_pk_mul_f32 v[68:69], v[68:69], s[88:89] op_sel_hi:[1,0]
    buffer_load_dwordx4 v[128:131], v241, s[20:23], 0 offen offset:1792 sc1
    buffer_load_dwordx4 v[132:135], v241, s[20:23], 0 offen offset:2688 sc1
    buffer_load_dwordx4 v[136:139], v241, s[20:23], 0 offen offset:0 sc1
    buffer_load_dwordx4 v[140:143], v241, s[20:23], 0 offen offset:896 sc1
    buffer_load_dword a255, v198, s[16:19], s40 offen
    v_pk_mul_f32 v[70:71], v[70:71], s[88:89] op_sel_hi:[1,0]
    v_pk_mul_f32 v[72:73], v[72:73], s[88:89] op_sel:[0,1] op_sel_hi:[1,1]
    v_pk_mul_f32 v[74:75], v[74:75], s[88:89] op_sel:[0,1] op_sel_hi:[1,1]
    v_pk_mul_f32 v[76:77], v[76:77], s[88:89] op_sel:[0,1] op_sel_hi:[1,1]
    v_pk_mul_f32 v[78:79], v[78:79], s[88:89] op_sel:[0,1] op_sel_hi:[1,1]
    buffer_load_dwordx4 v233, s[16:19], s29 offen offset:3168 lds
    v_pk_mul_f32 v[80:81], v[80:81], s[90:91] op_sel_hi:[1,0]
    v_pk_mul_f32 v[82:83], v[82:83], s[90:91] op_sel_hi:[1,0]
    v_pk_mul_f32 v[84:85], v[84:85], s[90:91] op_sel_hi:[1,0]
    v_pk_mul_f32 v[86:87], v[86:87], s[90:91] op_sel_hi:[1,0]
    v_pk_mul_f32 v[88:89], v[88:89], s[90:91] op_sel:[0,1] op_sel_hi:[1,1]
    v_pk_mul_f32 v[90:91], v[90:91], s[90:91] op_sel:[0,1] op_sel_hi:[1,1]
    v_pk_mul_f32 v[92:93], v[92:93], s[90:91] op_sel:[0,1] op_sel_hi:[1,1]
    v_pk_mul_f32 v[94:95], v[94:95], s[90:91] op_sel:[0,1] op_sel_hi:[1,1]
    v_pk_mul_f32 v[96:97], v[96:97], s[92:93] op_sel_hi:[1,0]
    v_pk_mul_f32 v[98:99], v[98:99], s[92:93] op_sel_hi:[1,0]
    v_pk_mul_f32 v[100:101], v[100:101], s[92:93] op_sel_hi:[1,0]
    v_pk_mul_f32 v[102:103], v[102:103], s[92:93] op_sel_hi:[1,0]
    s_add_u32 s28, s28, 262144
    v_pk_mul_f32 v[104:105], v[104:105], s[92:93] op_sel:[0,1] op_sel_hi:[1,1]
    v_pk_mul_f32 v[106:107], v[106:107], s[92:93] op_sel:[0,1] op_sel_hi:[1,1]
    v_pk_mul_f32 v[108:109], v[108:109], s[92:93] op_sel:[0,1] op_sel_hi:[1,1]
    v_pk_mul_f32 v[110:111], v[110:111], s[92:93] op_sel:[0,1] op_sel_hi:[1,1]
    v_pk_mul_f32 v[112:113], v[112:113], s[94:95] op_sel_hi:[1,0]
    v_pk_mul_f32 v[114:115], v[114:115], s[94:95] op_sel_hi:[1,0]
    v_pk_mul_f32 v[116:117], v[116:117], s[94:95] op_sel_hi:[1,0]
    v_pk_mul_f32 v[118:119], v[118:119], s[94:95] op_sel_hi:[1,0]
    v_pk_mul_f32 v[120:121], v[120:121], s[94:95] op_sel:[0,1] op_sel_hi:[1,1]
    v_pk_mul_f32 v[122:123], v[122:123], s[94:95] op_sel:[0,1] op_sel_hi:[1,1]
    v_pk_mul_f32 v[124:125], v[124:125], s[94:95] op_sel:[0,1] op_sel_hi:[1,1]
    v_pk_mul_f32 v[126:127], v[126:127], s[94:95] op_sel:[0,1] op_sel_hi:[1,1]
    s_add_u32 s29, s29, 262144
    s_mov_b32 s43, 0x8000
    s_waitcnt vmcnt(2)
KB_mp:
    v_min3_u32 v144, v129, v131, v133
    v_max3_u32 v145, v129, v131, v133
    v_min3_u32 v144, v144, v135, v137
    v_max3_u32 v145, v145, v135, v137
    v_min3_u32 v144, v144, v139, v141
    v_max3_u32 v145, v145, v139, v141
    v_min_u32 v144, v144, v143
    v_max_u32 v145, v145, v143
    v_xor_b32 v144, s3, v144
    v_xor_b32 v145, s3, v145
    v_or_b32 v144, v144, v145
    v_cmp_ne_u32 vcc, 0, v144
    s_sub_u32 s43, s43, 1
    s_cbranch_vccz KB_m2
    s_cmp_eq_u32 s43, 0
    s_cbranch_scc1 KB_m2
    buffer_load_dwordx4 v[128:131], v241, s[20:23], 0 offen offset:1792 sc1
    buffer_load_dwordx4 v[132:135], v241, s[20:23], 0 offen offset:2688 sc1
    buffer_load_dwordx4 v[136:139], v241, s[20:23], 0 offen offset:0 sc1
    buffer_load_dwordx4 v[140:143], v241, s[20:23], 0 offen offset:896 sc1
    s_waitcnt vmcnt(0)
    s_branch KB_mp
KB_m2:
    s_mov_b32 s40, 0xffff0000
    v_and_b32 v129, s40, v128
    v_lshlrev_b32 v128, 16, v128
    v_and_b32 v131, s40, v130
    v_lshlrev_b32 v130, 16, v130
    v_and_b32 v133, s40, v132
    v_lshlrev_b32 v132, 16, v132
    v_and_b32 v135, s40, v134
    v_lshlrev_b32 v134, 16, v134
    v_and_b32 v137, s40, v136
    v_lshlrev_b32 v136, 16, v136
    v_and_b32 v139, s40, v138
    v_lshlrev_b32 v138, 16, v138
    v_and_b32 v141, s40, v140
    v_lshlrev_b32 v140, 16, v140
    v_and_b32 v143, s40, v142
    v_lshlrev_b32 v142, 16, v142
    v_pk_mul_f32 v[128:129], v[128:129], s[34:35] op_sel:[0,1] op_sel_hi:[1,1]
    v_pk_mul_f32 v[130:131], v[130:131], s[34:35] op_sel:[0,1] op_sel_hi:[1,1]
    v_pk_mul_f32 v[132:133], v[132:133], s[34:35] op_sel:[0,1] op_sel_hi:[1,1]
    v_pk_mul_f32 v[134:135], v[134:135], s[34:35] op_sel:[0,1] op_sel_hi:[1,1]
    v_pk_mul_f32 v[136:137], v[136:137], s[34:35] op_sel:[0,1] op_sel_hi:[1,1]
    v_pk_mul_f32 v[138:139], v[138:139], s[34:35] op_sel:[0,1] op_sel_hi:[1,1]
    v_pk_mul_f32 v[140:141], v[140:141], s[34:35] op_sel:[0,1] op_sel_hi:[1,1]
    v_pk_mul_f32 v[142:143], v[142:143], s[34:35] op_sel:[0,1] op_sel_hi:[1,1]
    v_pk_fma_f32 v[0:1], v[0:1], v[128:129], v[136:137]
    v_pk_fma_f32 v[2:3], v[2:3], v[130:131], v[138:139]
    v_pk_fma_f32 v[4:5], v[4:5], v[132:133], v[140:141]
    v_pk_fma_f32 v[6:7], v[6:7], v[134:135], v[142:143]
    v_xor_b32 v160, 0, v240
    v_cvt_pk_bf16_f32 v144, v0, v1
    v_cvt_pk_bf16_f32 v145, v2, v3
    v_cvt_pk_bf16_f32 v146, v4, v5
    v_cvt_pk_bf16_f32 v147, v6, v7
    ds_write_b128 v160, v[144:147]
    v_pk_fma_f32 v[8:9], v[8:9], v[128:129], v[136:137]
    v_pk_fma_f32 v[10:11], v[10:11], v[130:131], v[138:139]
    v_pk_fma_f32 v[12:13], v[12:13], v[132:133], v[140:141]
    v_pk_fma_f32 v[14:15], v[14:15], v[134:135], v[142:143]
    v_xor_b32 v161, 16, v240
    v_cvt_pk_bf16_f32 v148, v8, v9
    v_cvt_pk_bf16_f32 v149, v10, v11
    v_cvt_pk_bf16_f32 v150, v12, v13
    v_cvt_pk_bf16_f32 v151, v14, v15
    ds_write_b128 v161, v[148:151]
    v_pk_fma_f32 v[16:17], v[16:17], v[128:129], v[136:137]
    v_pk_fma_f32 v[18:19], v[18:19], v[130:131], v[138:139]
    v_pk_fma_f32 v[20:21], v[20:21], v[132:133], v[140:141]
    v_pk_fma_f32 v[22:23], v[22:23], v[134:135], v[142:143]
    v_xor_b32 v162, 32, v240
    v_cvt_pk_bf16_f32 v152, v16, v17
    v_cvt_pk_bf16_f32 v153, v18, v19
    v_cvt_pk_bf16_f32 v154, v20, v21
    v_cvt_pk_bf16_f32 v155, v22, v23
    ds_write_b128 v162, v[152:155]
    v_pk_fma_f32 v[24:25], v[24:25], v[128:129], v[136:137]
    v_pk_fma_f32 v[26:27], v[26:27], v[130:131], v[138:139]
    v_pk_fma_f32 v[28:29], v[28:29], v[132:133], v[140:141]
    v_pk_fma_f32 v[30:31], v[30:31], v[134:135], v[142:143]
    v_xor_b32 v163, 48, v240
    v_cvt_pk_bf16_f32 v156, v24, v25
    v_cvt_pk_bf16_f32 v157, v26, v27
    v_cvt_pk_bf16_f32 v158, v28, v29
    v_cvt_pk_bf16_f32 v159, v30, v31
    ds_write_b128 v163, v[156:159]
    v_pk_fma_f32 v[32:33], v[32:33], v[128:129], v[136:137]
    v_pk_fma_f32 v[34:35], v[34:35], v[130:131], v[138:139]
    v_pk_fma_f32 v[36:37], v[36:37], v[132:133], v[140:141]
    v_pk_fma_f32 v[38:39], v[38:39], v[134:135], v[142:143]
    v_xor_b32 v160, 64, v240
    v_cvt_pk_bf16_f32 v144, v32, v33
    v_cvt_pk_bf16_f32 v145, v34, v35
    v_cvt_pk_bf16_f32 v146, v36, v37
    v_cvt_pk_bf16_f32 v147, v38, v39
    ds_write_b128 v160, v[144:147]
    v_pk_fma_f32 v[40:41], v[40:41], v[128:129], v[136:137]
    v_pk_fma_f32 v[42:43], v[42:43], v[130:131], v[138:139]
    v_pk_fma_f32 v[44:45], v[44:45], v[132:133], v[140:141]
    v_pk_fma_f32 v[46:47], v[46:47], v[134:135], v[142:143]
    v_xor_b32 v161, 80, v240
    v_cvt_pk_bf16_f32 v148, v40, v41
    v_cvt_pk_bf16_f32 v149, v42, v43
    v_cvt_pk_bf16_f32 v150, v44, v45
    v_cvt_pk_bf16_f32 v151, v46, v47
    ds_write_b128 v161, v[148:151]
    v_pk_fma_f32 v[48:49], v[48:49], v[128:129], v[136:137]
    v_pk_fma_f32 v[50:51], v[50:51], v[130:131], v[138:139]
    v_pk_fma_f32 v[52:53], v[52:53], v[132:133], v[140:141]
    v_pk_fma_f32 v[54:55], v[54:55], v[134:135], v[142:143]
    v_xor_b32 v162, 96, v240
    v_cvt_pk_bf16_f32 v152, v48, v49
    v_cvt_pk_bf16_f32 v153, v50, v51
    v_cvt_pk_bf16_f32 v154, v52, v53
    v_cvt_pk_bf16_f32 v155, v54, v55
    ds_write_b128 v162, v[152:155]
    v_pk_fma_f32 v[56:57], v[56:57], v[128:129], v[136:137]
    v_pk_fma_f32 v[58:59], v[58:59], v[130:131], v[138:139]
    v_pk_fma_f32 v[60:61], v[60:61], v[132:133], v[140:141]
    v_pk_fma_f32 v[62:63], v[62:63], v[134:135], v[142:143]
    v_xor_b32 v163, 112, v240
    v_cvt_pk_bf16_f32 v156, v56, v57
    v_cvt_pk_bf16_f32 v157, v58, v59
    v_cvt_pk_bf16_f32 v158, v60, v61
    v_cvt_pk_bf16_f32 v159, v62, v63
    ds_write_b128 v163, v[156:159]
    v_pk_fma_f32 v[64:65], v[64:65], v[128:129], v[136:137]
    v_pk_fma_f32 v[66:67], v[66:67], v[130:131], v[138:139]
    v_pk_fma_f32 v[68:69], v[68:69], v[132:133], v[140:141]
    v_pk_fma_f32 v[70:71], v[70:71], v[134:135], v[142:143]
    v_xor_b32 v160, 128, v240
    v_cvt_pk_bf16_f32 v144, v64, v65
    v_cvt_pk_bf16_f32 v145, v66, v67
    v_cvt_pk_bf16_f32 v146, v68, v69
    v_cvt_pk_bf16_f32 v147, v70, v71
    ds_write_b128 v160, v[144:147]
    v_pk_fma_f32 v[72:73], v[72:73], v[128:129], v[136:137]
    v_pk_fma_f32 v[74:75], v[74:75], v[130:131], v[138:139]
    v_pk_fma_f32 v[76:77], v[76:77], v[132:133], v[140:141]
    v_pk_fma_f32 v[78:79], v[78:79], v[134:135], v[142:143]
    v_xor_b32 v161, 144, v240
    v_cvt_pk_bf16_f32 v148, v72, v73
    v_cvt_pk_bf16_f32 v149, v74, v75
    v_cvt_pk_bf16_f32 v150, v76, v77
    v_cvt_pk_bf16_f32 v151, v78, v79
    ds_write_b128 v161, v[148:151]
    v_pk_fma_f32 v[80:81], v[80:81], v[128:129], v[136:137]
    v_pk_fma_f32 v[82:83], v[82:83], v[130:131], v[138:139]
    v_pk_fma_f32 v[84:85], v[84:85], v[132:133], v[140:141]
    v_pk_fma_f32 v[86:87], v[86:87], v[134:135], v[142:143]
    v_xor_b32 v162, 160, v240
    v_cvt_pk_bf16_f32 v152, v80, v81
    v_cvt_pk_bf16_f32 v153, v82, v83
    v_cvt_pk_bf16_f32 v154, v84, v85
    v_cvt_pk_bf16_f32 v155, v86, v87
    ds_write_b128 v162, v[152:155]
    v_pk_fma_f32 v[88:89], v[88:89], v[128:129], v[136:137]
    v_pk_fma_f32 v[90:91], v[90:91], v[130:131], v[138:139]
    v_pk_fma_f32 v[92:93], v[92:93], v[132:133], v[140:141]
    v_pk_fma_f32 v[94:95], v[94:95], v[134:135], v[142:143]
    v_xor_b32 v163, 176, v240
    v_cvt_pk_bf16_f32 v156, v88, v89
    v_cvt_pk_bf16_f32 v157, v90, v91
    v_cvt_pk_bf16_f32 v158, v92, v93
    v_cvt_pk_bf16_f32 v159, v94, v95
    ds_write_b128 v163, v[156:159]
    v_pk_fma_f32 v[96:97], v[96:97], v[128:129], v[136:137]
    v_pk_fma_f32 v[98:99], v[98:99], v[130:131], v[138:139]
    v_pk_fma_f32 v[100:101], v[100:101], v[132:133], v[140:141]
    v_pk_fma_f32 v[102:103], v[102:103], v[134:135], v[142:143]
    v_xor_b32 v160, 192, v240
    v_cvt_pk_bf16_f32 v144, v96, v97
    v_cvt_pk_bf16_f32 v145, v98, v99
    v_cvt_pk_bf16_f32 v146, v100, v101
    v_cvt_pk_bf16_f32 v147, v102, v103
    ds_write_b128 v160, v[144:147]
    v_pk_fma_f32 v[104:105], v[104:105], v[128:129], v[136:137]
    v_pk_fma_f32 v[106:107], v[106:107], v[130:131], v[138:139]
    v_pk_fma_f32 v[108:109], v[108:109], v[132:133], v[140:141]
    v_pk_fma_f32 v[110:111], v[110:111], v[134:135], v[142:143]
    v_xor_b32 v161, 208, v240
    v_cvt_pk_bf16_f32 v148, v104, v105
    v_cvt_pk_bf16_f32 v149, v106, v107
    v_cvt_pk_bf16_f32 v150, v108, v109
    v_cvt_pk_bf16_f32 v151, v110, v111
    ds_write_b128 v161, v[148:151]
    v_pk_fma_f32 v[112:113], v[112:113], v[128:129], v[136:137]
    v_pk_fma_f32 v[114:115], v[114:115], v[130:131], v[138:139]
    v_pk_fma_f32 v[116:117], v[116:117], v[132:133], v[140:141]
    v_pk_fma_f32 v[118:119], v[118:119], v[134:135], v[142:143]
    v_xor_b32 v162, 224, v240
    v_cvt_pk_bf16_f32 v152, v112, v113
    v_cvt_pk_bf16_f32 v153, v114, v115
    v_cvt_pk_bf16_f32 v154, v116, v117
    v_cvt_pk_bf16_f32 v155, v118, v119
    ds_write_b128 v162, v[152:155]
    v_pk_fma_f32 v[120:121], v[120:121], v[128:129], v[136:137]
    v_pk_fma_f32 v[122:123], v[122:123], v[130:131], v[138:139]
    v_pk_fma_f32 v[124:125], v[124:125], v[132:133], v[140:141]
    v_pk_fma_f32 v[126:127], v[126:127], v[134:135], v[142:143]
    v_xor_b32 v163, 240, v240
    v_cvt_pk_bf16_f32 v156, v120, v121
    v_cvt_pk_bf16_f32 v157, v122, v123
    v_cvt_pk_bf16_f32 v158, v124, v125
    v_cvt_pk_bf16_f32 v159, v126, v127
    ds_write_b128 v163, v[156:159]
    s_cmp_lg_u32 s24, 0
    s_cbranch_scc1 KB_w0b
    s_cmp_lt_u32 s2, 254
    s_cbranch_scc1 KB_w0b
    v_mov_b64 v[4:5], 0
    v_mov_b64 v[6:7], 0
    s_sub_u32 s40, s2, 254
    s_mul_i32 s40, s40, 1849344
    s_add_u32 s40, s40, 8388608
    s_mov_b32 s41, 14
KB_gz:
    buffer_store_dwordx4 v[4:7], v205, s[20:23], s40 offen sc1
    s_add_u32 s40, s40, 1024
    s_sub_u32 s41, s41, 1
    s_cmp_lg_u32 s41, 0
    s_cbranch_scc1 KB_gz
KB_w0b:
    s_lshl_b32 s40, s25, 20
    s_add_u32 s8, s44, s40
    s_addc_u32 s9, s45, 0
    s_sub_u32 s8, s8, 1584
    s_subb_u32 s9, s9, 0
    s_mov_b32 s10, 1050160
    s_mov_b32 s11, 0x20000
    s_add_u32 s12, s46, s40
    s_addc_u32 s13, s47, 0
    s_sub_u32 s12, s12, 1632
    s_subb_u32 s13, s13, 0
    s_mov_b32 s14, 1050208
    s_mov_b32 s15, 0x20000
    s_getpc_b64 s[46:47]
KB_pt_pc:
    s_add_u32 s46, s46, KB_exit-KB_pt_pc
    s_addc_u32 s47, s47, 0
    v_and_b32 v0, 63, v255
    v_lshlrev_b32 v2, 7, v0
    v_cmp_gt_u32 vcc, 6, v0
    s_nop 1
    v_cndmask_b32 v3, v254, v2, vcc
    v_cmp_gt_u32 vcc, 4, v0
    s_nop 1
    v_cndmask_b32 v2, v254, v2, vcc
    s_lshl_b32 s44, s26, 2
    s_add_u32 s44, s44, s24
    s_mul_i32 s45, s44, 768
    s_add_u32 s45, s45, 1584
    s_mul_i32 s44, s44, 512
    s_add_u32 s44, s44, 1632
    buffer_load_dword a255, v3, s[8:11], s45 offen
    buffer_load_dword a255, v2, s[12:15], s44 offen
    s_waitcnt vmcnt(10) lgkmcnt(0)
    s_barrier
    v_add_u32 v247, 67584, v238
    v_xor_b32 v248, 64, v239
    ds_read_b128 v[128:131], v239 offset:0
    ds_read_b128 v[132:135], v239 offset:14336
    ds_read_b128 v[136:139], v239 offset:28672
    ds_read_b128 v[140:143], v239 offset:43008
    ds_read_b64_tr_b16 a[128:129], v238 offset:0
    ds_read_b64_tr_b16 a[130:131], v238 offset:256
    ds_read_b64_tr_b16 a[132:133], v238 offset:32
    ds_read_b64_tr_b16 a[134:135], v238 offset:288
    ds_read_b64_tr_b16 a[136:137], v238 offset:64
    ds_read_b64_tr_b16 a[138:139], v238 offset:320
    ds_read_b64_tr_b16 a[140:141], v238 offset:96
    ds_read_b64_tr_b16 a[142:143], v238 offset:352
    s_waitcnt lgkmcnt(4)
    v_mfma_f32_16x16x32_bf16 v[0:3], a[128:131], v[128:131], 0
    ds_read_b64_tr_b16 a[144:145], v238 offset:128
    ds_read_b64_tr_b16 a[146:147], v238 offset:384
    v_mfma_f32_16x16x32_bf16 v[4:7], a[128:131], v[132:135], 0
    s_add_u32 m0, s32, 67584
    v_mfma_f32_16x16x32_bf16 v[8:11], a[128:131], v[136:139], 0
    buffer_load_dwordx4 v230, s[16:19], s28 offen offset:0 lds
    v_mfma_f32_16x16x32_bf16 v[12:15], a[128:131], v[140:143], 0
    s_mov_b32 s40, 0
    s_mov_b32 s66, 0
    v_mfma_f32_16x16x32_bf16 v[16:19], a[132:135], v[128:131], 0
    ds_read_b64_tr_b16 a[148:149], v238 offset:160
    ds_read_b64_tr_b16 a[150:151], v238 offset:416
    v_mfma_f32_16x16x32_bf16 v[20:23], a[132:135], v[132:135], 0
    s_add_u32 s64, s60, s40
    s_addc_u32 s65, s61, 0
    v_mfma_f32_16x16x32_bf16 v[24:27], a[132:135], v[136:139], 0
    buffer_load_dwordx4 v231, s[16:19], s28 offen offset:1056 lds
    v_mfma_f32_16x16x32_bf16 v[28:31], a[132:135], v[140:143], 0
    s_waitcnt lgkmcnt(4)
    v_mfma_f32_16x16x32_bf16 v[32:35], a[136:139], v[128:131], 0
    ds_read_b64_tr_b16 a[152:153], v238 offset:192
    ds_read_b64_tr_b16 a[154:155], v238 offset:448
    v_mfma_f32_16x16x32_bf16 v[36:39], a[136:139], v[132:135], 0
    s_mov_b32 s40, 0
    s_mov_b32 s69, 0
    v_mfma_f32_16x16x32_bf16 v[40:43], a[136:139], v[136:139], 0
    buffer_load_dwordx4 v232, s[16:19], s28 offen offset:2112 lds
    v_mfma_f32_16x16x32_bf16 v[44:47], a[136:139], v[140:143], 0
    s_add_u32 s67, s60, s40
    s_addc_u32 s68, s61, 0
    v_mfma_f32_16x16x32_bf16 v[48:51], a[140:143], v[128:131], 0
    ds_read_b64_tr_b16 a[156:157], v238 offset:224
    ds_read_b64_tr_b16 a[158:159], v238 offset:480
    v_mfma_f32_16x16x32_bf16 v[52:55], a[140:143], v[132:135], 0
    s_mul_i32 s40, s26, 12544
    s_mov_b32 s72, 12544
    v_mfma_f32_16x16x32_bf16 v[56:59], a[140:143], v[136:139], 0
    s_waitcnt vmcnt(5)
    buffer_load_dwordx4 v233, s[16:19], s28 offen offset:3168 lds
    v_mfma_f32_16x16x32_bf16 v[60:63], a[140:143], v[140:143], 0
    s_waitcnt lgkmcnt(4)
    v_mfma_f32_16x16x32_bf16 v[64:67], a[144:147], v[128:131], 0
    ds_read_b64_tr_b16 a[128:129], v238 offset:33792
    ds_read_b64_tr_b16 a[130:131], v238 offset:34048
    v_mfma_f32_16x16x32_bf16 v[68:71], a[144:147], v[132:135], 0
    s_add_u32 m0, s32, 71808
    ds_read_b128 v[144:147], v248 offset:1024
    v_mfma_f32_16x16x32_bf16 v[72:75], a[144:147], v[136:139], 0
    buffer_load_dwordx4 v230, s[16:19], s29 offen offset:0 lds
    v_mfma_f32_16x16x32_bf16 v[76:79], a[144:147], v[140:143], 0
    ds_read_b128 v[148:151], v248 offset:15360
    v_mfma_f32_16x16x32_bf16 v[80:83], a[148:151], v[128:131], 0
    ds_read_b64_tr_b16 a[132:133], v238 offset:33824
    ds_read_b64_tr_b16 a[134:135], v238 offset:34080
    v_mfma_f32_16x16x32_bf16 v[84:87], a[148:151], v[132:135], 0
    ds_read_b128 v[152:155], v248 offset:29696
    v_mfma_f32_16x16x32_bf16 v[88:91], a[148:151], v[136:139], 0
    buffer_load_dwordx4 v231, s[16:19], s29 offen offset:1056 lds
    v_mfma_f32_16x16x32_bf16 v[92:95], a[148:151], v[140:143], 0
    s_waitcnt lgkmcnt(7)
    ds_read_b128 v[156:159], v248 offset:44032
    v_mfma_f32_16x16x32_bf16 v[96:99], a[152:155], v[128:131], 0
    ds_read_b64_tr_b16 a[136:137], v238 offset:33856
    ds_read_b64_tr_b16 a[138:139], v238 offset:34112
    v_mfma_f32_16x16x32_bf16 v[100:103], a[152:155], v[132:135], 0
    s_add_u32 s70, s58, s40
    s_addc_u32 s71, s59, 0
    v_mfma_f32_16x16x32_bf16 v[104:107], a[152:155], v[136:139], 0
    buffer_load_dwordx4 v232, s[16:19], s29 offen offset:2112 lds
    v_mfma_f32_16x16x32_bf16 v[108:111], a[152:155], v[140:143], 0
    s_mul_i32 s40, s26, 12544
    s_mov_b32 s75, 12544
    v_mfma_f32_16x16x32_bf16 v[112:115], a[156:159], v[128:131], 0
    ds_read_b64_tr_b16 a[140:141], v238 offset:33888
    ds_read_b64_tr_b16 a[142:143], v238 offset:34144
    v_mfma_f32_16x16x32_bf16 v[116:119], a[156:159], v[132:135], 0
    s_add_u32 s73, s56, s40
    s_addc_u32 s74, s57, 0
    v_mfma_f32_16x16x32_bf16 v[120:123], a[156:159], v[136:139], 0
    s_add_u32 s28, s28, 262144
    buffer_load_dwordx4 v233, s[16:19], s29 offen offset:3168 lds
    v_mfma_f32_16x16x32_bf16 v[124:127], a[156:159], v[140:143], 0
    s_waitcnt lgkmcnt(4)
    s_add_u32 s29, s29, 262144
    v_mfma_f32_16x16x32_bf16 v[0:3], a[128:131], v[144:147], v[0:3]
    ds_read_b64_tr_b16 a[144:145], v238 offset:33920
    ds_read_b64_tr_b16 a[146:147], v238 offset:34176
    v_mfma_f32_16x16x32_bf16 v[4:7], a[128:131], v[148:151], v[4:7]
    s_add_u32 m0, s32, 0
    v_mfma_f32_16x16x32_bf16 v[8:11], a[128:131], v[152:155], v[8:11]
    buffer_load_dwordx4 v230, s[16:19], s28 offen offset:0 lds
    v_mfma_f32_16x16x32_bf16 v[12:15], a[128:131], v[156:159], v[12:15]
    s_mul_i32 s40, s25, 458752
    s_mul_i32 s41, s26, 14336
    v_mfma_f32_16x16x32_bf16 v[16:19], a[132:135], v[144:147], v[16:19]
    ds_read_b64_tr_b16 a[148:149], v238 offset:33952
    ds_read_b64_tr_b16 a[150:151], v238 offset:34208
    v_mfma_f32_16x16x32_bf16 v[20:23], a[132:135], v[148:151], v[20:23]
    s_add_u32 s40, s40, s41
    s_mov_b32 s78, 14336
    v_mfma_f32_16x16x32_bf16 v[24:27], a[132:135], v[152:155], v[24:27]
    buffer_load_dwordx4 v231, s[16:19], s28 offen offset:1056 lds
    v_mfma_f32_16x16x32_bf16 v[28:31], a[132:135], v[156:159], v[28:31]
    s_waitcnt lgkmcnt(4)
    v_mfma_f32_16x16x32_bf16 v[32:35], a[136:139], v[144:147], v[32:35]
    ds_read_b64_tr_b16 a[152:153], v238 offset:33984
    ds_read_b64_tr_b16 a[154:155], v238 offset:34240
    v_mfma_f32_16x16x32_bf16 v[36:39], a[136:139], v[148:151], v[36:39]
    s_add_u32 s76, s50, s40
    s_addc_u32 s77, s51, 0
    v_mfma_f32_16x16x32_bf16 v[40:43], a[136:139], v[152:155], v[40:43]
    buffer_load_dwordx4 v232, s[16:19], s28 offen offset:2112 lds
    v_mfma_f32_16x16x32_bf16 v[44:47], a[136:139], v[156:159], v[44:47]
    s_lshl_b32 s40, s26, 11
    s_min_u32 s40, s40, KB_done-KB_exit
    v_mfma_f32_16x16x32_bf16 v[48:51], a[140:143], v[144:147], v[48:51]
    ds_read_b64_tr_b16 a[156:157], v238 offset:34016
    ds_read_b64_tr_b16 a[158:159], v238 offset:34272
    v_mfma_f32_16x16x32_bf16 v[52:55], a[140:143], v[148:151], v[52:55]
    s_sub_u32 s81, KB_done-KB_exit, s40
    s_min_u32 s81, s81, 2048
    v_mfma_f32_16x16x32_bf16 v[56:59], a[140:143], v[152:155], v[56:59]
    s_waitcnt vmcnt(3)
    buffer_load_dwordx4 v233, s[16:19], s28 offen offset:3168 lds
    v_mfma_f32_16x16x32_bf16 v[60:63], a[140:143], v[156:159], v[60:63]
    s_waitcnt lgkmcnt(4)
    v_mfma_f32_16x16x32_bf16 v[64:67], a[144:147], v[144:147], v[64:67]
    ds_read_b64_tr_b16 a[128:129], v247 offset:0
    ds_read_b64_tr_b16 a[130:131], v247 offset:256
    v_mfma_f32_16x16x32_bf16 v[68:71], a[144:147], v[148:151], v[68:71]
    s_add_u32 m0, s32, 4224
    ds_read_b128 v[128:131], v239 offset:2048
    v_mfma_f32_16x16x32_bf16 v[72:75], a[144:147], v[152:155], v[72:75]
    buffer_load_dwordx4 v230, s[16:19], s29 offen offset:0 lds
    v_mfma_f32_16x16x32_bf16 v[76:79], a[144:147], v[156:159], v[76:79]
    ds_read_b128 v[132:135], v239 offset:16384
    v_mfma_f32_16x16x32_bf16 v[80:83], a[148:151], v[144:147], v[80:83]
    ds_read_b64_tr_b16 a[132:133], v247 offset:32
    ds_read_b64_tr_b16 a[134:135], v247 offset:288
    v_mfma_f32_16x16x32_bf16 v[84:87], a[148:151], v[148:151], v[84:87]
    ds_read_b128 v[136:139], v239 offset:30720
    v_mfma_f32_16x16x32_bf16 v[88:91], a[148:151], v[152:155], v[88:91]
    buffer_load_dwordx4 v231, s[16:19], s29 offen offset:1056 lds
    v_mfma_f32_16x16x32_bf16 v[92:95], a[148:151], v[156:159], v[92:95]
    s_waitcnt lgkmcnt(7)
    ds_read_b128 v[140:143], v239 offset:45056
    v_mfma_f32_16x16x32_bf16 v[96:99], a[152:155], v[144:147], v[96:99]
    ds_read_b64_tr_b16 a[136:137], v247 offset:64
    ds_read_b64_tr_b16 a[138:139], v247 offset:320
    v_mfma_f32_16x16x32_bf16 v[100:103], a[152:155], v[148:151], v[100:103]
    s_add_u32 s79, s46, s40
    s_addc_u32 s80, s47, 0
    v_mfma_f32_16x16x32_bf16 v[104:107], a[152:155], v[152:155], v[104:107]
    buffer_load_dwordx4 v232, s[16:19], s29 offen offset:2112 lds
    v_mfma_f32_16x16x32_bf16 v[108:111], a[152:155], v[156:159], v[108:111]
    s_mul_i32 s40, s2, 6272
    s_mov_b32 s84, 6272
    v_mfma_f32_16x16x32_bf16 v[112:115], a[156:159], v[144:147], v[112:115]
    ds_read_b64_tr_b16 a[140:141], v247 offset:96
    ds_read_b64_tr_b16 a[142:143], v247 offset:352
    v_mfma_f32_16x16x32_bf16 v[116:119], a[156:159], v[148:151], v[116:119]
    s_add_u32 s82, s62, s40
    s_addc_u32 s83, s63, 0
    v_mfma_f32_16x16x32_bf16 v[120:123], a[156:159], v[152:155], v[120:123]
    s_add_u32 s28, s28, 262144
    buffer_load_dwordx4 v233, s[16:19], s29 offen offset:3168 lds
    v_mfma_f32_16x16x32_bf16 v[124:127], a[156:159], v[156:159], v[124:127]
    s_waitcnt lgkmcnt(4)
    s_add_u32 s29, s29, 262144
    v_mfma_f32_16x16x32_bf16 v[0:3], a[128:131], v[128:131], v[0:3]
    ds_read_b64_tr_b16 a[144:145], v247 offset:128
    ds_read_b64_tr_b16 a[146:147], v247 offset:384
    v_mfma_f32_16x16x32_bf16 v[4:7], a[128:131], v[132:135], v[4:7]
    s_add_u32 m0, s32, 33792
    v_mfma_f32_16x16x32_bf16 v[8:11], a[128:131], v[136:139], v[8:11]
    buffer_load_dwordx4 v230, s[16:19], s28 offen offset:0 lds
    v_mfma_f32_16x16x32_bf16 v[12:15], a[128:131], v[140:143], v[12:15]
    s_mul_i32 s40, s2, 6272
    s_mov_b32 s87, 6272
    v_mfma_f32_16x16x32_bf16 v[16:19], a[132:135], v[128:131], v[16:19]
    ds_read_b64_tr_b16 a[148:149], v247 offset:160
    ds_read_b64_tr_b16 a[150:151], v247 offset:416
    v_mfma_f32_16x16x32_bf16 v[20:23], a[132:135], v[132:135], v[20:23]
    s_add_u32 s85, s60, s40
    s_addc_u32 s86, s61, 0
    v_mfma_f32_16x16x32_bf16 v[24:27], a[132:135], v[136:139], v[24:27]
    buffer_load_dwordx4 v231, s[16:19], s28 offen offset:1056 lds
    v_mfma_f32_16x16x32_bf16 v[28:31], a[132:135], v[140:143], v[28:31]
    s_waitcnt lgkmcnt(4)
    v_mfma_f32_16x16x32_bf16 v[32:35], a[136:139], v[128:131], v[32:35]
    ds_read_b64_tr_b16 a[152:153], v247 offset:192
    ds_read_b64_tr_b16 a[154:155], v247 offset:448
    v_mfma_f32_16x16x32_bf16 v[36:39], a[136:139], v[132:135], v[36:39]
    s_mov_b32 s88, s54
    s_mov_b32 s89, s55
    v_mfma_f32_16x16x32_bf16 v[40:43], a[136:139], v[136:139], v[40:43]
    buffer_load_dwordx4 v232, s[16:19], s28 offen offset:2112 lds
    v_mfma_f32_16x16x32_bf16 v[44:47], a[136:139], v[140:143], v[44:47]
    s_mov_b32 s90, 0
    s_lshr_b32 s40, s2, 6
    v_mfma_f32_16x16x32_bf16 v[48:51], a[140:143], v[128:131], v[48:51]
    ds_read_b64_tr_b16 a[156:157], v247 offset:224
    ds_read_b64_tr_b16 a[158:159], v247 offset:480
    v_mfma_f32_16x16x32_bf16 v[52:55], a[140:143], v[132:135], v[52:55]
    s_lshl_b32 s40, s40, 3
    s_add_u32 s40, s40, s25
    v_mfma_f32_16x16x32_bf16 v[56:59], a[140:143], v[136:139], v[56:59]
    s_waitcnt vmcnt(3)
    buffer_load_dwordx4 v233, s[16:19], s28 offen offset:3168 lds
    v_mfma_f32_16x16x32_bf16 v[60:63], a[140:143], v[140:143], v[60:63]
    s_waitcnt lgkmcnt(4)
    v_mfma_f32_16x16x32_bf16 v[64:67], a[144:147], v[128:131], v[64:67]
    ds_read_b64_tr_b16 a[128:129], v238 offset:0
    ds_read_b64_tr_b16 a[130:131], v238 offset:256
    v_mfma_f32_16x16x32_bf16 v[68:71], a[144:147], v[132:135], v[68:71]
    s_add_u32 m0, s32, 38016
    ds_read_b128 v[144:147], v248 offset:3072
    v_mfma_f32_16x16x32_bf16 v[72:75], a[144:147], v[136:139], v[72:75]
    buffer_load_dwordx4 v230, s[16:19], s29 offen offset:0 lds
    v_mfma_f32_16x16x32_bf16 v[76:79], a[144:147], v[140:143], v[76:79]
    ds_read_b128 v[148:151], v248 offset:17408
    v_mfma_f32_16x16x32_bf16 v[80:83], a[148:151], v[128:131], v[80:83]
    ds_read_b64_tr_b16 a[132:133], v238 offset:32
    ds_read_b64_tr_b16 a[134:135], v238 offset:288
    v_mfma_f32_16x16x32_bf16 v[84:87], a[148:151], v[132:135], v[84:87]
    ds_read_b128 v[152:155], v248 offset:31744
    v_mfma_f32_16x16x32_bf16 v[88:91], a[148:151], v[136:139], v[88:91]
    buffer_load_dwordx4 v231, s[16:19], s29 offen offset:1056 lds
    v_mfma_f32_16x16x32_bf16 v[92:95], a[148:151], v[140:143], v[92:95]
    s_waitcnt lgkmcnt(7)
    ds_read_b128 v[156:159], v248 offset:46080
    v_mfma_f32_16x16x32_bf16 v[96:99], a[152:155], v[128:131], v[96:99]
    ds_read_b64_tr_b16 a[136:137], v238 offset:64
    ds_read_b64_tr_b16 a[138:139], v238 offset:320
    v_mfma_f32_16x16x32_bf16 v[100:103], a[152:155], v[132:135], v[100:103]
    s_lshl_b32 s40, s40, 3
    s_and_b32 s41, s26, 7
    v_mfma_f32_16x16x32_bf16 v[104:107], a[152:155], v[136:139], v[104:107]
    buffer_load_dwordx4 v232, s[16:19], s29 offen offset:2112 lds
    v_mfma_f32_16x16x32_bf16 v[108:111], a[152:155], v[140:143], v[108:111]
    s_add_u32 s40, s40, s41
    s_lshl_b32 s93, s40, 4
    v_mfma_f32_16x16x32_bf16 v[112:115], a[156:159], v[128:131], v[112:115]
    ds_read_b64_tr_b16 a[140:141], v238 offset:96
    ds_read_b64_tr_b16 a[142:143], v238 offset:352
    v_mfma_f32_16x16x32_bf16 v[116:119], a[156:159], v[132:135], v[116:119]
    s_add_u32 s93, s93, 53248
    s_mul_i32 s40, s40, 7168
    v_mfma_f32_16x16x32_bf16 v[120:123], a[156:159], v[136:139], v[120:123]
    s_add_u32 s28, s28, 262144
    buffer_load_dwordx4 v233, s[16:19], s29 offen offset:3168 lds
    v_mfma_f32_16x16x32_bf16 v[124:127], a[156:159], v[140:143], v[124:127]
    s_waitcnt lgkmcnt(4)
    s_add_u32 s29, s29, 262144
    v_mfma_f32_16x16x32_bf16 v[0:3], a[128:131], v[144:147], v[0:3]
    ds_read_b64_tr_b16 a[144:145], v238 offset:128
    ds_read_b64_tr_b16 a[146:147], v238 offset:384
    v_mfma_f32_16x16x32_bf16 v[4:7], a[128:131], v[148:151], v[4:7]
    s_add_u32 m0, s32, 67584
    v_mfma_f32_16x16x32_bf16 v[8:11], a[128:131], v[152:155], v[8:11]
    buffer_load_dwordx4 v230, s[16:19], s28 offen offset:0 lds
    v_mfma_f32_16x16x32_bf16 v[12:15], a[128:131], v[156:159], v[12:15]
    s_lshl_b32 s92, s40, 2
    s_add_u32 s92, s92, 12582912
    v_mfma_f32_16x16x32_bf16 v[16:19], a[132:135], v[144:147], v[16:19]
    ds_read_b64_tr_b16 a[148:149], v238 offset:160
    ds_read_b64_tr_b16 a[150:151], v238 offset:416
    v_mfma_f32_16x16x32_bf16 v[20:23], a[132:135], v[148:151], v[20:23]
    s_add_u32 s94, s40, 10485760
    s_add_u32 s95, s94, 3072
    v_mfma_f32_16x16x32_bf16 v[24:27], a[132:135], v[152:155], v[24:27]
    buffer_load_dwordx4 v231, s[16:19], s28 offen offset:1056 lds
    v_mfma_f32_16x16x32_bf16 v[28:31], a[132:135], v[156:159], v[28:31]
    s_waitcnt lgkmcnt(4)
    v_mfma_f32_16x16x32_bf16 v[32:35], a[136:139], v[144:147], v[32:35]
    ds_read_b64_tr_b16 a[152:153], v238 offset:192
    ds_read_b64_tr_b16 a[154:155], v238 offset:448
    v_mfma_f32_16x16x32_bf16 v[36:39], a[136:139], v[148:151], v[36:39]
    s_add_u32 s96, s40, 8402944
    s_add_u32 s97, s96, 3072
    v_mfma_f32_16x16x32_bf16 v[40:43], a[136:139], v[152:155], v[40:43]
    buffer_load_dwordx4 v232, s[16:19], s28 offen offset:2112 lds
    v_mfma_f32_16x16x32_bf16 v[44:47], a[136:139], v[156:159], v[44:47]
    s_mov_b32 s4, s54
    s_mov_b32 s5, s55
    v_mfma_f32_16x16x32_bf16 v[48:51], a[140:143], v[144:147], v[48:51]
    ds_read_b64_tr_b16 a[156:157], v238 offset:224
    ds_read_b64_tr_b16 a[158:159], v238 offset:480
    v_mfma_f32_16x16x32_bf16 v[52:55], a[140:143], v[148:151], v[52:55]
    s_mov_b32 s6, 0
    s_mov_b32 s7, 0x20000
    v_mfma_f32_16x16x32_bf16 v[56:59], a[140:143], v[152:155], v[56:59]
    s_waitcnt vmcnt(3)
    buffer_load_dwordx4 v233, s[16:19], s28 offen offset:3168 lds
    v_mfma_f32_16x16x32_bf16 v[60:63], a[140:143], v[156:159], v[60:63]
    s_waitcnt lgkmcnt(4)
    v_mfma_f32_16x16x32_bf16 v[64:67], a[144:147], v[144:147], v[64:67]
    ds_read_b64_tr_b16 a[128:129], v238 offset:33792
    ds_read_b64_tr_b16 a[130:131], v238 offset:34048
    v_mfma_f32_16x16x32_bf16 v[68:71], a[144:147], v[148:151], v[68:71]
    s_add_u32 m0, s32, 71808
    ds_read_b128 v[128:131], v239 offset:4096
    v_mfma_f32_16x16x32_bf16 v[72:75], a[144:147], v[152:155], v[72:75]
    buffer_load_dwordx4 v230, s[16:19], s29 offen offset:0 lds
    v_mfma_f32_16x16x32_bf16 v[76:79], a[144:147], v[156:159], v[76:79]
    ds_read_b128 v[132:135], v239 offset:18432
    v_mfma_f32_16x16x32_bf16 v[80:83], a[148:151], v[144:147], v[80:83]
    ds_read_b64_tr_b16 a[132:133], v238 offset:33824
    ds_read_b64_tr_b16 a[134:135], v238 offset:34080
    v_mfma_f32_16x16x32_bf16 v[84:87], a[148:151], v[148:151], v[84:87]
    ds_read_b128 v[136:139], v239 offset:32768
    v_mfma_f32_16x16x32_bf16 v[88:91], a[148:151], v[152:155], v[88:91]
    buffer_load_dwordx4 v231, s[16:19], s29 offen offset:1056 lds
    v_mfma_f32_16x16x32_bf16 v[92:95], a[148:151], v[156:159], v[92:95]
    s_waitcnt lgkmcnt(7)
    ds_read_b128 v[140:143], v239 offset:47104
    v_mfma_f32_16x16x32_bf16 v[96:99], a[152:155], v[144:147], v[96:99]
    ds_read_b64_tr_b16 a[136:137], v238 offset:33856
    ds_read_b64_tr_b16 a[138:139], v238 offset:34112
    v_mfma_f32_16x16x32_bf16 v[100:103], a[152:155], v[148:151], v[100:103]
    v_mfma_f32_16x16x32_bf16 v[104:107], a[152:155], v[152:155], v[104:107]
    buffer_load_dwordx4 v232, s[16:19], s29 offen offset:2112 lds
    v_mfma_f32_16x16x32_bf16 v[108:111], a[152:155], v[156:159], v[108:111]
    v_mfma_f32_16x16x32_bf16 v[112:115], a[156:159], v[144:147], v[112:115]
    ds_read_b64_tr_b16 a[140:141], v238 offset:33888
    ds_read_b64_tr_b16 a[142:143], v238 offset:34144
    v_mfma_f32_16x16x32_bf16 v[116:119], a[156:159], v[148:151], v[116:119]
    v_mfma_f32_16x16x32_bf16 v[120:123], a[156:159], v[152:155], v[120:123]
    s_add_u32 s28, s28, 262144
    buffer_load_dwordx4 v233, s[16:19], s29 offen offset:3168 lds
    v_mfma_f32_16x16x32_bf16 v[124:127], a[156:159], v[156:159], v[124:127]
    s_waitcnt lgkmcnt(4)
    s_add_u32 s29, s29, 262144
    v_mfma_f32_16x16x32_bf16 v[0:3], a[128:131], v[128:131], v[0:3]
    ds_read_b64_tr_b16 a[144:145], v238 offset:33920
    ds_read_b64_tr_b16 a[146:147], v238 offset:34176
    v_mfma_f32_16x16x32_bf16 v[4:7], a[128:131], v[132:135], v[4:7]
    s_add_u32 m0, s32, 0
    v_mfma_f32_16x16x32_bf16 v[8:11], a[128:131], v[136:139], v[8:11]
    buffer_load_dwordx4 v230, s[16:19], s28 offen offset:0 lds
    v_mfma_f32_16x16x32_bf16 v[12:15], a[128:131], v[140:143], v[12:15]
    v_mfma_f32_16x16x32_bf16 v[16:19], a[132:135], v[128:131], v[16:19]
    ds_read_b64_tr_b16 a[148:149], v238 offset:33952
    ds_read_b64_tr_b16 a[150:151], v238 offset:34208
    v_mfma_f32_16x16x32_bf16 v[20:23], a[132:135], v[132:135], v[20:23]
    v_mfma_f32_16x16x32_bf16 v[24:27], a[132:135], v[136:139], v[24:27]
    buffer_load_dwordx4 v231, s[16:19], s28 offen offset:1056 lds
    v_mfma_f32_16x16x32_bf16 v[28:31], a[132:135], v[140:143], v[28:31]
    s_waitcnt lgkmcnt(4)
    v_mfma_f32_16x16x32_bf16 v[32:35], a[136:139], v[128:131], v[32:35]
    ds_read_b64_tr_b16 a[152:153], v238 offset:33984
    ds_read_b64_tr_b16 a[154:155], v238 offset:34240
    v_mfma_f32_16x16x32_bf16 v[36:39], a[136:139], v[132:135], v[36:39]
    v_mfma_f32_16x16x32_bf16 v[40:43], a[136:139], v[136:139], v[40:43]
    buffer_load_dwordx4 v232, s[16:19], s28 offen offset:2112 lds
    v_mfma_f32_16x16x32_bf16 v[44:47], a[136:139], v[140:143], v[44:47]
    v_mfma_f32_16x16x32_bf16 v[48:51], a[140:143], v[128:131], v[48:51]
    ds_read_b64_tr_b16 a[156:157], v238 offset:34016
    ds_read_b64_tr_b16 a[158:159], v238 offset:34272
    v_mfma_f32_16x16x32_bf16 v[52:55], a[140:143], v[132:135], v[52:55]
    v_mfma_f32_16x16x32_bf16 v[56:59], a[140:143], v[136:139], v[56:59]
    s_waitcnt vmcnt(3)
    buffer_load_dwordx4 v233, s[16:19], s28 offen offset:3168 lds
    v_mfma_f32_16x16x32_bf16 v[60:63], a[140:143], v[140:143], v[60:63]
    s_waitcnt lgkmcnt(4)
    v_mfma_f32_16x16x32_bf16 v[64:67], a[144:147], v[128:131], v[64:67]
    ds_read_b64_tr_b16 a[128:129], v247 offset:0
    ds_read_b64_tr_b16 a[130:131], v247 offset:256
    v_mfma_f32_16x16x32_bf16 v[68:71], a[144:147], v[132:135], v[68:71]
    s_add_u32 m0, s32, 4224
    ds_read_b128 v[144:147], v248 offset:5120
    v_mfma_f32_16x16x32_bf16 v[72:75], a[144:147], v[136:139], v[72:75]
    buffer_load_dwordx4 v230, s[16:19], s29 offen offset:0 lds
    v_mfma_f32_16x16x32_bf16 v[76:79], a[144:147], v[140:143], v[76:79]
    ds_read_b128 v[148:151], v248 offset:19456
    v_mfma_f32_16x16x32_bf16 v[80:83], a[148:151], v[128:131], v[80:83]
    ds_read_b64_tr_b16 a[132:133], v247 offset:32
    ds_read_b64_tr_b16 a[134:135], v247 offset:288
    v_mfma_f32_16x16x32_bf16 v[84:87], a[148:151], v[132:135], v[84:87]
    ds_read_b128 v[152:155], v248 offset:33792
    v_mfma_f32_16x16x32_bf16 v[88:91], a[148:151], v[136:139], v[88:91]
    buffer_load_dwordx4 v231, s[16:19], s29 offen offset:1056 lds
    v_mfma_f32_16x16x32_bf16 v[92:95], a[148:151], v[140:143], v[92:95]
    s_waitcnt lgkmcnt(7)
    ds_read_b128 v[156:159], v248 offset:48128
    v_mfma_f32_16x16x32_bf16 v[96:99], a[152:155], v[128:131], v[96:99]
    ds_read_b64_tr_b16 a[136:137], v247 offset:64
    ds_read_b64_tr_b16 a[138:139], v247 offset:320
    v_mfma_f32_16x16x32_bf16 v[100:103], a[152:155], v[132:135], v[100:103]
    v_mfma_f32_16x16x32_bf16 v[104:107], a[152:155], v[136:139], v[104:107]
    buffer_load_dwordx4 v232, s[16:19], s29 offen offset:2112 lds
    v_mfma_f32_16x16x32_bf16 v[108:111], a[152:155], v[140:143], v[108:111]
    v_mfma_f32_16x16x32_bf16 v[112:115], a[156:159], v[128:131], v[112:115]
    ds_read_b64_tr_b16 a[140:141], v247 offset:96
    ds_read_b64_tr_b16 a[142:143], v247 offset:352
    v_mfma_f32_16x16x32_bf16 v[116:119], a[156:159], v[132:135], v[116:119]
    v_mfma_f32_16x16x32_bf16 v[120:123], a[156:159], v[136:139], v[120:123]
    s_add_u32 s28, s28, 262144
    buffer_load_dwordx4 v233, s[16:19], s29 offen offset:3168 lds
    v_mfma_f32_16x16x32_bf16 v[124:127], a[156:159], v[140:143], v[124:127]
    s_waitcnt lgkmcnt(4)
    s_add_u32 s29, s29, 262144
    v_mfma_f32_16x16x32_bf16 v[0:3], a[128:131], v[144:147], v[0:3]
    ds_read_b64_tr_b16 a[144:145], v247 offset:128
    ds_read_b64_tr_b16 a[146:147], v247 offset:384
    v_mfma_f32_16x16x32_bf16 v[4:7], a[128:131], v[148:151], v[4:7]
    s_add_u32 m0, s32, 33792
    v_mfma_f32_16x16x32_bf16 v[8:11], a[128:131], v[152:155], v[8:11]
    buffer_load_dwordx4 v230, s[16:19], s28 offen offset:0 lds
    v_mfma_f32_16x16x32_bf16 v[12:15], a[128:131], v[156:159], v[12:15]
    v_mfma_f32_16x16x32_bf16 v[16:19], a[132:135], v[144:147], v[16:19]
    ds_read_b64_tr_b16 a[148:149], v247 offset:160
    ds_read_b64_tr_b16 a[150:151], v247 offset:416
    v_mfma_f32_16x16x32_bf16 v[20:23], a[132:135], v[148:151], v[20:23]
    v_mfma_f32_16x16x32_bf16 v[24:27], a[132:135], v[152:155], v[24:27]
    buffer_load_dwordx4 v231, s[16:19], s28 offen offset:1056 lds
    v_mfma_f32_16x16x32_bf16 v[28:31], a[132:135], v[156:159], v[28:31]
    s_waitcnt lgkmcnt(4)
    v_mfma_f32_16x16x32_bf16 v[32:35], a[136:139], v[144:147], v[32:35]
    ds_read_b64_tr_b16 a[152:153], v247 offset:192
    ds_read_b64_tr_b16 a[154:155], v247 offset:448
    v_mfma_f32_16x16x32_bf16 v[36:39], a[136:139], v[148:151], v[36:39]
    v_mfma_f32_16x16x32_bf16 v[40:43], a[136:139], v[152:155], v[40:43]
    buffer_load_dwordx4 v232, s[16:19], s28 offen offset:2112 lds
    v_mfma_f32_16x16x32_bf16 v[44:47], a[136:139], v[156:159], v[44:47]
    v_mfma_f32_16x16x32_bf16 v[48:51], a[140:143], v[144:147], v[48:51]
    ds_read_b64_tr_b16 a[156:157], v247 offset:224
    ds_read_b64_tr_b16 a[158:159], v247 offset:480
    v_mfma_f32_16x16x32_bf16 v[52:55], a[140:143], v[148:151], v[52:55]
    v_mfma_f32_16x16x32_bf16 v[56:59], a[140:143], v[152:155], v[56:59]
    s_waitcnt vmcnt(3)
    buffer_load_dwordx4 v233, s[16:19], s28 offen offset:3168 lds
    v_mfma_f32_16x16x32_bf16 v[60:63], a[140:143], v[156:159], v[60:63]
    s_waitcnt lgkmcnt(4)
    v_mfma_f32_16x16x32_bf16 v[64:67], a[144:147], v[144:147], v[64:67]
    ds_read_b64_tr_b16 a[128:129], v238 offset:0
    ds_read_b64_tr_b16 a[130:131], v238 offset:256
    v_mfma_f32_16x16x32_bf16 v[68:71], a[144:147], v[148:151], v[68:71]
    s_add_u32 m0, s32, 38016
    ds_read_b128 v[128:131], v239 offset:6144
    v_mfma_f32_16x16x32_bf16 v[72:75], a[144:147], v[152:155], v[72:75]
    buffer_load_dwordx4 v230, s[16:19], s29 offen offset:0 lds
    v_mfma_f32_16x16x32_bf16 v[76:79], a[144:147], v[156:159], v[76:79]
    ds_read_b128 v[132:135], v239 offset:20480
    v_mfma_f32_16x16x32_bf16 v[80:83], a[148:151], v[144:147], v[80:83]
    ds_read_b64_tr_b16 a[132:133], v238 offset:32
    ds_read_b64_tr_b16 a[134:135], v238 offset:288
    v_mfma_f32_16x16x32_bf16 v[84:87], a[148:151], v[148:151], v[84:87]
    ds_read_b128 v[136:139], v239 offset:34816
    v_mfma_f32_16x16x32_bf16 v[88:91], a[148:151], v[152:155], v[88:91]
    buffer_load_dwordx4 v231, s[16:19], s29 offen offset:1056 lds
    v_mfma_f32_16x16x32_bf16 v[92:95], a[148:151], v[156:159], v[92:95]
    s_waitcnt lgkmcnt(7)
    ds_read_b128 v[140:143], v239 offset:49152
    v_mfma_f32_16x16x32_bf16 v[96:99], a[152:155], v[144:147], v[96:99]
    ds_read_b64_tr_b16 a[136:137], v238 offset:64
    ds_read_b64_tr_b16 a[138:139], v238 offset:320
    v_mfma_f32_16x16x32_bf16 v[100:103], a[152:155], v[148:151], v[100:103]
    v_mfma_f32_16x16x32_bf16 v[104:107], a[152:155], v[152:155], v[104:107]
    buffer_load_dwordx4 v232, s[16:19], s29 offen offset:2112 lds
    v_mfma_f32_16x16x32_bf16 v[108:111], a[152:155], v[156:159], v[108:111]
    v_mfma_f32_16x16x32_bf16 v[112:115], a[156:159], v[144:147], v[112:115]
    ds_read_b64_tr_b16 a[140:141], v238 offset:96
    ds_read_b64_tr_b16 a[142:143], v238 offset:352
    v_mfma_f32_16x16x32_bf16 v[116:119], a[156:159], v[148:151], v[116:119]
    v_mfma_f32_16x16x32_bf16 v[120:123], a[156:159], v[152:155], v[120:123]
    s_add_u32 s28, s28, 262144
    buffer_load_dwordx4 v233, s[16:19], s29 offen offset:3168 lds
    v_mfma_f32_16x16x32_bf16 v[124:127], a[156:159], v[156:159], v[124:127]
    s_waitcnt lgkmcnt(4)
    s_add_u32 s29, s29, 262144
    v_mfma_f32_16x16x32_bf16 v[0:3], a[128:131], v[128:131], v[0:3]
    ds_read_b64_tr_b16 a[144:145], v238 offset:128
    ds_read_b64_tr_b16 a[146:147], v238 offset:384
    v_mfma_f32_16x16x32_bf16 v[4:7], a[128:131], v[132:135], v[4:7]
    s_add_u32 m0, s32, 67584
    v_mfma_f32_16x16x32_bf16 v[8:11], a[128:131], v[136:139], v[8:11]
    buffer_load_dwordx4 v230, s[16:19], s28 offen offset:0 lds
    v_mfma_f32_16x16x32_bf16 v[12:15], a[128:131], v[140:143], v[12:15]
    v_mfma_f32_16x16x32_bf16 v[16:19], a[132:135], v[128:131], v[16:19]
    ds_read_b64_tr_b16 a[148:149], v238 offset:160
    ds_read_b64_tr_b16 a[150:151], v238 offset:416
    v_mfma_f32_16x16x32_bf16 v[20:23], a[132:135], v[132:135], v[20:23]
    v_mfma_f32_16x16x32_bf16 v[24:27], a[132:135], v[136:139], v[24:27]
    buffer_load_dwordx4 v231, s[16:19], s28 offen offset:1056 lds
    v_mfma_f32_16x16x32_bf16 v[28:31], a[132:135], v[140:143], v[28:31]
    s_waitcnt lgkmcnt(4)
    v_mfma_f32_16x16x32_bf16 v[32:35], a[136:139], v[128:131], v[32:35]
    ds_read_b64_tr_b16 a[152:153], v238 offset:192
    ds_read_b64_tr_b16 a[154:155], v238 offset:448
    v_mfma_f32_16x16x32_bf16 v[36:39], a[136:139], v[132:135], v[36:39]
    v_mfma_f32_16x16x32_bf16 v[40:43], a[136:139], v[136:139], v[40:43]
    buffer_load_dwordx4 v232, s[16:19], s28 offen offset:2112 lds
    v_mfma_f32_16x16x32_bf16 v[44:47], a[136:139], v[140:143], v[44:47]
    v_mfma_f32_16x16x32_bf16 v[48:51], a[140:143], v[128:131], v[48:51]
    ds_read_b64_tr_b16 a[156:157], v238 offset:224
    ds_read_b64_tr_b16 a[158:159], v238 offset:480
    v_mfma_f32_16x16x32_bf16 v[52:55], a[140:143], v[132:135], v[52:55]
    v_mfma_f32_16x16x32_bf16 v[56:59], a[140:143], v[136:139], v[56:59]
    s_waitcnt vmcnt(3)
    buffer_load_dwordx4 v233, s[16:19], s28 offen offset:3168 lds
    v_mfma_f32_16x16x32_bf16 v[60:63], a[140:143], v[140:143], v[60:63]
    s_waitcnt lgkmcnt(4)
    v_mfma_f32_16x16x32_bf16 v[64:67], a[144:147], v[128:131], v[64:67]
    ds_read_b64_tr_b16 a[128:129], v238 offset:33792
    ds_read_b64_tr_b16 a[130:131], v238 offset:34048
    v_mfma_f32_16x16x32_bf16 v[68:71], a[144:147], v[132:135], v[68:71]
    s_add_u32 m0, s32, 71808
    ds_read_b128 v[144:147], v248 offset:7168
    v_mfma_f32_16x16x32_bf16 v[72:75], a[144:147], v[136:139], v[72:75]
    buffer_load_dwordx4 v230, s[16:19], s29 offen offset:0 lds
    v_mfma_f32_16x16x32_bf16 v[76:79], a[144:147], v[140:143], v[76:79]
    ds_read_b128 v[148:151], v248 offset:21504
    v_mfma_f32_16x16x32_bf16 v[80:83], a[148:151], v[128:131], v[80:83]
    ds_read_b64_tr_b16 a[132:133], v238 offset:33824
    ds_read_b64_tr_b16 a[134:135], v238 offset:34080
    v_mfma_f32_16x16x32_bf16 v[84:87], a[148:151], v[132:135], v[84:87]
    ds_read_b128 v[152:155], v248 offset:35840
    v_mfma_f32_16x16x32_bf16 v[88:91], a[148:151], v[136:139], v[88:91]
    buffer_load_dwordx4 v231, s[16:19], s29 offen offset:1056 lds
    v_mfma_f32_16x16x32_bf16 v[92:95], a[148:151], v[140:143], v[92:95]
    s_waitcnt lgkmcnt(7)
    ds_read_b128 v[156:159], v248 offset:50176
    v_mfma_f32_16x16x32_bf16 v[96:99], a[152:155], v[128:131], v[96:99]
    ds_read_b64_tr_b16 a[136:137], v238 offset:33856
    ds_read_b64_tr_b16 a[138:139], v238 offset:34112
    v_mfma_f32_16x16x32_bf16 v[100:103], a[152:155], v[132:135], v[100:103]
    v_mfma_f32_16x16x32_bf16 v[104:107], a[152:155], v[136:139], v[104:107]
    buffer_load_dwordx4 v232, s[16:19], s29 offen offset:2112 lds
    v_mfma_f32_16x16x32_bf16 v[108:111], a[152:155], v[140:143], v[108:111]
    v_mfma_f32_16x16x32_bf16 v[112:115], a[156:159], v[128:131], v[112:115]
    ds_read_b64_tr_b16 a[140:141], v238 offset:33888
    ds_read_b64_tr_b16 a[142:143], v238 offset:34144
    v_mfma_f32_16x16x32_bf16 v[116:119], a[156:159], v[132:135], v[116:119]
    v_mfma_f32_16x16x32_bf16 v[120:123], a[156:159], v[136:139], v[120:123]
    s_add_u32 s28, s28, 262144
    buffer_load_dwordx4 v233, s[16:19], s29 offen offset:3168 lds
    v_mfma_f32_16x16x32_bf16 v[124:127], a[156:159], v[140:143], v[124:127]
    s_waitcnt lgkmcnt(4)
    s_add_u32 s29, s29, 262144
    v_mfma_f32_16x16x32_bf16 v[0:3], a[128:131], v[144:147], v[0:3]
    ds_read_b64_tr_b16 a[144:145], v238 offset:33920
    ds_read_b64_tr_b16 a[146:147], v238 offset:34176
    v_mfma_f32_16x16x32_bf16 v[4:7], a[128:131], v[148:151], v[4:7]
    s_add_u32 m0, s32, 0
    v_mfma_f32_16x16x32_bf16 v[8:11], a[128:131], v[152:155], v[8:11]
    buffer_load_dwordx4 v230, s[16:19], s28 offen offset:0 lds
    v_mfma_f32_16x16x32_bf16 v[12:15], a[128:131], v[156:159], v[12:15]
    v_mfma_f32_16x16x32_bf16 v[16:19], a[132:135], v[144:147], v[16:19]
    ds_read_b64_tr_b16 a[148:149], v238 offset:33952
    ds_read_b64_tr_b16 a[150:151], v238 offset:34208
    v_mfma_f32_16x16x32_bf16 v[20:23], a[132:135], v[148:151], v[20:23]
    v_mfma_f32_16x16x32_bf16 v[24:27], a[132:135], v[152:155], v[24:27]
    buffer_load_dwordx4 v231, s[16:19], s28 offen offset:1056 lds
    v_mfma_f32_16x16x32_bf16 v[28:31], a[132:135], v[156:159], v[28:31]
    s_waitcnt lgkmcnt(4)
    v_mfma_f32_16x16x32_bf16 v[32:35], a[136:139], v[144:147], v[32:35]
    ds_read_b64_tr_b16 a[152:153], v238 offset:33984
    ds_read_b64_tr_b16 a[154:155], v238 offset:34240
    v_mfma_f32_16x16x32_bf16 v[36:39], a[136:139], v[148:151], v[36:39]
    v_mfma_f32_16x16x32_bf16 v[40:43], a[136:139], v[152:155], v[40:43]
    buffer_load_dwordx4 v232, s[16:19], s28 offen offset:2112 lds
    v_mfma_f32_16x16x32_bf16 v[44:47], a[136:139], v[156:159], v[44:47]
    v_mfma_f32_16x16x32_bf16 v[48:51], a[140:143], v[144:147], v[48:51]
    ds_read_b64_tr_b16 a[156:157], v238 offset:34016
    ds_read_b64_tr_b16 a[158:159], v238 offset:34272
    v_mfma_f32_16x16x32_bf16 v[52:55], a[140:143], v[148:151], v[52:55]
    v_mfma_f32_16x16x32_bf16 v[56:59], a[140:143], v[152:155], v[56:59]
    s_waitcnt vmcnt(3)
    buffer_load_dwordx4 v233, s[16:19], s28 offen offset:3168 lds
    v_mfma_f32_16x16x32_bf16 v[60:63], a[140:143], v[156:159], v[60:63]
    s_waitcnt lgkmcnt(4)
    v_mfma_f32_16x16x32_bf16 v[64:67], a[144:147], v[144:147], v[64:67]
    ds_read_b64_tr_b16 a[128:129], v247 offset:0
    ds_read_b64_tr_b16 a[130:131], v247 offset:256
    v_mfma_f32_16x16x32_bf16 v[68:71], a[144:147], v[148:151], v[68:71]
    s_add_u32 m0, s32, 4224
    ds_read_b128 v[128:131], v239 offset:8192
    v_mfma_f32_16x16x32_bf16 v[72:75], a[144:147], v[152:155], v[72:75]
    buffer_load_dwordx4 v230, s[16:19], s29 offen offset:0 lds
    v_mfma_f32_16x16x32_bf16 v[76:79], a[144:147], v[156:159], v[76:79]
    ds_read_b128 v[132:135], v239 offset:22528
    v_mfma_f32_16x16x32_bf16 v[80:83], a[148:151], v[144:147], v[80:83]
    ds_read_b64_tr_b16 a[132:133], v247 offset:32
    ds_read_b64_tr_b16 a[134:135], v247 offset:288
    v_mfma_f32_16x16x32_bf16 v[84:87], a[148:151], v[148:151], v[84:87]
    ds_read_b128 v[136:139], v239 offset:36864
    v_mfma_f32_16x16x32_bf16 v[88:91], a[148:151], v[152:155], v[88:91]
    buffer_load_dwordx4 v231, s[16:19], s29 offen offset:1056 lds
    v_mfma_f32_16x16x32_bf16 v[92:95], a[148:151], v[156:159], v[92:95]
    s_waitcnt lgkmcnt(7)
    ds_read_b128 v[140:143], v239 offset:51200
    v_mfma_f32_16x16x32_bf16 v[96:99], a[152:155], v[144:147], v[96:99]
    ds_read_b64_tr_b16 a[136:137], v247 offset:64
    ds_read_b64_tr_b16 a[138:139], v247 offset:320
    v_mfma_f32_16x16x32_bf16 v[100:103], a[152:155], v[148:151], v[100:103]
    v_mfma_f32_16x16x32_bf16 v[104:107], a[152:155], v[152:155], v[104:107]
    buffer_load_dwordx4 v232, s[16:19], s29 offen offset:2112 lds
    v_mfma_f32_16x16x32_bf16 v[108:111], a[152:155], v[156:159], v[108:111]
    v_mfma_f32_16x16x32_bf16 v[112:115], a[156:159], v[144:147], v[112:115]
    ds_read_b64_tr_b16 a[140:141], v247 offset:96
    ds_read_b64_tr_b16 a[142:143], v247 offset:352
    v_mfma_f32_16x16x32_bf16 v[116:119], a[156:159], v[148:151], v[116:119]
    v_mfma_f32_16x16x32_bf16 v[120:123], a[156:159], v[152:155], v[120:123]
    s_add_u32 s28, s28, 262144
    buffer_load_dwordx4 v233, s[16:19], s29 offen offset:3168 lds
    v_mfma_f32_16x16x32_bf16 v[124:127], a[156:159], v[156:159], v[124:127]
    s_waitcnt lgkmcnt(4)
    s_add_u32 s29, s29, 262144
    v_mfma_f32_16x16x32_bf16 v[0:3], a[128:131], v[128:131], v[0:3]
    ds_read_b64_tr_b16 a[144:145], v247 offset:128
    ds_read_b64_tr_b16 a[146:147], v247 offset:384
    v_mfma_f32_16x16x32_bf16 v[4:7], a[128:131], v[132:135], v[4:7]
    s_add_u32 m0, s32, 33792
    v_mfma_f32_16x16x32_bf16 v[8:11], a[128:131], v[136:139], v[8:11]
    buffer_load_dwordx4 v230, s[16:19], s28 offen offset:0 lds
    v_mfma_f32_16x16x32_bf16 v[12:15], a[128:131], v[140:143], v[12:15]
    v_mfma_f32_16x16x32_bf16 v[16:19], a[132:135], v[128:131], v[16:19]
    ds_read_b64_tr_b16 a[148:149], v247 offset:160
    ds_read_b64_tr_b16 a[150:151], v247 offset:416
    v_mfma_f32_16x16x32_bf16 v[20:23], a[132:135], v[132:135], v[20:23]
    v_mfma_f32_16x16x32_bf16 v[24:27], a[132:135], v[136:139], v[24:27]
    buffer_load_dwordx4 v231, s[16:19], s28 offen offset:1056 lds
    v_mfma_f32_16x16x32_bf16 v[28:31], a[132:135], v[140:143], v[28:31]
    s_waitcnt lgkmcnt(4)
    v_mfma_f32_16x16x32_bf16 v[32:35], a[136:139], v[128:131], v[32:35]
    ds_read_b64_tr_b16 a[152:153], v247 offset:192
    ds_read_b64_tr_b16 a[154:155], v247 offset:448
    v_mfma_f32_16x16x32_bf16 v[36:39], a[136:139], v[132:135], v[36:39]
    v_mfma_f32_16x16x32_bf16 v[40:43], a[136:139], v[136:139], v[40:43]
    buffer_load_dwordx4 v232, s[16:19], s28 offen offset:2112 lds
    v_mfma_f32_16x16x32_bf16 v[44:47], a[136:139], v[140:143], v[44:47]
    v_mfma_f32_16x16x32_bf16 v[48:51], a[140:143], v[128:131], v[48:51]
    ds_read_b64_tr_b16 a[156:157], v247 offset:224
    ds_read_b64_tr_b16 a[158:159], v247 offset:480
    v_mfma_f32_16x16x32_bf16 v[52:55], a[140:143], v[132:135], v[52:55]
    v_mfma_f32_16x16x32_bf16 v[56:59], a[140:143], v[136:139], v[56:59]
    s_waitcnt vmcnt(3)
    buffer_load_dwordx4 v233, s[16:19], s28 offen offset:3168 lds
    v_mfma_f32_16x16x32_bf16 v[60:63], a[140:143], v[140:143], v[60:63]
    s_waitcnt lgkmcnt(4)
    v_mfma_f32_16x16x32_bf16 v[64:67], a[144:147], v[128:131], v[64:67]
    ds_read_b64_tr_b16 a[128:129], v238 offset:0
    ds_read_b64_tr_b16 a[130:131], v238 offset:256
    v_mfma_f32_16x16x32_bf16 v[68:71], a[144:147], v[132:135], v[68:71]
    s_add_u32 m0, s32, 38016
    ds_read_b128 v[144:147], v248 offset:9216
    v_mfma_f32_16x16x32_bf16 v[72:75], a[144:147], v[136:139], v[72:75]
    buffer_load_dwordx4 v230, s[16:19], s29 offen offset:0 lds
    v_mfma_f32_16x16x32_bf16 v[76:79], a[144:147], v[140:143], v[76:79]
    ds_read_b128 v[148:151], v248 offset:23552
    v_mfma_f32_16x16x32_bf16 v[80:83], a[148:151], v[128:131], v[80:83]
    ds_read_b64_tr_b16 a[132:133], v238 offset:32
    ds_read_b64_tr_b16 a[134:135], v238 offset:288
    v_mfma_f32_16x16x32_bf16 v[84:87], a[148:151], v[132:135], v[84:87]
    ds_read_b128 v[152:155], v248 offset:37888
    v_mfma_f32_16x16x32_bf16 v[88:91], a[148:151], v[136:139], v[88:91]
    buffer_load_dwordx4 v231, s[16:19], s29 offen offset:1056 lds
    v_mfma_f32_16x16x32_bf16 v[92:95], a[148:151], v[140:143], v[92:95]
    s_waitcnt lgkmcnt(7)
    ds_read_b128 v[156:159], v248 offset:52224
    v_mfma_f32_16x16x32_bf16 v[96:99], a[152:155], v[128:131], v[96:99]
    ds_read_b64_tr_b16 a[136:137], v238 offset:64
    ds_read_b64_tr_b16 a[138:139], v238 offset:320
    v_mfma_f32_16x16x32_bf16 v[100:103], a[152:155], v[132:135], v[100:103]
    v_mfma_f32_16x16x32_bf16 v[104:107], a[152:155], v[136:139], v[104:107]
    buffer_load_dwordx4 v232, s[16:19], s29 offen offset:2112 lds
    v_mfma_f32_16x16x32_bf16 v[108:111], a[152:155], v[140:143], v[108:111]
    v_mfma_f32_16x16x32_bf16 v[112:115], a[156:159], v[128:131], v[112:115]
    ds_read_b64_tr_b16 a[140:141], v238 offset:96
    ds_read_b64_tr_b16 a[142:143], v238 offset:352
    v_mfma_f32_16x16x32_bf16 v[116:119], a[156:159], v[132:135], v[116:119]
    v_mfma_f32_16x16x32_bf16 v[120:123], a[156:159], v[136:139], v[120:123]
    s_add_u32 s28, s28, 262144
    buffer_load_dwordx4 v233, s[16:19], s29 offen offset:3168 lds
    v_mfma_f32_16x16x32_bf16 v[124:127], a[156:159], v[140:143], v[124:127]
    s_waitcnt lgkmcnt(4)
    s_add_u32 s29, s29, 262144
    v_mfma_f32_16x16x32_bf16 v[0:3], a[128:131], v[144:147], v[0:3]
    ds_read_b64_tr_b16 a[144:145], v238 offset:128
    ds_read_b64_tr_b16 a[146:147], v238 offset:384
    v_mfma_f32_16x16x32_bf16 v[4:7], a[128:131], v[148:151], v[4:7]
    s_add_u32 m0, s32, 67584
    v_mfma_f32_16x16x32_bf16 v[8:11], a[128:131], v[152:155], v[8:11]
    buffer_load_dwordx4 v230, s[16:19], s28 offen offset:0 lds
    v_mfma_f32_16x16x32_bf16 v[12:15], a[128:131], v[156:159], v[12:15]
    v_mfma_f32_16x16x32_bf16 v[16:19], a[132:135], v[144:147], v[16:19]
    ds_read_b64_tr_b16 a[148:149], v238 offset:160
    ds_read_b64_tr_b16 a[150:151], v238 offset:416
    v_mfma_f32_16x16x32_bf16 v[20:23], a[132:135], v[148:151], v[20:23]
    v_mfma_f32_16x16x32_bf16 v[24:27], a[132:135], v[152:155], v[24:27]
    buffer_load_dwordx4 v231, s[16:19], s28 offen offset:1056 lds
    v_mfma_f32_16x16x32_bf16 v[28:31], a[132:135], v[156:159], v[28:31]
    s_waitcnt lgkmcnt(4)
    v_mfma_f32_16x16x32_bf16 v[32:35], a[136:139], v[144:147], v[32:35]
    ds_read_b64_tr_b16 a[152:153], v238 offset:192
    ds_read_b64_tr_b16 a[154:155], v238 offset:448
    v_mfma_f32_16x16x32_bf16 v[36:39], a[136:139], v[148:151], v[36:39]
    v_mfma_f32_16x16x32_bf16 v[40:43], a[136:139], v[152:155], v[40:43]
    buffer_load_dwordx4 v232, s[16:19], s28 offen offset:2112 lds
    v_mfma_f32_16x16x32_bf16 v[44:47], a[136:139], v[156:159], v[44:47]
    v_mfma_f32_16x16x32_bf16 v[48:51], a[140:143], v[144:147], v[48:51]
    ds_read_b64_tr_b16 a[156:157], v238 offset:224
    ds_read_b64_tr_b16 a[158:159], v238 offset:480
    v_mfma_f32_16x16x32_bf16 v[52:55], a[140:143], v[148:151], v[52:55]
    v_mfma_f32_16x16x32_bf16 v[56:59], a[140:143], v[152:155], v[56:59]
    s_waitcnt vmcnt(3)
    buffer_load_dwordx4 v233, s[16:19], s28 offen offset:3168 lds
    v_mfma_f32_16x16x32_bf16 v[60:63], a[140:143], v[156:159], v[60:63]
    s_waitcnt lgkmcnt(4)
    v_mfma_f32_16x16x32_bf16 v[64:67], a[144:147], v[144:147], v[64:67]
    ds_read_b64_tr_b16 a[128:129], v238 offset:33792
    ds_read_b64_tr_b16 a[130:131], v238 offset:34048
    v_mfma_f32_16x16x32_bf16 v[68:71], a[144:147], v[148:151], v[68:71]
    s_add_u32 m0, s32, 71808
    ds_read_b128 v[128:131], v239 offset:10240
    v_mfma_f32_16x16x32_bf16 v[72:75], a[144:147], v[152:155], v[72:75]
    buffer_load_dwordx4 v230, s[16:19], s29 offen offset:0 lds
    v_mfma_f32_16x16x32_bf16 v[76:79], a[144:147], v[156:159], v[76:79]
    ds_read_b128 v[132:135], v239 offset:24576
    v_mfma_f32_16x16x32_bf16 v[80:83], a[148:151], v[144:147], v[80:83]
    ds_read_b64_tr_b16 a[132:133], v238 offset:33824
    ds_read_b64_tr_b16 a[134:135], v238 offset:34080
    v_mfma_f32_16x16x32_bf16 v[84:87], a[148:151], v[148:151], v[84:87]
    ds_read_b128 v[136:139], v239 offset:38912
    v_mfma_f32_16x16x32_bf16 v[88:91], a[148:151], v[152:155], v[88:91]
    buffer_load_dwordx4 v231, s[16:19], s29 offen offset:1056 lds
    v_mfma_f32_16x16x32_bf16 v[92:95], a[148:151], v[156:159], v[92:95]
    s_waitcnt lgkmcnt(7)
    ds_read_b128 v[140:143], v239 offset:53248
    v_mfma_f32_16x16x32_bf16 v[96:99], a[152:155], v[144:147], v[96:99]
    ds_read_b64_tr_b16 a[136:137], v238 offset:33856
    ds_read_b64_tr_b16 a[138:139], v238 offset:34112
    v_mfma_f32_16x16x32_bf16 v[100:103], a[152:155], v[148:151], v[100:103]
    v_mfma_f32_16x16x32_bf16 v[104:107], a[152:155], v[152:155], v[104:107]
    buffer_load_dwordx4 v232, s[16:19], s29 offen offset:2112 lds
    v_mfma_f32_16x16x32_bf16 v[108:111], a[152:155], v[156:159], v[108:111]
    v_mfma_f32_16x16x32_bf16 v[112:115], a[156:159], v[144:147], v[112:115]
    ds_read_b64_tr_b16 a[140:141], v238 offset:33888
    ds_read_b64_tr_b16 a[142:143], v238 offset:34144
    v_mfma_f32_16x16x32_bf16 v[116:119], a[156:159], v[148:151], v[116:119]
    v_mfma_f32_16x16x32_bf16 v[120:123], a[156:159], v[152:155], v[120:123]
    s_add_u32 s28, s28, 262144
    buffer_load_dwordx4 v233, s[16:19], s29 offen offset:3168 lds
    v_mfma_f32_16x16x32_bf16 v[124:127], a[156:159], v[156:159], v[124:127]
    s_waitcnt lgkmcnt(4)
    s_add_u32 s29, s29, 262144
    v_mfma_f32_16x16x32_bf16 v[0:3], a[128:131], v[128:131], v[0:3]
    ds_read_b64_tr_b16 a[144:145], v238 offset:33920
    ds_read_b64_tr_b16 a[146:147], v238 offset:34176
    v_mfma_f32_16x16x32_bf16 v[4:7], a[128:131], v[132:135], v[4:7]
    s_add_u32 m0, s32, 0
    v_mfma_f32_16x16x32_bf16 v[8:11], a[128:131], v[136:139], v[8:11]
    buffer_load_dwordx4 v230, s[16:19], s28 offen offset:0 lds
    v_mfma_f32_16x16x32_bf16 v[12:15], a[128:131], v[140:143], v[12:15]
    v_mfma_f32_16x16x32_bf16 v[16:19], a[132:135], v[128:131], v[16:19]
    ds_read_b64_tr_b16 a[148:149], v238 offset:33952
    ds_read_b64_tr_b16 a[150:151], v238 offset:34208
    v_mfma_f32_16x16x32_bf16 v[20:23], a[132:135], v[132:135], v[20:23]
    v_mfma_f32_16x16x32_bf16 v[24:27], a[132:135], v[136:139], v[24:27]
    buffer_load_dwordx4 v231, s[16:19], s28 offen offset:1056 lds
    v_mfma_f32_16x16x32_bf16 v[28:31], a[132:135], v[140:143], v[28:31]
    s_waitcnt lgkmcnt(4)
    v_mfma_f32_16x16x32_bf16 v[32:35], a[136:139], v[128:131], v[32:35]
    ds_read_b64_tr_b16 a[152:153], v238 offset:33984
    ds_read_b64_tr_b16 a[154:155], v238 offset:34240
    v_mfma_f32_16x16x32_bf16 v[36:39], a[136:139], v[132:135], v[36:39]
    v_mfma_f32_16x16x32_bf16 v[40:43], a[136:139], v[136:139], v[40:43]
    buffer_load_dwordx4 v232, s[16:19], s28 offen offset:2112 lds
    v_mfma_f32_16x16x32_bf16 v[44:47], a[136:139], v[140:143], v[44:47]
    v_mfma_f32_16x16x32_bf16 v[48:51], a[140:143], v[128:131], v[48:51]
    ds_read_b64_tr_b16 a[156:157], v238 offset:34016
    ds_read_b64_tr_b16 a[158:159], v238 offset:34272
    v_mfma_f32_16x16x32_bf16 v[52:55], a[140:143], v[132:135], v[52:55]
    v_mfma_f32_16x16x32_bf16 v[56:59], a[140:143], v[136:139], v[56:59]
    s_waitcnt vmcnt(3)
    buffer_load_dwordx4 v233, s[16:19], s28 offen offset:3168 lds
    v_mfma_f32_16x16x32_bf16 v[60:63], a[140:143], v[140:143], v[60:63]
    s_waitcnt lgkmcnt(4)
    v_mfma_f32_16x16x32_bf16 v[64:67], a[144:147], v[128:131], v[64:67]
    ds_read_b64_tr_b16 a[128:129], v247 offset:0
    ds_read_b64_tr_b16 a[130:131], v247 offset:256
    v_mfma_f32_16x16x32_bf16 v[68:71], a[144:147], v[132:135], v[68:71]
    s_add_u32 m0, s32, 4224
    ds_read_b128 v[144:147], v248 offset:11264
    v_mfma_f32_16x16x32_bf16 v[72:75], a[144:147], v[136:139], v[72:75]
    buffer_load_dwordx4 v230, s[16:19], s29 offen offset:0 lds
    v_mfma_f32_16x16x32_bf16 v[76:79], a[144:147], v[140:143], v[76:79]
    ds_read_b128 v[148:151], v248 offset:25600
    v_mfma_f32_16x16x32_bf16 v[80:83], a[148:151], v[128:131], v[80:83]
    ds_read_b64_tr_b16 a[132:133], v247 offset:32
    ds_read_b64_tr_b16 a[134:135], v247 offset:288
    v_mfma_f32_16x16x32_bf16 v[84:87], a[148:151], v[132:135], v[84:87]
    ds_read_b128 v[152:155], v248 offset:39936
    v_mfma_f32_16x16x32_bf16 v[88:91], a[148:151], v[136:139], v[88:91]
    buffer_load_dwordx4 v231, s[16:19], s29 offen offset:1056 lds
    v_mfma_f32_16x16x32_bf16 v[92:95], a[148:151], v[140:143], v[92:95]
    s_waitcnt lgkmcnt(7)
    ds_read_b128 v[156:159], v248 offset:54272
    v_mfma_f32_16x16x32_bf16 v[96:99], a[152:155], v[128:131], v[96:99]
    ds_read_b64_tr_b16 a[136:137], v247 offset:64
    ds_read_b64_tr_b16 a[138:139], v247 offset:320
    v_mfma_f32_16x16x32_bf16 v[100:103], a[152:155], v[132:135], v[100:103]
    v_mfma_f32_16x16x32_bf16 v[104:107], a[152:155], v[136:139], v[104:107]
    buffer_load_dwordx4 v232, s[16:19], s29 offen offset:2112 lds
    v_mfma_f32_16x16x32_bf16 v[108:111], a[152:155], v[140:143], v[108:111]
    v_mfma_f32_16x16x32_bf16 v[112:115], a[156:159], v[128:131], v[112:115]
    ds_read_b64_tr_b16 a[140:141], v247 offset:96
    ds_read_b64_tr_b16 a[142:143], v247 offset:352
    v_mfma_f32_16x16x32_bf16 v[116:119], a[156:159], v[132:135], v[116:119]
    v_mfma_f32_16x16x32_bf16 v[120:123], a[156:159], v[136:139], v[120:123]
    s_add_u32 s28, s28, 262144
    buffer_load_dwordx4 v233, s[16:19], s29 offen offset:3168 lds
    v_mfma_f32_16x16x32_bf16 v[124:127], a[156:159], v[140:143], v[124:127]
    s_waitcnt lgkmcnt(4)
    s_add_u32 s29, s29, 262144
    v_mfma_f32_16x16x32_bf16 v[0:3], a[128:131], v[144:147], v[0:3]
    ds_read_b64_tr_b16 a[144:145], v247 offset:128
    ds_read_b64_tr_b16 a[146:147], v247 offset:384
    v_mfma_f32_16x16x32_bf16 v[4:7], a[128:131], v[148:151], v[4:7]
    s_add_u32 m0, s32, 33792
    v_mfma_f32_16x16x32_bf16 v[8:11], a[128:131], v[152:155], v[8:11]
    buffer_load_dwordx4 v230, s[16:19], s28 offen offset:0 lds
    v_mfma_f32_16x16x32_bf16 v[12:15], a[128:131], v[156:159], v[12:15]
    v_mfma_f32_16x16x32_bf16 v[16:19], a[132:135], v[144:147], v[16:19]
    ds_read_b64_tr_b16 a[148:149], v247 offset:160
    ds_read_b64_tr_b16 a[150:151], v247 offset:416
    v_mfma_f32_16x16x32_bf16 v[20:23], a[132:135], v[148:151], v[20:23]
    v_mfma_f32_16x16x32_bf16 v[24:27], a[132:135], v[152:155], v[24:27]
    buffer_load_dwordx4 v231, s[16:19], s28 offen offset:1056 lds
    v_mfma_f32_16x16x32_bf16 v[28:31], a[132:135], v[156:159], v[28:31]
    s_waitcnt lgkmcnt(4)
    v_mfma_f32_16x16x32_bf16 v[32:35], a[136:139], v[144:147], v[32:35]
    ds_read_b64_tr_b16 a[152:153], v247 offset:192
    ds_read_b64_tr_b16 a[154:155], v247 offset:448
    v_mfma_f32_16x16x32_bf16 v[36:39], a[136:139], v[148:151], v[36:39]
    v_mfma_f32_16x16x32_bf16 v[40:43], a[136:139], v[152:155], v[40:43]
    buffer_load_dwordx4 v232, s[16:19], s28 offen offset:2112 lds
    v_mfma_f32_16x16x32_bf16 v[44:47], a[136:139], v[156:159], v[44:47]
    v_mfma_f32_16x16x32_bf16 v[48:51], a[140:143], v[144:147], v[48:51]
    ds_read_b64_tr_b16 a[156:157], v247 offset:224
    ds_read_b64_tr_b16 a[158:159], v247 offset:480
    v_mfma_f32_16x16x32_bf16 v[52:55], a[140:143], v[148:151], v[52:55]
    v_mfma_f32_16x16x32_bf16 v[56:59], a[140:143], v[152:155], v[56:59]
    s_waitcnt vmcnt(3)
    buffer_load_dwordx4 v233, s[16:19], s28 offen offset:3168 lds
    v_mfma_f32_16x16x32_bf16 v[60:63], a[140:143], v[156:159], v[60:63]
    s_waitcnt lgkmcnt(4)
    v_mfma_f32_16x16x32_bf16 v[64:67], a[144:147], v[144:147], v[64:67]
    ds_read_b64_tr_b16 a[128:129], v238 offset:0
    ds_read_b64_tr_b16 a[130:131], v238 offset:256
    v_mfma_f32_16x16x32_bf16 v[68:71], a[144:147], v[148:151], v[68:71]
    s_add_u32 m0, s32, 38016
    ds_read_b128 v[128:131], v239 offset:12288
    v_mfma_f32_16x16x32_bf16 v[72:75], a[144:147], v[152:155], v[72:75]
    buffer_load_dwordx4 v230, s[16:19], s29 offen offset:0 lds
    v_mfma_f32_16x16x32_bf16 v[76:79], a[144:147], v[156:159], v[76:79]
    ds_read_b128 v[132:135], v239 offset:26624
    v_mfma_f32_16x16x32_bf16 v[80:83], a[148:151], v[144:147], v[80:83]
    ds_read_b64_tr_b16 a[132:133], v238 offset:32
    ds_read_b64_tr_b16 a[134:135], v238 offset:288
    v_mfma_f32_16x16x32_bf16 v[84:87], a[148:151], v[148:151], v[84:87]
    ds_read_b128 v[136:139], v239 offset:40960
    v_mfma_f32_16x16x32_bf16 v[88:91], a[148:151], v[152:155], v[88:91]
    buffer_load_dwordx4 v231, s[16:19], s29 offen offset:1056 lds
    v_mfma_f32_16x16x32_bf16 v[92:95], a[148:151], v[156:159], v[92:95]
    s_waitcnt lgkmcnt(7)
    ds_read_b128 v[140:143], v239 offset:55296
    v_mfma_f32_16x16x32_bf16 v[96:99], a[152:155], v[144:147], v[96:99]
    ds_read_b64_tr_b16 a[136:137], v238 offset:64
    ds_read_b64_tr_b16 a[138:139], v238 offset:320
    v_mfma_f32_16x16x32_bf16 v[100:103], a[152:155], v[148:151], v[100:103]
    v_mfma_f32_16x16x32_bf16 v[104:107], a[152:155], v[152:155], v[104:107]
    buffer_load_dwordx4 v232, s[16:19], s29 offen offset:2112 lds
    v_mfma_f32_16x16x32_bf16 v[108:111], a[152:155], v[156:159], v[108:111]
    v_mfma_f32_16x16x32_bf16 v[112:115], a[156:159], v[144:147], v[112:115]
    ds_read_b64_tr_b16 a[140:141], v238 offset:96
    ds_read_b64_tr_b16 a[142:143], v238 offset:352
    v_mfma_f32_16x16x32_bf16 v[116:119], a[156:159], v[148:151], v[116:119]
    v_mfma_f32_16x16x32_bf16 v[120:123], a[156:159], v[152:155], v[120:123]
    s_add_u32 s28, s28, 262144
    buffer_load_dwordx4 v233, s[16:19], s29 offen offset:3168 lds
    v_mfma_f32_16x16x32_bf16 v[124:127], a[156:159], v[156:159], v[124:127]
    s_waitcnt lgkmcnt(4)
    s_add_u32 s29, s29, 262144
    v_mfma_f32_16x16x32_bf16 v[0:3], a[128:131], v[128:131], v[0:3]
    ds_read_b64_tr_b16 a[144:145], v238 offset:128
    ds_read_b64_tr_b16 a[146:147], v238 offset:384
    v_mfma_f32_16x16x32_bf16 v[4:7], a[128:131], v[132:135], v[4:7]
    v_and_b32 v230, 63, v255
    v_mfma_f32_16x16x32_bf16 v[8:11], a[128:131], v[136:139], v[8:11]
    v_lshrrev_b32 v231, 5, v230
    v_and_b32 v230, 31, v230
    v_mfma_f32_16x16x32_bf16 v[12:15], a[128:131], v[140:143], v[12:15]
    v_lshlrev_b32 v230, 4, v230
    v_mfma_f32_16x16x32_bf16 v[16:19], a[132:135], v[128:131], v[16:19]
    ds_read_b64_tr_b16 a[148:149], v238 offset:160
    ds_read_b64_tr_b16 a[150:151], v238 offset:416
    v_mfma_f32_16x16x32_bf16 v[20:23], a[132:135], v[132:135], v[20:23]
    v_lshl_add_u32 v233, v231, 13, v230
    v_mfma_f32_16x16x32_bf16 v[24:27], a[132:135], v[136:139], v[24:27]
    v_add_u32 v230, 1584, v233
    v_add_u32 v231, 1056, v233
    v_mfma_f32_16x16x32_bf16 v[28:31], a[132:135], v[140:143], v[28:31]
    s_waitcnt lgkmcnt(4)
    v_add_u32 v232, 528, v233
    v_mfma_f32_16x16x32_bf16 v[32:35], a[136:139], v[128:131], v[32:35]
    s_lshl_b32 s43, s27, 12
    ds_read_b64_tr_b16 a[152:153], v238 offset:192
    ds_read_b64_tr_b16 a[154:155], v238 offset:448
    v_mfma_f32_16x16x32_bf16 v[36:39], a[136:139], v[132:135], v[36:39]
    s_lshr_b32 s28, s24, 1
    s_lshl_b32 s28, s28, 14
    v_mfma_f32_16x16x32_bf16 v[40:43], a[136:139], v[136:139], v[40:43]
    s_add_u32 s28, s28, s43
    s_add_u32 s29, s28, 2048
    v_mfma_f32_16x16x32_bf16 v[44:47], a[136:139], v[140:143], v[44:47]
    s_add_u32 s37, s28, 1015808
    s_mul_i32 s32, s24, 8320
    v_mfma_f32_16x16x32_bf16 v[48:51], a[140:143], v[128:131], v[48:51]
    s_lshl_b32 s30, s24, 13
    ds_read_b64_tr_b16 a[156:157], v238 offset:224
    ds_read_b64_tr_b16 a[158:159], v238 offset:480
    v_mfma_f32_16x16x32_bf16 v[52:55], a[140:143], v[132:135], v[52:55]
    s_add_u32 s31, s30, 2048
    v_and_b32 v160, 63, v255
    v_mfma_f32_16x16x32_bf16 v[56:59], a[140:143], v[136:139], v[56:59]
    s_waitcnt vmcnt(0)
    v_lshlrev_b32 v162, 7, v160
    v_cmp_gt_u32 vcc, 8, v160
    v_mfma_f32_16x16x32_bf16 v[60:63], a[140:143], v[140:143], v[60:63]
    s_waitcnt lgkmcnt(4)
    v_cndmask_b32 v163, v254, v162, vcc
    v_cmp_gt_u32 vcc, 6, v160
    v_mfma_f32_16x16x32_bf16 v[64:67], a[144:147], v[128:131], v[64:67]
    ds_read_b64_tr_b16 a[128:129], v238 offset:33792
    ds_read_b64_tr_b16 a[130:131], v238 offset:34048
    v_mfma_f32_16x16x32_bf16 v[68:71], a[144:147], v[132:135], v[68:71]
    s_lshl_b32 s44, s26, 2
    ds_read_b128 v[144:147], v248 offset:13312
    v_cndmask_b32 v162, v254, v162, vcc
    v_mfma_f32_16x16x32_bf16 v[72:75], a[144:147], v[136:139], v[72:75]
    s_add_u32 s44, s44, s24
    s_mul_i32 s45, s44, 1024
    v_mfma_f32_16x16x32_bf16 v[76:79], a[144:147], v[140:143], v[76:79]
    s_add_u32 s45, s45, 99888
    ds_read_b128 v[148:151], v248 offset:27648
    v_mfma_f32_16x16x32_bf16 v[80:83], a[148:151], v[128:131], v[80:83]
    s_mul_i32 s44, s44, 768
    ds_read_b64_tr_b16 a[132:133], v238 offset:33824
    ds_read_b64_tr_b16 a[134:135], v238 offset:34080
    v_mfma_f32_16x16x32_bf16 v[84:87], a[148:151], v[132:135], v[84:87]
    s_add_u32 s44, s44, 67168
    ds_read_b128 v[152:155], v248 offset:41984
    v_mfma_f32_16x16x32_bf16 v[88:91], a[148:151], v[136:139], v[88:91]
    buffer_load_dword a255, v163, s[8:11], s45 offen
    v_mfma_f32_16x16x32_bf16 v[92:95], a[148:151], v[140:143], v[92:95]
    s_waitcnt lgkmcnt(7)
    ds_read_b128 v[156:159], v248 offset:56320
    v_mfma_f32_16x16x32_bf16 v[96:99], a[152:155], v[128:131], v[96:99]
    ds_read_b64_tr_b16 a[136:137], v238 offset:33856
    ds_read_b64_tr_b16 a[138:139], v238 offset:34112
    v_mfma_f32_16x16x32_bf16 v[100:103], a[152:155], v[132:135], v[100:103]
    buffer_load_dword a255, v162, s[12:15], s44 offen
    v_mfma_f32_16x16x32_bf16 v[104:107], a[152:155], v[136:139], v[104:107]
    v_mfma_f32_16x16x32_bf16 v[108:111], a[152:155], v[140:143], v[108:111]
    v_mfma_f32_16x16x32_bf16 v[112:115], a[156:159], v[128:131], v[112:115]
    ds_read_b64_tr_b16 a[140:141], v238 offset:33888
    ds_read_b64_tr_b16 a[142:143], v238 offset:34144
    v_mfma_f32_16x16x32_bf16 v[116:119], a[156:159], v[132:135], v[116:119]
    v_mfma_f32_16x16x32_bf16 v[120:123], a[156:159], v[136:139], v[120:123]
    v_mfma_f32_16x16x32_bf16 v[124:127], a[156:159], v[140:143], v[124:127]
    s_waitcnt lgkmcnt(4)
    s_barrier
    v_mfma_f32_16x16x32_bf16 v[0:3], a[128:131], v[144:147], v[0:3]
    ds_read_b64_tr_b16 a[144:145], v238 offset:33920
    ds_read_b64_tr_b16 a[146:147], v238 offset:34176
    v_mfma_f32_16x16x32_bf16 v[4:7], a[128:131], v[148:151], v[4:7]
    s_add_u32 m0, s32, 0
    v_mfma_f32_16x16x32_bf16 v[8:11], a[128:131], v[152:155], v[8:11]
    buffer_load_dwordx4 v230, s[8:11], s28 offen offset:0 lds
    v_mfma_f32_16x16x32_bf16 v[12:15], a[128:131], v[156:159], v[12:15]
    v_mfma_f32_16x16x32_bf16 v[16:19], a[132:135], v[144:147], v[16:19]
    ds_read_b64_tr_b16 a[148:149], v238 offset:33952
    ds_read_b64_tr_b16 a[150:151], v238 offset:34208
    v_mfma_f32_16x16x32_bf16 v[20:23], a[132:135], v[148:151], v[20:23]
    v_mfma_f32_16x16x32_bf16 v[24:27], a[132:135], v[152:155], v[24:27]
    buffer_load_dwordx4 v231, s[8:11], s28 offen offset:1040 lds
    v_mfma_f32_16x16x32_bf16 v[28:31], a[132:135], v[156:159], v[28:31]
    s_waitcnt lgkmcnt(4)
    v_mfma_f32_16x16x32_bf16 v[32:35], a[136:139], v[144:147], v[32:35]
    ds_read_b64_tr_b16 a[152:153], v238 offset:33984
    ds_read_b64_tr_b16 a[154:155], v238 offset:34240
    v_mfma_f32_16x16x32_bf16 v[36:39], a[136:139], v[148:151], v[36:39]
    v_mfma_f32_16x16x32_bf16 v[40:43], a[136:139], v[152:155], v[40:43]
    buffer_load_dwordx4 v232, s[8:11], s28 offen offset:2080 lds
    v_mfma_f32_16x16x32_bf16 v[44:47], a[136:139], v[156:159], v[44:47]
    v_mfma_f32_16x16x32_bf16 v[48:51], a[140:143], v[144:147], v[48:51]
    ds_read_b64_tr_b16 a[156:157], v238 offset:34016
    ds_read_b64_tr_b16 a[158:159], v238 offset:34272
    v_mfma_f32_16x16x32_bf16 v[52:55], a[140:143], v[148:151], v[52:55]
    v_mfma_f32_16x16x32_bf16 v[56:59], a[140:143], v[152:155], v[56:59]
    buffer_load_dwordx4 v233, s[8:11], s28 offen offset:3120 lds
    v_mfma_f32_16x16x32_bf16 v[60:63], a[140:143], v[156:159], v[60:63]
    s_waitcnt lgkmcnt(4)
    v_mfma_f32_16x16x32_bf16 v[64:67], a[144:147], v[144:147], v[64:67]
    v_mfma_f32_16x16x32_bf16 v[68:71], a[144:147], v[148:151], v[68:71]
    s_add_u32 m0, s32, 4160
    v_mfma_f32_16x16x32_bf16 v[72:75], a[144:147], v[152:155], v[72:75]
    buffer_load_dwordx4 v230, s[8:11], s29 offen offset:0 lds
    v_mfma_f32_16x16x32_bf16 v[76:79], a[144:147], v[156:159], v[76:79]
    v_mfma_f32_16x16x32_bf16 v[80:83], a[148:151], v[144:147], v[80:83]
    v_mfma_f32_16x16x32_bf16 v[84:87], a[148:151], v[148:151], v[84:87]
    v_mfma_f32_16x16x32_bf16 v[88:91], a[148:151], v[152:155], v[88:91]
    buffer_load_dwordx4 v231, s[8:11], s29 offen offset:1040 lds
    v_mfma_f32_16x16x32_bf16 v[92:95], a[148:151], v[156:159], v[92:95]
    s_waitcnt lgkmcnt(0)
    v_mfma_f32_16x16x32_bf16 v[96:99], a[152:155], v[144:147], v[96:99]
    v_mfma_f32_16x16x32_bf16 v[100:103], a[152:155], v[148:151], v[100:103]
    v_mfma_f32_16x16x32_bf16 v[104:107], a[152:155], v[152:155], v[104:107]
    buffer_load_dwordx4 v232, s[8:11], s29 offen offset:2080 lds
    v_mfma_f32_16x16x32_bf16 v[108:111], a[152:155], v[156:159], v[108:111]
    v_mfma_f32_16x16x32_bf16 v[112:115], a[156:159], v[144:147], v[112:115]
    v_mfma_f32_16x16x32_bf16 v[116:119], a[156:159], v[148:151], v[116:119]
    v_mfma_f32_16x16x32_bf16 v[120:123], a[156:159], v[152:155], v[120:123]
    s_add_u32 s28, s28, 0x8000
    buffer_load_dwordx4 v233, s[8:11], s29 offen offset:3120 lds
    v_mfma_f32_16x16x32_bf16 v[124:127], a[156:159], v[156:159], v[124:127]
    s_min_u32 s28, s28, s37
    s_add_u32 s29, s28, 2048
    s_barrier
    s_lshr_b32 s40, s24, 1
    s_mul_i32 s40, s40, 33792
    s_add_u32 s40, s40, 96256
    v_mul_u32_u24 v238, 528, v245
    v_add_u32 v238, s40, v238
    v_add_u32 v239, v238, v242
    s_lshl_b32 s40, s27, 8
    v_lshl_add_u32 v240, v246, 3, v238
    v_add_u32 v240, s40, v240
    v_cvt_pk_bf16_f32 v128, v0, v1
    v_cvt_pk_bf16_f32 v129, v2, v3
    ds_write_b64 v240, v[128:129] offset:0
    v_cvt_pk_bf16_f32 v130, v4, v5
    v_cvt_pk_bf16_f32 v131, v6, v7
    ds_write_b64 v240, v[130:131] offset:8448
    v_cvt_pk_bf16_f32 v132, v8, v9
    v_cvt_pk_bf16_f32 v133, v10, v11
    ds_write_b64 v240, v[132:133] offset:16896
    v_cvt_pk_bf16_f32 v134, v12, v13
    v_cvt_pk_bf16_f32 v135, v14, v15
    ds_write_b64 v240, v[134:135] offset:25344
    v_cvt_pk_bf16_f32 v136, v16, v17
    v_cvt_pk_bf16_f32 v137, v18, v19
    ds_write_b64 v240, v[136:137] offset:32
    v_cvt_pk_bf16_f32 v138, v20, v21
    v_cvt_pk_bf16_f32 v139, v22, v23
    ds_write_b64 v240, v[138:139] offset:8480
    v_cvt_pk_bf16_f32 v140, v24, v25
    v_cvt_pk_bf16_f32 v141, v26, v27
    ds_write_b64 v240, v[140:141] offset:16928
    v_cvt_pk_bf16_f32 v142, v28, v29
    v_cvt_pk_bf16_f32 v143, v30, v31
    ds_write_b64 v240, v[142:143] offset:25376
    v_cvt_pk_bf16_f32 v128, v32, v33
    v_cvt_pk_bf16_f32 v129, v34, v35
    ds_write_b64 v240, v[128:129] offset:64
    v_cvt_pk_bf16_f32 v130, v36, v37
    v_cvt_pk_bf16_f32 v131, v38, v39
    ds_write_b64 v240, v[130:131] offset:8512
    v_cvt_pk_bf16_f32 v132, v40, v41
    v_cvt_pk_bf16_f32 v133, v42, v43
    ds_write_b64 v240, v[132:133] offset:16960
    v_cvt_pk_bf16_f32 v134, v44, v45
    v_cvt_pk_bf16_f32 v135, v46, v47
    ds_write_b64 v240, v[134:135] offset:25408
    v_cvt_pk_bf16_f32 v136, v48, v49
    v_cvt_pk_bf16_f32 v137, v50, v51
    ds_write_b64 v240, v[136:137] offset:96
    v_cvt_pk_bf16_f32 v138, v52, v53
    v_cvt_pk_bf16_f32 v139, v54, v55
    ds_write_b64 v240, v[138:139] offset:8544
    v_cvt_pk_bf16_f32 v140, v56, v57
    v_cvt_pk_bf16_f32 v141, v58, v59
    ds_write_b64 v240, v[140:141] offset:16992
    v_cvt_pk_bf16_f32 v142, v60, v61
    v_cvt_pk_bf16_f32 v143, v62, v63
    ds_write_b64 v240, v[142:143] offset:25440
    v_cvt_pk_bf16_f32 v128, v64, v65
    v_cvt_pk_bf16_f32 v129, v66, v67
    ds_write_b64 v240, v[128:129] offset:128
    v_cvt_pk_bf16_f32 v130, v68, v69
    v_cvt_pk_bf16_f32 v131, v70, v71
    ds_write_b64 v240, v[130:131] offset:8576
    v_cvt_pk_bf16_f32 v132, v72, v73
    v_cvt_pk_bf16_f32 v133, v74, v75
    ds_write_b64 v240, v[132:133] offset:17024
    v_cvt_pk_bf16_f32 v134, v76, v77
    v_cvt_pk_bf16_f32 v135, v78, v79
    ds_write_b64 v240, v[134:135] offset:25472
    v_cvt_pk_bf16_f32 v136, v80, v81
    v_cvt_pk_bf16_f32 v137, v82, v83
    ds_write_b64 v240, v[136:137] offset:160
    v_cvt_pk_bf16_f32 v138, v84, v85
    v_cvt_pk_bf16_f32 v139, v86, v87
    ds_write_b64 v240, v[138:139] offset:8608
    v_cvt_pk_bf16_f32 v140, v88, v89
    v_cvt_pk_bf16_f32 v141, v90, v91
    ds_write_b64 v240, v[140:141] offset:17056
    v_cvt_pk_bf16_f32 v142, v92, v93
    v_cvt_pk_bf16_f32 v143, v94, v95
    ds_write_b64 v240, v[142:143] offset:25504
    v_cvt_pk_bf16_f32 v128, v96, v97
    v_cvt_pk_bf16_f32 v129, v98, v99
    ds_write_b64 v240, v[128:129] offset:192
    v_cvt_pk_bf16_f32 v130, v100, v101
    v_cvt_pk_bf16_f32 v131, v102, v103
    ds_write_b64 v240, v[130:131] offset:8640
    v_cvt_pk_bf16_f32 v132, v104, v105
    v_cvt_pk_bf16_f32 v133, v106, v107
    ds_write_b64 v240, v[132:133] offset:17088
    v_cvt_pk_bf16_f32 v134, v108, v109
    v_cvt_pk_bf16_f32 v135, v110, v111
    ds_write_b64 v240, v[134:135] offset:25536
    v_cvt_pk_bf16_f32 v136, v112, v113
    v_cvt_pk_bf16_f32 v137, v114, v115
    ds_write_b64 v240, v[136:137] offset:224
    v_cvt_pk_bf16_f32 v138, v116, v117
    v_cvt_pk_bf16_f32 v139, v118, v119
    ds_write_b64 v240, v[138:139] offset:8672
    v_cvt_pk_bf16_f32 v140, v120, v121
    v_cvt_pk_bf16_f32 v141, v122, v123
    ds_write_b64 v240, v[140:141] offset:17120
    v_cvt_pk_bf16_f32 v142, v124, v125
    v_cvt_pk_bf16_f32 v143, v126, v127
    ds_write_b64 v240, v[142:143] offset:25568
    s_waitcnt vmcnt(0) lgkmcnt(0)
    s_barrier
    ds_read_b128 a[0:3], v239 offset:0
    ds_read_b128 a[32:35], v239 offset:8448
    ds_read_b128 a[64:67], v239 offset:16896
    ds_read_b128 a[96:99], v239 offset:25344
    ds_read_b128 a[4:7], v239 offset:32
    ds_read_b128 a[36:39], v239 offset:8480
    ds_read_b128 a[68:71], v239 offset:16928
    ds_read_b128 a[100:103], v239 offset:25376
    ds_read_b128 a[8:11], v239 offset:64
    ds_read_b128 a[40:43], v239 offset:8512
    ds_read_b128 a[72:75], v239 offset:16960
    ds_read_b128 a[104:107], v239 offset:25408
    ds_read_b128 a[12:15], v239 offset:96
    ds_read_b128 a[44:47], v239 offset:8544
    ds_read_b128 a[76:79], v239 offset:16992
    ds_read_b128 a[108:111], v239 offset:25440
    ds_read_b128 a[16:19], v239 offset:128
    ds_read_b128 a[48:51], v239 offset:8576
    ds_read_b128 a[80:83], v239 offset:17024
    ds_read_b128 a[112:115], v239 offset:25472
    ds_read_b128 a[20:23], v239 offset:160
    ds_read_b128 a[52:55], v239 offset:8608
    ds_read_b128 a[84:87], v239 offset:17056
    ds_read_b128 a[116:119], v239 offset:25504
    ds_read_b128 a[24:27], v239 offset:192
    ds_read_b128 a[56:59], v239 offset:8640
    ds_read_b128 a[88:91], v239 offset:17088
    ds_read_b128 a[120:123], v239 offset:25536
    ds_read_b128 a[28:31], v239 offset:224
    ds_read_b128 a[60:63], v239 offset:8672
    ds_read_b128 a[92:95], v239 offset:17120
    ds_read_b128 a[124:127], v239 offset:25568
    v_mov_b32 v244, 0x3f803f80
    v_accvgpr_write_b32 a208, v244
    v_mov_b32 v240, 0xff800000
    v_accvgpr_write_b32 a209, v244
    v_mov_b32 v241, 0xff800000
    v_accvgpr_write_b32 a210, v244
    v_mov_b32 v242, 0xff800000
    v_accvgpr_write_b32 a211, v244
    v_mov_b32 v243, 0xff800000
    v_mov_b32 v244, s3
    s_mov_b32 s47, 4
    s_mov_b32 s91, 7
    v_accvgpr_write_b32 a212, v244
    v_accvgpr_write_b32 a213, v244
    v_accvgpr_write_b32 a214, v244
    v_accvgpr_write_b32 a215, v244
KB_restart:
    s_mov_b32 s16, s54
    s_or_b32 s17, s55, 1048576
    s_mov_b32 s18, 0
    s_mov_b32 s19, 0x20000
    v_mov_b64 v[0:1], 0
    v_mov_b64 v[2:3], 0
    v_mov_b64 v[4:5], 0
    v_mov_b64 v[6:7], 0
    v_mov_b64 v[8:9], 0
    v_mov_b64 v[10:11], 0
    v_mov_b64 v[12:13], 0
    v_mov_b64 v[14:15], 0
    v_mov_b64 v[16:17], 0
    v_mov_b64 v[18:19], 0
    v_mov_b64 v[20:21], 0
    v_mov_b64 v[22:23], 0
    v_mov_b64 v[24:25], 0
    v_mov_b64 v[26:27], 0
    v_mov_b64 v[28:29], 0
    v_mov_b64 v[30:31], 0
    v_mov_b64 v[32:33], 0
    v_mov_b64 v[34:35], 0
    v_mov_b64 v[36:37], 0
    v_mov_b64 v[38:39], 0
    v_mov_b64 v[40:41], 0
    v_mov_b64 v[42:43], 0
    v_mov_b64 v[44:45], 0
    v_mov_b64 v[46:47], 0
    v_mov_b64 v[48:49], 0
    v_mov_b64 v[50:51], 0
    v_mov_b64 v[52:53], 0
    v_mov_b64 v[54:55], 0
    v_mov_b64 v[56:57], 0
    v_mov_b64 v[58:59], 0
    v_mov_b64 v[60:61], 0
    v_mov_b64 v[62:63], 0
    v_mov_b64 v[64:65], 0
    v_mov_b64 v[66:67], 0
    v_mov_b64 v[68:69], 0
    v_mov_b64 v[70:71], 0
    v_mov_b64 v[72:73], 0
    v_mov_b64 v[74:75], 0
    v_mov_b64 v[76:77], 0
    v_mov_b64 v[78:79], 0
    v_mov_b64 v[80:81], 0
    v_mov_b64 v[82:83], 0
    v_mov_b64 v[84:85], 0
    v_mov_b64 v[86:87], 0
    v_mov_b64 v[88:89], 0
    v_mov_b64 v[90:91], 0
    v_mov_b64 v[92:93], 0
    v_mov_b64 v[94:95], 0
    v_mov_b64 v[96:97], 0
    v_mov_b64 v[98:99], 0
    v_mov_b64 v[100:101], 0
    v_mov_b64 v[102:103], 0
    v_mov_b64 v[104:105], 0
    v_mov_b64 v[106:107], 0
    v_mov_b64 v[108:109], 0
    v_mov_b64 v[110:111], 0
    v_mov_b64 v[112:113], 0
    v_mov_b64 v[114:115], 0
    v_mov_b64 v[116:117], 0
    v_mov_b64 v[118:119], 0
    v_mov_b64 v[120:121], 0
    v_mov_b64 v[122:123], 0
    v_mov_b64 v[124:125], 0
    v_mov_b64 v[126:127], 0
    v_accvgpr_write_b32 a192, 0
    v_accvgpr_write_b32 a193, 0
    v_accvgpr_write_b32 a194, 0
    v_accvgpr_write_b32 a195, 0
    v_accvgpr_write_b32 a196, 0
    v_accvgpr_write_b32 a197, 0
    v_accvgpr_write_b32 a198, 0
    v_accvgpr_write_b32 a199, 0
    v_accvgpr_write_b32 a200, 0
    v_accvgpr_write_b32 a201, 0
    v_accvgpr_write_b32 a202, 0
    v_accvgpr_write_b32 a203, 0
    v_accvgpr_write_b32 a204, 0
    v_accvgpr_write_b32 a205, 0
    v_accvgpr_write_b32 a206, 0
    v_accvgpr_write_b32 a207, 0
    v_mov_b32 v229, 1073741824
    s_mov_b32 s6, 0
    v_and_b32 v128, 1, v255
    v_bfe_u32 v129, v255, 2, 1
    v_sub_u32 v129, 13, v129
    v_lshlrev_b32 v128, v129, v128
    v_bfe_u32 v129, v255, 1, 1
    v_lshl_add_u32 v128, v129, 15, v128
    s_lshl_b32 s40, s26, 7
    s_add_u32 s40, s40, 67200
    v_add_u32 v128, s40, v128
    v_and_b32 v129, 63, v255
    v_cmp_gt_u32 vcc, 8, v129
    s_nop 1
    v_cndmask_b32 v254, v229, v128, vcc
    v_lshlrev_b32 v229, 7, v255
    s_waitcnt lgkmcnt(0)
    ds_read_b128 a[128:131], v224 offset:0
    ds_read_b128 a[132:135], v224 offset:512
    ds_read_b128 a[136:139], v224 offset:32
    ds_read_b128 a[140:143], v224 offset:544
    s_barrier
    s_waitcnt lgkmcnt(2)
    v_mfma_f32_16x16x32_bf16 v[128:131], a[128:131], a[0:3], 0
    s_add_u32 m0, s32, 33280
    ds_read_b128 a[144:147], v224 offset:64
    v_mfma_f32_16x16x32_bf16 v[132:135], a[128:131], a[32:35], 0
    buffer_load_dwordx4 v230, s[8:11], s28 offen offset:0 lds
    v_mfma_f32_16x16x32_bf16 v[136:139], a[128:131], a[64:67], 0
    v_mfma_f32_16x16x32_bf16 v[140:143], a[128:131], a[96:99], 0
    v_mfma_f32_16x16x32_bf16 v[144:147], a[132:135], a[0:3], 0
    ds_read_b128 a[148:151], v224 offset:576
    v_mfma_f32_16x16x32_bf16 v[148:151], a[132:135], a[32:35], 0
    buffer_load_dwordx4 v231, s[8:11], s28 offen offset:1040 lds
    v_mfma_f32_16x16x32_bf16 v[152:155], a[132:135], a[64:67], 0
    v_mfma_f32_16x16x32_bf16 v[156:159], a[132:135], a[96:99], 0
    s_waitcnt lgkmcnt(2)
    v_mfma_f32_16x16x32_bf16 v[128:131], a[136:139], a[4:7], v[128:131]
    ds_read_b128 a[152:155], v224 offset:96
    v_mfma_f32_16x16x32_bf16 v[132:135], a[136:139], a[36:39], v[132:135]
    buffer_load_dwordx4 v232, s[8:11], s28 offen offset:2080 lds
    v_mfma_f32_16x16x32_bf16 v[136:139], a[136:139], a[68:71], v[136:139]
    v_mfma_f32_16x16x32_bf16 v[140:143], a[136:139], a[100:103], v[140:143]
    buffer_load_dwordx4 v233, s[8:11], s28 offen offset:3120 lds
    v_mfma_f32_16x16x32_bf16 v[144:147], a[140:143], a[4:7], v[144:147]
    ds_read_b128 a[156:159], v224 offset:608
    v_mfma_f32_16x16x32_bf16 v[148:151], a[140:143], a[36:39], v[148:151]
    v_mfma_f32_16x16x32_bf16 v[152:155], a[140:143], a[68:71], v[152:155]
    s_add_u32 m0, s32, 37440
    v_mfma_f32_16x16x32_bf16 v[156:159], a[140:143], a[100:103], v[156:159]
    s_waitcnt lgkmcnt(2)
    buffer_load_dwordx4 v230, s[8:11], s29 offen offset:0 lds
    v_mfma_f32_16x16x32_bf16 v[128:131], a[144:147], a[8:11], v[128:131]
    ds_read_b128 a[128:131], v224 offset:128
    v_mfma_f32_16x16x32_bf16 v[132:135], a[144:147], a[40:43], v[132:135]
    v_mfma_f32_16x16x32_bf16 v[136:139], a[144:147], a[72:75], v[136:139]
    buffer_load_dwordx4 v231, s[8:11], s29 offen offset:1040 lds
    v_mfma_f32_16x16x32_bf16 v[140:143], a[144:147], a[104:107], v[140:143]
    v_mfma_f32_16x16x32_bf16 v[144:147], a[148:151], a[8:11], v[144:147]
    ds_read_b128 a[132:135], v224 offset:640
    v_mfma_f32_16x16x32_bf16 v[148:151], a[148:151], a[40:43], v[148:151]
    v_mfma_f32_16x16x32_bf16 v[152:155], a[148:151], a[72:75], v[152:155]
    buffer_load_dwordx4 v232, s[8:11], s29 offen offset:2080 lds
    v_mfma_f32_16x16x32_bf16 v[156:159], a[148:151], a[104:107], v[156:159]
    s_waitcnt lgkmcnt(2)
    v_mfma_f32_16x16x32_bf16 v[128:131], a[152:155], a[12:15], v[128:131]
    ds_read_b128 a[136:139], v224 offset:160
    v_mfma_f32_16x16x32_bf16 v[132:135], a[152:155], a[44:47], v[132:135]
    buffer_load_dwordx4 v233, s[8:11], s29 offen offset:3120 lds
    v_mfma_f32_16x16x32_bf16 v[136:139], a[152:155], a[76:79], v[136:139]
    v_mfma_f32_16x16x32_bf16 v[140:143], a[152:155], a[108:111], v[140:143]
    v_mfma_f32_16x16x32_bf16 v[144:147], a[156:159], a[12:15], v[144:147]
    s_add_u32 s28, s28, 0x8000
    ds_read_b128 a[140:143], v224 offset:672
    v_mfma_f32_16x16x32_bf16 v[148:151], a[156:159], a[44:47], v[148:151]
    s_min_u32 s28, s28, s37
    s_add_u32 s29, s28, 2048
    v_mfma_f32_16x16x32_bf16 v[152:155], a[156:159], a[76:79], v[152:155]
    s_add_u32 m0, s33, 66560
    v_mfma_f32_16x16x32_bf16 v[156:159], a[156:159], a[108:111], v[156:159]
    s_waitcnt lgkmcnt(2)
    buffer_load_dwordx4 v234, s[12:15], s30 offen offset:0 lds
    v_mfma_f32_16x16x32_bf16 v[128:131], a[128:131], a[16:19], v[128:131]
    ds_read_b128 a[144:147], v224 offset:192
    v_mfma_f32_16x16x32_bf16 v[132:135], a[128:131], a[48:51], v[132:135]
    buffer_load_dwordx4 v235, s[12:15], s30 offen offset:1056 lds
    v_mfma_f32_16x16x32_bf16 v[136:139], a[128:131], a[80:83], v[136:139]
    v_mfma_f32_16x16x32_bf16 v[140:143], a[128:131], a[112:115], v[140:143]
    v_mfma_f32_16x16x32_bf16 v[144:147], a[132:135], a[16:19], v[144:147]
    ds_read_b128 a[148:151], v224 offset:704
    v_mfma_f32_16x16x32_bf16 v[148:151], a[132:135], a[48:51], v[148:151]
    buffer_load_dwordx4 v236, s[12:15], s30 offen offset:2112 lds
    v_mfma_f32_16x16x32_bf16 v[152:155], a[132:135], a[80:83], v[152:155]
    v_mfma_f32_16x16x32_bf16 v[156:159], a[132:135], a[112:115], v[156:159]
    s_waitcnt lgkmcnt(2)
    buffer_load_dwordx4 v237, s[12:15], s30 offen offset:3168 lds
    v_mfma_f32_16x16x32_bf16 v[128:131], a[136:139], a[20:23], v[128:131]
    ds_read_b128 a[152:155], v224 offset:224
    v_mfma_f32_16x16x32_bf16 v[132:135], a[136:139], a[52:55], v[132:135]
    v_mfma_f32_16x16x32_bf16 v[136:139], a[136:139], a[84:87], v[136:139]
    s_add_u32 m0, s33, 70784
    v_mfma_f32_16x16x32_bf16 v[140:143], a[136:139], a[116:119], v[140:143]
    buffer_load_dwordx4 v234, s[12:15], s31 offen offset:0 lds
    v_mfma_f32_16x16x32_bf16 v[144:147], a[140:143], a[20:23], v[144:147]
    ds_read_b128 a[156:159], v224 offset:736
    v_mfma_f32_16x16x32_bf16 v[148:151], a[140:143], a[52:55], v[148:151]
    v_mfma_f32_16x16x32_bf16 v[152:155], a[140:143], a[84:87], v[152:155]
    buffer_load_dwordx4 v235, s[12:15], s31 offen offset:1056 lds
    v_mfma_f32_16x16x32_bf16 v[156:159], a[140:143], a[116:119], v[156:159]
    s_waitcnt lgkmcnt(2)
    v_mfma_f32_16x16x32_bf16 v[128:131], a[144:147], a[24:27], v[128:131]
    v_mfma_f32_16x16x32_bf16 v[132:135], a[144:147], a[56:59], v[132:135]
    v_mfma_f32_16x16x32_bf16 v[136:139], a[144:147], a[88:91], v[136:139]
    buffer_load_dwordx4 v236, s[12:15], s31 offen offset:2112 lds
    v_mfma_f32_16x16x32_bf16 v[140:143], a[144:147], a[120:123], v[140:143]
    v_mfma_f32_16x16x32_bf16 v[144:147], a[148:151], a[24:27], v[144:147]
    v_mfma_f32_16x16x32_bf16 v[148:151], a[148:151], a[56:59], v[148:151]
    buffer_load_dwordx4 v237, s[12:15], s31 offen offset:3168 lds
    v_mfma_f32_16x16x32_bf16 v[152:155], a[148:151], a[88:91], v[152:155]
    s_add_u32 s30, s30, 0x8000
    s_add_u32 s31, s31, 0x8000
    v_mfma_f32_16x16x32_bf16 v[156:159], a[148:151], a[120:123], v[156:159]
    s_waitcnt lgkmcnt(0)
    v_mfma_f32_16x16x32_bf16 v[128:131], a[152:155], a[28:31], v[128:131]
    v_mfma_f32_16x16x32_bf16 v[132:135], a[152:155], a[60:63], v[132:135]
    v_mfma_f32_16x16x32_bf16 v[136:139], a[152:155], a[92:95], v[136:139]
    v_mfma_f32_16x16x32_bf16 v[140:143], a[152:155], a[124:127], v[140:143]
    v_mfma_f32_16x16x32_bf16 v[144:147], a[156:159], a[28:31], v[144:147]
    v_mfma_f32_16x16x32_bf16 v[148:151], a[156:159], a[60:63], v[148:151]
    v_mfma_f32_16x16x32_bf16 v[152:155], a[156:159], a[92:95], v[152:155]
    v_mfma_f32_16x16x32_bf16 v[156:159], a[156:159], a[124:127], v[156:159]
    s_nop 7
    v_max3_f32 v240, v240, v128, v129
    v_max3_f32 v240, v240, v130, v131
    v_max3_f32 v240, v240, v144, v145
    v_max3_f32 v240, v240, v146, v147
    v_max3_f32 v241, v241, v132, v133
    v_max3_f32 v241, v241, v134, v135
    v_max3_f32 v241, v241, v148, v149
    v_max3_f32 v241, v241, v150, v151
    v_max3_f32 v242, v242, v136, v137
    v_max3_f32 v242, v242, v138, v139
    v_max3_f32 v242, v242, v152, v153
    v_max3_f32 v242, v242, v154, v155
    v_max3_f32 v243, v243, v140, v141
    v_max3_f32 v243, v243, v142, v143
    v_max3_f32 v243, v243, v156, v157
    v_max3_f32 v243, v243, v158, v159
    v_mov_b32 v244, v240
    v_mov_b32 v245, v241
    v_mov_b32 v246, v242
    v_mov_b32 v247, v243
    v_permlane16_swap_b32 v240, v244
    v_permlane16_swap_b32 v241, v245
    v_permlane16_swap_b32 v242, v246
    v_permlane16_swap_b32 v243, v247
    v_max_f32 v240, v240, v244
    v_max_f32 v241, v241, v245
    v_max_f32 v242, v242, v246
    v_max_f32 v243, v243, v247
    v_mov_b32 v244, v240
    v_mov_b32 v245, v241
    v_mov_b32 v246, v242
    v_mov_b32 v247, v243
    v_permlane32_swap_b32 v240, v244
    v_permlane32_swap_b32 v241, v245
    v_permlane32_swap_b32 v242, v246
    v_permlane32_swap_b32 v243, v247
    v_max_f32 v240, v240, v244
    v_max_f32 v241, v241, v245
    v_max_f32 v242, v242, v246
    v_max_f32 v243, v243, v247
    ds_write_b64 v227, v[240:241]
    ds_write_b64 v227, v[242:243] offset:512
    s_waitcnt vmcnt(8) lgkmcnt(0)
    s_barrier
    ds_read2st64_b64 v[192:195], v228 offset0:0 offset1:1
    ds_read_b128 a[128:131], v224 offset:33280
    ds_read_b128 a[132:135], v224 offset:33792
    ds_read_b128 a[136:139], v224 offset:33312
    ds_read_b128 a[140:143], v224 offset:33824
    s_waitcnt lgkmcnt(4)
    v_max_f32 v240, v240, v192
    v_add_f32 v240, s36, v240
    v_sub_f32 v196, 0, v240
    v_max_f32 v241, v241, v193
    v_add_f32 v241, s36, v241
    v_sub_f32 v198, 0, v241
    s_add_u32 m0, s32, 0
    v_max_f32 v242, v242, v194
    v_add_f32 v242, s36, v242
    v_sub_f32 v200, 0, v242
    v_max_f32 v243, v243, v195
    v_add_f32 v243, s36, v243
    buffer_load_dwordx4 v230, s[8:11], s28 offen offset:0 lds
    v_sub_f32 v202, 0, v243
    v_pk_add_f32 v[128:129], v[128:129], v[196:197] op_sel_hi:[1,0]
    v_pk_add_f32 v[130:131], v[130:131], v[196:197] op_sel_hi:[1,0]
    v_pk_add_f32 v[144:145], v[144:145], v[196:197] op_sel_hi:[1,0]
    v_pk_add_f32 v[146:147], v[146:147], v[196:197] op_sel_hi:[1,0]
    v_pk_add_f32 v[132:133], v[132:133], v[198:199] op_sel_hi:[1,0]
    buffer_load_dwordx4 v231, s[8:11], s28 offen offset:1040 lds
    v_pk_add_f32 v[134:135], v[134:135], v[198:199] op_sel_hi:[1,0]
    v_pk_add_f32 v[148:149], v[148:149], v[198:199] op_sel_hi:[1,0]
    v_pk_add_f32 v[150:151], v[150:151], v[198:199] op_sel_hi:[1,0]
    v_pk_add_f32 v[136:137], v[136:137], v[200:201] op_sel_hi:[1,0]
    v_pk_add_f32 v[138:139], v[138:139], v[200:201] op_sel_hi:[1,0]
    buffer_load_dwordx4 v232, s[8:11], s28 offen offset:2080 lds
    v_pk_add_f32 v[152:153], v[152:153], v[200:201] op_sel_hi:[1,0]
    v_pk_add_f32 v[154:155], v[154:155], v[200:201] op_sel_hi:[1,0]
    v_pk_add_f32 v[140:141], v[140:141], v[202:203] op_sel_hi:[1,0]
    v_pk_add_f32 v[142:143], v[142:143], v[202:203] op_sel_hi:[1,0]
    v_pk_add_f32 v[156:157], v[156:157], v[202:203] op_sel_hi:[1,0]
    v_pk_add_f32 v[158:159], v[158:159], v[202:203] op_sel_hi:[1,0]
    buffer_load_dwordx4 v233, s[8:11], s28 offen offset:3120 lds
    v_mov_b32 v238, v196
    v_mov_b32 v239, v196
    v_mov_b32 v240, v196
    v_mov_b32 v241, v196
    v_mov_b32 v242, v198
    s_add_u32 m0, s32, 4160
    v_mov_b32 v243, v198
    v_mov_b32 v244, v198
    v_mov_b32 v245, v198
    v_mov_b32 v246, v200
    v_mov_b32 v247, v200
    v_mov_b32 v248, v200
    buffer_load_dwordx4 v230, s[8:11], s29 offen offset:0 lds
    v_mov_b32 v249, v200
    v_mov_b32 v250, v202
    v_mov_b32 v251, v202
    v_mov_b32 v252, v202
    v_mov_b32 v253, v202
    buffer_load_dwordx4 v231, s[8:11], s29 offen offset:1040 lds
    v_exp_f32 v128, v128
    v_exp_f32 v129, v129
    v_exp_f32 v130, v130
    v_exp_f32 v131, v131
    v_exp_f32 v144, v144
    v_cvt_pk_bf16_f32 v192, v128, v129
    buffer_load_dwordx4 v232, s[8:11], s29 offen offset:2080 lds
    v_cvt_pk_bf16_f32 v193, v130, v131
    v_exp_f32 v145, v145
    v_exp_f32 v146, v146
    v_exp_f32 v147, v147
    v_exp_f32 v132, v132
    buffer_load_dwordx4 v233, s[8:11], s29 offen offset:3120 lds
    v_cvt_pk_bf16_f32 v194, v144, v145
    v_cvt_pk_bf16_f32 v195, v146, v147
    v_exp_f32 v133, v133
    v_exp_f32 v134, v134
    v_exp_f32 v135, v135
    v_exp_f32 v148, v148
    s_add_u32 s28, s28, 0x8000
    v_cvt_pk_bf16_f32 v196, v132, v133
    v_cvt_pk_bf16_f32 v197, v134, v135
    v_exp_f32 v149, v149
    v_exp_f32 v150, v150
    v_exp_f32 v151, v151
    s_min_u32 s28, s28, s37
    v_exp_f32 v136, v136
    v_cvt_pk_bf16_f32 v198, v148, v149
    v_cvt_pk_bf16_f32 v199, v150, v151
    v_exp_f32 v137, v137
    v_exp_f32 v138, v138
    s_add_u32 s29, s28, 2048
    s_mov_b64 exec, 1
    buffer_load_dword a255, v229, s[4:7], 0 offen
    buffer_load_dword a255, v229, s[4:7], 0 offen
    buffer_load_dword a255, v229, s[4:7], 0 offen
    buffer_load_dword a255, v229, s[4:7], 0 offen
    s_mov_b64 exec, -1
    s_waitcnt vmcnt(12) lgkmcnt(2)
    s_barrier
    s_mov_b32 s34, 15
KB_loop:
    v_mfma_f32_16x16x32_bf16 v[160:163], a[128:131], a[0:3], v[238:241]
    s_add_u32 m0, s33, 100352
    ds_read_b128 a[144:147], v224 offset:33344
    v_mfma_f32_16x16x32_bf16 v[164:167], a[128:131], a[32:35], v[242:245]
    ds_write_b64 v227, v[192:193] offset:0
    v_mfma_f32_16x16x32_bf16 v[168:171], a[128:131], a[64:67], v[246:249]
    buffer_load_dwordx4 v234, s[12:15], s30 offen offset:0 lds
    v_mfma_f32_16x16x32_bf16 v[172:175], a[128:131], a[96:99], v[250:253]
    ds_write_b64 v227, v[194:195] offset:512
    v_mfma_f32_16x16x32_bf16 v[176:179], a[132:135], a[0:3], v[238:241]
    ds_read_b128 a[148:151], v224 offset:33856
    v_mfma_f32_16x16x32_bf16 v[180:183], a[132:135], a[32:35], v[242:245]
    ds_write_b64 v227, v[196:197] offset:1024
    v_mfma_f32_16x16x32_bf16 v[184:187], a[132:135], a[64:67], v[246:249]
    v_exp_f32 v139, v139
    v_mfma_f32_16x16x32_bf16 v[188:191], a[132:135], a[96:99], v[250:253]
    s_waitcnt lgkmcnt(5)
    ds_write_b64 v227, v[198:199] offset:1536
    v_mfma_f32_16x16x32_bf16 v[160:163], a[136:139], a[4:7], v[160:163]
    ds_read_b128 a[152:155], v224 offset:33376
    v_mfma_f32_16x16x32_bf16 v[164:167], a[136:139], a[36:39], v[164:167]
    buffer_load_dwordx4 v235, s[12:15], s30 offen offset:1056 lds
    v_mfma_f32_16x16x32_bf16 v[168:171], a[136:139], a[68:71], v[168:171]
    v_exp_f32 v152, v152
    v_mfma_f32_16x16x32_bf16 v[172:175], a[136:139], a[100:103], v[172:175]
    v_cvt_pk_bf16_f32 v200, v136, v137
    v_cvt_pk_bf16_f32 v201, v138, v139
    v_mfma_f32_16x16x32_bf16 v[176:179], a[140:143], a[4:7], v[176:179]
    ds_read_b128 a[156:159], v224 offset:33888
    v_mfma_f32_16x16x32_bf16 v[180:183], a[140:143], a[36:39], v[180:183]
    ds_write_b64 v227, v[200:201] offset:2048
    v_mfma_f32_16x16x32_bf16 v[184:187], a[140:143], a[68:71], v[184:187]
    v_exp_f32 v153, v153
    v_mfma_f32_16x16x32_bf16 v[188:191], a[140:143], a[100:103], v[188:191]
    s_waitcnt lgkmcnt(5)
    v_exp_f32 v154, v154
    v_mfma_f32_16x16x32_bf16 v[160:163], a[144:147], a[8:11], v[160:163]
    ds_read_b128 a[128:131], v224 offset:33408
    v_mfma_f32_16x16x32_bf16 v[164:167], a[144:147], a[40:43], v[164:167]
    buffer_load_dwordx4 v236, s[12:15], s30 offen offset:2112 lds
    v_mfma_f32_16x16x32_bf16 v[168:171], a[144:147], a[72:75], v[168:171]
    v_exp_f32 v155, v155
    v_mfma_f32_16x16x32_bf16 v[172:175], a[144:147], a[104:107], v[172:175]
    v_exp_f32 v140, v140
    v_mfma_f32_16x16x32_bf16 v[176:179], a[148:151], a[8:11], v[176:179]
    ds_read_b128 a[132:135], v224 offset:33920
    v_cvt_pk_bf16_f32 v202, v152, v153
    v_mfma_f32_16x16x32_bf16 v[180:183], a[148:151], a[40:43], v[180:183]
    v_cvt_pk_bf16_f32 v203, v154, v155
    v_mfma_f32_16x16x32_bf16 v[184:187], a[148:151], a[72:75], v[184:187]
    ds_write_b64 v227, v[202:203] offset:2560
    v_mfma_f32_16x16x32_bf16 v[188:191], a[148:151], a[104:107], v[188:191]
    s_waitcnt lgkmcnt(4)
    v_exp_f32 v141, v141
    v_mfma_f32_16x16x32_bf16 v[160:163], a[152:155], a[12:15], v[160:163]
    ds_read_b128 a[136:139], v224 offset:33440
    v_mfma_f32_16x16x32_bf16 v[164:167], a[152:155], a[44:47], v[164:167]
    buffer_load_dwordx4 v237, s[12:15], s30 offen offset:3168 lds
    v_mfma_f32_16x16x32_bf16 v[168:171], a[152:155], a[76:79], v[168:171]
    v_exp_f32 v142, v142
    v_mfma_f32_16x16x32_bf16 v[172:175], a[152:155], a[108:111], v[172:175]
    v_exp_f32 v143, v143
    v_mfma_f32_16x16x32_bf16 v[176:179], a[156:159], a[12:15], v[176:179]
    ds_read_b128 a[140:143], v224 offset:33952
    v_mfma_f32_16x16x32_bf16 v[180:183], a[156:159], a[44:47], v[180:183]
    v_exp_f32 v156, v156
    v_mfma_f32_16x16x32_bf16 v[184:187], a[156:159], a[76:79], v[184:187]
    v_cvt_pk_bf16_f32 v204, v140, v141
    v_cvt_pk_bf16_f32 v205, v142, v143
    v_mfma_f32_16x16x32_bf16 v[188:191], a[156:159], a[108:111], v[188:191]
    s_waitcnt lgkmcnt(3)
    ds_write_b64 v227, v[204:205] offset:3072
    v_mfma_f32_16x16x32_bf16 v[160:163], a[128:131], a[16:19], v[160:163]
    s_add_u32 m0, s33, 104576
    ds_read_b128 a[144:147], v224 offset:33472
    v_mfma_f32_16x16x32_bf16 v[164:167], a[128:131], a[48:51], v[164:167]
    buffer_load_dwordx4 v234, s[12:15], s31 offen offset:0 lds
    v_mfma_f32_16x16x32_bf16 v[168:171], a[128:131], a[80:83], v[168:171]
    v_exp_f32 v157, v157
    v_mfma_f32_16x16x32_bf16 v[172:175], a[128:131], a[112:115], v[172:175]
    v_exp_f32 v158, v158
    v_mfma_f32_16x16x32_bf16 v[176:179], a[132:135], a[16:19], v[176:179]
    ds_read_b128 a[148:151], v224 offset:33984
    v_mfma_f32_16x16x32_bf16 v[180:183], a[132:135], a[48:51], v[180:183]
    v_exp_f32 v159, v159
    v_mfma_f32_16x16x32_bf16 v[184:187], a[132:135], a[80:83], v[184:187]
    v_cvt_pk_bf16_f32 v206, v156, v157
    v_cvt_pk_bf16_f32 v207, v158, v159
    v_mfma_f32_16x16x32_bf16 v[188:191], a[132:135], a[112:115], v[188:191]
    s_waitcnt lgkmcnt(3)
    ds_write_b64 v227, v[206:207] offset:3584
    v_mfma_f32_16x16x32_bf16 v[160:163], a[136:139], a[20:23], v[160:163]
    ds_read_b128 a[152:155], v224 offset:33504
    v_mfma_f32_16x16x32_bf16 v[164:167], a[136:139], a[52:55], v[164:167]
    buffer_load_dwordx4 v235, s[12:15], s31 offen offset:1056 lds
    v_mfma_f32_16x16x32_bf16 v[168:171], a[136:139], a[84:87], v[168:171]
    v_mfma_f32_16x16x32_bf16 v[172:175], a[136:139], a[116:119], v[172:175]
    v_mfma_f32_16x16x32_bf16 v[176:179], a[140:143], a[20:23], v[176:179]
    ds_read_b128 a[156:159], v224 offset:34016
    v_mfma_f32_16x16x32_bf16 v[180:183], a[140:143], a[52:55], v[180:183]
    v_mfma_f32_16x16x32_bf16 v[184:187], a[140:143], a[84:87], v[184:187]
    v_mfma_f32_16x16x32_bf16 v[188:191], a[140:143], a[116:119], v[188:191]
    s_waitcnt lgkmcnt(3)
    v_mfma_f32_16x16x32_bf16 v[160:163], a[144:147], a[24:27], v[160:163]
    ds_read_b64_tr_b16 a[128:129], v225 offset:0
    ds_read_b64_tr_b16 a[130:131], v225 offset:8448
    v_mfma_f32_16x16x32_bf16 v[164:167], a[144:147], a[56:59], v[164:167]
    buffer_load_dwordx4 v236, s[12:15], s31 offen offset:2112 lds
    v_mfma_f32_16x16x32_bf16 v[168:171], a[144:147], a[88:91], v[168:171]
    v_mfma_f32_16x16x32_bf16 v[172:175], a[144:147], a[120:123], v[172:175]
    v_mfma_f32_16x16x32_bf16 v[176:179], a[148:151], a[24:27], v[176:179]
    ds_read_b64_tr_b16 a[132:133], v225 offset:32
    ds_read_b64_tr_b16 a[134:135], v225 offset:8480
    v_mfma_f32_16x16x32_bf16 v[180:183], a[148:151], a[56:59], v[180:183]
    v_mfma_f32_16x16x32_bf16 v[184:187], a[148:151], a[88:91], v[184:187]
    v_mfma_f32_16x16x32_bf16 v[188:191], a[148:151], a[120:123], v[188:191]
    s_waitcnt lgkmcnt(4)
    v_mfma_f32_16x16x32_bf16 v[160:163], a[152:155], a[28:31], v[160:163]
    ds_read_b64_tr_b16 a[136:137], v225 offset:64
    ds_read_b64_tr_b16 a[138:139], v225 offset:8512
    v_mfma_f32_16x16x32_bf16 v[164:167], a[152:155], a[60:63], v[164:167]
    buffer_load_dwordx4 v237, s[12:15], s31 offen offset:3168 lds
    v_mfma_f32_16x16x32_bf16 v[168:171], a[152:155], a[92:95], v[168:171]
    s_add_u32 s30, s30, 0x8000
    s_add_u32 s31, s31, 0x8000
    v_mfma_f32_16x16x32_bf16 v[172:175], a[152:155], a[124:127], v[172:175]
    v_mfma_f32_16x16x32_bf16 v[176:179], a[156:159], a[28:31], v[176:179]
    ds_read_b64_tr_b16 a[140:141], v225 offset:96
    ds_read_b64_tr_b16 a[142:143], v225 offset:8544
    v_mfma_f32_16x16x32_bf16 v[180:183], a[156:159], a[60:63], v[180:183]
    v_mfma_f32_16x16x32_bf16 v[184:187], a[156:159], a[92:95], v[184:187]
    v_mfma_f32_16x16x32_bf16 v[188:191], a[156:159], a[124:127], v[188:191]
    s_waitcnt vmcnt(12) lgkmcnt(10)
    s_barrier
    v_mfma_f32_16x16x32_bf16 a[192:195], a[208:211], v[192:195], a[192:195]
    s_sub_u32 s44, s34, 10
    ds_read2st64_b64 a[160:163], v228 offset0:0 offset1:1
    v_mfma_f32_16x16x32_bf16 a[196:199], a[208:211], v[196:199], a[196:199]
    s_min_u32 m0, s44, 4
    ds_read2st64_b64 a[164:167], v228 offset0:2 offset1:3
    v_mfma_f32_16x16x32_bf16 a[200:203], a[208:211], v[200:203], a[200:203]
    s_cmp_eq_u32 s34, 9
    ds_read2st64_b64 a[168:171], v228 offset0:4 offset1:5
    v_mfma_f32_16x16x32_bf16 a[204:207], a[208:211], v[204:207], a[204:207]
    s_waitcnt lgkmcnt(7)
    ds_read2st64_b64 a[172:175], v228 offset0:6 offset1:7
    v_mfma_f32_16x16x32_bf16 v[0:3], a[128:131], v[192:195], v[0:3]
    s_cselect_b32 m0, 0, m0
    ds_read_b64_tr_b16 a[144:145], v225 offset:128
    ds_read_b64_tr_b16 a[146:147], v225 offset:8576
    v_mfma_f32_16x16x32_bf16 v[4:7], a[128:131], v[196:199], v[4:7]
    s_cselect_b32 s18, 1, 0
    s_movrels_b32 s43, s93
    v_mfma_f32_16x16x32_bf16 v[8:11], a[128:131], v[200:203], v[8:11]
    s_sub_u32 s44, s34, 11
    s_cmp_lt_u32 s44, s47
    v_mfma_f32_16x16x32_bf16 v[12:15], a[128:131], v[204:207], v[12:15]
    s_cselect_b32 s18, 256, s18
    s_add_u32 m0, s32, 33280
    v_mfma_f32_16x16x32_bf16 v[16:19], a[132:135], v[192:195], v[16:19]
    ds_read_b64_tr_b16 a[148:149], v225 offset:160
    ds_read_b64_tr_b16 a[150:151], v225 offset:8608
    v_mfma_f32_16x16x32_bf16 v[20:23], a[132:135], v[196:199], v[20:23]
    buffer_load_dwordx4 v230, s[8:11], s28 offen offset:0 lds
    v_mfma_f32_16x16x32_bf16 v[24:27], a[132:135], v[200:203], v[24:27]
    buffer_load_dwordx4 v231, s[8:11], s28 offen offset:1040 lds
    v_mfma_f32_16x16x32_bf16 v[28:31], a[132:135], v[204:207], v[28:31]
    s_waitcnt lgkmcnt(8)
    v_exp_f32 v160, v160
    v_mfma_f32_16x16x32_bf16 v[32:35], a[136:139], v[192:195], v[32:35]
    ds_read_b64_tr_b16 a[152:153], v225 offset:192
    ds_read_b64_tr_b16 a[154:155], v225 offset:8640
    v_mfma_f32_16x16x32_bf16 v[36:39], a[136:139], v[196:199], v[36:39]
    v_exp_f32 v161, v161
    v_mfma_f32_16x16x32_bf16 v[40:43], a[136:139], v[200:203], v[40:43]
    v_exp_f32 v162, v162
    v_mfma_f32_16x16x32_bf16 v[44:47], a[136:139], v[204:207], v[44:47]
    v_exp_f32 v163, v163
    v_mfma_f32_16x16x32_bf16 v[48:51], a[140:143], v[192:195], v[48:51]
    ds_read_b64_tr_b16 a[156:157], v225 offset:224
    ds_read_b64_tr_b16 a[158:159], v225 offset:8672
    v_mfma_f32_16x16x32_bf16 v[52:55], a[140:143], v[196:199], v[52:55]
    buffer_load_dwordx4 v232, s[8:11], s28 offen offset:2080 lds
    v_mfma_f32_16x16x32_bf16 v[56:59], a[140:143], v[200:203], v[56:59]
    v_exp_f32 v176, v176
    v_mfma_f32_16x16x32_bf16 v[60:63], a[140:143], v[204:207], v[60:63]
    s_waitcnt lgkmcnt(4)
    v_cvt_pk_bf16_f32 v208, v160, v161
    v_cvt_pk_bf16_f32 v209, v162, v163
    v_mfma_f32_16x16x32_bf16 v[64:67], a[144:147], v[192:195], v[64:67]
    ds_read_b64_tr_b16 a[128:129], v226 offset:0
    ds_read_b64_tr_b16 a[130:131], v226 offset:8448
    v_mfma_f32_16x16x32_bf16 v[68:71], a[144:147], v[196:199], v[68:71]
    v_exp_f32 v177, v177
    v_mfma_f32_16x16x32_bf16 v[72:75], a[144:147], v[200:203], v[72:75]
    v_exp_f32 v178, v178
    v_mfma_f32_16x16x32_bf16 v[76:79], a[144:147], v[204:207], v[76:79]
    v_exp_f32 v179, v179
    v_mfma_f32_16x16x32_bf16 v[80:83], a[148:151], v[192:195], v[80:83]
    ds_read_b64_tr_b16 a[132:133], v226 offset:32
    ds_read_b64_tr_b16 a[134:135], v226 offset:8480
    v_mfma_f32_16x16x32_bf16 v[84:87], a[148:151], v[196:199], v[84:87]
    buffer_load_dwordx4 v233, s[8:11], s28 offen offset:3120 lds
    v_mfma_f32_16x16x32_bf16 v[88:91], a[148:151], v[200:203], v[88:91]
    v_exp_f32 v164, v164
    v_mfma_f32_16x16x32_bf16 v[92:95], a[148:151], v[204:207], v[92:95]
    s_waitcnt lgkmcnt(4)
    v_cvt_pk_bf16_f32 v210, v176, v177
    v_cvt_pk_bf16_f32 v211, v178, v179
    v_mfma_f32_16x16x32_bf16 v[96:99], a[152:155], v[192:195], v[96:99]
    ds_read_b64_tr_b16 a[136:137], v226 offset:64
    ds_read_b64_tr_b16 a[138:139], v226 offset:8512
    v_mfma_f32_16x16x32_bf16 v[100:103], a[152:155], v[196:199], v[100:103]
    v_exp_f32 v165, v165
    v_mfma_f32_16x16x32_bf16 v[104:107], a[152:155], v[200:203], v[104:107]
    v_exp_f32 v166, v166
    v_mfma_f32_16x16x32_bf16 v[108:111], a[152:155], v[204:207], v[108:111]
    v_exp_f32 v167, v167
    v_mfma_f32_16x16x32_bf16 v[112:115], a[156:159], v[192:195], v[112:115]
    s_add_u32 m0, s32, 37440
    ds_read_b64_tr_b16 a[140:141], v226 offset:96
    ds_read_b64_tr_b16 a[142:143], v226 offset:8544
    v_mfma_f32_16x16x32_bf16 v[116:119], a[156:159], v[196:199], v[116:119]
    buffer_load_dwordx4 v230, s[8:11], s29 offen offset:0 lds
    v_mfma_f32_16x16x32_bf16 v[120:123], a[156:159], v[200:203], v[120:123]
    v_exp_f32 v180, v180
    v_mfma_f32_16x16x32_bf16 v[124:127], a[156:159], v[204:207], v[124:127]
    s_waitcnt lgkmcnt(4)
    v_cvt_pk_bf16_f32 v212, v164, v165
    v_cvt_pk_bf16_f32 v213, v166, v167
    v_mfma_f32_16x16x32_bf16 v[0:3], a[128:131], a[160:163], v[0:3]
    ds_read_b64_tr_b16 a[144:145], v226 offset:128
    ds_read_b64_tr_b16 a[146:147], v226 offset:8576
    v_mfma_f32_16x16x32_bf16 v[4:7], a[128:131], a[164:167], v[4:7]
    v_exp_f32 v181, v181
    v_mfma_f32_16x16x32_bf16 v[8:11], a[128:131], a[168:171], v[8:11]
    v_exp_f32 v182, v182
    v_mfma_f32_16x16x32_bf16 v[12:15], a[128:131], a[172:175], v[12:15]
    v_exp_f32 v183, v183
    v_mfma_f32_16x16x32_bf16 v[16:19], a[132:135], a[160:163], v[16:19]
    ds_read_b64_tr_b16 a[148:149], v226 offset:160
    ds_read_b64_tr_b16 a[150:151], v226 offset:8608
    v_mfma_f32_16x16x32_bf16 v[20:23], a[132:135], a[164:167], v[20:23]
    buffer_load_dwordx4 v231, s[8:11], s29 offen offset:1040 lds
    v_mfma_f32_16x16x32_bf16 v[24:27], a[132:135], a[168:171], v[24:27]
    v_exp_f32 v168, v168
    v_mfma_f32_16x16x32_bf16 v[28:31], a[132:135], a[172:175], v[28:31]
    s_waitcnt lgkmcnt(4)
    v_cvt_pk_bf16_f32 v214, v180, v181
    v_cvt_pk_bf16_f32 v215, v182, v183
    v_mfma_f32_16x16x32_bf16 v[32:35], a[136:139], a[160:163], v[32:35]
    ds_read_b64_tr_b16 a[152:153], v226 offset:192
    ds_read_b64_tr_b16 a[154:155], v226 offset:8640
    v_mfma_f32_16x16x32_bf16 v[36:39], a[136:139], a[164:167], v[36:39]
    v_exp_f32 v169, v169
    v_mfma_f32_16x16x32_bf16 v[40:43], a[136:139], a[168:171], v[40:43]
    v_exp_f32 v170, v170
    v_mfma_f32_16x16x32_bf16 v[44:47], a[136:139], a[172:175], v[44:47]
    v_mfma_f32_16x16x32_bf16 v[48:51], a[140:143], a[160:163], v[48:51]
    ds_read_b64_tr_b16 a[156:157], v226 offset:224
    ds_read_b64_tr_b16 a[158:159], v226 offset:8672
    v_mfma_f32_16x16x32_bf16 v[52:55], a[140:143], a[164:167], v[52:55]
    buffer_load_dwordx4 v232, s[8:11], s29 offen offset:2080 lds
    v_mfma_f32_16x16x32_bf16 v[56:59], a[140:143], a[168:171], v[56:59]
    v_mfma_f32_16x16x32_bf16 v[60:63], a[140:143], a[172:175], v[60:63]
    s_waitcnt lgkmcnt(4)
    v_mfma_f32_16x16x32_bf16 v[64:67], a[144:147], a[160:163], v[64:67]
    ds_read_b128 a[128:131], v224 offset:0
    v_mfma_f32_16x16x32_bf16 v[68:71], a[144:147], a[164:167], v[68:71]
    v_mfma_f32_16x16x32_bf16 v[72:75], a[144:147], a[168:171], v[72:75]
    v_mfma_f32_16x16x32_bf16 v[76:79], a[144:147], a[172:175], v[76:79]
    v_mfma_f32_16x16x32_bf16 v[80:83], a[148:151], a[160:163], v[80:83]
    ds_read_b128 a[132:135], v224 offset:512
    v_mfma_f32_16x16x32_bf16 v[84:87], a[148:151], a[164:167], v[84:87]
    buffer_load_dwordx4 v233, s[8:11], s29 offen offset:3120 lds
    v_mfma_f32_16x16x32_bf16 v[88:91], a[148:151], a[168:171], v[88:91]
    s_add_u32 s28, s28, 0x8000
    s_min_u32 s28, s28, s37
    v_mfma_f32_16x16x32_bf16 v[92:95], a[148:151], a[172:175], v[92:95]
    s_waitcnt lgkmcnt(2)
    s_add_u32 s29, s28, 2048
    v_mfma_f32_16x16x32_bf16 v[96:99], a[152:155], a[160:163], v[96:99]
    ds_read_b128 a[136:139], v224 offset:32
    v_mfma_f32_16x16x32_bf16 v[100:103], a[152:155], a[164:167], v[100:103]
    v_mfma_f32_16x16x32_bf16 v[104:107], a[152:155], a[168:171], v[104:107]
    v_mfma_f32_16x16x32_bf16 v[108:111], a[152:155], a[172:175], v[108:111]
    v_mfma_f32_16x16x32_bf16 v[112:115], a[156:159], a[160:163], v[112:115]
    ds_read_b128 a[140:143], v224 offset:544
    v_mfma_f32_16x16x32_bf16 v[116:119], a[156:159], a[164:167], v[116:119]
    v_mfma_f32_16x16x32_bf16 v[120:123], a[156:159], a[168:171], v[120:123]
    v_mfma_f32_16x16x32_bf16 v[124:127], a[156:159], a[172:175], v[124:127]
    s_waitcnt vmcnt(8) lgkmcnt(2)
    s_barrier
    v_mfma_f32_16x16x32_bf16 v[128:131], a[128:131], a[0:3], v[238:241]
    s_sub_u32 s45, s34, 1
    ds_read_b128 a[144:147], v224 offset:64
    v_mfma_f32_16x16x32_bf16 v[132:135], a[128:131], a[32:35], v[242:245]
    s_min_u32 s45, s45, 8
    ds_write_b64 v227, v[208:209] offset:0
    v_mfma_f32_16x16x32_bf16 v[136:139], a[128:131], a[64:67], v[246:249]
    s_mul_i32 m0, s45, 3
    s_nop 0
    s_movrels_b32 s4, s64
    v_mfma_f32_16x16x32_bf16 v[140:143], a[128:131], a[96:99], v[250:253]
    s_movrels_b32 s5, s65
    ds_write_b64 v227, v[210:211] offset:512
    v_mfma_f32_16x16x32_bf16 v[144:147], a[132:135], a[0:3], v[238:241]
    s_movrels_b32 s6, s66
    ds_read_b128 a[148:151], v224 offset:576
    v_mfma_f32_16x16x32_bf16 v[148:151], a[132:135], a[32:35], v[242:245]
    s_add_u32 m0, s33, 66560
    ds_write_b64 v227, v[212:213] offset:1024
    v_mfma_f32_16x16x32_bf16 v[152:155], a[132:135], a[64:67], v[246:249]
    buffer_load_dwordx4 v234, s[12:15], s30 offen offset:0 lds
    v_mfma_f32_16x16x32_bf16 v[156:159], a[132:135], a[96:99], v[250:253]
    s_waitcnt lgkmcnt(5)
    ds_write_b64 v227, v[214:215] offset:1536
    v_mfma_f32_16x16x32_bf16 v[128:131], a[136:139], a[4:7], v[128:131]
    ds_read_b128 a[152:155], v224 offset:96
    v_mfma_f32_16x16x32_bf16 v[132:135], a[136:139], a[36:39], v[132:135]
    buffer_load_dwordx4 v235, s[12:15], s30 offen offset:1056 lds
    v_mfma_f32_16x16x32_bf16 v[136:139], a[136:139], a[68:71], v[136:139]
    v_exp_f32 v171, v171
    v_mfma_f32_16x16x32_bf16 v[140:143], a[136:139], a[100:103], v[140:143]
    v_exp_f32 v184, v184
    v_mfma_f32_16x16x32_bf16 v[144:147], a[140:143], a[4:7], v[144:147]
    ds_read_b128 a[156:159], v224 offset:608
    v_cvt_pk_bf16_f32 v216, v168, v169
    v_mfma_f32_16x16x32_bf16 v[148:151], a[140:143], a[36:39], v[148:151]
    v_cvt_pk_bf16_f32 v217, v170, v171
    v_mfma_f32_16x16x32_bf16 v[152:155], a[140:143], a[68:71], v[152:155]
    ds_write_b64 v227, v[216:217] offset:2048
    v_mfma_f32_16x16x32_bf16 v[156:159], a[140:143], a[100:103], v[156:159]
    s_waitcnt lgkmcnt(5)
    v_exp_f32 v185, v185
    v_mfma_f32_16x16x32_bf16 v[128:131], a[144:147], a[8:11], v[128:131]
    ds_read_b128 a[128:131], v224 offset:128
    v_mfma_f32_16x16x32_bf16 v[132:135], a[144:147], a[40:43], v[132:135]
    buffer_load_dwordx4 v236, s[12:15], s30 offen offset:2112 lds
    v_mfma_f32_16x16x32_bf16 v[136:139], a[144:147], a[72:75], v[136:139]
    v_exp_f32 v186, v186
    v_mfma_f32_16x16x32_bf16 v[140:143], a[144:147], a[104:107], v[140:143]
    v_exp_f32 v187, v187
    v_mfma_f32_16x16x32_bf16 v[144:147], a[148:151], a[8:11], v[144:147]
    ds_read_b128 a[132:135], v224 offset:640
    v_mfma_f32_16x16x32_bf16 v[148:151], a[148:151], a[40:43], v[148:151]
    v_exp_f32 v172, v172
    v_mfma_f32_16x16x32_bf16 v[152:155], a[148:151], a[72:75], v[152:155]
    v_cvt_pk_bf16_f32 v218, v184, v185
    v_cvt_pk_bf16_f32 v219, v186, v187
    v_mfma_f32_16x16x32_bf16 v[156:159], a[148:151], a[104:107], v[156:159]
    s_waitcnt lgkmcnt(3)
    ds_write_b64 v227, v[218:219] offset:2560
    v_mfma_f32_16x16x32_bf16 v[128:131], a[152:155], a[12:15], v[128:131]
    ds_read_b128 a[136:139], v224 offset:160
    v_mfma_f32_16x16x32_bf16 v[132:135], a[152:155], a[44:47], v[132:135]
    buffer_load_dwordx4 v237, s[12:15], s30 offen offset:3168 lds
    v_mfma_f32_16x16x32_bf16 v[136:139], a[152:155], a[76:79], v[136:139]
    v_exp_f32 v173, v173
    v_mfma_f32_16x16x32_bf16 v[140:143], a[152:155], a[108:111], v[140:143]
    v_exp_f32 v174, v174
    v_mfma_f32_16x16x32_bf16 v[144:147], a[156:159], a[12:15], v[144:147]
    ds_read_b128 a[140:143], v224 offset:672
    v_mfma_f32_16x16x32_bf16 v[148:151], a[156:159], a[44:47], v[148:151]
    v_exp_f32 v175, v175
    v_mfma_f32_16x16x32_bf16 v[152:155], a[156:159], a[76:79], v[152:155]
    v_exp_f32 v188, v188
    v_mfma_f32_16x16x32_bf16 v[156:159], a[156:159], a[108:111], v[156:159]
    s_waitcnt lgkmcnt(3)
    v_cvt_pk_bf16_f32 v220, v172, v173
    v_cvt_pk_bf16_f32 v221, v174, v175
    v_mfma_f32_16x16x32_bf16 v[128:131], a[128:131], a[16:19], v[128:131]
    s_add_u32 m0, s33, 70784
    ds_read_b128 a[144:147], v224 offset:192
    v_mfma_f32_16x16x32_bf16 v[132:135], a[128:131], a[48:51], v[132:135]
    buffer_load_dwordx4 v234, s[12:15], s31 offen offset:0 lds
    v_mfma_f32_16x16x32_bf16 v[136:139], a[128:131], a[80:83], v[136:139]
    ds_write_b64 v227, v[220:221] offset:3072
    v_mfma_f32_16x16x32_bf16 v[140:143], a[128:131], a[112:115], v[140:143]
    v_exp_f32 v189, v189
    v_mfma_f32_16x16x32_bf16 v[144:147], a[132:135], a[16:19], v[144:147]
    ds_read_b128 a[148:151], v224 offset:704
    v_mfma_f32_16x16x32_bf16 v[148:151], a[132:135], a[48:51], v[148:151]
    v_exp_f32 v190, v190
    v_mfma_f32_16x16x32_bf16 v[152:155], a[132:135], a[80:83], v[152:155]
    v_exp_f32 v191, v191
    v_mfma_f32_16x16x32_bf16 v[156:159], a[132:135], a[112:115], v[156:159]
    s_waitcnt lgkmcnt(3)
    v_cvt_pk_bf16_f32 v222, v188, v189
    v_cvt_pk_bf16_f32 v223, v190, v191
    v_mfma_f32_16x16x32_bf16 v[128:131], a[136:139], a[20:23], v[128:131]
    ds_read_b128 a[152:155], v224 offset:224
    v_mfma_f32_16x16x32_bf16 v[132:135], a[136:139], a[52:55], v[132:135]
    buffer_load_dwordx4 v235, s[12:15], s31 offen offset:1056 lds
    v_mfma_f32_16x16x32_bf16 v[136:139], a[136:139], a[84:87], v[136:139]
    ds_write_b64 v227, v[222:223] offset:3584
    v_mfma_f32_16x16x32_bf16 v[140:143], a[136:139], a[116:119], v[140:143]
    v_mfma_f32_16x16x32_bf16 v[144:147], a[140:143], a[20:23], v[144:147]
    ds_read_b128 a[156:159], v224 offset:736
    v_mfma_f32_16x16x32_bf16 v[148:151], a[140:143], a[52:55], v[148:151]
    v_mfma_f32_16x16x32_bf16 v[152:155], a[140:143], a[84:87], v[152:155]
    v_mfma_f32_16x16x32_bf16 v[156:159], a[140:143], a[116:119], v[156:159]
    s_waitcnt lgkmcnt(3)
    v_mfma_f32_16x16x32_bf16 v[128:131], a[144:147], a[24:27], v[128:131]
    ds_read_b64_tr_b16 a[128:129], v225 offset:33792
    ds_read_b64_tr_b16 a[130:131], v225 offset:42240
    v_mfma_f32_16x16x32_bf16 v[132:135], a[144:147], a[56:59], v[132:135]
    buffer_load_dwordx4 v236, s[12:15], s31 offen offset:2112 lds
    v_mfma_f32_16x16x32_bf16 v[136:139], a[144:147], a[88:91], v[136:139]
    v_mfma_f32_16x16x32_bf16 v[140:143], a[144:147], a[120:123], v[140:143]
    v_mfma_f32_16x16x32_bf16 v[144:147], a[148:151], a[24:27], v[144:147]
    ds_read_b64_tr_b16 a[132:133], v225 offset:33824
    ds_read_b64_tr_b16 a[134:135], v225 offset:42272
    v_mfma_f32_16x16x32_bf16 v[148:151], a[148:151], a[56:59], v[148:151]
    v_mfma_f32_16x16x32_bf16 v[152:155], a[148:151], a[88:91], v[152:155]
    v_mfma_f32_16x16x32_bf16 v[156:159], a[148:151], a[120:123], v[156:159]
    s_waitcnt lgkmcnt(4)
    v_mfma_f32_16x16x32_bf16 v[128:131], a[152:155], a[28:31], v[128:131]
    ds_read_b64_tr_b16 a[136:137], v225 offset:33856
    ds_read_b64_tr_b16 a[138:139], v225 offset:42304
    v_mfma_f32_16x16x32_bf16 v[132:135], a[152:155], a[60:63], v[132:135]
    buffer_load_dwordx4 v237, s[12:15], s31 offen offset:3168 lds
    v_mfma_f32_16x16x32_bf16 v[136:139], a[152:155], a[92:95], v[136:139]
    s_add_u32 s30, s30, 0x8000
    s_add_u32 s31, s31, 0x8000
    v_mfma_f32_16x16x32_bf16 v[140:143], a[152:155], a[124:127], v[140:143]
    v_mfma_f32_16x16x32_bf16 v[144:147], a[156:159], a[28:31], v[144:147]
    ds_read_b64_tr_b16 a[140:141], v225 offset:33888
    ds_read_b64_tr_b16 a[142:143], v225 offset:42336
    v_mfma_f32_16x16x32_bf16 v[148:151], a[156:159], a[60:63], v[148:151]
    v_mfma_f32_16x16x32_bf16 v[152:155], a[156:159], a[92:95], v[152:155]
    v_mfma_f32_16x16x32_bf16 v[156:159], a[156:159], a[124:127], v[156:159]
    s_waitcnt vmcnt(8) lgkmcnt(9)
    s_barrier
    v_mfma_f32_16x16x32_bf16 a[192:195], a[208:211], v[208:211], a[192:195]
    s_add_u32 m0, s32, 0
    ds_read2st64_b64 a[160:163], v228 offset0:0 offset1:1
    v_mfma_f32_16x16x32_bf16 a[196:199], a[208:211], v[212:215], a[196:199]
    ds_read2st64_b64 a[164:167], v228 offset0:2 offset1:3
    v_mfma_f32_16x16x32_bf16 a[200:203], a[208:211], v[216:219], a[200:203]
    ds_read2st64_b64 a[168:171], v228 offset0:4 offset1:5
    v_mfma_f32_16x16x32_bf16 a[204:207], a[208:211], v[220:223], a[204:207]
    s_waitcnt lgkmcnt(7)
    ds_read2st64_b64 a[172:175], v228 offset0:6 offset1:7
    v_mfma_f32_16x16x32_bf16 v[0:3], a[128:131], v[208:211], v[0:3]
    ds_read_b64_tr_b16 a[144:145], v225 offset:33920
    ds_read_b64_tr_b16 a[146:147], v225 offset:42368
    v_mfma_f32_16x16x32_bf16 v[4:7], a[128:131], v[212:215], v[4:7]
    buffer_load_dwordx4 v230, s[8:11], s28 offen offset:0 lds
    v_mfma_f32_16x16x32_bf16 v[8:11], a[128:131], v[216:219], v[8:11]
    v_exp_f32 v128, v128
    v_mfma_f32_16x16x32_bf16 v[12:15], a[128:131], v[220:223], v[12:15]
    v_exp_f32 v129, v129
    v_mfma_f32_16x16x32_bf16 v[16:19], a[132:135], v[208:211], v[16:19]
    ds_read_b64_tr_b16 a[148:149], v225 offset:33952
    ds_read_b64_tr_b16 a[150:151], v225 offset:42400
    v_mfma_f32_16x16x32_bf16 v[20:23], a[132:135], v[212:215], v[20:23]
    buffer_load_dwordx4 v231, s[8:11], s28 offen offset:1040 lds
    v_mfma_f32_16x16x32_bf16 v[24:27], a[132:135], v[216:219], v[24:27]
    v_exp_f32 v130, v130
    v_mfma_f32_16x16x32_bf16 v[28:31], a[132:135], v[220:223], v[28:31]
    s_waitcnt lgkmcnt(8)
    v_exp_f32 v131, v131
    v_mfma_f32_16x16x32_bf16 v[32:35], a[136:139], v[208:211], v[32:35]
    ds_read_b64_tr_b16 a[152:153], v225 offset:33984
    ds_read_b64_tr_b16 a[154:155], v225 offset:42432
    v_mfma_f32_16x16x32_bf16 v[36:39], a[136:139], v[212:215], v[36:39]
    v_exp_f32 v144, v144
    v_mfma_f32_16x16x32_bf16 v[40:43], a[136:139], v[216:219], v[40:43]
    v_cvt_pk_bf16_f32 v192, v128, v129
    v_cvt_pk_bf16_f32 v193, v130, v131
    v_mfma_f32_16x16x32_bf16 v[44:47], a[136:139], v[220:223], v[44:47]
    v_exp_f32 v145, v145
    v_mfma_f32_16x16x32_bf16 v[48:51], a[140:143], v[208:211], v[48:51]
    ds_read_b64_tr_b16 a[156:157], v225 offset:34016
    ds_read_b64_tr_b16 a[158:159], v225 offset:42464
    v_mfma_f32_16x16x32_bf16 v[52:55], a[140:143], v[212:215], v[52:55]
    buffer_load_dwordx4 v232, s[8:11], s28 offen offset:2080 lds
    v_mfma_f32_16x16x32_bf16 v[56:59], a[140:143], v[216:219], v[56:59]
    v_exp_f32 v146, v146
    v_mfma_f32_16x16x32_bf16 v[60:63], a[140:143], v[220:223], v[60:63]
    s_waitcnt lgkmcnt(4)
    v_exp_f32 v147, v147
    v_mfma_f32_16x16x32_bf16 v[64:67], a[144:147], v[208:211], v[64:67]
    ds_read_b64_tr_b16 a[128:129], v226 offset:33792
    ds_read_b64_tr_b16 a[130:131], v226 offset:42240
    v_mfma_f32_16x16x32_bf16 v[68:71], a[144:147], v[212:215], v[68:71]
    v_exp_f32 v132, v132
    v_mfma_f32_16x16x32_bf16 v[72:75], a[144:147], v[216:219], v[72:75]
    v_cvt_pk_bf16_f32 v194, v144, v145
    v_cvt_pk_bf16_f32 v195, v146, v147
    v_mfma_f32_16x16x32_bf16 v[76:79], a[144:147], v[220:223], v[76:79]
    v_exp_f32 v133, v133
    v_mfma_f32_16x16x32_bf16 v[80:83], a[148:151], v[208:211], v[80:83]
    ds_read_b64_tr_b16 a[132:133], v226 offset:33824
    ds_read_b64_tr_b16 a[134:135], v226 offset:42272
    v_mfma_f32_16x16x32_bf16 v[84:87], a[148:151], v[212:215], v[84:87]
    buffer_load_dwordx4 v233, s[8:11], s28 offen offset:3120 lds
    v_mfma_f32_16x16x32_bf16 v[88:91], a[148:151], v[216:219], v[88:91]
    v_exp_f32 v134, v134
    v_mfma_f32_16x16x32_bf16 v[92:95], a[148:151], v[220:223], v[92:95]
    s_waitcnt lgkmcnt(4)
    v_exp_f32 v135, v135
    v_mfma_f32_16x16x32_bf16 v[96:99], a[152:155], v[208:211], v[96:99]
    ds_read_b64_tr_b16 a[136:137], v226 offset:33856
    ds_read_b64_tr_b16 a[138:139], v226 offset:42304
    v_mfma_f32_16x16x32_bf16 v[100:103], a[152:155], v[212:215], v[100:103]
    v_exp_f32 v148, v148
    v_mfma_f32_16x16x32_bf16 v[104:107], a[152:155], v[216:219], v[104:107]
    v_cvt_pk_bf16_f32 v196, v132, v133
    v_cvt_pk_bf16_f32 v197, v134, v135
    v_mfma_f32_16x16x32_bf16 v[108:111], a[152:155], v[220:223], v[108:111]
    v_exp_f32 v149, v149
    v_mfma_f32_16x16x32_bf16 v[112:115], a[156:159], v[208:211], v[112:115]
    s_add_u32 m0, s32, 4160
    ds_read_b64_tr_b16 a[140:141], v226 offset:33888
    ds_read_b64_tr_b16 a[142:143], v226 offset:42336
    v_mfma_f32_16x16x32_bf16 v[116:119], a[156:159], v[212:215], v[116:119]
    buffer_load_dwordx4 v230, s[8:11], s29 offen offset:0 lds
    v_mfma_f32_16x16x32_bf16 v[120:123], a[156:159], v[216:219], v[120:123]
    v_exp_f32 v150, v150
    v_mfma_f32_16x16x32_bf16 v[124:127], a[156:159], v[220:223], v[124:127]
    s_waitcnt lgkmcnt(4)
    v_exp_f32 v151, v151
    v_mfma_f32_16x16x32_bf16 v[0:3], a[128:131], a[160:163], v[0:3]
    ds_read_b64_tr_b16 a[144:145], v226 offset:33920
    ds_read_b64_tr_b16 a[146:147], v226 offset:42368
    v_mfma_f32_16x16x32_bf16 v[4:7], a[128:131], a[164:167], v[4:7]
    v_exp_f32 v136, v136
    v_mfma_f32_16x16x32_bf16 v[8:11], a[128:131], a[168:171], v[8:11]
    v_cvt_pk_bf16_f32 v198, v148, v149
    v_cvt_pk_bf16_f32 v199, v150, v151
    v_mfma_f32_16x16x32_bf16 v[12:15], a[128:131], a[172:175], v[12:15]
    v_exp_f32 v137, v137
    v_mfma_f32_16x16x32_bf16 v[16:19], a[132:135], a[160:163], v[16:19]
    ds_read_b64_tr_b16 a[148:149], v226 offset:33952
    ds_read_b64_tr_b16 a[150:151], v226 offset:42400
    v_mfma_f32_16x16x32_bf16 v[20:23], a[132:135], a[164:167], v[20:23]
    buffer_load_dwordx4 v231, s[8:11], s29 offen offset:1040 lds
    v_mfma_f32_16x16x32_bf16 v[24:27], a[132:135], a[168:171], v[24:27]
    v_exp_f32 v138, v138
    v_mfma_f32_16x16x32_bf16 v[28:31], a[132:135], a[172:175], v[28:31]
    s_waitcnt lgkmcnt(4)
    v_mfma_f32_16x16x32_bf16 v[32:35], a[136:139], a[160:163], v[32:35]
    ds_read_b64_tr_b16 a[152:153], v226 offset:33984
    ds_read_b64_tr_b16 a[154:155], v226 offset:42432
    v_mfma_f32_16x16x32_bf16 v[36:39], a[136:139], a[164:167], v[36:39]
    v_mfma_f32_16x16x32_bf16 v[40:43], a[136:139], a[168:171], v[40:43]
    v_mfma_f32_16x16x32_bf16 v[44:47], a[136:139], a[172:175], v[44:47]
    v_mfma_f32_16x16x32_bf16 v[48:51], a[140:143], a[160:163], v[48:51]
    ds_read_b64_tr_b16 a[156:157], v226 offset:34016
    ds_read_b64_tr_b16 a[158:159], v226 offset:42464
    v_mfma_f32_16x16x32_bf16 v[52:55], a[140:143], a[164:167], v[52:55]
    buffer_load_dwordx4 v232, s[8:11], s29 offen offset:2080 lds
    v_mfma_f32_16x16x32_bf16 v[56:59], a[140:143], a[168:171], v[56:59]
    v_mfma_f32_16x16x32_bf16 v[60:63], a[140:143], a[172:175], v[60:63]
    s_waitcnt lgkmcnt(4)
    v_mfma_f32_16x16x32_bf16 v[64:67], a[144:147], a[160:163], v[64:67]
    ds_read_b128 a[128:131], v224 offset:33280
    v_mfma_f32_16x16x32_bf16 v[68:71], a[144:147], a[164:167], v[68:71]
    v_mfma_f32_16x16x32_bf16 v[72:75], a[144:147], a[168:171], v[72:75]
    v_mfma_f32_16x16x32_bf16 v[76:79], a[144:147], a[172:175], v[76:79]
    v_mfma_f32_16x16x32_bf16 v[80:83], a[148:151], a[160:163], v[80:83]
    ds_read_b128 a[132:135], v224 offset:33792
    v_mfma_f32_16x16x32_bf16 v[84:87], a[148:151], a[164:167], v[84:87]
    buffer_load_dwordx4 v233, s[8:11], s29 offen offset:3120 lds
    v_mfma_f32_16x16x32_bf16 v[88:91], a[148:151], a[168:171], v[88:91]
    s_add_u32 s28, s28, 0x8000
    s_min_u32 s28, s28, s37
    v_mfma_f32_16x16x32_bf16 v[92:95], a[148:151], a[172:175], v[92:95]
    s_waitcnt lgkmcnt(2)
    s_add_u32 s29, s28, 2048
    v_mfma_f32_16x16x32_bf16 v[96:99], a[152:155], a[160:163], v[96:99]
    ds_read_b128 a[136:139], v224 offset:33312
    v_mfma_f32_16x16x32_bf16 v[100:103], a[152:155], a[164:167], v[100:103]
    buffer_load_dword a255, v229, s[4:7], 0 offen
    v_mfma_f32_16x16x32_bf16 v[104:107], a[152:155], a[168:171], v[104:107]
    buffer_load_dword a255, v254, s[8:11], s28 offen
    v_mfma_f32_16x16x32_bf16 v[108:111], a[152:155], a[172:175], v[108:111]
    buffer_load_dword a255, v254, s[12:15], s30 offen
    v_mfma_f32_16x16x32_bf16 v[112:115], a[156:159], a[160:163], v[112:115]
    ds_read_b128 a[140:143], v224 offset:33824
    v_mfma_f32_16x16x32_bf16 v[116:119], a[156:159], a[164:167], v[116:119]
    buffer_store_dwordx4 a[212:215], v255, s[16:19], s43 idxen sc1
    v_mfma_f32_16x16x32_bf16 v[120:123], a[156:159], a[168:171], v[120:123]
    s_sub_u32 s34, s34, 1
    s_cmp_lg_u32 s34, 0
    v_mfma_f32_16x16x32_bf16 v[124:127], a[156:159], a[172:175], v[124:127]
    s_waitcnt vmcnt(12) lgkmcnt(2)
    s_barrier
    s_cbranch_scc1 KB_loop
KB_exit:
    v_mfma_f32_16x16x32_bf16 v[160:163], a[128:131], a[0:3], v[238:241]
    s_add_u32 m0, s33, 100352
    ds_read_b128 a[144:147], v224 offset:33344
    v_mfma_f32_16x16x32_bf16 v[164:167], a[128:131], a[32:35], v[242:245]
    ds_write_b64 v227, v[192:193] offset:0
    v_mfma_f32_16x16x32_bf16 v[168:171], a[128:131], a[64:67], v[246:249]
    buffer_load_dwordx4 v234, s[12:15], s30 offen offset:0 lds
    v_mfma_f32_16x16x32_bf16 v[172:175], a[128:131], a[96:99], v[250:253]
    ds_write_b64 v227, v[194:195] offset:512
    v_mfma_f32_16x16x32_bf16 v[176:179], a[132:135], a[0:3], v[238:241]
    ds_read_b128 a[148:151], v224 offset:33856
    v_mfma_f32_16x16x32_bf16 v[180:183], a[132:135], a[32:35], v[242:245]
    ds_write_b64 v227, v[196:197] offset:1024
    v_mfma_f32_16x16x32_bf16 v[184:187], a[132:135], a[64:67], v[246:249]
    v_exp_f32 v139, v139
    v_mfma_f32_16x16x32_bf16 v[188:191], a[132:135], a[96:99], v[250:253]
    s_waitcnt lgkmcnt(5)
    ds_write_b64 v227, v[198:199] offset:1536
    v_mfma_f32_16x16x32_bf16 v[160:163], a[136:139], a[4:7], v[160:163]
    ds_read_b128 a[152:155], v224 offset:33376
    v_mfma_f32_16x16x32_bf16 v[164:167], a[136:139], a[36:39], v[164:167]
    buffer_load_dwordx4 v235, s[12:15], s30 offen offset:1056 lds
    v_mfma_f32_16x16x32_bf16 v[168:171], a[136:139], a[68:71], v[168:171]
    v_exp_f32 v152, v152
    v_mfma_f32_16x16x32_bf16 v[172:175], a[136:139], a[100:103], v[172:175]
    v_cvt_pk_bf16_f32 v200, v136, v137
    v_cvt_pk_bf16_f32 v201, v138, v139
    v_mfma_f32_16x16x32_bf16 v[176:179], a[140:143], a[4:7], v[176:179]
    ds_read_b128 a[156:159], v224 offset:33888
    v_mfma_f32_16x16x32_bf16 v[180:183], a[140:143], a[36:39], v[180:183]
    ds_write_b64 v227, v[200:201] offset:2048
    v_mfma_f32_16x16x32_bf16 v[184:187], a[140:143], a[68:71], v[184:187]
    v_exp_f32 v153, v153
    v_mfma_f32_16x16x32_bf16 v[188:191], a[140:143], a[100:103], v[188:191]
    s_waitcnt lgkmcnt(5)
    v_exp_f32 v154, v154
    v_mfma_f32_16x16x32_bf16 v[160:163], a[144:147], a[8:11], v[160:163]
    ds_read_b128 a[128:131], v224 offset:33408
    v_mfma_f32_16x16x32_bf16 v[164:167], a[144:147], a[40:43], v[164:167]
    buffer_load_dwordx4 v236, s[12:15], s30 offen offset:2112 lds
    v_mfma_f32_16x16x32_bf16 v[168:171], a[144:147], a[72:75], v[168:171]
    v_exp_f32 v155, v155
    v_mfma_f32_16x16x32_bf16 v[172:175], a[144:147], a[104:107], v[172:175]
    v_exp_f32 v140, v140
    v_mfma_f32_16x16x32_bf16 v[176:179], a[148:151], a[8:11], v[176:179]
    ds_read_b128 a[132:135], v224 offset:33920
    v_cvt_pk_bf16_f32 v202, v152, v153
    v_mfma_f32_16x16x32_bf16 v[180:183], a[148:151], a[40:43], v[180:183]
    v_cvt_pk_bf16_f32 v203, v154, v155
    v_mfma_f32_16x16x32_bf16 v[184:187], a[148:151], a[72:75], v[184:187]
    ds_write_b64 v227, v[202:203] offset:2560
    v_mfma_f32_16x16x32_bf16 v[188:191], a[148:151], a[104:107], v[188:191]
    s_waitcnt lgkmcnt(4)
    v_exp_f32 v141, v141
    v_mfma_f32_16x16x32_bf16 v[160:163], a[152:155], a[12:15], v[160:163]
    ds_read_b128 a[136:139], v224 offset:33440
    v_mfma_f32_16x16x32_bf16 v[164:167], a[152:155], a[44:47], v[164:167]
    buffer_load_dwordx4 v237, s[12:15], s30 offen offset:3168 lds
    v_mfma_f32_16x16x32_bf16 v[168:171], a[152:155], a[76:79], v[168:171]
    v_exp_f32 v142, v142
    v_mfma_f32_16x16x32_bf16 v[172:175], a[152:155], a[108:111], v[172:175]
    v_exp_f32 v143, v143
    v_mfma_f32_16x16x32_bf16 v[176:179], a[156:159], a[12:15], v[176:179]
    ds_read_b128 a[140:143], v224 offset:33952
    v_mfma_f32_16x16x32_bf16 v[180:183], a[156:159], a[44:47], v[180:183]
    v_exp_f32 v156, v156
    v_mfma_f32_16x16x32_bf16 v[184:187], a[156:159], a[76:79], v[184:187]
    v_cvt_pk_bf16_f32 v204, v140, v141
    v_cvt_pk_bf16_f32 v205, v142, v143
    v_mfma_f32_16x16x32_bf16 v[188:191], a[156:159], a[108:111], v[188:191]
    s_waitcnt lgkmcnt(3)
    ds_write_b64 v227, v[204:205] offset:3072
    v_mfma_f32_16x16x32_bf16 v[160:163], a[128:131], a[16:19], v[160:163]
    s_add_u32 m0, s33, 104576
    ds_read_b128 a[144:147], v224 offset:33472
    v_mfma_f32_16x16x32_bf16 v[164:167], a[128:131], a[48:51], v[164:167]
    buffer_load_dwordx4 v234, s[12:15], s31 offen offset:0 lds
    v_mfma_f32_16x16x32_bf16 v[168:171], a[128:131], a[80:83], v[168:171]
    v_exp_f32 v157, v157
    v_mfma_f32_16x16x32_bf16 v[172:175], a[128:131], a[112:115], v[172:175]
    v_exp_f32 v158, v158
    v_mfma_f32_16x16x32_bf16 v[176:179], a[132:135], a[16:19], v[176:179]
    ds_read_b128 a[148:151], v224 offset:33984
    v_mfma_f32_16x16x32_bf16 v[180:183], a[132:135], a[48:51], v[180:183]
    v_exp_f32 v159, v159
    v_mfma_f32_16x16x32_bf16 v[184:187], a[132:135], a[80:83], v[184:187]
    v_cvt_pk_bf16_f32 v206, v156, v157
    v_cvt_pk_bf16_f32 v207, v158, v159
    v_mfma_f32_16x16x32_bf16 v[188:191], a[132:135], a[112:115], v[188:191]
    s_waitcnt lgkmcnt(3)
    ds_write_b64 v227, v[206:207] offset:3584
    v_mfma_f32_16x16x32_bf16 v[160:163], a[136:139], a[20:23], v[160:163]
    ds_read_b128 a[152:155], v224 offset:33504
    v_mfma_f32_16x16x32_bf16 v[164:167], a[136:139], a[52:55], v[164:167]
    buffer_load_dwordx4 v235, s[12:15], s31 offen offset:1056 lds
    v_mfma_f32_16x16x32_bf16 v[168:171], a[136:139], a[84:87], v[168:171]
    v_mfma_f32_16x16x32_bf16 v[172:175], a[136:139], a[116:119], v[172:175]
    v_mfma_f32_16x16x32_bf16 v[176:179], a[140:143], a[20:23], v[176:179]
    ds_read_b128 a[156:159], v224 offset:34016
    v_mfma_f32_16x16x32_bf16 v[180:183], a[140:143], a[52:55], v[180:183]
    v_mfma_f32_16x16x32_bf16 v[184:187], a[140:143], a[84:87], v[184:187]
    v_mfma_f32_16x16x32_bf16 v[188:191], a[140:143], a[116:119], v[188:191]
    s_waitcnt lgkmcnt(3)
    v_mfma_f32_16x16x32_bf16 v[160:163], a[144:147], a[24:27], v[160:163]
    ds_read_b64_tr_b16 a[128:129], v225 offset:0
    ds_read_b64_tr_b16 a[130:131], v225 offset:8448
    v_mfma_f32_16x16x32_bf16 v[164:167], a[144:147], a[56:59], v[164:167]
    buffer_load_dwordx4 v236, s[12:15], s31 offen offset:2112 lds
    v_mfma_f32_16x16x32_bf16 v[168:171], a[144:147], a[88:91], v[168:171]
    v_mfma_f32_16x16x32_bf16 v[172:175], a[144:147], a[120:123], v[172:175]
    v_mfma_f32_16x16x32_bf16 v[176:179], a[148:151], a[24:27], v[176:179]
    ds_read_b64_tr_b16 a[132:133], v225 offset:32
    ds_read_b64_tr_b16 a[134:135], v225 offset:8480
    v_mfma_f32_16x16x32_bf16 v[180:183], a[148:151], a[56:59], v[180:183]
    v_mfma_f32_16x16x32_bf16 v[184:187], a[148:151], a[88:91], v[184:187]
    v_mfma_f32_16x16x32_bf16 v[188:191], a[148:151], a[120:123], v[188:191]
    s_waitcnt lgkmcnt(4)
    v_mfma_f32_16x16x32_bf16 v[160:163], a[152:155], a[28:31], v[160:163]
    ds_read_b64_tr_b16 a[136:137], v225 offset:64
    ds_read_b64_tr_b16 a[138:139], v225 offset:8512
    v_mfma_f32_16x16x32_bf16 v[164:167], a[152:155], a[60:63], v[164:167]
    buffer_load_dwordx4 v237, s[12:15], s31 offen offset:3168 lds
    v_mfma_f32_16x16x32_bf16 v[168:171], a[152:155], a[92:95], v[168:171]
    s_add_u32 s30, s30, 0x8000
    s_add_u32 s31, s31, 0x8000
    v_mfma_f32_16x16x32_bf16 v[172:175], a[152:155], a[124:127], v[172:175]
    v_mfma_f32_16x16x32_bf16 v[176:179], a[156:159], a[28:31], v[176:179]
    ds_read_b64_tr_b16 a[140:141], v225 offset:96
    ds_read_b64_tr_b16 a[142:143], v225 offset:8544
    v_mfma_f32_16x16x32_bf16 v[180:183], a[156:159], a[60:63], v[180:183]
    v_mfma_f32_16x16x32_bf16 v[184:187], a[156:159], a[92:95], v[184:187]
    v_mfma_f32_16x16x32_bf16 v[188:191], a[156:159], a[124:127], v[188:191]
    s_waitcnt vmcnt(12) lgkmcnt(10)
    s_barrier
    v_and_b32 v131, 63, v255
    v_mov_b32 v254, 1073741824
    v_lshrrev_b32 v128, 3, v131
    v_mul_u32_u24 v128, 3584, v128
    v_and_b32 v129, 7, v131
    v_lshl_add_u32 v128, v129, 4, v128
    v_add_u32 v230, 480, v128
    v_add_u32 v231, 320, v128
    v_add_u32 v232, 160, v128
    v_add_u32 v233, 0, v128
    v_lshlrev_b32 v131, 4, v131
    s_mov_b32 s6, 53248
    buffer_load_dword v132, v131, s[20:23], s6 offen offset:0 sc1
    buffer_load_dword v133, v131, s[20:23], s6 offen offset:1024 sc1
    buffer_load_dword v134, v131, s[20:23], s6 offen offset:2048 sc1
    buffer_load_dword v135, v131, s[20:23], s6 offen offset:3072 sc1
    s_sub_u32 s16, s50, 480
    s_subb_u32 s17, s51, 0
    s_mov_b32 s18, 3670496
    s_mov_b32 s19, 0x20000
    s_mul_i32 s29, s25, 458752
    s_lshl_b32 s40, s24, 7
    s_add_u32 s28, s29, s40
    s_add_u32 s29, s28, 512
    s_mul_i32 s32, s24, 4224
    v_bfe_u32 v128, v255, 2, 2
    v_mul_u32_u24 v128, 1056, v128
    v_bfe_u32 v129, v255, 4, 2
    v_lshl_add_u32 v128, v129, 7, v128
    v_and_b32 v129, 3, v255
    v_lshl_add_u32 v128, v129, 3, v128
    v_add_u32 v140, s32, v128
    v_mfma_f32_16x16x32_bf16 a[192:195], a[208:211], v[192:195], a[192:195]
    s_add_u32 m0, s32, 0
    ds_read2st64_b64 a[160:163], v228 offset0:0 offset1:1
    v_mfma_f32_16x16x32_bf16 a[196:199], a[208:211], v[196:199], a[196:199]
    ds_read2st64_b64 a[164:167], v228 offset0:2 offset1:3
    v_mfma_f32_16x16x32_bf16 a[200:203], a[208:211], v[200:203], a[200:203]
    ds_read2st64_b64 a[168:171], v228 offset0:4 offset1:5
    v_mfma_f32_16x16x32_bf16 a[204:207], a[208:211], v[204:207], a[204:207]
    s_waitcnt lgkmcnt(7)
    ds_read2st64_b64 a[172:175], v228 offset0:6 offset1:7
    v_mfma_f32_16x16x32_bf16 v[0:3], a[128:131], v[192:195], v[0:3]
    ds_read_b64_tr_b16 a[144:145], v225 offset:128
    ds_read_b64_tr_b16 a[146:147], v225 offset:8576
    v_mfma_f32_16x16x32_bf16 v[4:7], a[128:131], v[196:199], v[4:7]
    buffer_load_dwordx4 v230, s[16:19], s28 offen offset:0 lds
    v_mfma_f32_16x16x32_bf16 v[8:11], a[128:131], v[200:203], v[8:11]
    buffer_load_dwordx4 v231, s[16:19], s28 offen offset:1056 lds
    v_mfma_f32_16x16x32_bf16 v[12:15], a[128:131], v[204:207], v[12:15]
    v_exp_f32 v160, v160
    v_mfma_f32_16x16x32_bf16 v[16:19], a[132:135], v[192:195], v[16:19]
    ds_read_b64_tr_b16 a[148:149], v225 offset:160
    ds_read_b64_tr_b16 a[150:151], v225 offset:8608
    v_mfma_f32_16x16x32_bf16 v[20:23], a[132:135], v[196:199], v[20:23]
    v_exp_f32 v161, v161
    v_mfma_f32_16x16x32_bf16 v[24:27], a[132:135], v[200:203], v[24:27]
    v_exp_f32 v162, v162
    v_mfma_f32_16x16x32_bf16 v[28:31], a[132:135], v[204:207], v[28:31]
    s_waitcnt lgkmcnt(8)
    buffer_load_dwordx4 v232, s[16:19], s28 offen offset:2112 lds
    v_mfma_f32_16x16x32_bf16 v[32:35], a[136:139], v[192:195], v[32:35]
    ds_read_b64_tr_b16 a[152:153], v225 offset:192
    ds_read_b64_tr_b16 a[154:155], v225 offset:8640
    v_mfma_f32_16x16x32_bf16 v[36:39], a[136:139], v[196:199], v[36:39]
    v_exp_f32 v163, v163
    v_mfma_f32_16x16x32_bf16 v[40:43], a[136:139], v[200:203], v[40:43]
    v_exp_f32 v176, v176
    v_mfma_f32_16x16x32_bf16 v[44:47], a[136:139], v[204:207], v[44:47]
    v_cvt_pk_bf16_f32 v208, v160, v161
    v_cvt_pk_bf16_f32 v209, v162, v163
    v_mfma_f32_16x16x32_bf16 v[48:51], a[140:143], v[192:195], v[48:51]
    ds_read_b64_tr_b16 a[156:157], v225 offset:224
    ds_read_b64_tr_b16 a[158:159], v225 offset:8672
    v_mfma_f32_16x16x32_bf16 v[52:55], a[140:143], v[196:199], v[52:55]
    buffer_load_dwordx4 v233, s[16:19], s28 offen offset:3168 lds
    v_mfma_f32_16x16x32_bf16 v[56:59], a[140:143], v[200:203], v[56:59]
    v_exp_f32 v177, v177
    v_mfma_f32_16x16x32_bf16 v[60:63], a[140:143], v[204:207], v[60:63]
    s_waitcnt lgkmcnt(4)
    v_exp_f32 v178, v178
    v_mfma_f32_16x16x32_bf16 v[64:67], a[144:147], v[192:195], v[64:67]
    s_add_u32 s28, s28, 28672
    ds_read_b64_tr_b16 a[128:129], v226 offset:0
    ds_read_b64_tr_b16 a[130:131], v226 offset:8448
    v_mfma_f32_16x16x32_bf16 v[68:71], a[144:147], v[196:199], v[68:71]
    s_add_u32 m0, s32, 16896
    v_exp_f32 v179, v179
    v_mfma_f32_16x16x32_bf16 v[72:75], a[144:147], v[200:203], v[72:75]
    buffer_load_dwordx4 v230, s[16:19], s28 offen offset:0 lds
    v_mfma_f32_16x16x32_bf16 v[76:79], a[144:147], v[204:207], v[76:79]
    v_exp_f32 v164, v164
    v_mfma_f32_16x16x32_bf16 v[80:83], a[148:151], v[192:195], v[80:83]
    ds_read_b64_tr_b16 a[132:133], v226 offset:32
    ds_read_b64_tr_b16 a[134:135], v226 offset:8480
    v_mfma_f32_16x16x32_bf16 v[84:87], a[148:151], v[196:199], v[84:87]
    v_cvt_pk_bf16_f32 v210, v176, v177
    v_cvt_pk_bf16_f32 v211, v178, v179
    v_mfma_f32_16x16x32_bf16 v[88:91], a[148:151], v[200:203], v[88:91]
    buffer_load_dwordx4 v231, s[16:19], s28 offen offset:1056 lds
    v_mfma_f32_16x16x32_bf16 v[92:95], a[148:151], v[204:207], v[92:95]
    s_waitcnt lgkmcnt(4)
    v_exp_f32 v165, v165
    v_mfma_f32_16x16x32_bf16 v[96:99], a[152:155], v[192:195], v[96:99]
    ds_read_b64_tr_b16 a[136:137], v226 offset:64
    ds_read_b64_tr_b16 a[138:139], v226 offset:8512
    v_mfma_f32_16x16x32_bf16 v[100:103], a[152:155], v[196:199], v[100:103]
    v_exp_f32 v166, v166
    v_mfma_f32_16x16x32_bf16 v[104:107], a[152:155], v[200:203], v[104:107]
    v_exp_f32 v167, v167
    v_mfma_f32_16x16x32_bf16 v[108:111], a[152:155], v[204:207], v[108:111]
    buffer_load_dwordx4 v232, s[16:19], s28 offen offset:2112 lds
    v_mfma_f32_16x16x32_bf16 v[112:115], a[156:159], v[192:195], v[112:115]
    ds_read_b64_tr_b16 a[140:141], v226 offset:96
    ds_read_b64_tr_b16 a[142:143], v226 offset:8544
    v_mfma_f32_16x16x32_bf16 v[116:119], a[156:159], v[196:199], v[116:119]
    v_exp_f32 v180, v180
    v_mfma_f32_16x16x32_bf16 v[120:123], a[156:159], v[200:203], v[120:123]
    v_cvt_pk_bf16_f32 v212, v164, v165
    v_cvt_pk_bf16_f32 v213, v166, v167
    v_mfma_f32_16x16x32_bf16 v[124:127], a[156:159], v[204:207], v[124:127]
    s_waitcnt lgkmcnt(4)
    v_exp_f32 v181, v181
    v_mfma_f32_16x16x32_bf16 v[0:3], a[128:131], a[160:163], v[0:3]
    ds_read_b64_tr_b16 a[144:145], v226 offset:128
    ds_read_b64_tr_b16 a[146:147], v226 offset:8576
    v_mfma_f32_16x16x32_bf16 v[4:7], a[128:131], a[164:167], v[4:7]
    buffer_load_dwordx4 v233, s[16:19], s28 offen offset:3168 lds
    v_mfma_f32_16x16x32_bf16 v[8:11], a[128:131], a[168:171], v[8:11]
    v_exp_f32 v182, v182
    v_mfma_f32_16x16x32_bf16 v[12:15], a[128:131], a[172:175], v[12:15]
    v_exp_f32 v183, v183
    v_mfma_f32_16x16x32_bf16 v[16:19], a[132:135], a[160:163], v[16:19]
    s_add_u32 s28, s28, 28672
    ds_read_b64_tr_b16 a[148:149], v226 offset:160
    ds_read_b64_tr_b16 a[150:151], v226 offset:8608
    v_mfma_f32_16x16x32_bf16 v[20:23], a[132:135], a[164:167], v[20:23]
    s_add_u32 m0, s32, 33792
    v_exp_f32 v168, v168
    v_mfma_f32_16x16x32_bf16 v[24:27], a[132:135], a[168:171], v[24:27]
    buffer_load_dwordx4 v230, s[16:19], s28 offen offset:0 lds
    v_mfma_f32_16x16x32_bf16 v[28:31], a[132:135], a[172:175], v[28:31]
    s_waitcnt lgkmcnt(4)
    v_cvt_pk_bf16_f32 v214, v180, v181
    v_cvt_pk_bf16_f32 v215, v182, v183
    v_mfma_f32_16x16x32_bf16 v[32:35], a[136:139], a[160:163], v[32:35]
    ds_read_b64_tr_b16 a[152:153], v226 offset:192
    ds_read_b64_tr_b16 a[154:155], v226 offset:8640
    v_mfma_f32_16x16x32_bf16 v[36:39], a[136:139], a[164:167], v[36:39]
    v_exp_f32 v169, v169
    v_mfma_f32_16x16x32_bf16 v[40:43], a[136:139], a[168:171], v[40:43]
    buffer_load_dwordx4 v231, s[16:19], s28 offen offset:1056 lds
    v_mfma_f32_16x16x32_bf16 v[44:47], a[136:139], a[172:175], v[44:47]
    v_exp_f32 v170, v170
    v_mfma_f32_16x16x32_bf16 v[48:51], a[140:143], a[160:163], v[48:51]
    ds_read_b64_tr_b16 a[156:157], v226 offset:224
    ds_read_b64_tr_b16 a[158:159], v226 offset:8672
    v_mfma_f32_16x16x32_bf16 v[52:55], a[140:143], a[164:167], v[52:55]
    v_mfma_f32_16x16x32_bf16 v[56:59], a[140:143], a[168:171], v[56:59]
    v_mfma_f32_16x16x32_bf16 v[60:63], a[140:143], a[172:175], v[60:63]
    s_waitcnt lgkmcnt(4)
    buffer_load_dwordx4 v232, s[16:19], s28 offen offset:2112 lds
    v_mfma_f32_16x16x32_bf16 v[64:67], a[144:147], a[160:163], v[64:67]
    v_mfma_f32_16x16x32_bf16 v[68:71], a[144:147], a[164:167], v[68:71]
    v_mfma_f32_16x16x32_bf16 v[72:75], a[144:147], a[168:171], v[72:75]
    v_mfma_f32_16x16x32_bf16 v[76:79], a[144:147], a[172:175], v[76:79]
    v_mfma_f32_16x16x32_bf16 v[80:83], a[148:151], a[160:163], v[80:83]
    buffer_load_dwordx4 v233, s[16:19], s28 offen offset:3168 lds
    v_mfma_f32_16x16x32_bf16 v[84:87], a[148:151], a[164:167], v[84:87]
    s_add_u32 s28, s28, 28672
    v_mfma_f32_16x16x32_bf16 v[88:91], a[148:151], a[168:171], v[88:91]
    v_mfma_f32_16x16x32_bf16 v[92:95], a[148:151], a[172:175], v[92:95]
    s_waitcnt lgkmcnt(0)
    v_mfma_f32_16x16x32_bf16 v[96:99], a[152:155], a[160:163], v[96:99]
    v_mfma_f32_16x16x32_bf16 v[100:103], a[152:155], a[164:167], v[100:103]
    v_mfma_f32_16x16x32_bf16 v[104:107], a[152:155], a[168:171], v[104:107]
    v_mfma_f32_16x16x32_bf16 v[108:111], a[152:155], a[172:175], v[108:111]
    v_mfma_f32_16x16x32_bf16 v[112:115], a[156:159], a[160:163], v[112:115]
    v_mfma_f32_16x16x32_bf16 v[116:119], a[156:159], a[164:167], v[116:119]
    v_mfma_f32_16x16x32_bf16 v[120:123], a[156:159], a[168:171], v[120:123]
    v_mfma_f32_16x16x32_bf16 v[124:127], a[156:159], a[172:175], v[124:127]
    s_waitcnt vmcnt(12) lgkmcnt(8)
    s_barrier
    s_cmp_lg_u32 s24, 0
    s_cbranch_scc1 KB_arok
    s_mov_b32 s43, 0x8000
KB_arp:
    v_xor_b32 v132, s3, v132
    v_xor_b32 v133, s3, v133
    v_xor_b32 v134, s3, v134
    v_xor_b32 v135, s3, v135
    v_or3_b32 v132, v132, v133, v134
    v_or_b32 v132, v132, v135
    v_cmp_ne_u32 vcc, 0, v132
    s_sub_u32 s43, s43, 1
    s_cbranch_vccz KB_arok
    s_cmp_eq_u32 s43, 0
    s_cbranch_scc1 KB_arok
    buffer_load_dword v132, v131, s[20:23], s6 offen offset:0 sc1
    buffer_load_dword v133, v131, s[20:23], s6 offen offset:1024 sc1
    buffer_load_dword v134, v131, s[20:23], s6 offen offset:2048 sc1
    buffer_load_dword v135, v131, s[20:23], s6 offen offset:3072 sc1
    s_waitcnt vmcnt(0)
    s_branch KB_arp
KB_arok:
    s_lshl_b32 s40, s2, 2
    s_or_b32 s40, s40, s24
    s_cmp_lg_u32 s40, 1012
    s_cbranch_scc1 KB_ar2
    s_mov_b32 s4, s52
    s_mov_b32 s5, s53
    s_mov_b32 s6, 256
    v_mov_b32 v132, 0
    s_mov_b64 exec, 1
    buffer_store_dword v132, off, s[4:7], 0 offset:112 sc1
    s_mov_b64 exec, -1
KB_ar2:
    v_exp_f32 v171, v171
    v_exp_f32 v184, v184
    v_cvt_pk_bf16_f32 v216, v168, v169
    v_cvt_pk_bf16_f32 v217, v170, v171
    v_exp_f32 v185, v185
    v_exp_f32 v186, v186
    v_exp_f32 v187, v187
    v_exp_f32 v172, v172
    v_cvt_pk_bf16_f32 v218, v184, v185
    v_cvt_pk_bf16_f32 v219, v186, v187
    v_exp_f32 v173, v173
    v_exp_f32 v174, v174
    v_exp_f32 v175, v175
    v_exp_f32 v188, v188
    v_cvt_pk_bf16_f32 v220, v172, v173
    v_cvt_pk_bf16_f32 v221, v174, v175
    v_exp_f32 v189, v189
    v_exp_f32 v190, v190
    v_exp_f32 v191, v191
    s_nop 0
    v_cvt_pk_bf16_f32 v222, v188, v189
    v_cvt_pk_bf16_f32 v223, v190, v191
    ds_write_b64 v227, v[208:209] offset:0
    ds_write_b64 v227, v[210:211] offset:512
    ds_write_b64 v227, v[212:213] offset:1024
    ds_write_b64 v227, v[214:215] offset:1536
    ds_write_b64 v227, v[216:217] offset:2048
    ds_write_b64 v227, v[218:219] offset:2560
    ds_write_b64 v227, v[220:221] offset:3072
    ds_write_b64 v227, v[222:223] offset:3584
    ds_read_b64_tr_b16 a[128:129], v225 offset:33792
    ds_read_b64_tr_b16 a[130:131], v225 offset:42240
    ds_read_b64_tr_b16 a[132:133], v225 offset:33824
    ds_read_b64_tr_b16 a[134:135], v225 offset:42272
    ds_read_b64_tr_b16 a[136:137], v225 offset:33856
    ds_read_b64_tr_b16 a[138:139], v225 offset:42304
    ds_read_b64_tr_b16 a[140:141], v225 offset:33888
    ds_read_b64_tr_b16 a[142:143], v225 offset:42336
    v_max3_f32 v128, abs(v0), abs(v1), abs(v4)
    v_max3_f32 v128, v128, abs(v8), abs(v12)
    v_max3_f32 v128, v128, abs(v24), abs(v28)
    v_max3_f32 v128, v128, abs(v40), abs(v44)
    v_max3_f32 v128, v128, abs(v56), abs(v60)
    v_max3_f32 v128, v128, abs(v72), abs(v76)
    v_max3_f32 v128, v128, abs(v88), abs(v92)
    v_max3_f32 v128, v128, abs(v104), abs(v108)
    v_max3_f32 v128, v128, abs(v120), abs(v124)
    v_cmp_lt_f32 vcc, 0x02000000, v128
    v_and_b32 v130, 15, v255
    v_lshlrev_b32 v130, 4, v130
    s_lshl_b32 s40, s24, 8
    s_add_u32 s40, s40, 84480
    v_add_u32 v131, s40, v130
    s_xor_b32 s40, s40, 256
    v_add_u32 v130, s40, v130
    s_cmp_eq_u64 vcc, 0
    s_cselect_b32 s42, 1, 0
    s_waitcnt lgkmcnt(8)
    s_barrier
    v_mfma_f32_16x16x32_bf16 a[192:195], a[208:211], v[208:211], a[192:195]
    ds_read2st64_b64 a[160:163], v228 offset0:0 offset1:1
    v_mfma_f32_16x16x32_bf16 a[196:199], a[208:211], v[212:215], a[196:199]
    ds_read2st64_b64 a[164:167], v228 offset0:2 offset1:3
    v_mfma_f32_16x16x32_bf16 a[200:203], a[208:211], v[216:219], a[200:203]
    ds_read2st64_b64 a[168:171], v228 offset0:4 offset1:5
    v_mfma_f32_16x16x32_bf16 a[204:207], a[208:211], v[220:223], a[204:207]
    s_waitcnt lgkmcnt(7)
    ds_read2st64_b64 a[172:175], v228 offset0:6 offset1:7
    v_mfma_f32_16x16x32_bf16 v[0:3], a[128:131], v[208:211], v[0:3]
    s_add_u32 m0, s32, 50688
    ds_read_b64_tr_b16 a[144:145], v225 offset:33920
    ds_read_b64_tr_b16 a[146:147], v225 offset:42368
    v_mfma_f32_16x16x32_bf16 v[4:7], a[128:131], v[212:215], v[4:7]
    buffer_load_dwordx4 v230, s[16:19], s28 offen offset:0 lds
    v_mfma_f32_16x16x32_bf16 v[8:11], a[128:131], v[216:219], v[8:11]
    v_mfma_f32_16x16x32_bf16 v[12:15], a[128:131], v[220:223], v[12:15]
    v_mfma_f32_16x16x32_bf16 v[16:19], a[132:135], v[208:211], v[16:19]
    s_waitcnt vmcnt(13)
    ds_read_b64_tr_b16 a[148:149], v225 offset:33952
    ds_read_b64_tr_b16 a[150:151], v225 offset:42400
    v_mfma_f32_16x16x32_bf16 v[20:23], a[132:135], v[212:215], v[20:23]
    buffer_load_dwordx4 v231, s[16:19], s28 offen offset:1056 lds
    v_mfma_f32_16x16x32_bf16 v[24:27], a[132:135], v[216:219], v[24:27]
    v_mfma_f32_16x16x32_bf16 v[28:31], a[132:135], v[220:223], v[28:31]
    s_waitcnt lgkmcnt(8)
    v_mfma_f32_16x16x32_bf16 v[32:35], a[136:139], v[208:211], v[32:35]
    ds_read_b64_tr_b16 a[152:153], v225 offset:33984
    ds_read_b64_tr_b16 a[154:155], v225 offset:42432
    v_mfma_f32_16x16x32_bf16 v[36:39], a[136:139], v[212:215], v[36:39]
    v_accvgpr_read_b32 v240, a192
    v_accvgpr_read_b32 v241, a196
    v_mfma_f32_16x16x32_bf16 v[40:43], a[136:139], v[216:219], v[40:43]
    v_accvgpr_read_b32 v242, a200
    v_accvgpr_read_b32 v243, a204
    v_mfma_f32_16x16x32_bf16 v[44:47], a[136:139], v[220:223], v[44:47]
    s_lshl_b32 s40, s24, 2
    v_max3_f32 v129, v240, v241, v242
    v_mfma_f32_16x16x32_bf16 v[48:51], a[140:143], v[208:211], v[48:51]
    ds_read_b64_tr_b16 a[156:157], v225 offset:34016
    ds_read_b64_tr_b16 a[158:159], v225 offset:42464
    v_mfma_f32_16x16x32_bf16 v[52:55], a[140:143], v[212:215], v[52:55]
    s_add_u32 s40, s40, 85504
    v_max_f32 v129, v129, v243
    v_mfma_f32_16x16x32_bf16 v[56:59], a[140:143], v[216:219], v[56:59]
    v_cmp_ngt_f32 vcc, 0x53800000, v129
    v_mov_b32 v132, s40
    v_mfma_f32_16x16x32_bf16 v[60:63], a[140:143], v[220:223], v[60:63]
    s_waitcnt lgkmcnt(4)
    v_mov_b32 v134, 85504
    v_mfma_f32_16x16x32_bf16 v[64:67], a[144:147], v[208:211], v[64:67]
    ds_read_b64_tr_b16 a[128:129], v226 offset:33792
    ds_read_b64_tr_b16 a[130:131], v226 offset:42240
    v_mfma_f32_16x16x32_bf16 v[68:71], a[144:147], v[212:215], v[68:71]
    s_cmp_lg_u64 vcc, 0
    ds_write_b128 v131, v[240:243]
    v_mfma_f32_16x16x32_bf16 v[72:75], a[144:147], v[216:219], v[72:75]
    s_cselect_b32 s42, 1, s42
    v_mov_b32 v133, s42
    v_mfma_f32_16x16x32_bf16 v[76:79], a[144:147], v[220:223], v[76:79]
    ds_write_b32 v132, v133
    v_mfma_f32_16x16x32_bf16 v[80:83], a[148:151], v[208:211], v[80:83]
    ds_read_b64_tr_b16 a[132:133], v226 offset:33824
    ds_read_b64_tr_b16 a[134:135], v226 offset:42272
    v_mfma_f32_16x16x32_bf16 v[84:87], a[148:151], v[212:215], v[84:87]
    buffer_load_dwordx4 v232, s[16:19], s28 offen offset:2112 lds
    v_mfma_f32_16x16x32_bf16 v[88:91], a[148:151], v[216:219], v[88:91]
    buffer_load_dwordx4 v233, s[16:19], s28 offen offset:3168 lds
    v_mfma_f32_16x16x32_bf16 v[92:95], a[148:151], v[220:223], v[92:95]
    s_waitcnt lgkmcnt(6)
    s_add_u32 s28, s28, 28672
    v_mfma_f32_16x16x32_bf16 v[96:99], a[152:155], v[208:211], v[96:99]
    s_add_u32 m0, s32, 67584
    ds_read_b64_tr_b16 a[136:137], v226 offset:33856
    ds_read_b64_tr_b16 a[138:139], v226 offset:42304
    v_mfma_f32_16x16x32_bf16 v[100:103], a[152:155], v[212:215], v[100:103]
    buffer_load_dwordx4 v230, s[16:19], s28 offen offset:0 lds
    v_mfma_f32_16x16x32_bf16 v[104:107], a[152:155], v[216:219], v[104:107]
    buffer_load_dwordx4 v231, s[16:19], s28 offen offset:1056 lds
    v_mfma_f32_16x16x32_bf16 v[108:111], a[152:155], v[220:223], v[108:111]
    buffer_load_dwordx4 v232, s[16:19], s28 offen offset:2112 lds
    v_mfma_f32_16x16x32_bf16 v[112:115], a[156:159], v[208:211], v[112:115]
    ds_read_b64_tr_b16 a[140:141], v226 offset:33888
    ds_read_b64_tr_b16 a[142:143], v226 offset:42336
    v_mfma_f32_16x16x32_bf16 v[116:119], a[156:159], v[212:215], v[116:119]
    buffer_load_dwordx4 v233, s[16:19], s28 offen offset:3168 lds
    v_mfma_f32_16x16x32_bf16 v[120:123], a[156:159], v[216:219], v[120:123]
    s_waitcnt lgkmcnt(0)
    s_barrier
    v_mfma_f32_16x16x32_bf16 v[124:127], a[156:159], v[220:223], v[124:127]
    s_waitcnt lgkmcnt(4)
    ds_read_b128 v[144:147], v130
    v_mfma_f32_16x16x32_bf16 v[0:3], a[128:131], a[160:163], v[0:3]
    s_add_u32 s28, s28, 28672
    ds_read_b64_tr_b16 a[144:145], v226 offset:33920
    ds_read_b64_tr_b16 a[146:147], v226 offset:42368
    v_mfma_f32_16x16x32_bf16 v[4:7], a[128:131], a[164:167], v[4:7]
    ds_read_b128 v[148:151], v134
    v_mfma_f32_16x16x32_bf16 v[8:11], a[128:131], a[168:171], v[8:11]
    v_mfma_f32_16x16x32_bf16 v[12:15], a[128:131], a[172:175], v[12:15]
    v_mfma_f32_16x16x32_bf16 v[16:19], a[132:135], a[160:163], v[16:19]
    ds_read_b64_tr_b16 a[148:149], v226 offset:33952
    ds_read_b64_tr_b16 a[150:151], v226 offset:42400
    v_mfma_f32_16x16x32_bf16 v[20:23], a[132:135], a[164:167], v[20:23]
    v_mfma_f32_16x16x32_bf16 v[24:27], a[132:135], a[168:171], v[24:27]
    v_mfma_f32_16x16x32_bf16 v[28:31], a[132:135], a[172:175], v[28:31]
    s_waitcnt lgkmcnt(6)
    v_mfma_f32_16x16x32_bf16 v[32:35], a[136:139], a[160:163], v[32:35]
    ds_read_b64_tr_b16 a[152:153], v226 offset:33984
    ds_read_b64_tr_b16 a[154:155], v226 offset:42432
    v_mfma_f32_16x16x32_bf16 v[36:39], a[136:139], a[164:167], v[36:39]
    v_mfma_f32_16x16x32_bf16 v[40:43], a[136:139], a[168:171], v[40:43]
    v_mfma_f32_16x16x32_bf16 v[44:47], a[136:139], a[172:175], v[44:47]
    v_mfma_f32_16x16x32_bf16 v[48:51], a[140:143], a[160:163], v[48:51]
    ds_read_b64_tr_b16 a[156:157], v226 offset:34016
    ds_read_b64_tr_b16 a[158:159], v226 offset:42464
    v_mfma_f32_16x16x32_bf16 v[52:55], a[140:143], a[164:167], v[52:55]
    v_mfma_f32_16x16x32_bf16 v[56:59], a[140:143], a[168:171], v[56:59]
    v_mfma_f32_16x16x32_bf16 v[60:63], a[140:143], a[172:175], v[60:63]
    s_waitcnt lgkmcnt(4)
    v_mfma_f32_16x16x32_bf16 v[64:67], a[144:147], a[160:163], v[64:67]
    v_mfma_f32_16x16x32_bf16 v[68:71], a[144:147], a[164:167], v[68:71]
    v_mfma_f32_16x16x32_bf16 v[72:75], a[144:147], a[168:171], v[72:75]
    v_mfma_f32_16x16x32_bf16 v[76:79], a[144:147], a[172:175], v[76:79]
    v_mfma_f32_16x16x32_bf16 v[80:83], a[148:151], a[160:163], v[80:83]
    v_mfma_f32_16x16x32_bf16 v[84:87], a[148:151], a[164:167], v[84:87]
    v_mfma_f32_16x16x32_bf16 v[88:91], a[148:151], a[168:171], v[88:91]
    v_mfma_f32_16x16x32_bf16 v[92:95], a[148:151], a[172:175], v[92:95]
    s_waitcnt lgkmcnt(0)
    v_mfma_f32_16x16x32_bf16 v[96:99], a[152:155], a[160:163], v[96:99]
    v_mfma_f32_16x16x32_bf16 v[100:103], a[152:155], a[164:167], v[100:103]
    v_mfma_f32_16x16x32_bf16 v[104:107], a[152:155], a[168:171], v[104:107]
    v_mfma_f32_16x16x32_bf16 v[108:111], a[152:155], a[172:175], v[108:111]
    v_mfma_f32_16x16x32_bf16 v[112:115], a[156:159], a[160:163], v[112:115]
    v_mfma_f32_16x16x32_bf16 v[116:119], a[156:159], a[164:167], v[116:119]
    v_mfma_f32_16x16x32_bf16 v[120:123], a[156:159], a[168:171], v[120:123]
    v_mfma_f32_16x16x32_bf16 v[124:127], a[156:159], a[172:175], v[124:127]
    v_and_b32 v238, 63, v255
    v_lshlrev_b32 v238, 4, v238
    v_add_u32 v238, 98304, v238
    s_lshl_b32 s40, s24, 14
    v_add_u32 v239, s40, v238
    v_mov_b32 v252, v140
    v_add_u32 v253, 50688, v140
    s_waitcnt lgkmcnt(0)
    v_or3_b32 v148, v148, v149, v150
    v_or_b32 v148, v148, v151
    s_nop 0
    v_readfirstlane_b32 s40, v148
    v_add_f32 v240, v240, v144
    v_add_f32 v241, v241, v145
    v_add_f32 v242, v242, v146
    v_add_f32 v243, v243, v147
    s_barrier
    s_cmp_gt_u32 s40, s38
    s_cbranch_scc1 KB_redo
    v_rcp_f32 v200, v240
    v_rcp_f32 v202, v241
    v_rcp_f32 v204, v242
    v_rcp_f32 v206, v243
    v_pk_mul_f32 v[0:1], v[0:1], v[200:201] op_sel_hi:[1,0]
    v_pk_mul_f32 v[2:3], v[2:3], v[200:201] op_sel_hi:[1,0]
    v_cvt_pk_bf16_f32 v128, v0, v1
    v_cvt_pk_bf16_f32 v129, v2, v3
    v_pk_mul_f32 v[16:17], v[16:17], v[200:201] op_sel_hi:[1,0]
    v_pk_mul_f32 v[18:19], v[18:19], v[200:201] op_sel_hi:[1,0]
    v_cvt_pk_bf16_f32 v130, v16, v17
    v_cvt_pk_bf16_f32 v131, v18, v19
    ds_write_b128 v239, v[128:131] offset:0
    v_pk_mul_f32 v[4:5], v[4:5], v[202:203] op_sel_hi:[1,0]
    v_pk_mul_f32 v[6:7], v[6:7], v[202:203] op_sel_hi:[1,0]
    v_cvt_pk_bf16_f32 v132, v4, v5
    v_cvt_pk_bf16_f32 v133, v6, v7
    v_pk_mul_f32 v[20:21], v[20:21], v[202:203] op_sel_hi:[1,0]
    v_pk_mul_f32 v[22:23], v[22:23], v[202:203] op_sel_hi:[1,0]
    v_cvt_pk_bf16_f32 v134, v20, v21
    v_cvt_pk_bf16_f32 v135, v22, v23
    ds_write_b128 v239, v[132:135] offset:1024
    v_pk_mul_f32 v[8:9], v[8:9], v[204:205] op_sel_hi:[1,0]
    v_pk_mul_f32 v[10:11], v[10:11], v[204:205] op_sel_hi:[1,0]
    v_cvt_pk_bf16_f32 v136, v8, v9
    v_cvt_pk_bf16_f32 v137, v10, v11
    v_pk_mul_f32 v[24:25], v[24:25], v[204:205] op_sel_hi:[1,0]
    v_pk_mul_f32 v[26:27], v[26:27], v[204:205] op_sel_hi:[1,0]
    v_cvt_pk_bf16_f32 v138, v24, v25
    v_cvt_pk_bf16_f32 v139, v26, v27
    ds_write_b128 v239, v[136:139] offset:2048
    v_pk_mul_f32 v[12:13], v[12:13], v[206:207] op_sel_hi:[1,0]
    v_pk_mul_f32 v[14:15], v[14:15], v[206:207] op_sel_hi:[1,0]
    v_cvt_pk_bf16_f32 v140, v12, v13
    v_cvt_pk_bf16_f32 v141, v14, v15
    v_pk_mul_f32 v[28:29], v[28:29], v[206:207] op_sel_hi:[1,0]
    v_pk_mul_f32 v[30:31], v[30:31], v[206:207] op_sel_hi:[1,0]
    v_cvt_pk_bf16_f32 v142, v28, v29
    v_cvt_pk_bf16_f32 v143, v30, v31
    ds_write_b128 v239, v[140:143] offset:3072
    v_pk_mul_f32 v[32:33], v[32:33], v[200:201] op_sel_hi:[1,0]
    v_pk_mul_f32 v[34:35], v[34:35], v[200:201] op_sel_hi:[1,0]
    v_cvt_pk_bf16_f32 v128, v32, v33
    v_cvt_pk_bf16_f32 v129, v34, v35
    v_pk_mul_f32 v[48:49], v[48:49], v[200:201] op_sel_hi:[1,0]
    v_pk_mul_f32 v[50:51], v[50:51], v[200:201] op_sel_hi:[1,0]
    v_cvt_pk_bf16_f32 v130, v48, v49
    v_cvt_pk_bf16_f32 v131, v50, v51
    ds_write_b128 v239, v[128:131] offset:4096
    v_pk_mul_f32 v[36:37], v[36:37], v[202:203] op_sel_hi:[1,0]
    v_pk_mul_f32 v[38:39], v[38:39], v[202:203] op_sel_hi:[1,0]
    v_cvt_pk_bf16_f32 v132, v36, v37
    v_cvt_pk_bf16_f32 v133, v38, v39
    v_pk_mul_f32 v[52:53], v[52:53], v[202:203] op_sel_hi:[1,0]
    v_pk_mul_f32 v[54:55], v[54:55], v[202:203] op_sel_hi:[1,0]
    v_cvt_pk_bf16_f32 v134, v52, v53
    v_cvt_pk_bf16_f32 v135, v54, v55
    ds_write_b128 v239, v[132:135] offset:5120
    v_pk_mul_f32 v[40:41], v[40:41], v[204:205] op_sel_hi:[1,0]
    v_pk_mul_f32 v[42:43], v[42:43], v[204:205] op_sel_hi:[1,0]
    v_cvt_pk_bf16_f32 v136, v40, v41
    v_cvt_pk_bf16_f32 v137, v42, v43
    v_pk_mul_f32 v[56:57], v[56:57], v[204:205] op_sel_hi:[1,0]
    v_pk_mul_f32 v[58:59], v[58:59], v[204:205] op_sel_hi:[1,0]
    v_cvt_pk_bf16_f32 v138, v56, v57
    v_cvt_pk_bf16_f32 v139, v58, v59
    ds_write_b128 v239, v[136:139] offset:6144
    v_pk_mul_f32 v[44:45], v[44:45], v[206:207] op_sel_hi:[1,0]
    v_pk_mul_f32 v[46:47], v[46:47], v[206:207] op_sel_hi:[1,0]
    v_cvt_pk_bf16_f32 v140, v44, v45
    v_cvt_pk_bf16_f32 v141, v46, v47
    v_pk_mul_f32 v[60:61], v[60:61], v[206:207] op_sel_hi:[1,0]
    v_pk_mul_f32 v[62:63], v[62:63], v[206:207] op_sel_hi:[1,0]
    v_cvt_pk_bf16_f32 v142, v60, v61
    v_cvt_pk_bf16_f32 v143, v62, v63
    ds_write_b128 v239, v[140:143] offset:7168
    v_pk_mul_f32 v[64:65], v[64:65], v[200:201] op_sel_hi:[1,0]
    v_pk_mul_f32 v[66:67], v[66:67], v[200:201] op_sel_hi:[1,0]
    v_cvt_pk_bf16_f32 v128, v64, v65
    v_cvt_pk_bf16_f32 v129, v66, v67
    v_pk_mul_f32 v[80:81], v[80:81], v[200:201] op_sel_hi:[1,0]
    v_pk_mul_f32 v[82:83], v[82:83], v[200:201] op_sel_hi:[1,0]
    v_cvt_pk_bf16_f32 v130, v80, v81
    v_cvt_pk_bf16_f32 v131, v82, v83
    ds_write_b128 v239, v[128:131] offset:8192
    v_pk_mul_f32 v[68:69], v[68:69], v[202:203] op_sel_hi:[1,0]
    v_pk_mul_f32 v[70:71], v[70:71], v[202:203] op_sel_hi:[1,0]
    v_cvt_pk_bf16_f32 v132, v68, v69
    v_cvt_pk_bf16_f32 v133, v70, v71
    v_pk_mul_f32 v[84:85], v[84:85], v[202:203] op_sel_hi:[1,0]
    v_pk_mul_f32 v[86:87], v[86:87], v[202:203] op_sel_hi:[1,0]
    v_cvt_pk_bf16_f32 v134, v84, v85
    v_cvt_pk_bf16_f32 v135, v86, v87
    ds_write_b128 v239, v[132:135] offset:9216
    v_pk_mul_f32 v[72:73], v[72:73], v[204:205] op_sel_hi:[1,0]
    v_pk_mul_f32 v[74:75], v[74:75], v[204:205] op_sel_hi:[1,0]
    v_cvt_pk_bf16_f32 v136, v72, v73
    v_cvt_pk_bf16_f32 v137, v74, v75
    v_pk_mul_f32 v[88:89], v[88:89], v[204:205] op_sel_hi:[1,0]
    v_pk_mul_f32 v[90:91], v[90:91], v[204:205] op_sel_hi:[1,0]
    v_cvt_pk_bf16_f32 v138, v88, v89
    v_cvt_pk_bf16_f32 v139, v90, v91
    ds_write_b128 v239, v[136:139] offset:10240
    v_pk_mul_f32 v[76:77], v[76:77], v[206:207] op_sel_hi:[1,0]
    v_pk_mul_f32 v[78:79], v[78:79], v[206:207] op_sel_hi:[1,0]
    v_cvt_pk_bf16_f32 v140, v76, v77
    v_cvt_pk_bf16_f32 v141, v78, v79
    v_pk_mul_f32 v[92:93], v[92:93], v[206:207] op_sel_hi:[1,0]
    v_pk_mul_f32 v[94:95], v[94:95], v[206:207] op_sel_hi:[1,0]
    v_cvt_pk_bf16_f32 v142, v92, v93
    v_cvt_pk_bf16_f32 v143, v94, v95
    ds_write_b128 v239, v[140:143] offset:11264
    v_pk_mul_f32 v[96:97], v[96:97], v[200:201] op_sel_hi:[1,0]
    v_pk_mul_f32 v[98:99], v[98:99], v[200:201] op_sel_hi:[1,0]
    v_cvt_pk_bf16_f32 v128, v96, v97
    v_cvt_pk_bf16_f32 v129, v98, v99
    v_pk_mul_f32 v[112:113], v[112:113], v[200:201] op_sel_hi:[1,0]
    v_pk_mul_f32 v[114:115], v[114:115], v[200:201] op_sel_hi:[1,0]
    v_cvt_pk_bf16_f32 v130, v112, v113
    v_cvt_pk_bf16_f32 v131, v114, v115
    ds_write_b128 v239, v[128:131] offset:12288
    v_pk_mul_f32 v[100:101], v[100:101], v[202:203] op_sel_hi:[1,0]
    v_pk_mul_f32 v[102:103], v[102:103], v[202:203] op_sel_hi:[1,0]
    v_cvt_pk_bf16_f32 v132, v100, v101
    v_cvt_pk_bf16_f32 v133, v102, v103
    v_pk_mul_f32 v[116:117], v[116:117], v[202:203] op_sel_hi:[1,0]
    v_pk_mul_f32 v[118:119], v[118:119], v[202:203] op_sel_hi:[1,0]
    v_cvt_pk_bf16_f32 v134, v116, v117
    v_cvt_pk_bf16_f32 v135, v118, v119
    ds_write_b128 v239, v[132:135] offset:13312
    v_pk_mul_f32 v[104:105], v[104:105], v[204:205] op_sel_hi:[1,0]
    v_pk_mul_f32 v[106:107], v[106:107], v[204:205] op_sel_hi:[1,0]
    v_cvt_pk_bf16_f32 v136, v104, v105
    v_cvt_pk_bf16_f32 v137, v106, v107
    v_pk_mul_f32 v[120:121], v[120:121], v[204:205] op_sel_hi:[1,0]
    v_pk_mul_f32 v[122:123], v[122:123], v[204:205] op_sel_hi:[1,0]
    v_cvt_pk_bf16_f32 v138, v120, v121
    v_cvt_pk_bf16_f32 v139, v122, v123
    ds_write_b128 v239, v[136:139] offset:14336
    v_pk_mul_f32 v[108:109], v[108:109], v[206:207] op_sel_hi:[1,0]
    v_pk_mul_f32 v[110:111], v[110:111], v[206:207] op_sel_hi:[1,0]
    v_cvt_pk_bf16_f32 v140, v108, v109
    v_cvt_pk_bf16_f32 v141, v110, v111
    v_pk_mul_f32 v[124:125], v[124:125], v[206:207] op_sel_hi:[1,0]
    v_pk_mul_f32 v[126:127], v[126:127], v[206:207] op_sel_hi:[1,0]
    v_cvt_pk_bf16_f32 v142, v124, v125
    v_cvt_pk_bf16_f32 v143, v126, v127
    ds_write_b128 v239, v[140:143] offset:15360
    v_bfe_u32 v160, v255, 4, 1
    v_bfe_u32 v161, v255, 5, 1
    v_and_b32 v162, 15, v255
    v_lshlrev_b32 v162, 4, v162
    v_lshl_add_u32 v162, v161, 8, v162
    v_lshl_add_u32 v250, v160, 9, v162
    v_mul_u32_u24 v160, 14336, v160
    v_add_u32 v251, v160, v162
    s_mul_i32 s40, s25, 1835008
    s_mul_i32 s41, s26, 57344
    s_add_u32 s40, s40, s41
    s_add_u32 s40, s40, 20971520
    s_lshl_b32 s41, s24, 11
    s_add_u32 s66, s40, s41
    s_add_u32 s67, s66, 8192
    s_cmp_eq_u32 s24, 3
    s_cselect_b32 s29, 1073741824, s29
    s_waitcnt vmcnt(16) lgkmcnt(0)
    s_barrier
    ds_read_b128 v[128:131], v238 offset:0
    ds_read_b128 v[132:135], v238 offset:1024
    ds_read_b128 v[136:139], v238 offset:2048
    ds_read_b128 v[140:143], v238 offset:3072
    ds_read_b64_tr_b16 a[128:129], v252 offset:0
    ds_read_b64_tr_b16 a[130:131], v252 offset:512
    ds_read_b64_tr_b16 a[132:133], v252 offset:32
    ds_read_b64_tr_b16 a[134:135], v252 offset:544
    ds_read_b64_tr_b16 a[136:137], v252 offset:64
    ds_read_b64_tr_b16 a[138:139], v252 offset:576
    ds_read_b64_tr_b16 a[140:141], v252 offset:96
    ds_read_b64_tr_b16 a[142:143], v252 offset:608
    s_waitcnt lgkmcnt(4)
    s_waitcnt vmcnt(12)
    v_mfma_f32_16x16x32_bf16 v[0:3], a[128:131], v[128:131], 0
    ds_read_b64_tr_b16 a[144:145], v252 offset:16896
    ds_read_b64_tr_b16 a[146:147], v252 offset:17408
    v_mfma_f32_16x16x32_bf16 v[4:7], a[128:131], v[132:135], 0
    ds_read_b128 v[144:147], v238 offset:4096
    v_mfma_f32_16x16x32_bf16 v[8:11], a[128:131], v[136:139], 0
    ds_read_b128 v[148:151], v238 offset:5120
    v_mfma_f32_16x16x32_bf16 v[12:15], a[128:131], v[140:143], 0
    v_mfma_f32_16x16x32_bf16 v[16:19], a[132:135], v[128:131], 0
    ds_read_b64_tr_b16 a[148:149], v252 offset:16928
    ds_read_b64_tr_b16 a[150:151], v252 offset:17440
    v_mfma_f32_16x16x32_bf16 v[20:23], a[132:135], v[132:135], 0
    ds_read_b128 v[152:155], v238 offset:6144
    v_mfma_f32_16x16x32_bf16 v[24:27], a[132:135], v[136:139], 0
    ds_read_b128 v[156:159], v238 offset:7168
    v_mfma_f32_16x16x32_bf16 v[28:31], a[132:135], v[140:143], 0
    s_waitcnt lgkmcnt(8)
    s_add_u32 m0, s32, 0
    v_mfma_f32_16x16x32_bf16 v[32:35], a[136:139], v[128:131], 0
    ds_read_b64_tr_b16 a[152:153], v252 offset:16960
    ds_read_b64_tr_b16 a[154:155], v252 offset:17472
    v_mfma_f32_16x16x32_bf16 v[36:39], a[136:139], v[132:135], 0
    buffer_load_dwordx4 v230, s[16:19], s28 offen offset:0 lds
    v_mfma_f32_16x16x32_bf16 v[40:43], a[136:139], v[136:139], 0
    buffer_load_dwordx4 v231, s[16:19], s28 offen offset:1056 lds
    v_mfma_f32_16x16x32_bf16 v[44:47], a[136:139], v[140:143], 0
    v_mfma_f32_16x16x32_bf16 v[48:51], a[140:143], v[128:131], 0
    ds_read_b64_tr_b16 a[156:157], v252 offset:16992
    ds_read_b64_tr_b16 a[158:159], v252 offset:17504
    v_mfma_f32_16x16x32_bf16 v[52:55], a[140:143], v[132:135], 0
    buffer_load_dwordx4 v232, s[16:19], s28 offen offset:2112 lds
    v_mfma_f32_16x16x32_bf16 v[56:59], a[140:143], v[136:139], 0
    buffer_load_dwordx4 v233, s[16:19], s28 offen offset:3168 lds
    v_mfma_f32_16x16x32_bf16 v[60:63], a[140:143], v[140:143], 0
    s_waitcnt lgkmcnt(4)
    s_add_u32 s28, s28, 28672
    s_waitcnt vmcnt(12)
    v_mfma_f32_16x16x32_bf16 v[0:3], a[144:147], v[144:147], v[0:3]
    ds_read_b64_tr_b16 a[128:129], v252 offset:33792
    ds_read_b64_tr_b16 a[130:131], v252 offset:34304
    v_mfma_f32_16x16x32_bf16 v[4:7], a[144:147], v[148:151], v[4:7]
    ds_read_b128 v[128:131], v238 offset:8192
    v_mfma_f32_16x16x32_bf16 v[8:11], a[144:147], v[152:155], v[8:11]
    ds_read_b128 v[132:135], v238 offset:9216
    v_mfma_f32_16x16x32_bf16 v[12:15], a[144:147], v[156:159], v[12:15]
    v_mfma_f32_16x16x32_bf16 v[16:19], a[148:151], v[144:147], v[16:19]
    ds_read_b64_tr_b16 a[132:133], v252 offset:33824
    ds_read_b64_tr_b16 a[134:135], v252 offset:34336
    v_mfma_f32_16x16x32_bf16 v[20:23], a[148:151], v[148:151], v[20:23]
    ds_read_b128 v[136:139], v238 offset:10240
    v_mfma_f32_16x16x32_bf16 v[24:27], a[148:151], v[152:155], v[24:27]
    ds_read_b128 v[140:143], v238 offset:11264
    v_mfma_f32_16x16x32_bf16 v[28:31], a[148:151], v[156:159], v[28:31]
    s_waitcnt lgkmcnt(8)
    s_add_u32 m0, s32, 16896
    v_mfma_f32_16x16x32_bf16 v[32:35], a[152:155], v[144:147], v[32:35]
    ds_read_b64_tr_b16 a[136:137], v252 offset:33856
    ds_read_b64_tr_b16 a[138:139], v252 offset:34368
    v_mfma_f32_16x16x32_bf16 v[36:39], a[152:155], v[148:151], v[36:39]
    buffer_load_dwordx4 v230, s[16:19], s28 offen offset:0 lds
    v_mfma_f32_16x16x32_bf16 v[40:43], a[152:155], v[152:155], v[40:43]
    buffer_load_dwordx4 v231, s[16:19], s28 offen offset:1056 lds
    v_mfma_f32_16x16x32_bf16 v[44:47], a[152:155], v[156:159], v[44:47]
    v_mfma_f32_16x16x32_bf16 v[48:51], a[156:159], v[144:147], v[48:51]
    ds_read_b64_tr_b16 a[140:141], v252 offset:33888
    ds_read_b64_tr_b16 a[142:143], v252 offset:34400
    v_mfma_f32_16x16x32_bf16 v[52:55], a[156:159], v[148:151], v[52:55]
    buffer_load_dwordx4 v232, s[16:19], s28 offen offset:2112 lds
    v_mfma_f32_16x16x32_bf16 v[56:59], a[156:159], v[152:155], v[56:59]
    buffer_load_dwordx4 v233, s[16:19], s28 offen offset:3168 lds
    v_mfma_f32_16x16x32_bf16 v[60:63], a[156:159], v[156:159], v[60:63]
    s_waitcnt lgkmcnt(4)
    s_add_u32 s28, s28, 28672
    s_waitcnt vmcnt(12)
    v_mfma_f32_16x16x32_bf16 v[0:3], a[128:131], v[128:131], v[0:3]
    ds_read_b64_tr_b16 a[144:145], v253 offset:0
    ds_read_b64_tr_b16 a[146:147], v253 offset:512
    v_mfma_f32_16x16x32_bf16 v[4:7], a[128:131], v[132:135], v[4:7]
    ds_read_b128 v[144:147], v238 offset:12288
    v_mfma_f32_16x16x32_bf16 v[8:11], a[128:131], v[136:139], v[8:11]
    ds_read_b128 v[148:151], v238 offset:13312
    v_mfma_f32_16x16x32_bf16 v[12:15], a[128:131], v[140:143], v[12:15]
    v_mfma_f32_16x16x32_bf16 v[16:19], a[132:135], v[128:131], v[16:19]
    ds_read_b64_tr_b16 a[148:149], v253 offset:32
    ds_read_b64_tr_b16 a[150:151], v253 offset:544
    v_mfma_f32_16x16x32_bf16 v[20:23], a[132:135], v[132:135], v[20:23]
    ds_read_b128 v[152:155], v238 offset:14336
    v_mfma_f32_16x16x32_bf16 v[24:27], a[132:135], v[136:139], v[24:27]
    ds_read_b128 v[156:159], v238 offset:15360
    v_mfma_f32_16x16x32_bf16 v[28:31], a[132:135], v[140:143], v[28:31]
    s_waitcnt lgkmcnt(8)
    s_add_u32 m0, s32, 33792
    v_mfma_f32_16x16x32_bf16 v[32:35], a[136:139], v[128:131], v[32:35]
    ds_read_b64_tr_b16 a[152:153], v253 offset:64
    ds_read_b64_tr_b16 a[154:155], v253 offset:576
    v_mfma_f32_16x16x32_bf16 v[36:39], a[136:139], v[132:135], v[36:39]
    buffer_load_dwordx4 v230, s[16:19], s28 offen offset:0 lds
    v_mfma_f32_16x16x32_bf16 v[40:43], a[136:139], v[136:139], v[40:43]
    buffer_load_dwordx4 v231, s[16:19], s28 offen offset:1056 lds
    v_mfma_f32_16x16x32_bf16 v[44:47], a[136:139], v[140:143], v[44:47]
    v_mfma_f32_16x16x32_bf16 v[48:51], a[140:143], v[128:131], v[48:51]
    ds_read_b64_tr_b16 a[156:157], v253 offset:96
    ds_read_b64_tr_b16 a[158:159], v253 offset:608
    v_mfma_f32_16x16x32_bf16 v[52:55], a[140:143], v[132:135], v[52:55]
    buffer_load_dwordx4 v232, s[16:19], s28 offen offset:2112 lds
    v_mfma_f32_16x16x32_bf16 v[56:59], a[140:143], v[136:139], v[56:59]
    buffer_load_dwordx4 v233, s[16:19], s28 offen offset:3168 lds
    v_mfma_f32_16x16x32_bf16 v[60:63], a[140:143], v[140:143], v[60:63]
    s_waitcnt lgkmcnt(4)
    s_add_u32 s28, s28, 28672
    s_waitcnt vmcnt(12)
    v_mfma_f32_16x16x32_bf16 v[0:3], a[144:147], v[144:147], v[0:3]
    ds_read_b64_tr_b16 a[128:129], v253 offset:16896
    ds_read_b64_tr_b16 a[130:131], v253 offset:17408
    v_mfma_f32_16x16x32_bf16 v[4:7], a[144:147], v[148:151], v[4:7]
    ds_read_b128 v[128:131], v238 offset:16384
    v_mfma_f32_16x16x32_bf16 v[8:11], a[144:147], v[152:155], v[8:11]
    ds_read_b128 v[132:135], v238 offset:17408
    v_mfma_f32_16x16x32_bf16 v[12:15], a[144:147], v[156:159], v[12:15]
    v_mfma_f32_16x16x32_bf16 v[16:19], a[148:151], v[144:147], v[16:19]
    ds_read_b64_tr_b16 a[132:133], v253 offset:16928
    ds_read_b64_tr_b16 a[134:135], v253 offset:17440
    v_mfma_f32_16x16x32_bf16 v[20:23], a[148:151], v[148:151], v[20:23]
    ds_read_b128 v[136:139], v238 offset:18432
    v_mfma_f32_16x16x32_bf16 v[24:27], a[148:151], v[152:155], v[24:27]
    ds_read_b128 v[140:143], v238 offset:19456
    v_mfma_f32_16x16x32_bf16 v[28:31], a[148:151], v[156:159], v[28:31]
    s_waitcnt lgkmcnt(8)
    s_add_u32 m0, s32, 50688
    v_mfma_f32_16x16x32_bf16 v[32:35], a[152:155], v[144:147], v[32:35]
    ds_read_b64_tr_b16 a[136:137], v253 offset:16960
    ds_read_b64_tr_b16 a[138:139], v253 offset:17472
    v_mfma_f32_16x16x32_bf16 v[36:39], a[152:155], v[148:151], v[36:39]
    buffer_load_dwordx4 v230, s[16:19], s28 offen offset:0 lds
    v_mfma_f32_16x16x32_bf16 v[40:43], a[152:155], v[152:155], v[40:43]
    buffer_load_dwordx4 v231, s[16:19], s28 offen offset:1056 lds
    v_mfma_f32_16x16x32_bf16 v[44:47], a[152:155], v[156:159], v[44:47]
    v_mfma_f32_16x16x32_bf16 v[48:51], a[156:159], v[144:147], v[48:51]
    ds_read_b64_tr_b16 a[140:141], v253 offset:16992
    ds_read_b64_tr_b16 a[142:143], v253 offset:17504
    v_mfma_f32_16x16x32_bf16 v[52:55], a[156:159], v[148:151], v[52:55]
    buffer_load_dwordx4 v232, s[16:19], s28 offen offset:2112 lds
    v_mfma_f32_16x16x32_bf16 v[56:59], a[156:159], v[152:155], v[56:59]
    buffer_load_dwordx4 v233, s[16:19], s28 offen offset:3168 lds
    v_mfma_f32_16x16x32_bf16 v[60:63], a[156:159], v[156:159], v[60:63]
    s_waitcnt lgkmcnt(4)
    s_add_u32 s28, s28, 28672
    s_waitcnt vmcnt(12)
    v_mfma_f32_16x16x32_bf16 v[0:3], a[128:131], v[128:131], v[0:3]
    ds_read_b64_tr_b16 a[144:145], v252 offset:0
    ds_read_b64_tr_b16 a[146:147], v252 offset:512
    v_mfma_f32_16x16x32_bf16 v[4:7], a[128:131], v[132:135], v[4:7]
    ds_read_b128 v[144:147], v238 offset:20480
    v_mfma_f32_16x16x32_bf16 v[8:11], a[128:131], v[136:139], v[8:11]
    ds_read_b128 v[148:151], v238 offset:21504
    v_mfma_f32_16x16x32_bf16 v[12:15], a[128:131], v[140:143], v[12:15]
    v_mfma_f32_16x16x32_bf16 v[16:19], a[132:135], v[128:131], v[16:19]
    ds_read_b64_tr_b16 a[148:149], v252 offset:32
    ds_read_b64_tr_b16 a[150:151], v252 offset:544
    v_mfma_f32_16x16x32_bf16 v[20:23], a[132:135], v[132:135], v[20:23]
    ds_read_b128 v[152:155], v238 offset:22528
    v_mfma_f32_16x16x32_bf16 v[24:27], a[132:135], v[136:139], v[24:27]
    ds_read_b128 v[156:159], v238 offset:23552
    v_mfma_f32_16x16x32_bf16 v[28:31], a[132:135], v[140:143], v[28:31]
    s_waitcnt lgkmcnt(8)
    s_add_u32 m0, s32, 67584
    v_mfma_f32_16x16x32_bf16 v[32:35], a[136:139], v[128:131], v[32:35]
    ds_read_b64_tr_b16 a[152:153], v252 offset:64
    ds_read_b64_tr_b16 a[154:155], v252 offset:576
    v_mfma_f32_16x16x32_bf16 v[36:39], a[136:139], v[132:135], v[36:39]
    buffer_load_dwordx4 v230, s[16:19], s28 offen offset:0 lds
    v_mfma_f32_16x16x32_bf16 v[40:43], a[136:139], v[136:139], v[40:43]
    buffer_load_dwordx4 v231, s[16:19], s28 offen offset:1056 lds
    v_mfma_f32_16x16x32_bf16 v[44:47], a[136:139], v[140:143], v[44:47]
    v_mfma_f32_16x16x32_bf16 v[48:51], a[140:143], v[128:131], v[48:51]
    ds_read_b64_tr_b16 a[156:157], v252 offset:96
    ds_read_b64_tr_b16 a[158:159], v252 offset:608
    v_mfma_f32_16x16x32_bf16 v[52:55], a[140:143], v[132:135], v[52:55]
    buffer_load_dwordx4 v232, s[16:19], s28 offen offset:2112 lds
    v_mfma_f32_16x16x32_bf16 v[56:59], a[140:143], v[136:139], v[56:59]
    buffer_load_dwordx4 v233, s[16:19], s28 offen offset:3168 lds
    v_mfma_f32_16x16x32_bf16 v[60:63], a[140:143], v[140:143], v[60:63]
    s_waitcnt lgkmcnt(4)
    s_add_u32 s28, s28, 28672
    s_waitcnt vmcnt(12)
    v_mfma_f32_16x16x32_bf16 v[0:3], a[144:147], v[144:147], v[0:3]
    ds_read_b64_tr_b16 a[128:129], v252 offset:16896
    ds_read_b64_tr_b16 a[130:131], v252 offset:17408
    v_mfma_f32_16x16x32_bf16 v[4:7], a[144:147], v[148:151], v[4:7]
    ds_read_b128 v[128:131], v238 offset:24576
    v_mfma_f32_16x16x32_bf16 v[8:11], a[144:147], v[152:155], v[8:11]
    ds_read_b128 v[132:135], v238 offset:25600
    v_mfma_f32_16x16x32_bf16 v[12:15], a[144:147], v[156:159], v[12:15]
    v_mfma_f32_16x16x32_bf16 v[16:19], a[148:151], v[144:147], v[16:19]
    ds_read_b64_tr_b16 a[132:133], v252 offset:16928
    ds_read_b64_tr_b16 a[134:135], v252 offset:17440
    v_mfma_f32_16x16x32_bf16 v[20:23], a[148:151], v[148:151], v[20:23]
    ds_read_b128 v[136:139], v238 offset:26624
    v_mfma_f32_16x16x32_bf16 v[24:27], a[148:151], v[152:155], v[24:27]
    ds_read_b128 v[140:143], v238 offset:27648
    v_mfma_f32_16x16x32_bf16 v[28:31], a[148:151], v[156:159], v[28:31]
    s_waitcnt lgkmcnt(8)
    s_add_u32 m0, s32, 0
    v_mfma_f32_16x16x32_bf16 v[32:35], a[152:155], v[144:147], v[32:35]
    ds_read_b64_tr_b16 a[136:137], v252 offset:16960
    ds_read_b64_tr_b16 a[138:139], v252 offset:17472
    v_mfma_f32_16x16x32_bf16 v[36:39], a[152:155], v[148:151], v[36:39]
    buffer_load_dwordx4 v230, s[16:19], s28 offen offset:0 lds
    v_mfma_f32_16x16x32_bf16 v[40:43], a[152:155], v[152:155], v[40:43]
    buffer_load_dwordx4 v231, s[16:19], s28 offen offset:1056 lds
    v_mfma_f32_16x16x32_bf16 v[44:47], a[152:155], v[156:159], v[44:47]
    v_mfma_f32_16x16x32_bf16 v[48:51], a[156:159], v[144:147], v[48:51]
    ds_read_b64_tr_b16 a[140:141], v252 offset:16992
    ds_read_b64_tr_b16 a[142:143], v252 offset:17504
    v_mfma_f32_16x16x32_bf16 v[52:55], a[156:159], v[148:151], v[52:55]
    buffer_load_dwordx4 v232, s[16:19], s28 offen offset:2112 lds
    v_mfma_f32_16x16x32_bf16 v[56:59], a[156:159], v[152:155], v[56:59]
    buffer_load_dwordx4 v233, s[16:19], s28 offen offset:3168 lds
    v_mfma_f32_16x16x32_bf16 v[60:63], a[156:159], v[156:159], v[60:63]
    s_waitcnt lgkmcnt(4)
    s_add_u32 s28, s28, 28672
    s_waitcnt vmcnt(12)
    v_mfma_f32_16x16x32_bf16 v[0:3], a[128:131], v[128:131], v[0:3]
    ds_read_b64_tr_b16 a[144:145], v252 offset:33792
    ds_read_b64_tr_b16 a[146:147], v252 offset:34304
    v_mfma_f32_16x16x32_bf16 v[4:7], a[128:131], v[132:135], v[4:7]
    ds_read_b128 v[144:147], v238 offset:28672
    v_mfma_f32_16x16x32_bf16 v[8:11], a[128:131], v[136:139], v[8:11]
    ds_read_b128 v[148:151], v238 offset:29696
    v_mfma_f32_16x16x32_bf16 v[12:15], a[128:131], v[140:143], v[12:15]
    v_mfma_f32_16x16x32_bf16 v[16:19], a[132:135], v[128:131], v[16:19]
    ds_read_b64_tr_b16 a[148:149], v252 offset:33824
    ds_read_b64_tr_b16 a[150:151], v252 offset:34336
    v_mfma_f32_16x16x32_bf16 v[20:23], a[132:135], v[132:135], v[20:23]
    ds_read_b128 v[152:155], v238 offset:30720
    v_mfma_f32_16x16x32_bf16 v[24:27], a[132:135], v[136:139], v[24:27]
    ds_read_b128 v[156:159], v238 offset:31744
    v_mfma_f32_16x16x32_bf16 v[28:31], a[132:135], v[140:143], v[28:31]
    s_waitcnt lgkmcnt(8)
    s_add_u32 m0, s32, 16896
    v_mfma_f32_16x16x32_bf16 v[32:35], a[136:139], v[128:131], v[32:35]
    ds_read_b64_tr_b16 a[152:153], v252 offset:33856
    ds_read_b64_tr_b16 a[154:155], v252 offset:34368
    v_mfma_f32_16x16x32_bf16 v[36:39], a[136:139], v[132:135], v[36:39]
    buffer_load_dwordx4 v230, s[16:19], s28 offen offset:0 lds
    v_mfma_f32_16x16x32_bf16 v[40:43], a[136:139], v[136:139], v[40:43]
    buffer_load_dwordx4 v231, s[16:19], s28 offen offset:1056 lds
    v_mfma_f32_16x16x32_bf16 v[44:47], a[136:139], v[140:143], v[44:47]
    v_mfma_f32_16x16x32_bf16 v[48:51], a[140:143], v[128:131], v[48:51]
    ds_read_b64_tr_b16 a[156:157], v252 offset:33888
    ds_read_b64_tr_b16 a[158:159], v252 offset:34400
    v_mfma_f32_16x16x32_bf16 v[52:55], a[140:143], v[132:135], v[52:55]
    buffer_load_dwordx4 v232, s[16:19], s28 offen offset:2112 lds
    v_mfma_f32_16x16x32_bf16 v[56:59], a[140:143], v[136:139], v[56:59]
    buffer_load_dwordx4 v233, s[16:19], s28 offen offset:3168 lds
    v_mfma_f32_16x16x32_bf16 v[60:63], a[140:143], v[140:143], v[60:63]
    s_waitcnt lgkmcnt(4)
    s_add_u32 s28, s28, 28672
    s_waitcnt vmcnt(12)
    v_mfma_f32_16x16x32_bf16 v[0:3], a[144:147], v[144:147], v[0:3]
    ds_read_b64_tr_b16 a[128:129], v253 offset:0
    ds_read_b64_tr_b16 a[130:131], v253 offset:512
    v_mfma_f32_16x16x32_bf16 v[4:7], a[144:147], v[148:151], v[4:7]
    ds_read_b128 v[128:131], v238 offset:32768
    v_mfma_f32_16x16x32_bf16 v[8:11], a[144:147], v[152:155], v[8:11]
    ds_read_b128 v[132:135], v238 offset:33792
    v_mfma_f32_16x16x32_bf16 v[12:15], a[144:147], v[156:159], v[12:15]
    v_mfma_f32_16x16x32_bf16 v[16:19], a[148:151], v[144:147], v[16:19]
    ds_read_b64_tr_b16 a[132:133], v253 offset:32
    ds_read_b64_tr_b16 a[134:135], v253 offset:544
    v_mfma_f32_16x16x32_bf16 v[20:23], a[148:151], v[148:151], v[20:23]
    ds_read_b128 v[136:139], v238 offset:34816
    v_mfma_f32_16x16x32_bf16 v[24:27], a[148:151], v[152:155], v[24:27]
    ds_read_b128 v[140:143], v238 offset:35840
    v_mfma_f32_16x16x32_bf16 v[28:31], a[148:151], v[156:159], v[28:31]
    s_waitcnt lgkmcnt(8)
    s_add_u32 m0, s32, 33792
    v_mfma_f32_16x16x32_bf16 v[32:35], a[152:155], v[144:147], v[32:35]
    ds_read_b64_tr_b16 a[136:137], v253 offset:64
    ds_read_b64_tr_b16 a[138:139], v253 offset:576
    v_mfma_f32_16x16x32_bf16 v[36:39], a[152:155], v[148:151], v[36:39]
    buffer_load_dwordx4 v230, s[16:19], s28 offen offset:0 lds
    v_mfma_f32_16x16x32_bf16 v[40:43], a[152:155], v[152:155], v[40:43]
    buffer_load_dwordx4 v231, s[16:19], s28 offen offset:1056 lds
    v_mfma_f32_16x16x32_bf16 v[44:47], a[152:155], v[156:159], v[44:47]
    v_mfma_f32_16x16x32_bf16 v[48:51], a[156:159], v[144:147], v[48:51]
    ds_read_b64_tr_b16 a[140:141], v253 offset:96
    ds_read_b64_tr_b16 a[142:143], v253 offset:608
    v_mfma_f32_16x16x32_bf16 v[52:55], a[156:159], v[148:151], v[52:55]
    buffer_load_dwordx4 v232, s[16:19], s28 offen offset:2112 lds
    v_mfma_f32_16x16x32_bf16 v[56:59], a[156:159], v[152:155], v[56:59]
    buffer_load_dwordx4 v233, s[16:19], s28 offen offset:3168 lds
    v_mfma_f32_16x16x32_bf16 v[60:63], a[156:159], v[156:159], v[60:63]
    s_waitcnt lgkmcnt(4)
    s_add_u32 s28, s28, 28672
    s_waitcnt vmcnt(12)
    v_mfma_f32_16x16x32_bf16 v[0:3], a[128:131], v[128:131], v[0:3]
    ds_read_b64_tr_b16 a[144:145], v253 offset:16896
    ds_read_b64_tr_b16 a[146:147], v253 offset:17408
    v_mfma_f32_16x16x32_bf16 v[4:7], a[128:131], v[132:135], v[4:7]
    ds_read_b128 v[144:147], v238 offset:36864
    v_mfma_f32_16x16x32_bf16 v[8:11], a[128:131], v[136:139], v[8:11]
    ds_read_b128 v[148:151], v238 offset:37888
    v_mfma_f32_16x16x32_bf16 v[12:15], a[128:131], v[140:143], v[12:15]
    v_mfma_f32_16x16x32_bf16 v[16:19], a[132:135], v[128:131], v[16:19]
    ds_read_b64_tr_b16 a[148:149], v253 offset:16928
    ds_read_b64_tr_b16 a[150:151], v253 offset:17440
    v_mfma_f32_16x16x32_bf16 v[20:23], a[132:135], v[132:135], v[20:23]
    ds_read_b128 v[152:155], v238 offset:38912
    v_mfma_f32_16x16x32_bf16 v[24:27], a[132:135], v[136:139], v[24:27]
    ds_read_b128 v[156:159], v238 offset:39936
    v_mfma_f32_16x16x32_bf16 v[28:31], a[132:135], v[140:143], v[28:31]
    s_waitcnt lgkmcnt(8)
    s_add_u32 m0, s32, 50688
    v_mfma_f32_16x16x32_bf16 v[32:35], a[136:139], v[128:131], v[32:35]
    ds_read_b64_tr_b16 a[152:153], v253 offset:16960
    ds_read_b64_tr_b16 a[154:155], v253 offset:17472
    v_mfma_f32_16x16x32_bf16 v[36:39], a[136:139], v[132:135], v[36:39]
    buffer_load_dwordx4 v230, s[16:19], s28 offen offset:0 lds
    v_mfma_f32_16x16x32_bf16 v[40:43], a[136:139], v[136:139], v[40:43]
    buffer_load_dwordx4 v231, s[16:19], s28 offen offset:1056 lds
    v_mfma_f32_16x16x32_bf16 v[44:47], a[136:139], v[140:143], v[44:47]
    v_mfma_f32_16x16x32_bf16 v[48:51], a[140:143], v[128:131], v[48:51]
    ds_read_b64_tr_b16 a[156:157], v253 offset:16992
    ds_read_b64_tr_b16 a[158:159], v253 offset:17504
    v_mfma_f32_16x16x32_bf16 v[52:55], a[140:143], v[132:135], v[52:55]
    buffer_load_dwordx4 v232, s[16:19], s28 offen offset:2112 lds
    v_mfma_f32_16x16x32_bf16 v[56:59], a[140:143], v[136:139], v[56:59]
    buffer_load_dwordx4 v233, s[16:19], s28 offen offset:3168 lds
    v_mfma_f32_16x16x32_bf16 v[60:63], a[140:143], v[140:143], v[60:63]
    s_waitcnt lgkmcnt(4)
    s_add_u32 s28, s28, 28672
    s_waitcnt vmcnt(12)
    v_mfma_f32_16x16x32_bf16 v[0:3], a[144:147], v[144:147], v[0:3]
    ds_read_b64_tr_b16 a[128:129], v252 offset:0
    ds_read_b64_tr_b16 a[130:131], v252 offset:512
    v_mfma_f32_16x16x32_bf16 v[4:7], a[144:147], v[148:151], v[4:7]
    ds_read_b128 v[128:131], v238 offset:40960
    v_mfma_f32_16x16x32_bf16 v[8:11], a[144:147], v[152:155], v[8:11]
    ds_read_b128 v[132:135], v238 offset:41984
    v_mfma_f32_16x16x32_bf16 v[12:15], a[144:147], v[156:159], v[12:15]
    v_mfma_f32_16x16x32_bf16 v[16:19], a[148:151], v[144:147], v[16:19]
    ds_read_b64_tr_b16 a[132:133], v252 offset:32
    ds_read_b64_tr_b16 a[134:135], v252 offset:544
    v_mfma_f32_16x16x32_bf16 v[20:23], a[148:151], v[148:151], v[20:23]
    ds_read_b128 v[136:139], v238 offset:43008
    v_mfma_f32_16x16x32_bf16 v[24:27], a[148:151], v[152:155], v[24:27]
    ds_read_b128 v[140:143], v238 offset:44032
    v_mfma_f32_16x16x32_bf16 v[28:31], a[148:151], v[156:159], v[28:31]
    s_waitcnt lgkmcnt(8)
    s_add_u32 m0, s32, 67584
    v_mfma_f32_16x16x32_bf16 v[32:35], a[152:155], v[144:147], v[32:35]
    ds_read_b64_tr_b16 a[136:137], v252 offset:64
    ds_read_b64_tr_b16 a[138:139], v252 offset:576
    v_mfma_f32_16x16x32_bf16 v[36:39], a[152:155], v[148:151], v[36:39]
    buffer_load_dwordx4 v230, s[16:19], s28 offen offset:0 lds
    v_mfma_f32_16x16x32_bf16 v[40:43], a[152:155], v[152:155], v[40:43]
    buffer_load_dwordx4 v231, s[16:19], s28 offen offset:1056 lds
    v_mfma_f32_16x16x32_bf16 v[44:47], a[152:155], v[156:159], v[44:47]
    v_mfma_f32_16x16x32_bf16 v[48:51], a[156:159], v[144:147], v[48:51]
    ds_read_b64_tr_b16 a[140:141], v252 offset:96
    ds_read_b64_tr_b16 a[142:143], v252 offset:608
    v_mfma_f32_16x16x32_bf16 v[52:55], a[156:159], v[148:151], v[52:55]
    buffer_load_dwordx4 v232, s[16:19], s28 offen offset:2112 lds
    v_mfma_f32_16x16x32_bf16 v[56:59], a[156:159], v[152:155], v[56:59]
    buffer_load_dwordx4 v233, s[16:19], s28 offen offset:3168 lds
    v_mfma_f32_16x16x32_bf16 v[60:63], a[156:159], v[156:159], v[60:63]
    s_waitcnt lgkmcnt(4)
    s_add_u32 s28, s28, 28672
    s_waitcnt vmcnt(12)
    v_mfma_f32_16x16x32_bf16 v[0:3], a[128:131], v[128:131], v[0:3]
    ds_read_b64_tr_b16 a[144:145], v252 offset:16896
    ds_read_b64_tr_b16 a[146:147], v252 offset:17408
    v_mfma_f32_16x16x32_bf16 v[4:7], a[128:131], v[132:135], v[4:7]
    ds_read_b128 v[144:147], v238 offset:45056
    v_mfma_f32_16x16x32_bf16 v[8:11], a[128:131], v[136:139], v[8:11]
    ds_read_b128 v[148:151], v238 offset:46080
    v_mfma_f32_16x16x32_bf16 v[12:15], a[128:131], v[140:143], v[12:15]
    v_mfma_f32_16x16x32_bf16 v[16:19], a[132:135], v[128:131], v[16:19]
    ds_read_b64_tr_b16 a[148:149], v252 offset:16928
    ds_read_b64_tr_b16 a[150:151], v252 offset:17440
    v_mfma_f32_16x16x32_bf16 v[20:23], a[132:135], v[132:135], v[20:23]
    ds_read_b128 v[152:155], v238 offset:47104
    v_mfma_f32_16x16x32_bf16 v[24:27], a[132:135], v[136:139], v[24:27]
    ds_read_b128 v[156:159], v238 offset:48128
    v_mfma_f32_16x16x32_bf16 v[28:31], a[132:135], v[140:143], v[28:31]
    s_waitcnt lgkmcnt(8)
    s_add_u32 m0, s32, 0
    v_mfma_f32_16x16x32_bf16 v[32:35], a[136:139], v[128:131], v[32:35]
    ds_read_b64_tr_b16 a[152:153], v252 offset:16960
    ds_read_b64_tr_b16 a[154:155], v252 offset:17472
    v_mfma_f32_16x16x32_bf16 v[36:39], a[136:139], v[132:135], v[36:39]
    buffer_load_dwordx4 v230, s[16:19], s28 offen offset:0 lds
    v_mfma_f32_16x16x32_bf16 v[40:43], a[136:139], v[136:139], v[40:43]
    buffer_load_dwordx4 v231, s[16:19], s28 offen offset:1056 lds
    v_mfma_f32_16x16x32_bf16 v[44:47], a[136:139], v[140:143], v[44:47]
    v_mfma_f32_16x16x32_bf16 v[48:51], a[140:143], v[128:131], v[48:51]
    ds_read_b64_tr_b16 a[156:157], v252 offset:16992
    ds_read_b64_tr_b16 a[158:159], v252 offset:17504
    v_mfma_f32_16x16x32_bf16 v[52:55], a[140:143], v[132:135], v[52:55]
    buffer_load_dwordx4 v232, s[16:19], s28 offen offset:2112 lds
    v_mfma_f32_16x16x32_bf16 v[56:59], a[140:143], v[136:139], v[56:59]
    buffer_load_dwordx4 v233, s[16:19], s28 offen offset:3168 lds
    v_mfma_f32_16x16x32_bf16 v[60:63], a[140:143], v[140:143], v[60:63]
    s_waitcnt lgkmcnt(4)
    s_add_u32 s28, s28, 28672
    s_waitcnt vmcnt(12)
    v_mfma_f32_16x16x32_bf16 v[0:3], a[144:147], v[144:147], v[0:3]
    ds_read_b64_tr_b16 a[128:129], v252 offset:33792
    ds_read_b64_tr_b16 a[130:131], v252 offset:34304
    v_mfma_f32_16x16x32_bf16 v[4:7], a[144:147], v[148:151], v[4:7]
    ds_read_b128 v[128:131], v238 offset:49152
    v_mfma_f32_16x16x32_bf16 v[8:11], a[144:147], v[152:155], v[8:11]
    ds_read_b128 v[132:135], v238 offset:50176
    v_mfma_f32_16x16x32_bf16 v[12:15], a[144:147], v[156:159], v[12:15]
    v_mfma_f32_16x16x32_bf16 v[16:19], a[148:151], v[144:147], v[16:19]
    ds_read_b64_tr_b16 a[132:133], v252 offset:33824
    ds_read_b64_tr_b16 a[134:135], v252 offset:34336
    v_mfma_f32_16x16x32_bf16 v[20:23], a[148:151], v[148:151], v[20:23]
    ds_read_b128 v[136:139], v238 offset:51200
    v_mfma_f32_16x16x32_bf16 v[24:27], a[148:151], v[152:155], v[24:27]
    ds_read_b128 v[140:143], v238 offset:52224
    v_mfma_f32_16x16x32_bf16 v[28:31], a[148:151], v[156:159], v[28:31]
    s_waitcnt lgkmcnt(8)
    s_add_u32 m0, s32, 16896
    v_mfma_f32_16x16x32_bf16 v[32:35], a[152:155], v[144:147], v[32:35]
    ds_read_b64_tr_b16 a[136:137], v252 offset:33856
    ds_read_b64_tr_b16 a[138:139], v252 offset:34368
    v_mfma_f32_16x16x32_bf16 v[36:39], a[152:155], v[148:151], v[36:39]
    buffer_load_dwordx4 v230, s[16:19], s29 offen offset:0 lds
    v_mfma_f32_16x16x32_bf16 v[40:43], a[152:155], v[152:155], v[40:43]
    buffer_load_dwordx4 v231, s[16:19], s29 offen offset:1056 lds
    v_mfma_f32_16x16x32_bf16 v[44:47], a[152:155], v[156:159], v[44:47]
    v_mfma_f32_16x16x32_bf16 v[48:51], a[156:159], v[144:147], v[48:51]
    ds_read_b64_tr_b16 a[140:141], v252 offset:33888
    ds_read_b64_tr_b16 a[142:143], v252 offset:34400
    v_mfma_f32_16x16x32_bf16 v[52:55], a[156:159], v[148:151], v[52:55]
    buffer_load_dwordx4 v232, s[16:19], s29 offen offset:2112 lds
    v_mfma_f32_16x16x32_bf16 v[56:59], a[156:159], v[152:155], v[56:59]
    buffer_load_dwordx4 v233, s[16:19], s29 offen offset:3168 lds
    v_mfma_f32_16x16x32_bf16 v[60:63], a[156:159], v[156:159], v[60:63]
    s_waitcnt lgkmcnt(4)
    s_add_u32 s29, s29, 28672
    s_waitcnt vmcnt(12)
    v_mfma_f32_16x16x32_bf16 v[0:3], a[128:131], v[128:131], v[0:3]
    ds_read_b64_tr_b16 a[144:145], v253 offset:0
    ds_read_b64_tr_b16 a[146:147], v253 offset:512
    v_mfma_f32_16x16x32_bf16 v[4:7], a[128:131], v[132:135], v[4:7]
    ds_read_b128 v[144:147], v238 offset:53248
    v_mfma_f32_16x16x32_bf16 v[8:11], a[128:131], v[136:139], v[8:11]
    ds_read_b128 v[148:151], v238 offset:54272
    v_mfma_f32_16x16x32_bf16 v[12:15], a[128:131], v[140:143], v[12:15]
    v_mfma_f32_16x16x32_bf16 v[16:19], a[132:135], v[128:131], v[16:19]
    ds_read_b64_tr_b16 a[148:149], v253 offset:32
    ds_read_b64_tr_b16 a[150:151], v253 offset:544
    v_mfma_f32_16x16x32_bf16 v[20:23], a[132:135], v[132:135], v[20:23]
    ds_read_b128 v[152:155], v238 offset:55296
    v_mfma_f32_16x16x32_bf16 v[24:27], a[132:135], v[136:139], v[24:27]
    ds_read_b128 v[156:159], v238 offset:56320
    v_mfma_f32_16x16x32_bf16 v[28:31], a[132:135], v[140:143], v[28:31]
    s_waitcnt lgkmcnt(8)
    s_add_u32 m0, s32, 33792
    v_mfma_f32_16x16x32_bf16 v[32:35], a[136:139], v[128:131], v[32:35]
    ds_read_b64_tr_b16 a[152:153], v253 offset:64
    ds_read_b64_tr_b16 a[154:155], v253 offset:576
    v_mfma_f32_16x16x32_bf16 v[36:39], a[136:139], v[132:135], v[36:39]
    buffer_load_dwordx4 v230, s[16:19], s29 offen offset:0 lds
    v_mfma_f32_16x16x32_bf16 v[40:43], a[136:139], v[136:139], v[40:43]
    buffer_load_dwordx4 v231, s[16:19], s29 offen offset:1056 lds
    v_mfma_f32_16x16x32_bf16 v[44:47], a[136:139], v[140:143], v[44:47]
    v_mfma_f32_16x16x32_bf16 v[48:51], a[140:143], v[128:131], v[48:51]
    ds_read_b64_tr_b16 a[156:157], v253 offset:96
    ds_read_b64_tr_b16 a[158:159], v253 offset:608
    v_mfma_f32_16x16x32_bf16 v[52:55], a[140:143], v[132:135], v[52:55]
    buffer_load_dwordx4 v232, s[16:19], s29 offen offset:2112 lds
    v_mfma_f32_16x16x32_bf16 v[56:59], a[140:143], v[136:139], v[56:59]
    buffer_load_dwordx4 v233, s[16:19], s29 offen offset:3168 lds
    v_mfma_f32_16x16x32_bf16 v[60:63], a[140:143], v[140:143], v[60:63]
    s_waitcnt lgkmcnt(4)
    s_add_u32 s29, s29, 28672
    s_waitcnt vmcnt(12)
    v_mfma_f32_16x16x32_bf16 v[0:3], a[144:147], v[144:147], v[0:3]
    ds_read_b64_tr_b16 a[128:129], v253 offset:16896
    ds_read_b64_tr_b16 a[130:131], v253 offset:17408
    v_mfma_f32_16x16x32_bf16 v[4:7], a[144:147], v[148:151], v[4:7]
    ds_read_b128 v[128:131], v238 offset:57344
    v_mfma_f32_16x16x32_bf16 v[8:11], a[144:147], v[152:155], v[8:11]
    ds_read_b128 v[132:135], v238 offset:58368
    v_mfma_f32_16x16x32_bf16 v[12:15], a[144:147], v[156:159], v[12:15]
    v_mfma_f32_16x16x32_bf16 v[16:19], a[148:151], v[144:147], v[16:19]
    ds_read_b64_tr_b16 a[132:133], v253 offset:16928
    ds_read_b64_tr_b16 a[134:135], v253 offset:17440
    v_mfma_f32_16x16x32_bf16 v[20:23], a[148:151], v[148:151], v[20:23]
    ds_read_b128 v[136:139], v238 offset:59392
    v_mfma_f32_16x16x32_bf16 v[24:27], a[148:151], v[152:155], v[24:27]
    ds_read_b128 v[140:143], v238 offset:60416
    v_mfma_f32_16x16x32_bf16 v[28:31], a[148:151], v[156:159], v[28:31]
    s_waitcnt lgkmcnt(8)
    s_add_u32 m0, s32, 50688
    v_mfma_f32_16x16x32_bf16 v[32:35], a[152:155], v[144:147], v[32:35]
    ds_read_b64_tr_b16 a[136:137], v253 offset:16960
    ds_read_b64_tr_b16 a[138:139], v253 offset:17472
    v_mfma_f32_16x16x32_bf16 v[36:39], a[152:155], v[148:151], v[36:39]
    buffer_load_dwordx4 v230, s[16:19], s29 offen offset:0 lds
    v_mfma_f32_16x16x32_bf16 v[40:43], a[152:155], v[152:155], v[40:43]
    buffer_load_dwordx4 v231, s[16:19], s29 offen offset:1056 lds
    v_mfma_f32_16x16x32_bf16 v[44:47], a[152:155], v[156:159], v[44:47]
    v_mfma_f32_16x16x32_bf16 v[48:51], a[156:159], v[144:147], v[48:51]
    ds_read_b64_tr_b16 a[140:141], v253 offset:16992
    ds_read_b64_tr_b16 a[142:143], v253 offset:17504
    v_mfma_f32_16x16x32_bf16 v[52:55], a[156:159], v[148:151], v[52:55]
    buffer_load_dwordx4 v232, s[16:19], s29 offen offset:2112 lds
    v_mfma_f32_16x16x32_bf16 v[56:59], a[156:159], v[152:155], v[56:59]
    buffer_load_dwordx4 v233, s[16:19], s29 offen offset:3168 lds
    v_mfma_f32_16x16x32_bf16 v[60:63], a[156:159], v[156:159], v[60:63]
    s_waitcnt lgkmcnt(4)
    s_add_u32 s29, s29, 28672
    s_waitcnt vmcnt(12)
    v_mfma_f32_16x16x32_bf16 v[0:3], a[128:131], v[128:131], v[0:3]
    ds_read_b64_tr_b16 a[144:145], v252 offset:0
    ds_read_b64_tr_b16 a[146:147], v252 offset:512
    v_mfma_f32_16x16x32_bf16 v[4:7], a[128:131], v[132:135], v[4:7]
    ds_read_b128 v[144:147], v238 offset:61440
    v_mfma_f32_16x16x32_bf16 v[8:11], a[128:131], v[136:139], v[8:11]
    ds_read_b128 v[148:151], v238 offset:62464
    v_mfma_f32_16x16x32_bf16 v[12:15], a[128:131], v[140:143], v[12:15]
    v_mfma_f32_16x16x32_bf16 v[16:19], a[132:135], v[128:131], v[16:19]
    ds_read_b64_tr_b16 a[148:149], v252 offset:32
    ds_read_b64_tr_b16 a[150:151], v252 offset:544
    v_mfma_f32_16x16x32_bf16 v[20:23], a[132:135], v[132:135], v[20:23]
    ds_read_b128 v[152:155], v238 offset:63488
    v_mfma_f32_16x16x32_bf16 v[24:27], a[132:135], v[136:139], v[24:27]
    ds_read_b128 v[156:159], v238 offset:64512
    v_mfma_f32_16x16x32_bf16 v[28:31], a[132:135], v[140:143], v[28:31]
    s_waitcnt lgkmcnt(8)
    s_add_u32 m0, s32, 67584
    v_mfma_f32_16x16x32_bf16 v[32:35], a[136:139], v[128:131], v[32:35]
    ds_read_b64_tr_b16 a[152:153], v252 offset:64
    ds_read_b64_tr_b16 a[154:155], v252 offset:576
    v_mfma_f32_16x16x32_bf16 v[36:39], a[136:139], v[132:135], v[36:39]
    buffer_load_dwordx4 v230, s[16:19], s29 offen offset:0 lds
    v_mfma_f32_16x16x32_bf16 v[40:43], a[136:139], v[136:139], v[40:43]
    buffer_load_dwordx4 v231, s[16:19], s29 offen offset:1056 lds
    v_mfma_f32_16x16x32_bf16 v[44:47], a[136:139], v[140:143], v[44:47]
    v_mfma_f32_16x16x32_bf16 v[48:51], a[140:143], v[128:131], v[48:51]
    ds_read_b64_tr_b16 a[156:157], v252 offset:96
    ds_read_b64_tr_b16 a[158:159], v252 offset:608
    v_mfma_f32_16x16x32_bf16 v[52:55], a[140:143], v[132:135], v[52:55]
    buffer_load_dwordx4 v232, s[16:19], s29 offen offset:2112 lds
    v_mfma_f32_16x16x32_bf16 v[56:59], a[140:143], v[136:139], v[56:59]
    buffer_load_dwordx4 v233, s[16:19], s29 offen offset:3168 lds
    v_mfma_f32_16x16x32_bf16 v[60:63], a[140:143], v[140:143], v[60:63]
    s_waitcnt lgkmcnt(4)
    s_add_u32 s29, s29, 28672
    s_waitcnt vmcnt(12)
    v_mfma_f32_16x16x32_bf16 v[0:3], a[144:147], v[144:147], v[0:3]
    ds_read_b64_tr_b16 a[128:129], v252 offset:16896
    ds_read_b64_tr_b16 a[130:131], v252 offset:17408
    v_mfma_f32_16x16x32_bf16 v[4:7], a[144:147], v[148:151], v[4:7]
    ds_read_b128 v[128:131], v238 offset:0
    v_mfma_f32_16x16x32_bf16 v[8:11], a[144:147], v[152:155], v[8:11]
    ds_read_b128 v[132:135], v238 offset:1024
    v_mfma_f32_16x16x32_bf16 v[12:15], a[144:147], v[156:159], v[12:15]
    v_mfma_f32_16x16x32_bf16 v[16:19], a[148:151], v[144:147], v[16:19]
    ds_read_b64_tr_b16 a[132:133], v252 offset:16928
    ds_read_b64_tr_b16 a[134:135], v252 offset:17440
    v_mfma_f32_16x16x32_bf16 v[20:23], a[148:151], v[148:151], v[20:23]
    ds_read_b128 v[136:139], v238 offset:2048
    v_mfma_f32_16x16x32_bf16 v[24:27], a[148:151], v[152:155], v[24:27]
    ds_read_b128 v[140:143], v238 offset:3072
    v_mfma_f32_16x16x32_bf16 v[28:31], a[148:151], v[156:159], v[28:31]
    s_waitcnt lgkmcnt(8)
    s_add_u32 m0, s32, 0
    v_mfma_f32_16x16x32_bf16 v[32:35], a[152:155], v[144:147], v[32:35]
    ds_read_b64_tr_b16 a[136:137], v252 offset:16960
    ds_read_b64_tr_b16 a[138:139], v252 offset:17472
    v_mfma_f32_16x16x32_bf16 v[36:39], a[152:155], v[148:151], v[36:39]
    buffer_load_dwordx4 v230, s[16:19], s29 offen offset:0 lds
    v_mfma_f32_16x16x32_bf16 v[40:43], a[152:155], v[152:155], v[40:43]
    buffer_load_dwordx4 v231, s[16:19], s29 offen offset:1056 lds
    v_mfma_f32_16x16x32_bf16 v[44:47], a[152:155], v[156:159], v[44:47]
    v_mfma_f32_16x16x32_bf16 v[48:51], a[156:159], v[144:147], v[48:51]
    ds_read_b64_tr_b16 a[140:141], v252 offset:16992
    ds_read_b64_tr_b16 a[142:143], v252 offset:17504
    v_mfma_f32_16x16x32_bf16 v[52:55], a[156:159], v[148:151], v[52:55]
    buffer_load_dwordx4 v232, s[16:19], s29 offen offset:2112 lds
    v_mfma_f32_16x16x32_bf16 v[56:59], a[156:159], v[152:155], v[56:59]
    buffer_load_dwordx4 v233, s[16:19], s29 offen offset:3168 lds
    v_mfma_f32_16x16x32_bf16 v[60:63], a[156:159], v[156:159], v[60:63]
    s_waitcnt lgkmcnt(4)
    s_add_u32 s29, s29, 28672
    s_cmp_eq_u32 s24, 3
    s_cbranch_scc1 KB_o3
    s_waitcnt vmcnt(12)
    v_mfma_f32_16x16x32_bf16 v[64:67], a[128:131], v[128:131], 0
    ds_read_b64_tr_b16 a[144:145], v252 offset:33792
    ds_read_b64_tr_b16 a[146:147], v252 offset:34304
    v_mfma_f32_16x16x32_bf16 v[68:71], a[128:131], v[132:135], 0
    ds_read_b128 v[144:147], v238 offset:4096
    v_mfma_f32_16x16x32_bf16 v[72:75], a[128:131], v[136:139], 0
    ds_read_b128 v[148:151], v238 offset:5120
    v_mfma_f32_16x16x32_bf16 v[76:79], a[128:131], v[140:143], 0
    v_mfma_f32_16x16x32_bf16 v[80:83], a[132:135], v[128:131], 0
    ds_read_b64_tr_b16 a[148:149], v252 offset:33824
    ds_read_b64_tr_b16 a[150:151], v252 offset:34336
    v_mfma_f32_16x16x32_bf16 v[84:87], a[132:135], v[132:135], 0
    ds_read_b128 v[152:155], v238 offset:6144
    v_mfma_f32_16x16x32_bf16 v[88:91], a[132:135], v[136:139], 0
    ds_read_b128 v[156:159], v238 offset:7168
    v_mfma_f32_16x16x32_bf16 v[92:95], a[132:135], v[140:143], 0
    s_waitcnt lgkmcnt(8)
    s_add_u32 m0, s32, 16896
    v_mfma_f32_16x16x32_bf16 v[96:99], a[136:139], v[128:131], 0
    ds_read_b64_tr_b16 a[152:153], v252 offset:33856
    ds_read_b64_tr_b16 a[154:155], v252 offset:34368
    v_mfma_f32_16x16x32_bf16 v[100:103], a[136:139], v[132:135], 0
    buffer_load_dwordx4 v230, s[16:19], s29 offen offset:0 lds
    v_mfma_f32_16x16x32_bf16 v[104:107], a[136:139], v[136:139], 0
    buffer_load_dwordx4 v231, s[16:19], s29 offen offset:1056 lds
    v_mfma_f32_16x16x32_bf16 v[108:111], a[136:139], v[140:143], 0
    v_mfma_f32_16x16x32_bf16 v[112:115], a[140:143], v[128:131], 0
    ds_read_b64_tr_b16 a[156:157], v252 offset:33888
    ds_read_b64_tr_b16 a[158:159], v252 offset:34400
    v_mfma_f32_16x16x32_bf16 v[116:119], a[140:143], v[132:135], 0
    buffer_load_dwordx4 v232, s[16:19], s29 offen offset:2112 lds
    v_mfma_f32_16x16x32_bf16 v[120:123], a[140:143], v[136:139], 0
    buffer_load_dwordx4 v233, s[16:19], s29 offen offset:3168 lds
    v_mfma_f32_16x16x32_bf16 v[124:127], a[140:143], v[140:143], 0
    s_waitcnt lgkmcnt(4)
    s_add_u32 s29, s29, 28672
    s_waitcnt vmcnt(12)
    v_mfma_f32_16x16x32_bf16 v[64:67], a[144:147], v[144:147], v[64:67]
    ds_read_b64_tr_b16 a[128:129], v253 offset:0
    ds_read_b64_tr_b16 a[130:131], v253 offset:512
    v_mfma_f32_16x16x32_bf16 v[68:71], a[144:147], v[148:151], v[68:71]
    ds_read_b128 v[128:131], v238 offset:8192
    v_mfma_f32_16x16x32_bf16 v[72:75], a[144:147], v[152:155], v[72:75]
    ds_read_b128 v[132:135], v238 offset:9216
    v_cvt_pk_bf16_f32 v0, v0, v1
    v_mfma_f32_16x16x32_bf16 v[76:79], a[144:147], v[156:159], v[76:79]
    v_cvt_pk_bf16_f32 v1, v2, v3
    v_cvt_pk_bf16_f32 v2, v16, v17
    v_mfma_f32_16x16x32_bf16 v[80:83], a[148:151], v[144:147], v[80:83]
    ds_read_b64_tr_b16 a[132:133], v253 offset:32
    ds_read_b64_tr_b16 a[134:135], v253 offset:544
    v_mfma_f32_16x16x32_bf16 v[84:87], a[148:151], v[148:151], v[84:87]
    ds_read_b128 v[136:139], v238 offset:10240
    v_cvt_pk_bf16_f32 v3, v18, v19
    v_mfma_f32_16x16x32_bf16 v[88:91], a[148:151], v[152:155], v[88:91]
    ds_read_b128 v[140:143], v238 offset:11264
    v_mfma_f32_16x16x32_bf16 v[92:95], a[148:151], v[156:159], v[92:95]
    s_waitcnt lgkmcnt(8)
    s_add_u32 m0, s32, 33792
    v_mfma_f32_16x16x32_bf16 v[96:99], a[152:155], v[144:147], v[96:99]
    ds_read_b64_tr_b16 a[136:137], v253 offset:64
    ds_read_b64_tr_b16 a[138:139], v253 offset:576
    v_mfma_f32_16x16x32_bf16 v[100:103], a[152:155], v[148:151], v[100:103]
    buffer_load_dwordx4 v230, s[16:19], s29 offen offset:0 lds
    v_mfma_f32_16x16x32_bf16 v[104:107], a[152:155], v[152:155], v[104:107]
    buffer_load_dwordx4 v231, s[16:19], s29 offen offset:1056 lds
    v_mfma_f32_16x16x32_bf16 v[108:111], a[152:155], v[156:159], v[108:111]
    v_mfma_f32_16x16x32_bf16 v[112:115], a[156:159], v[144:147], v[112:115]
    ds_read_b64_tr_b16 a[140:141], v253 offset:96
    ds_read_b64_tr_b16 a[142:143], v253 offset:608
    v_mfma_f32_16x16x32_bf16 v[116:119], a[156:159], v[148:151], v[116:119]
    buffer_load_dwordx4 v232, s[16:19], s29 offen offset:2112 lds
    v_mfma_f32_16x16x32_bf16 v[120:123], a[156:159], v[152:155], v[120:123]
    buffer_load_dwordx4 v233, s[16:19], s29 offen offset:3168 lds
    v_mfma_f32_16x16x32_bf16 v[124:127], a[156:159], v[156:159], v[124:127]
    s_waitcnt lgkmcnt(4)
    s_add_u32 s29, s29, 28672
    s_waitcnt vmcnt(12)
    v_mfma_f32_16x16x32_bf16 v[64:67], a[128:131], v[128:131], v[64:67]
    ds_read_b64_tr_b16 a[144:145], v253 offset:16896
    ds_read_b64_tr_b16 a[146:147], v253 offset:17408
    v_mfma_f32_16x16x32_bf16 v[68:71], a[128:131], v[132:135], v[68:71]
    ds_read_b128 v[144:147], v238 offset:12288
    v_mfma_f32_16x16x32_bf16 v[72:75], a[128:131], v[136:139], v[72:75]
    ds_read_b128 v[148:151], v238 offset:13312
    v_permlane16_swap_b32 v0, v2
    v_mfma_f32_16x16x32_bf16 v[76:79], a[128:131], v[140:143], v[76:79]
    v_permlane16_swap_b32 v1, v3
    v_mfma_f32_16x16x32_bf16 v[80:83], a[132:135], v[128:131], v[80:83]
    ds_read_b64_tr_b16 a[148:149], v253 offset:16928
    ds_read_b64_tr_b16 a[150:151], v253 offset:17440
    v_mfma_f32_16x16x32_bf16 v[84:87], a[132:135], v[132:135], v[84:87]
    ds_read_b128 v[152:155], v238 offset:14336
    v_mfma_f32_16x16x32_bf16 v[88:91], a[132:135], v[136:139], v[88:91]
    ds_read_b128 v[156:159], v238 offset:15360
    v_mfma_f32_16x16x32_bf16 v[92:95], a[132:135], v[140:143], v[92:95]
    s_waitcnt lgkmcnt(8)
    s_add_u32 m0, s32, 50688
    v_mfma_f32_16x16x32_bf16 v[96:99], a[136:139], v[128:131], v[96:99]
    ds_read_b64_tr_b16 a[152:153], v253 offset:16960
    ds_read_b64_tr_b16 a[154:155], v253 offset:17472
    v_mfma_f32_16x16x32_bf16 v[100:103], a[136:139], v[132:135], v[100:103]
    buffer_load_dwordx4 v230, s[16:19], s29 offen offset:0 lds
    v_mfma_f32_16x16x32_bf16 v[104:107], a[136:139], v[136:139], v[104:107]
    buffer_load_dwordx4 v231, s[16:19], s29 offen offset:1056 lds
    v_mfma_f32_16x16x32_bf16 v[108:111], a[136:139], v[140:143], v[108:111]
    buffer_store_dwordx4 v[0:3], v250, s[20:23], s66 offen offset:0 sc1
    v_mfma_f32_16x16x32_bf16 v[112:115], a[140:143], v[128:131], v[112:115]
    ds_read_b64_tr_b16 a[156:157], v253 offset:16992
    ds_read_b64_tr_b16 a[158:159], v253 offset:17504
    v_mfma_f32_16x16x32_bf16 v[116:119], a[140:143], v[132:135], v[116:119]
    buffer_load_dwordx4 v232, s[16:19], s29 offen offset:2112 lds
    v_mfma_f32_16x16x32_bf16 v[120:123], a[140:143], v[136:139], v[120:123]
    buffer_load_dwordx4 v233, s[16:19], s29 offen offset:3168 lds
    v_mfma_f32_16x16x32_bf16 v[124:127], a[140:143], v[140:143], v[124:127]
    s_waitcnt lgkmcnt(4)
    s_add_u32 s29, s29, 28672
    v_cvt_pk_bf16_f32 v32, v32, v33
    v_cvt_pk_bf16_f32 v33, v34, v35
    s_waitcnt vmcnt(13)
    v_mfma_f32_16x16x32_bf16 v[64:67], a[144:147], v[144:147], v[64:67]
    ds_read_b64_tr_b16 a[128:129], v252 offset:0
    ds_read_b64_tr_b16 a[130:131], v252 offset:512
    v_mfma_f32_16x16x32_bf16 v[68:71], a[144:147], v[148:151], v[68:71]
    ds_read_b128 v[128:131], v238 offset:16384
    v_mfma_f32_16x16x32_bf16 v[72:75], a[144:147], v[152:155], v[72:75]
    ds_read_b128 v[132:135], v238 offset:17408
    v_cvt_pk_bf16_f32 v34, v48, v49
    v_mfma_f32_16x16x32_bf16 v[76:79], a[144:147], v[156:159], v[76:79]
    v_cvt_pk_bf16_f32 v35, v50, v51
    v_permlane16_swap_b32 v32, v34
    v_mfma_f32_16x16x32_bf16 v[80:83], a[148:151], v[144:147], v[80:83]
    ds_read_b64_tr_b16 a[132:133], v252 offset:32
    ds_read_b64_tr_b16 a[134:135], v252 offset:544
    v_mfma_f32_16x16x32_bf16 v[84:87], a[148:151], v[148:151], v[84:87]
    ds_read_b128 v[136:139], v238 offset:18432
    v_permlane16_swap_b32 v33, v35
    v_mfma_f32_16x16x32_bf16 v[88:91], a[148:151], v[152:155], v[88:91]
    ds_read_b128 v[140:143], v238 offset:19456
    v_mfma_f32_16x16x32_bf16 v[92:95], a[148:151], v[156:159], v[92:95]
    s_waitcnt lgkmcnt(8)
    s_add_u32 m0, s32, 67584
    v_mfma_f32_16x16x32_bf16 v[96:99], a[152:155], v[144:147], v[96:99]
    ds_read_b64_tr_b16 a[136:137], v252 offset:64
    ds_read_b64_tr_b16 a[138:139], v252 offset:576
    v_mfma_f32_16x16x32_bf16 v[100:103], a[152:155], v[148:151], v[100:103]
    buffer_load_dwordx4 v230, s[16:19], s29 offen offset:0 lds
    v_mfma_f32_16x16x32_bf16 v[104:107], a[152:155], v[152:155], v[104:107]
    buffer_load_dwordx4 v231, s[16:19], s29 offen offset:1056 lds
    v_mfma_f32_16x16x32_bf16 v[108:111], a[152:155], v[156:159], v[108:111]
    v_mfma_f32_16x16x32_bf16 v[112:115], a[156:159], v[144:147], v[112:115]
    ds_read_b64_tr_b16 a[140:141], v252 offset:96
    ds_read_b64_tr_b16 a[142:143], v252 offset:608
    v_mfma_f32_16x16x32_bf16 v[116:119], a[156:159], v[148:151], v[116:119]
    buffer_load_dwordx4 v232, s[16:19], s29 offen offset:2112 lds
    v_mfma_f32_16x16x32_bf16 v[120:123], a[156:159], v[152:155], v[120:123]
    buffer_load_dwordx4 v233, s[16:19], s29 offen offset:3168 lds
    v_mfma_f32_16x16x32_bf16 v[124:127], a[156:159], v[156:159], v[124:127]
    s_waitcnt lgkmcnt(4)
    s_add_u32 s29, s29, 28672
    s_waitcnt vmcnt(13)
    v_mfma_f32_16x16x32_bf16 v[64:67], a[128:131], v[128:131], v[64:67]
    ds_read_b64_tr_b16 a[144:145], v252 offset:16896
    ds_read_b64_tr_b16 a[146:147], v252 offset:17408
    v_mfma_f32_16x16x32_bf16 v[68:71], a[128:131], v[132:135], v[68:71]
    ds_read_b128 v[144:147], v238 offset:20480
    v_mfma_f32_16x16x32_bf16 v[72:75], a[128:131], v[136:139], v[72:75]
    ds_read_b128 v[148:151], v238 offset:21504
    v_mfma_f32_16x16x32_bf16 v[76:79], a[128:131], v[140:143], v[76:79]
    buffer_store_dwordx4 v[32:35], v250, s[20:23], s66 offen offset:1024 sc1
    v_mfma_f32_16x16x32_bf16 v[80:83], a[132:135], v[128:131], v[80:83]
    s_add_u32 s66, s66, 14336
    ds_read_b64_tr_b16 a[148:149], v252 offset:16928
    ds_read_b64_tr_b16 a[150:151], v252 offset:17440
    v_mfma_f32_16x16x32_bf16 v[84:87], a[132:135], v[132:135], v[84:87]
    ds_read_b128 v[152:155], v238 offset:22528
    v_cvt_pk_bf16_f32 v4, v4, v5
    v_mfma_f32_16x16x32_bf16 v[88:91], a[132:135], v[136:139], v[88:91]
    ds_read_b128 v[156:159], v238 offset:23552
    v_cvt_pk_bf16_f32 v5, v6, v7
    v_mfma_f32_16x16x32_bf16 v[92:95], a[132:135], v[140:143], v[92:95]
    s_waitcnt lgkmcnt(8)
    s_add_u32 m0, s32, 0
    v_mfma_f32_16x16x32_bf16 v[96:99], a[136:139], v[128:131], v[96:99]
    ds_read_b64_tr_b16 a[152:153], v252 offset:16960
    ds_read_b64_tr_b16 a[154:155], v252 offset:17472
    v_mfma_f32_16x16x32_bf16 v[100:103], a[136:139], v[132:135], v[100:103]
    buffer_load_dwordx4 v230, s[16:19], s29 offen offset:0 lds
    v_mfma_f32_16x16x32_bf16 v[104:107], a[136:139], v[136:139], v[104:107]
    buffer_load_dwordx4 v231, s[16:19], s29 offen offset:1056 lds
    v_mfma_f32_16x16x32_bf16 v[108:111], a[136:139], v[140:143], v[108:111]
    v_cvt_pk_bf16_f32 v6, v20, v21
    v_mfma_f32_16x16x32_bf16 v[112:115], a[140:143], v[128:131], v[112:115]
    ds_read_b64_tr_b16 a[156:157], v252 offset:16992
    ds_read_b64_tr_b16 a[158:159], v252 offset:17504
    v_mfma_f32_16x16x32_bf16 v[116:119], a[140:143], v[132:135], v[116:119]
    buffer_load_dwordx4 v232, s[16:19], s29 offen offset:2112 lds
    v_mfma_f32_16x16x32_bf16 v[120:123], a[140:143], v[136:139], v[120:123]
    buffer_load_dwordx4 v233, s[16:19], s29 offen offset:3168 lds
    v_mfma_f32_16x16x32_bf16 v[124:127], a[140:143], v[140:143], v[124:127]
    s_waitcnt lgkmcnt(4)
    s_add_u32 s29, s29, 28672
    s_waitcnt vmcnt(14)
    v_mfma_f32_16x16x32_bf16 v[64:67], a[144:147], v[144:147], v[64:67]
    ds_read_b64_tr_b16 a[128:129], v252 offset:33792
    ds_read_b64_tr_b16 a[130:131], v252 offset:34304
    v_mfma_f32_16x16x32_bf16 v[68:71], a[144:147], v[148:151], v[68:71]
    ds_read_b128 v[128:131], v238 offset:24576
    v_mfma_f32_16x16x32_bf16 v[72:75], a[144:147], v[152:155], v[72:75]
    ds_read_b128 v[132:135], v238 offset:25600
    v_cvt_pk_bf16_f32 v7, v22, v23
    v_mfma_f32_16x16x32_bf16 v[76:79], a[144:147], v[156:159], v[76:79]
    v_permlane16_swap_b32 v4, v6
    v_permlane16_swap_b32 v5, v7
    v_mfma_f32_16x16x32_bf16 v[80:83], a[148:151], v[144:147], v[80:83]
    ds_read_b64_tr_b16 a[132:133], v252 offset:33824
    ds_read_b64_tr_b16 a[134:135], v252 offset:34336
    v_mfma_f32_16x16x32_bf16 v[84:87], a[148:151], v[148:151], v[84:87]
    ds_read_b128 v[136:139], v238 offset:26624
    v_mfma_f32_16x16x32_bf16 v[88:91], a[148:151], v[152:155], v[88:91]
    ds_read_b128 v[140:143], v238 offset:27648
    v_mfma_f32_16x16x32_bf16 v[92:95], a[148:151], v[156:159], v[92:95]
    s_waitcnt lgkmcnt(8)
    s_add_u32 m0, s32, 16896
    v_mfma_f32_16x16x32_bf16 v[96:99], a[152:155], v[144:147], v[96:99]
    ds_read_b64_tr_b16 a[136:137], v252 offset:33856
    ds_read_b64_tr_b16 a[138:139], v252 offset:34368
    v_mfma_f32_16x16x32_bf16 v[100:103], a[152:155], v[148:151], v[100:103]
    buffer_load_dwordx4 v230, s[16:19], s29 offen offset:0 lds
    v_mfma_f32_16x16x32_bf16 v[104:107], a[152:155], v[152:155], v[104:107]
    buffer_load_dwordx4 v231, s[16:19], s29 offen offset:1056 lds
    v_mfma_f32_16x16x32_bf16 v[108:111], a[152:155], v[156:159], v[108:111]
    buffer_store_dwordx4 v[4:7], v250, s[20:23], s66 offen offset:0 sc1
    v_mfma_f32_16x16x32_bf16 v[112:115], a[156:159], v[144:147], v[112:115]
    ds_read_b64_tr_b16 a[140:141], v252 offset:33888
    ds_read_b64_tr_b16 a[142:143], v252 offset:34400
    v_mfma_f32_16x16x32_bf16 v[116:119], a[156:159], v[148:151], v[116:119]
    buffer_load_dwordx4 v232, s[16:19], s29 offen offset:2112 lds
    v_mfma_f32_16x16x32_bf16 v[120:123], a[156:159], v[152:155], v[120:123]
    buffer_load_dwordx4 v233, s[16:19], s29 offen offset:3168 lds
    v_mfma_f32_16x16x32_bf16 v[124:127], a[156:159], v[156:159], v[124:127]
    s_waitcnt lgkmcnt(4)
    s_add_u32 s29, s29, 28672
    s_waitcnt vmcnt(14)
    v_mfma_f32_16x16x32_bf16 v[64:67], a[128:131], v[128:131], v[64:67]
    ds_read_b64_tr_b16 a[144:145], v253 offset:0
    ds_read_b64_tr_b16 a[146:147], v253 offset:512
    v_mfma_f32_16x16x32_bf16 v[68:71], a[128:131], v[132:135], v[68:71]
    ds_read_b128 v[144:147], v238 offset:28672
    v_mfma_f32_16x16x32_bf16 v[72:75], a[128:131], v[136:139], v[72:75]
    ds_read_b128 v[148:151], v238 offset:29696
    v_cvt_pk_bf16_f32 v36, v36, v37
    v_mfma_f32_16x16x32_bf16 v[76:79], a[128:131], v[140:143], v[76:79]
    v_cvt_pk_bf16_f32 v37, v38, v39
    v_cvt_pk_bf16_f32 v38, v52, v53
    v_mfma_f32_16x16x32_bf16 v[80:83], a[132:135], v[128:131], v[80:83]
    ds_read_b64_tr_b16 a[148:149], v253 offset:32
    ds_read_b64_tr_b16 a[150:151], v253 offset:544
    v_mfma_f32_16x16x32_bf16 v[84:87], a[132:135], v[132:135], v[84:87]
    ds_read_b128 v[152:155], v238 offset:30720
    v_cvt_pk_bf16_f32 v39, v54, v55
    v_mfma_f32_16x16x32_bf16 v[88:91], a[132:135], v[136:139], v[88:91]
    ds_read_b128 v[156:159], v238 offset:31744
    v_mfma_f32_16x16x32_bf16 v[92:95], a[132:135], v[140:143], v[92:95]
    s_waitcnt lgkmcnt(8)
    s_add_u32 m0, s32, 33792
    v_mfma_f32_16x16x32_bf16 v[96:99], a[136:139], v[128:131], v[96:99]
    ds_read_b64_tr_b16 a[152:153], v253 offset:64
    ds_read_b64_tr_b16 a[154:155], v253 offset:576
    v_mfma_f32_16x16x32_bf16 v[100:103], a[136:139], v[132:135], v[100:103]
    buffer_load_dwordx4 v230, s[16:19], s29 offen offset:0 lds
    v_mfma_f32_16x16x32_bf16 v[104:107], a[136:139], v[136:139], v[104:107]
    buffer_load_dwordx4 v231, s[16:19], s29 offen offset:1056 lds
    v_mfma_f32_16x16x32_bf16 v[108:111], a[136:139], v[140:143], v[108:111]
    v_mfma_f32_16x16x32_bf16 v[112:115], a[140:143], v[128:131], v[112:115]
    ds_read_b64_tr_b16 a[156:157], v253 offset:96
    ds_read_b64_tr_b16 a[158:159], v253 offset:608
    v_mfma_f32_16x16x32_bf16 v[116:119], a[140:143], v[132:135], v[116:119]
    buffer_load_dwordx4 v232, s[16:19], s29 offen offset:2112 lds
    v_mfma_f32_16x16x32_bf16 v[120:123], a[140:143], v[136:139], v[120:123]
    buffer_load_dwordx4 v233, s[16:19], s29 offen offset:3168 lds
    v_mfma_f32_16x16x32_bf16 v[124:127], a[140:143], v[140:143], v[124:127]
    s_waitcnt lgkmcnt(4)
    s_add_u32 s29, s29, 28672
    s_waitcnt vmcnt(14)
    v_mfma_f32_16x16x32_bf16 v[64:67], a[144:147], v[144:147], v[64:67]
    ds_read_b64_tr_b16 a[128:129], v253 offset:16896
    ds_read_b64_tr_b16 a[130:131], v253 offset:17408
    v_mfma_f32_16x16x32_bf16 v[68:71], a[144:147], v[148:151], v[68:71]
    ds_read_b128 v[128:131], v238 offset:32768
    v_mfma_f32_16x16x32_bf16 v[72:75], a[144:147], v[152:155], v[72:75]
    ds_read_b128 v[132:135], v238 offset:33792
    v_permlane16_swap_b32 v36, v38
    v_mfma_f32_16x16x32_bf16 v[76:79], a[144:147], v[156:159], v[76:79]
    v_permlane16_swap_b32 v37, v39
    v_mfma_f32_16x16x32_bf16 v[80:83], a[148:151], v[144:147], v[80:83]
    ds_read_b64_tr_b16 a[132:133], v253 offset:16928
    ds_read_b64_tr_b16 a[134:135], v253 offset:17440
    v_mfma_f32_16x16x32_bf16 v[84:87], a[148:151], v[148:151], v[84:87]
    ds_read_b128 v[136:139], v238 offset:34816
    v_mfma_f32_16x16x32_bf16 v[88:91], a[148:151], v[152:155], v[88:91]
    ds_read_b128 v[140:143], v238 offset:35840
    v_mfma_f32_16x16x32_bf16 v[92:95], a[148:151], v[156:159], v[92:95]
    s_waitcnt lgkmcnt(8)
    s_add_u32 m0, s32, 50688
    v_mfma_f32_16x16x32_bf16 v[96:99], a[152:155], v[144:147], v[96:99]
    ds_read_b64_tr_b16 a[136:137], v253 offset:16960
    ds_read_b64_tr_b16 a[138:139], v253 offset:17472
    v_mfma_f32_16x16x32_bf16 v[100:103], a[152:155], v[148:151], v[100:103]
    buffer_load_dwordx4 v230, s[16:19], s29 offen offset:0 lds
    v_mfma_f32_16x16x32_bf16 v[104:107], a[152:155], v[152:155], v[104:107]
    buffer_load_dwordx4 v231, s[16:19], s29 offen offset:1056 lds
    v_mfma_f32_16x16x32_bf16 v[108:111], a[152:155], v[156:159], v[108:111]
    buffer_store_dwordx4 v[36:39], v250, s[20:23], s66 offen offset:1024 sc1
    v_mfma_f32_16x16x32_bf16 v[112:115], a[156:159], v[144:147], v[112:115]
    s_add_u32 s66, s66, 14336
    ds_read_b64_tr_b16 a[140:141], v253 offset:16992
    ds_read_b64_tr_b16 a[142:143], v253 offset:17504
    v_mfma_f32_16x16x32_bf16 v[116:119], a[156:159], v[148:151], v[116:119]
    buffer_load_dwordx4 v232, s[16:19], s29 offen offset:2112 lds
    v_mfma_f32_16x16x32_bf16 v[120:123], a[156:159], v[152:155], v[120:123]
    buffer_load_dwordx4 v233, s[16:19], s29 offen offset:3168 lds
    v_mfma_f32_16x16x32_bf16 v[124:127], a[156:159], v[156:159], v[124:127]
    s_waitcnt lgkmcnt(4)
    s_add_u32 s29, s29, 28672
    v_cvt_pk_bf16_f32 v8, v8, v9
    s_waitcnt vmcnt(14)
    v_mfma_f32_16x16x32_bf16 v[64:67], a[128:131], v[128:131], v[64:67]
    ds_read_b64_tr_b16 a[144:145], v252 offset:0
    ds_read_b64_tr_b16 a[146:147], v252 offset:512
    v_mfma_f32_16x16x32_bf16 v[68:71], a[128:131], v[132:135], v[68:71]
    ds_read_b128 v[144:147], v238 offset:36864
    v_mfma_f32_16x16x32_bf16 v[72:75], a[128:131], v[136:139], v[72:75]
    ds_read_b128 v[148:151], v238 offset:37888
    v_cvt_pk_bf16_f32 v9, v10, v11
    v_mfma_f32_16x16x32_bf16 v[76:79], a[128:131], v[140:143], v[76:79]
    v_cvt_pk_bf16_f32 v10, v24, v25
    v_cvt_pk_bf16_f32 v11, v26, v27
    v_mfma_f32_16x16x32_bf16 v[80:83], a[132:135], v[128:131], v[80:83]
    ds_read_b64_tr_b16 a[148:149], v252 offset:32
    ds_read_b64_tr_b16 a[150:151], v252 offset:544
    v_mfma_f32_16x16x32_bf16 v[84:87], a[132:135], v[132:135], v[84:87]
    ds_read_b128 v[152:155], v238 offset:38912
    v_permlane16_swap_b32 v8, v10
    v_mfma_f32_16x16x32_bf16 v[88:91], a[132:135], v[136:139], v[88:91]
    ds_read_b128 v[156:159], v238 offset:39936
    v_mfma_f32_16x16x32_bf16 v[92:95], a[132:135], v[140:143], v[92:95]
    s_waitcnt lgkmcnt(8)
    s_add_u32 m0, s32, 67584
    v_mfma_f32_16x16x32_bf16 v[96:99], a[136:139], v[128:131], v[96:99]
    ds_read_b64_tr_b16 a[152:153], v252 offset:64
    ds_read_b64_tr_b16 a[154:155], v252 offset:576
    v_mfma_f32_16x16x32_bf16 v[100:103], a[136:139], v[132:135], v[100:103]
    buffer_load_dwordx4 v230, s[16:19], s29 offen offset:0 lds
    v_mfma_f32_16x16x32_bf16 v[104:107], a[136:139], v[136:139], v[104:107]
    buffer_load_dwordx4 v231, s[16:19], s29 offen offset:1056 lds
    v_mfma_f32_16x16x32_bf16 v[108:111], a[136:139], v[140:143], v[108:111]
    v_mfma_f32_16x16x32_bf16 v[112:115], a[140:143], v[128:131], v[112:115]
    ds_read_b64_tr_b16 a[156:157], v252 offset:96
    ds_read_b64_tr_b16 a[158:159], v252 offset:608
    v_mfma_f32_16x16x32_bf16 v[116:119], a[140:143], v[132:135], v[116:119]
    buffer_load_dwordx4 v232, s[16:19], s29 offen offset:2112 lds
    v_mfma_f32_16x16x32_bf16 v[120:123], a[140:143], v[136:139], v[120:123]
    buffer_load_dwordx4 v233, s[16:19], s29 offen offset:3168 lds
    v_mfma_f32_16x16x32_bf16 v[124:127], a[140:143], v[140:143], v[124:127]
    s_waitcnt lgkmcnt(4)
    s_add_u32 s29, s29, 28672
    s_waitcnt vmcnt(13)
    v_mfma_f32_16x16x32_bf16 v[64:67], a[144:147], v[144:147], v[64:67]
    ds_read_b64_tr_b16 a[128:129], v252 offset:16896
    ds_read_b64_tr_b16 a[130:131], v252 offset:17408
    v_mfma_f32_16x16x32_bf16 v[68:71], a[144:147], v[148:151], v[68:71]
    ds_read_b128 v[128:131], v238 offset:40960
    v_mfma_f32_16x16x32_bf16 v[72:75], a[144:147], v[152:155], v[72:75]
    ds_read_b128 v[132:135], v238 offset:41984
    v_permlane16_swap_b32 v9, v11
    v_mfma_f32_16x16x32_bf16 v[76:79], a[144:147], v[156:159], v[76:79]
    buffer_store_dwordx4 v[8:11], v250, s[20:23], s66 offen offset:0 sc1
    v_mfma_f32_16x16x32_bf16 v[80:83], a[148:151], v[144:147], v[80:83]
    ds_read_b64_tr_b16 a[132:133], v252 offset:16928
    ds_read_b64_tr_b16 a[134:135], v252 offset:17440
    v_mfma_f32_16x16x32_bf16 v[84:87], a[148:151], v[148:151], v[84:87]
    ds_read_b128 v[136:139], v238 offset:43008
    v_cvt_pk_bf16_f32 v40, v40, v41
    v_mfma_f32_16x16x32_bf16 v[88:91], a[148:151], v[152:155], v[88:91]
    ds_read_b128 v[140:143], v238 offset:44032
    v_cvt_pk_bf16_f32 v41, v42, v43
    v_mfma_f32_16x16x32_bf16 v[92:95], a[148:151], v[156:159], v[92:95]
    s_waitcnt lgkmcnt(8)
    s_add_u32 m0, s32, 0
    v_mfma_f32_16x16x32_bf16 v[96:99], a[152:155], v[144:147], v[96:99]
    ds_read_b64_tr_b16 a[136:137], v252 offset:16960
    ds_read_b64_tr_b16 a[138:139], v252 offset:17472
    v_mfma_f32_16x16x32_bf16 v[100:103], a[152:155], v[148:151], v[100:103]
    buffer_load_dwordx4 v230, s[16:19], s29 offen offset:0 lds
    v_mfma_f32_16x16x32_bf16 v[104:107], a[152:155], v[152:155], v[104:107]
    buffer_load_dwordx4 v231, s[16:19], s29 offen offset:1056 lds
    v_mfma_f32_16x16x32_bf16 v[108:111], a[152:155], v[156:159], v[108:111]
    v_cvt_pk_bf16_f32 v42, v56, v57
    v_mfma_f32_16x16x32_bf16 v[112:115], a[156:159], v[144:147], v[112:115]
    ds_read_b64_tr_b16 a[140:141], v252 offset:16992
    ds_read_b64_tr_b16 a[142:143], v252 offset:17504
    v_mfma_f32_16x16x32_bf16 v[116:119], a[156:159], v[148:151], v[116:119]
    buffer_load_dwordx4 v232, s[16:19], s29 offen offset:2112 lds
    v_mfma_f32_16x16x32_bf16 v[120:123], a[156:159], v[152:155], v[120:123]
    buffer_load_dwordx4 v233, s[16:19], s29 offen offset:3168 lds
    v_mfma_f32_16x16x32_bf16 v[124:127], a[156:159], v[156:159], v[124:127]
    s_waitcnt lgkmcnt(4)
    s_add_u32 s29, s29, 28672
    s_waitcnt vmcnt(14)
    v_mfma_f32_16x16x32_bf16 v[64:67], a[128:131], v[128:131], v[64:67]
    ds_read_b64_tr_b16 a[144:145], v252 offset:33792
    ds_read_b64_tr_b16 a[146:147], v252 offset:34304
    v_mfma_f32_16x16x32_bf16 v[68:71], a[128:131], v[132:135], v[68:71]
    ds_read_b128 v[144:147], v238 offset:45056
    v_mfma_f32_16x16x32_bf16 v[72:75], a[128:131], v[136:139], v[72:75]
    ds_read_b128 v[148:151], v238 offset:46080
    v_cvt_pk_bf16_f32 v43, v58, v59
    v_mfma_f32_16x16x32_bf16 v[76:79], a[128:131], v[140:143], v[76:79]
    v_permlane16_swap_b32 v40, v42
    v_permlane16_swap_b32 v41, v43
    v_mfma_f32_16x16x32_bf16 v[80:83], a[132:135], v[128:131], v[80:83]
    ds_read_b64_tr_b16 a[148:149], v252 offset:33824
    ds_read_b64_tr_b16 a[150:151], v252 offset:34336
    v_mfma_f32_16x16x32_bf16 v[84:87], a[132:135], v[132:135], v[84:87]
    ds_read_b128 v[152:155], v238 offset:47104
    v_mfma_f32_16x16x32_bf16 v[88:91], a[132:135], v[136:139], v[88:91]
    ds_read_b128 v[156:159], v238 offset:48128
    v_mfma_f32_16x16x32_bf16 v[92:95], a[132:135], v[140:143], v[92:95]
    s_waitcnt lgkmcnt(8)
    s_add_u32 m0, s32, 16896
    v_mfma_f32_16x16x32_bf16 v[96:99], a[136:139], v[128:131], v[96:99]
    ds_read_b64_tr_b16 a[152:153], v252 offset:33856
    ds_read_b64_tr_b16 a[154:155], v252 offset:34368
    v_mfma_f32_16x16x32_bf16 v[100:103], a[136:139], v[132:135], v[100:103]
    buffer_load_dwordx4 v230, s[16:19], s29 offen offset:0 lds
    v_mfma_f32_16x16x32_bf16 v[104:107], a[136:139], v[136:139], v[104:107]
    buffer_load_dwordx4 v231, s[16:19], s29 offen offset:1056 lds
    v_mfma_f32_16x16x32_bf16 v[108:111], a[136:139], v[140:143], v[108:111]
    buffer_store_dwordx4 v[40:43], v250, s[20:23], s66 offen offset:1024 sc1
    v_mfma_f32_16x16x32_bf16 v[112:115], a[140:143], v[128:131], v[112:115]
    ds_read_b64_tr_b16 a[156:157], v252 offset:33888
    ds_read_b64_tr_b16 a[158:159], v252 offset:34400
    v_mfma_f32_16x16x32_bf16 v[116:119], a[140:143], v[132:135], v[116:119]
    buffer_load_dwordx4 v232, s[16:19], s29 offen offset:2112 lds
    v_mfma_f32_16x16x32_bf16 v[120:123], a[140:143], v[136:139], v[120:123]
    buffer_load_dwordx4 v233, s[16:19], s29 offen offset:3168 lds
    v_mfma_f32_16x16x32_bf16 v[124:127], a[140:143], v[140:143], v[124:127]
    s_waitcnt lgkmcnt(4)
    s_add_u32 s29, s29, 28672
    s_waitcnt vmcnt(14)
    v_mfma_f32_16x16x32_bf16 v[64:67], a[144:147], v[144:147], v[64:67]
    ds_read_b64_tr_b16 a[128:129], v253 offset:0
    ds_read_b64_tr_b16 a[130:131], v253 offset:512
    v_mfma_f32_16x16x32_bf16 v[68:71], a[144:147], v[148:151], v[68:71]
    ds_read_b128 v[128:131], v238 offset:49152
    v_mfma_f32_16x16x32_bf16 v[72:75], a[144:147], v[152:155], v[72:75]
    s_add_u32 s66, s66, 14336
    ds_read_b128 v[132:135], v238 offset:50176
    v_mfma_f32_16x16x32_bf16 v[76:79], a[144:147], v[156:159], v[76:79]
    v_cvt_pk_bf16_f32 v12, v12, v13
    v_cvt_pk_bf16_f32 v13, v14, v15
    v_mfma_f32_16x16x32_bf16 v[80:83], a[148:151], v[144:147], v[80:83]
    ds_read_b64_tr_b16 a[132:133], v253 offset:32
    ds_read_b64_tr_b16 a[134:135], v253 offset:544
    v_mfma_f32_16x16x32_bf16 v[84:87], a[148:151], v[148:151], v[84:87]
    ds_read_b128 v[136:139], v238 offset:51200
    v_cvt_pk_bf16_f32 v14, v28, v29
    v_mfma_f32_16x16x32_bf16 v[88:91], a[148:151], v[152:155], v[88:91]
    ds_read_b128 v[140:143], v238 offset:52224
    v_cvt_pk_bf16_f32 v15, v30, v31
    v_mfma_f32_16x16x32_bf16 v[92:95], a[148:151], v[156:159], v[92:95]
    s_waitcnt lgkmcnt(8)
    v_mfma_f32_16x16x32_bf16 v[96:99], a[152:155], v[144:147], v[96:99]
    ds_read_b64_tr_b16 a[136:137], v253 offset:64
    ds_read_b64_tr_b16 a[138:139], v253 offset:576
    v_mfma_f32_16x16x32_bf16 v[100:103], a[152:155], v[148:151], v[100:103]
    v_mfma_f32_16x16x32_bf16 v[104:107], a[152:155], v[152:155], v[104:107]
    v_mfma_f32_16x16x32_bf16 v[108:111], a[152:155], v[156:159], v[108:111]
    v_mfma_f32_16x16x32_bf16 v[112:115], a[156:159], v[144:147], v[112:115]
    ds_read_b64_tr_b16 a[140:141], v253 offset:96
    ds_read_b64_tr_b16 a[142:143], v253 offset:608
    v_mfma_f32_16x16x32_bf16 v[116:119], a[156:159], v[148:151], v[116:119]
    v_mfma_f32_16x16x32_bf16 v[120:123], a[156:159], v[152:155], v[120:123]
    v_mfma_f32_16x16x32_bf16 v[124:127], a[156:159], v[156:159], v[124:127]
    s_waitcnt lgkmcnt(4)
    s_waitcnt vmcnt(10)
    v_mfma_f32_16x16x32_bf16 v[64:67], a[128:131], v[128:131], v[64:67]
    ds_read_b64_tr_b16 a[144:145], v253 offset:16896
    ds_read_b64_tr_b16 a[146:147], v253 offset:17408
    v_mfma_f32_16x16x32_bf16 v[68:71], a[128:131], v[132:135], v[68:71]
    ds_read_b128 v[144:147], v238 offset:53248
    v_mfma_f32_16x16x32_bf16 v[72:75], a[128:131], v[136:139], v[72:75]
    ds_read_b128 v[148:151], v238 offset:54272
    v_permlane16_swap_b32 v12, v14
    v_mfma_f32_16x16x32_bf16 v[76:79], a[128:131], v[140:143], v[76:79]
    v_permlane16_swap_b32 v13, v15
    v_mfma_f32_16x16x32_bf16 v[80:83], a[132:135], v[128:131], v[80:83]
    ds_read_b64_tr_b16 a[148:149], v253 offset:16928
    ds_read_b64_tr_b16 a[150:151], v253 offset:17440
    v_mfma_f32_16x16x32_bf16 v[84:87], a[132:135], v[132:135], v[84:87]
    ds_read_b128 v[152:155], v238 offset:55296
    v_mfma_f32_16x16x32_bf16 v[88:91], a[132:135], v[136:139], v[88:91]
    ds_read_b128 v[156:159], v238 offset:56320
    v_mfma_f32_16x16x32_bf16 v[92:95], a[132:135], v[140:143], v[92:95]
    s_waitcnt lgkmcnt(8)
    buffer_store_dwordx4 v[12:15], v250, s[20:23], s66 offen offset:0 sc1
    v_mfma_f32_16x16x32_bf16 v[96:99], a[136:139], v[128:131], v[96:99]
    ds_read_b64_tr_b16 a[152:153], v253 offset:16960
    ds_read_b64_tr_b16 a[154:155], v253 offset:17472
    v_mfma_f32_16x16x32_bf16 v[100:103], a[136:139], v[132:135], v[100:103]
    v_cvt_pk_bf16_f32 v44, v44, v45
    v_mfma_f32_16x16x32_bf16 v[104:107], a[136:139], v[136:139], v[104:107]
    v_mfma_f32_16x16x32_bf16 v[108:111], a[136:139], v[140:143], v[108:111]
    v_mfma_f32_16x16x32_bf16 v[112:115], a[140:143], v[128:131], v[112:115]
    ds_read_b64_tr_b16 a[156:157], v253 offset:16992
    ds_read_b64_tr_b16 a[158:159], v253 offset:17504
    v_mfma_f32_16x16x32_bf16 v[116:119], a[140:143], v[132:135], v[116:119]
    v_mfma_f32_16x16x32_bf16 v[120:123], a[140:143], v[136:139], v[120:123]
    v_mfma_f32_16x16x32_bf16 v[124:127], a[140:143], v[140:143], v[124:127]
    s_waitcnt lgkmcnt(4)
    s_waitcnt vmcnt(6)
    v_mfma_f32_16x16x32_bf16 v[64:67], a[144:147], v[144:147], v[64:67]
    ds_read_b64_tr_b16 a[128:129], v252 offset:0
    ds_read_b64_tr_b16 a[130:131], v252 offset:512
    v_mfma_f32_16x16x32_bf16 v[68:71], a[144:147], v[148:151], v[68:71]
    ds_read_b128 v[128:131], v238 offset:57344
    v_mfma_f32_16x16x32_bf16 v[72:75], a[144:147], v[152:155], v[72:75]
    ds_read_b128 v[132:135], v238 offset:58368
    v_cvt_pk_bf16_f32 v45, v46, v47
    v_mfma_f32_16x16x32_bf16 v[76:79], a[144:147], v[156:159], v[76:79]
    v_cvt_pk_bf16_f32 v46, v60, v61
    v_cvt_pk_bf16_f32 v47, v62, v63
    v_mfma_f32_16x16x32_bf16 v[80:83], a[148:151], v[144:147], v[80:83]
    ds_read_b64_tr_b16 a[132:133], v252 offset:32
    ds_read_b64_tr_b16 a[134:135], v252 offset:544
    v_mfma_f32_16x16x32_bf16 v[84:87], a[148:151], v[148:151], v[84:87]
    ds_read_b128 v[136:139], v238 offset:59392
    v_permlane16_swap_b32 v44, v46
    v_mfma_f32_16x16x32_bf16 v[88:91], a[148:151], v[152:155], v[88:91]
    ds_read_b128 v[140:143], v238 offset:60416
    v_permlane16_swap_b32 v45, v47
    v_mfma_f32_16x16x32_bf16 v[92:95], a[148:151], v[156:159], v[92:95]
    s_waitcnt lgkmcnt(8)
    buffer_store_dwordx4 v[44:47], v250, s[20:23], s66 offen offset:1024 sc1
    v_mfma_f32_16x16x32_bf16 v[96:99], a[152:155], v[144:147], v[96:99]
    s_add_u32 s66, s66, 14336
    ds_read_b64_tr_b16 a[136:137], v252 offset:64
    ds_read_b64_tr_b16 a[138:139], v252 offset:576
    v_mfma_f32_16x16x32_bf16 v[100:103], a[152:155], v[148:151], v[100:103]
    v_mfma_f32_16x16x32_bf16 v[104:107], a[152:155], v[152:155], v[104:107]
    v_mfma_f32_16x16x32_bf16 v[108:111], a[152:155], v[156:159], v[108:111]
    v_mfma_f32_16x16x32_bf16 v[112:115], a[156:159], v[144:147], v[112:115]
    ds_read_b64_tr_b16 a[140:141], v252 offset:96
    ds_read_b64_tr_b16 a[142:143], v252 offset:608
    v_mfma_f32_16x16x32_bf16 v[116:119], a[156:159], v[148:151], v[116:119]
    v_mfma_f32_16x16x32_bf16 v[120:123], a[156:159], v[152:155], v[120:123]
    v_mfma_f32_16x16x32_bf16 v[124:127], a[156:159], v[156:159], v[124:127]
    s_waitcnt lgkmcnt(4)
    s_load_dwordx2 s[52:53], s[0:1], 0
    s_load_dwordx2 s[54:55], s[0:1], 96
    s_mov_b64 s[44:45], s[56:57]
    s_mov_b64 s[46:47], s[58:59]
    s_mov_b64 s[48:49], s[60:61]
    s_mov_b64 s[50:51], s[62:63]
    s_and_b32 s57, s2, 7
    s_lshr_b32 s40, s2, 6
    s_lshl_b32 s40, s40, 3
    s_add_u32 s57, s57, s40
    s_bfe_u32 s58, s2, 0x30003
    s_lshl_b32 s59, s57, 3
    s_add_u32 s59, s59, s58
    s_lshl_b32 s59, s59, 2
    s_add_u32 s59, s59, s24
    s_mul_i32 s59, s59, 2*896
    v_and_b32 v248, 63, v255
    v_lshlrev_b32 v249, 5, v248
    v_lshlrev_b32 v248, 4, v248
    s_mov_b32 s40, 3584
    buffer_load_dwordx4 v[200:203], v248, s[20:23], s40 offen offset:0 sc1
    buffer_load_dwordx4 v[204:207], v248, s[20:23], s40 offen offset:896 sc1
    s_mov_b32 s40, 7168
    buffer_load_dwordx4 v[208:211], v248, s[20:23], s40 offen offset:0 sc1
    buffer_load_dwordx4 v[212:215], v248, s[20:23], s40 offen offset:896 sc1
    s_mov_b32 s40, 5376
    buffer_load_dwordx4 v[216:219], v248, s[20:23], s40 offen offset:0 sc1
    buffer_load_dwordx4 v[220:223], v248, s[20:23], s40 offen offset:896 sc1
    s_waitcnt lgkmcnt(0)
    s_mov_b32 s8, s52
    s_mov_b32 s9, s53
    s_mov_b32 s10, 1835008
    s_mov_b32 s11, 0x20000
    buffer_load_dwordx4 v[192:195], v248, s[8:11], s59 offen offset:0
    buffer_load_dwordx4 v[196:199], v248, s[8:11], s59 offen offset:896
    s_waitcnt vmcnt(10)
    v_mfma_f32_16x16x32_bf16 v[64:67], a[128:131], v[128:131], v[64:67]
    ds_read_b64_tr_b16 a[144:145], v252 offset:16896
    ds_read_b64_tr_b16 a[146:147], v252 offset:17408
    v_mfma_f32_16x16x32_bf16 v[68:71], a[128:131], v[132:135], v[68:71]
    ds_read_b128 v[144:147], v238 offset:61440
    v_mfma_f32_16x16x32_bf16 v[72:75], a[128:131], v[136:139], v[72:75]
    ds_read_b128 v[148:151], v238 offset:62464
    v_mfma_f32_16x16x32_bf16 v[76:79], a[128:131], v[140:143], v[76:79]
    v_mfma_f32_16x16x32_bf16 v[80:83], a[132:135], v[128:131], v[80:83]
    ds_read_b64_tr_b16 a[148:149], v252 offset:16928
    ds_read_b64_tr_b16 a[150:151], v252 offset:17440
    v_mfma_f32_16x16x32_bf16 v[84:87], a[132:135], v[132:135], v[84:87]
    ds_read_b128 v[152:155], v238 offset:63488
    v_mfma_f32_16x16x32_bf16 v[88:91], a[132:135], v[136:139], v[88:91]
    ds_read_b128 v[156:159], v238 offset:64512
    v_mfma_f32_16x16x32_bf16 v[92:95], a[132:135], v[140:143], v[92:95]
    s_waitcnt lgkmcnt(8)
    v_mfma_f32_16x16x32_bf16 v[96:99], a[136:139], v[128:131], v[96:99]
    ds_read_b64_tr_b16 a[152:153], v252 offset:16960
    ds_read_b64_tr_b16 a[154:155], v252 offset:17472
    v_mfma_f32_16x16x32_bf16 v[100:103], a[136:139], v[132:135], v[100:103]
    v_mfma_f32_16x16x32_bf16 v[104:107], a[136:139], v[136:139], v[104:107]
    v_mfma_f32_16x16x32_bf16 v[108:111], a[136:139], v[140:143], v[108:111]
    v_mfma_f32_16x16x32_bf16 v[112:115], a[140:143], v[128:131], v[112:115]
    ds_read_b64_tr_b16 a[156:157], v252 offset:16992
    ds_read_b64_tr_b16 a[158:159], v252 offset:17504
    v_mfma_f32_16x16x32_bf16 v[116:119], a[140:143], v[132:135], v[116:119]
    v_mfma_f32_16x16x32_bf16 v[120:123], a[140:143], v[136:139], v[120:123]
    v_mfma_f32_16x16x32_bf16 v[124:127], a[140:143], v[140:143], v[124:127]
    s_waitcnt lgkmcnt(4)
    v_mfma_f32_16x16x32_bf16 v[64:67], a[144:147], v[144:147], v[64:67]
    v_mfma_f32_16x16x32_bf16 v[68:71], a[144:147], v[148:151], v[68:71]
    v_mfma_f32_16x16x32_bf16 v[72:75], a[144:147], v[152:155], v[72:75]
    v_mfma_f32_16x16x32_bf16 v[76:79], a[144:147], v[156:159], v[76:79]
    v_mfma_f32_16x16x32_bf16 v[80:83], a[148:151], v[144:147], v[80:83]
    v_mfma_f32_16x16x32_bf16 v[84:87], a[148:151], v[148:151], v[84:87]
    v_mfma_f32_16x16x32_bf16 v[88:91], a[148:151], v[152:155], v[88:91]
    v_mfma_f32_16x16x32_bf16 v[92:95], a[148:151], v[156:159], v[92:95]
    s_waitcnt lgkmcnt(0)
    v_mfma_f32_16x16x32_bf16 v[96:99], a[152:155], v[144:147], v[96:99]
    v_mfma_f32_16x16x32_bf16 v[100:103], a[152:155], v[148:151], v[100:103]
    v_mfma_f32_16x16x32_bf16 v[104:107], a[152:155], v[152:155], v[104:107]
    v_mfma_f32_16x16x32_bf16 v[108:111], a[152:155], v[156:159], v[108:111]
    v_mfma_f32_16x16x32_bf16 v[112:115], a[156:159], v[144:147], v[112:115]
    v_mfma_f32_16x16x32_bf16 v[116:119], a[156:159], v[148:151], v[116:119]
    v_mfma_f32_16x16x32_bf16 v[120:123], a[156:159], v[152:155], v[120:123]
    v_mfma_f32_16x16x32_bf16 v[124:127], a[156:159], v[156:159], v[124:127]
    v_cvt_pk_bf16_f32 v64, v64, v65
    v_cvt_pk_bf16_f32 v65, v66, v67
    v_cvt_pk_bf16_f32 v66, v80, v81
    v_cvt_pk_bf16_f32 v67, v82, v83
    s_nop 0
    v_permlane16_swap_b32 v64, v66
    v_permlane16_swap_b32 v65, v67
    buffer_store_dwordx4 v[64:67], v250, s[20:23], s67 offen offset:0 sc1
    v_cvt_pk_bf16_f32 v96, v96, v97
    v_cvt_pk_bf16_f32 v97, v98, v99
    v_cvt_pk_bf16_f32 v98, v112, v113
    v_cvt_pk_bf16_f32 v99, v114, v115
    s_nop 0
    v_permlane16_swap_b32 v96, v98
    v_permlane16_swap_b32 v97, v99
    buffer_store_dwordx4 v[96:99], v250, s[20:23], s67 offen offset:1024 sc1
    s_add_u32 s67, s67, 14336
    v_cvt_pk_bf16_f32 v68, v68, v69
    v_cvt_pk_bf16_f32 v69, v70, v71
    v_cvt_pk_bf16_f32 v70, v84, v85
    v_cvt_pk_bf16_f32 v71, v86, v87
    s_nop 0
    v_permlane16_swap_b32 v68, v70
    v_permlane16_swap_b32 v69, v71
    buffer_store_dwordx4 v[68:71], v250, s[20:23], s67 offen offset:0 sc1
    v_cvt_pk_bf16_f32 v100, v100, v101
    v_cvt_pk_bf16_f32 v101, v102, v103
    v_cvt_pk_bf16_f32 v102, v116, v117
    v_cvt_pk_bf16_f32 v103, v118, v119
    s_nop 0
    v_permlane16_swap_b32 v100, v102
    v_permlane16_swap_b32 v101, v103
    buffer_store_dwordx4 v[100:103], v250, s[20:23], s67 offen offset:1024 sc1
    s_add_u32 s67, s67, 14336
    v_cvt_pk_bf16_f32 v72, v72, v73
    v_cvt_pk_bf16_f32 v73, v74, v75
    v_cvt_pk_bf16_f32 v74, v88, v89
    v_cvt_pk_bf16_f32 v75, v90, v91
    s_nop 0
    v_permlane16_swap_b32 v72, v74
    v_permlane16_swap_b32 v73, v75
    buffer_store_dwordx4 v[72:75], v250, s[20:23], s67 offen offset:0 sc1
    v_cvt_pk_bf16_f32 v104, v104, v105
    v_cvt_pk_bf16_f32 v105, v106, v107
    v_cvt_pk_bf16_f32 v106, v120, v121
    v_cvt_pk_bf16_f32 v107, v122, v123
    s_nop 0
    v_permlane16_swap_b32 v104, v106
    v_permlane16_swap_b32 v105, v107
    buffer_store_dwordx4 v[104:107], v250, s[20:23], s67 offen offset:1024 sc1
    s_add_u32 s67, s67, 14336
    v_cvt_pk_bf16_f32 v76, v76, v77
    v_cvt_pk_bf16_f32 v77, v78, v79
    v_cvt_pk_bf16_f32 v78, v92, v93
    v_cvt_pk_bf16_f32 v79, v94, v95
    s_nop 0
    v_permlane16_swap_b32 v76, v78
    v_permlane16_swap_b32 v77, v79
    buffer_store_dwordx4 v[76:79], v250, s[20:23], s67 offen offset:0 sc1
    v_cvt_pk_bf16_f32 v108, v108, v109
    v_cvt_pk_bf16_f32 v109, v110, v111
    v_cvt_pk_bf16_f32 v110, v124, v125
    v_cvt_pk_bf16_f32 v111, v126, v127
    s_nop 0
    v_permlane16_swap_b32 v108, v110
    v_permlane16_swap_b32 v109, v111
    buffer_store_dwordx4 v[108:111], v250, s[20:23], s67 offen offset:1024 sc1
    s_add_u32 s67, s67, 14336
    s_branch KB_o4
KB_o3:
    s_nop 7
    v_cvt_pk_bf16_f32 v0, v0, v1
    v_cvt_pk_bf16_f32 v1, v2, v3
    v_cvt_pk_bf16_f32 v2, v16, v17
    v_cvt_pk_bf16_f32 v3, v18, v19
    s_nop 0
    v_permlane16_swap_b32 v0, v2
    v_permlane16_swap_b32 v1, v3
    buffer_store_dwordx4 v[0:3], v250, s[20:23], s66 offen offset:0 sc1
    v_cvt_pk_bf16_f32 v32, v32, v33
    v_cvt_pk_bf16_f32 v33, v34, v35
    v_cvt_pk_bf16_f32 v34, v48, v49
    v_cvt_pk_bf16_f32 v35, v50, v51
    s_nop 0
    v_permlane16_swap_b32 v32, v34
    v_permlane16_swap_b32 v33, v35
    buffer_store_dwordx4 v[32:35], v250, s[20:23], s66 offen offset:1024 sc1
    s_add_u32 s66, s66, 14336
    v_cvt_pk_bf16_f32 v4, v4, v5
    v_cvt_pk_bf16_f32 v5, v6, v7
    v_cvt_pk_bf16_f32 v6, v20, v21
    v_cvt_pk_bf16_f32 v7, v22, v23
    s_nop 0
    v_permlane16_swap_b32 v4, v6
    v_permlane16_swap_b32 v5, v7
    buffer_store_dwordx4 v[4:7], v250, s[20:23], s66 offen offset:0 sc1
    v_cvt_pk_bf16_f32 v36, v36, v37
    v_cvt_pk_bf16_f32 v37, v38, v39
    v_cvt_pk_bf16_f32 v38, v52, v53
    v_cvt_pk_bf16_f32 v39, v54, v55
    s_nop 0
    v_permlane16_swap_b32 v36, v38
    v_permlane16_swap_b32 v37, v39
    buffer_store_dwordx4 v[36:39], v250, s[20:23], s66 offen offset:1024 sc1
    s_add_u32 s66, s66, 14336
    v_cvt_pk_bf16_f32 v8, v8, v9
    v_cvt_pk_bf16_f32 v9, v10, v11
    v_cvt_pk_bf16_f32 v10, v24, v25
    v_cvt_pk_bf16_f32 v11, v26, v27
    s_nop 0
    v_permlane16_swap_b32 v8, v10
    v_permlane16_swap_b32 v9, v11
    buffer_store_dwordx4 v[8:11], v250, s[20:23], s66 offen offset:0 sc1
    v_cvt_pk_bf16_f32 v40, v40, v41
    v_cvt_pk_bf16_f32 v41, v42, v43
    v_cvt_pk_bf16_f32 v42, v56, v57
    v_cvt_pk_bf16_f32 v43, v58, v59
    s_nop 0
    v_permlane16_swap_b32 v40, v42
    v_permlane16_swap_b32 v41, v43
    buffer_store_dwordx4 v[40:43], v250, s[20:23], s66 offen offset:1024 sc1
    s_add_u32 s66, s66, 14336
    v_cvt_pk_bf16_f32 v12, v12, v13
    v_cvt_pk_bf16_f32 v13, v14, v15
    v_cvt_pk_bf16_f32 v14, v28, v29
    v_cvt_pk_bf16_f32 v15, v30, v31
    s_nop 0
    v_permlane16_swap_b32 v12, v14
    v_permlane16_swap_b32 v13, v15
    buffer_store_dwordx4 v[12:15], v250, s[20:23], s66 offen offset:0 sc1
    v_cvt_pk_bf16_f32 v44, v44, v45
    v_cvt_pk_bf16_f32 v45, v46, v47
    v_cvt_pk_bf16_f32 v46, v60, v61
    v_cvt_pk_bf16_f32 v47, v62, v63
    s_nop 0
    v_permlane16_swap_b32 v44, v46
    v_permlane16_swap_b32 v45, v47
    buffer_store_dwordx4 v[44:47], v250, s[20:23], s66 offen offset:1024 sc1
    s_add_u32 s66, s66, 14336
    s_load_dwordx2 s[52:53], s[0:1], 0
    s_load_dwordx2 s[54:55], s[0:1], 96
    s_mov_b64 s[44:45], s[56:57]
    s_mov_b64 s[46:47], s[58:59]
    s_mov_b64 s[48:49], s[60:61]
    s_mov_b64 s[50:51], s[62:63]
    s_and_b32 s57, s2, 7
    s_lshr_b32 s40, s2, 6
    s_lshl_b32 s40, s40, 3
    s_add_u32 s57, s57, s40
    s_bfe_u32 s58, s2, 0x30003
    s_lshl_b32 s59, s57, 3
    s_add_u32 s59, s59, s58
    s_lshl_b32 s59, s59, 2
    s_add_u32 s59, s59, s24
    s_mul_i32 s59, s59, 2*896
    v_and_b32 v248, 63, v255
    v_lshlrev_b32 v249, 5, v248
    v_lshlrev_b32 v248, 4, v248
    s_mov_b32 s40, 3584
    buffer_load_dwordx4 v[200:203], v248, s[20:23], s40 offen offset:0 sc1
    buffer_load_dwordx4 v[204:207], v248, s[20:23], s40 offen offset:896 sc1
    s_mov_b32 s40, 7168
    buffer_load_dwordx4 v[208:211], v248, s[20:23], s40 offen offset:0 sc1
    buffer_load_dwordx4 v[212:215], v248, s[20:23], s40 offen offset:896 sc1
    s_mov_b32 s40, 5376
    buffer_load_dwordx4 v[216:219], v248, s[20:23], s40 offen offset:0 sc1
    buffer_load_dwordx4 v[220:223], v248, s[20:23], s40 offen offset:896 sc1
    s_waitcnt lgkmcnt(0)
    s_mov_b32 s8, s52
    s_mov_b32 s9, s53
    s_mov_b32 s10, 1835008
    s_mov_b32 s11, 0x20000
    buffer_load_dwordx4 v[192:195], v248, s[8:11], s59 offen offset:0
    buffer_load_dwordx4 v[196:199], v248, s[8:11], s59 offen offset:896
KB_o4:
    v_and_b32 v2, 63, v255
    v_and_b32 v3, 15, v2
    v_lshrrev_b32 v4, 4, v2
    s_mov_b32 s64, s26
    s_mov_b32 s39, s25
    s_mov_b32 s56, s26
    s_mov_b32 s25, s57
    s_mov_b32 s26, s58
    v_and_b32 v15, 7, v2
    v_lshrrev_b32 v16, 3, v2
    v_lshlrev_b32 v29, 8, v16
    v_lshl_add_u32 v29, v15, 4, v29
    v_add_u32 v28, 8192, v29
    s_lshl_b32 s31, s25, 2
    s_lshr_b32 s40, s26, 1
    s_add_u32 s28, s31, s40
    s_mul_i32 s28, s28, 14336
    s_and_b32 s40, s26, 1
    s_lshl_b32 s40, s40, 7
    s_add_u32 s28, s28, s40
    s_lshl_b32 s40, s24, 11
    s_add_u32 s28, s28, s40
    s_mov_b32 s66, 0
    s_min_u32 s27, s26, 6
    s_and_b32 s29, s24, 1
    s_lshr_b32 s30, s24, 1
    s_mov_b32 s34, -1
    s_mov_b32 s35, 0x00ffffff
    s_mov_b32 s36, 0xffff0000
    s_mov_b32 s37, 0x3b124925
    s_mov_b32 s38, 0xbb124925
    v_mov_b32 v9, 0x3727c5ac
    v_lshrrev_b32 v5, 3, v2
    v_and_b32 v6, 1, v5
    v_mul_u32_u24 v6, 7168, v6
    v_bfe_u32 v7, v5, 1, 1
    v_mul_u32_u24 v7, 3584, v7
    v_lshrrev_b32 v5, 2, v5
    v_mul_u32_u24 v5, 14336, v5
    v_add3_u32 v5, v5, v6, v7
    v_and_b32 v6, 7, v2
    v_lshl_add_u32 v5, v6, 4, v5
    v_add_u32 v10, 480, v5
    v_add_u32 v11, 320, v5
    v_add_u32 v12, 160, v5
    v_add_u32 v13, 0, v5
    s_mov_b32 s12, s54
    s_mov_b32 s13, s55
    s_mov_b32 s14, 1835008
    s_mov_b32 s15, 0x20000
    s_sub_u32 s16, s44, 480
    s_subb_u32 s17, s45, 0
    s_mov_b32 s18, 401888
    s_mov_b32 s19, 0x20000
    s_mul_i32 s60, s24, 4224
    s_mul_i32 s61, s24, 28672
    s_lshl_b32 s32, s27, 7
    s_add_u32 s61, s61, s32
    s_lshl_b32 s42, s25, 7
    s_add_u32 s42, s42, 32768
    v_and_b32 v6, 7, v2
    v_lshlrev_b32 v6, 2, v6
    v_add_u32 v6, s42, v6
    s_sub_u32 s40, s24, 1
    s_mul_i32 s60, s40, 4224
    s_mul_i32 s61, s40, 28672
    s_add_u32 s61, s61, s32
    v_mov_b32 v5, 95104
    s_lshl_b32 s40, s56, 7
    s_lshl_b32 s41, s39, 2
    s_add_u32 s40, s40, s41
    s_add_u32 s40, s40, 32768
    v_mov_b32 v7, s3
    s_waitcnt vmcnt(0)
    s_barrier
    s_cmp_lg_u32 s24, 0
    s_cbranch_scc1 HA_a
    s_mov_b64 exec, 1
    buffer_store_dword v7, off, s[20:23], s40 sc1
    s_mov_b64 exec, -1
    s_mov_b32 s43, 0
T1_poll:
    buffer_load_dword v8, v6, s[20:23], 0 offen sc1
    s_add_u32 s43, s43, 1
    s_waitcnt vmcnt(0)
    v_cmp_eq_u32 vcc, s3, v8
    s_nop 3
    s_and_b32 s41, vcc_lo, 0xff
    s_cmp_eq_u32 s41, 0xff
    s_cbranch_scc1 T1_go
    s_cmp_eq_u32 s43, 2
    s_cbranch_scc0 T1_poll
T1_go:
    v_mov_b32 v7, s41
    ds_write_b32 v5, v7
    s_waitcnt lgkmcnt(0)
    s_branch T1_b
HA_a:
    s_add_u32 m0, s60, 0
    s_add_u32 s39, s61, 0
    buffer_load_dwordx4 v10, s[16:19], s39 offen offset:0 lds
    buffer_load_dwordx4 v11, s[16:19], s39 offen offset:1056 lds
    buffer_load_dwordx4 v12, s[16:19], s39 offen offset:2112 lds
    buffer_load_dwordx4 v13, s[16:19], s39 offen offset:3168 lds
    s_add_u32 m0, s60, 12672
    s_add_u32 s39, s61, 86016
    buffer_load_dwordx4 v10, s[16:19], s39 offen offset:0 lds
    buffer_load_dwordx4 v11, s[16:19], s39 offen offset:1056 lds
    buffer_load_dwordx4 v12, s[16:19], s39 offen offset:2112 lds
    buffer_load_dwordx4 v13, s[16:19], s39 offen offset:3168 lds
    s_add_u32 m0, s60, 25344
    s_add_u32 s39, s61, 172032
    buffer_load_dwordx4 v10, s[16:19], s39 offen offset:0 lds
    buffer_load_dwordx4 v11, s[16:19], s39 offen offset:1056 lds
    buffer_load_dwordx4 v12, s[16:19], s39 offen offset:2112 lds
    buffer_load_dwordx4 v13, s[16:19], s39 offen offset:3168 lds
    s_add_u32 m0, s60, 38016
    s_add_u32 s39, s61, 258048
    buffer_load_dwordx4 v10, s[16:19], s39 offen offset:0 lds
    buffer_load_dwordx4 v11, s[16:19], s39 offen offset:1056 lds
    buffer_load_dwordx4 v12, s[16:19], s39 offen offset:2112 lds
    buffer_load_dwordx4 v13, s[16:19], s39 offen offset:3168 lds
    s_cmp_eq_u32 s24, 3
    s_cbranch_scc1 T1_d0
    s_add_u32 m0, s60, 50688
    s_add_u32 s39, s61, 344064
    buffer_load_dwordx4 v10, s[16:19], s39 offen offset:0 lds
    buffer_load_dwordx4 v11, s[16:19], s39 offen offset:1056 lds
    buffer_load_dwordx4 v12, s[16:19], s39 offen offset:2112 lds
    buffer_load_dwordx4 v13, s[16:19], s39 offen offset:3168 lds
T1_d0:
T1_b:
    s_barrier
    ds_read_b32 v7, v5
    s_waitcnt lgkmcnt(0)
    v_readfirstlane_b32 s64, v7
    s_mov_b32 s65, s66
    s_nop 2
    s_andn2_b32 s41, s64, s66
T1_ld:
    s_or_b32 s66, s66, s41
    s_bitcmp1_b32 s41, 0
    s_cbranch_scc0 T1_h0
    s_add_u32 s40, s28, 20971520
    buffer_load_dwordx4 v[32:35], v29, s[20:23], s40 offen sc1
    buffer_load_dwordx4 v[36:39], v28, s[20:23], s40 offen sc1
T1_h0:
    s_bitcmp1_b32 s41, 1
    s_cbranch_scc0 T1_h1
    s_add_u32 s40, s28, 22806528
    buffer_load_dwordx4 v[40:43], v29, s[20:23], s40 offen sc1
    buffer_load_dwordx4 v[44:47], v28, s[20:23], s40 offen sc1
T1_h1:
    s_bitcmp1_b32 s41, 2
    s_cbranch_scc0 T1_h2
    s_add_u32 s40, s28, 24641536
    buffer_load_dwordx4 v[48:51], v29, s[20:23], s40 offen sc1
    buffer_load_dwordx4 v[52:55], v28, s[20:23], s40 offen sc1
T1_h2:
    s_bitcmp1_b32 s41, 3
    s_cbranch_scc0 T1_h3
    s_add_u32 s40, s28, 26476544
    buffer_load_dwordx4 v[56:59], v29, s[20:23], s40 offen sc1
    buffer_load_dwordx4 v[60:63], v28, s[20:23], s40 offen sc1
T1_h3:
    s_bitcmp1_b32 s41, 4
    s_cbranch_scc0 T1_h4
    s_add_u32 s40, s28, 28311552
    buffer_load_dwordx4 v[64:67], v29, s[20:23], s40 offen sc1
    buffer_load_dwordx4 v[68:71], v28, s[20:23], s40 offen sc1
T1_h4:
    s_bitcmp1_b32 s41, 5
    s_cbranch_scc0 T1_h5
    s_add_u32 s40, s28, 30146560
    buffer_load_dwordx4 v[72:75], v29, s[20:23], s40 offen sc1
    buffer_load_dwordx4 v[76:79], v28, s[20:23], s40 offen sc1
T1_h5:
    s_bitcmp1_b32 s41, 6
    s_cbranch_scc0 T1_h6
    s_add_u32 s40, s28, 31981568
    buffer_load_dwordx4 v[80:83], v29, s[20:23], s40 offen sc1
    buffer_load_dwordx4 v[84:87], v28, s[20:23], s40 offen sc1
T1_h6:
    s_bitcmp1_b32 s41, 7
    s_cbranch_scc0 T1_h7
    s_add_u32 s40, s28, 33816576
    buffer_load_dwordx4 v[88:91], v29, s[20:23], s40 offen sc1
    buffer_load_dwordx4 v[92:95], v28, s[20:23], s40 offen sc1
T1_h7:
    s_cmp_eq_u32 s64, 0xff
    s_cbranch_scc1 T1_w
    s_mov_b32 s64, 0xff
    s_xor_b32 s41, s66, 0xff
    s_cmp_lg_u32 s24, 0
    s_cbranch_scc1 T1_b2
    s_mov_b32 s43, 0x8000
T1_p2:
    buffer_load_dword v8, v6, s[20:23], 0 offen sc1
    s_sub_u32 s43, s43, 1
    s_waitcnt vmcnt(0)
    v_cmp_ne_u32 vcc, s3, v8
    s_cmp_eq_u32 s43, 0
    s_cbranch_scc1 T1_b2
    s_cbranch_vccnz T1_p2
T1_b2:
    s_mov_b32 s65, 1
    s_barrier
    s_branch T1_ld
T1_w:
    s_sub_u32 s16, s46, 480
    s_subb_u32 s17, s47, 0
    s_mov_b32 s18, 401888
    s_mov_b32 s19, 0x20000
    s_lshl_b32 s40, s24, 1
    v_xor_b32 v5, s40, v15
    v_lshlrev_b32 v17, 7, v2
    v_add_u32 v17, 59136, v17
    v_lshl_add_u32 v30, v5, 4, v17
    v_xor_b32 v5, 1, v5
    v_lshl_add_u32 v31, v5, 4, v17
    v_xor_b32 v17, v15, v16
    v_lshlrev_b32 v17, 4, v17
    v_lshl_add_u32 v17, v16, 7, v17
    s_lshl_b32 s40, s24, 10
    s_add_u32 s40, s40, 59136
    v_add_u32 v20, s40, v17
    v_mul_u32_u24 v26, 1808, v15
    v_lshl_add_u32 v26, v16, 5, v26
    s_lshl_b32 s40, s24, 8
    s_add_u32 s40, s40, 80640
    v_add_u32 v26, s40, v26
    v_min_u32 v27, 55, v2
    v_lshlrev_b32 v27, 5, v27
    s_mul_i32 s40, s24, 3616
    s_add_u32 s40, s40, 80640
    v_add_u32 v27, s40, v27
    v_bfe_u32 v18, v2, 2, 2
    v_mul_u32_u24 v18, 1056, v18
    v_and_b32 v5, 1, v4
    v_lshl_add_u32 v18, v5, 7, v18
    v_lshrrev_b32 v5, 1, v4
    v_lshl_add_u32 v18, v5, 9, v18
    v_and_b32 v5, 3, v2
    v_lshl_add_u32 v18, v5, 3, v18
    v_add_u32 v19, 104704, v18
    v_lshlrev_b32 v14, 4, v2
    v_and_b32 v23, 1, v4
    v_lshlrev_b32 v23, 1, v23
    v_lshrrev_b32 v24, 1, v4
    v_add_u32 v24, v24, v23
    v_lshlrev_b32 v23, 4, v3
    v_lshl_add_u32 v23, v24, 8, v23
    v_mul_u32_u24 v21, 896, v3
    v_lshl_add_u32 v22, v24, 4, v21
    s_add_u32 s33, s31, s24
    s_mul_i32 s33, s33, 14336
    s_lshl_b32 s40, s27, 11
    s_add_u32 s62, s33, s40
    v_add_u32 v15, 15, v3
    v_lshrrev_b32 v5, 4, v15
    v_and_b32 v15, 15, v15
    v_mul_u32_u24 v5, 14336, v5
    v_lshl_add_u32 v15, v15, 4, v5
    v_lshl_add_u32 v15, v4, 8, v15
    v_add_u32 v16, 17, v3
    v_lshrrev_b32 v5, 4, v16
    v_and_b32 v16, 15, v16
    v_mul_u32_u24 v5, 14336, v5
    v_lshl_add_u32 v16, v16, 4, v5
    v_lshl_add_u32 v16, v4, 8, v16
    v_add_u32 v17, 14, v3
    v_lshrrev_b32 v5, 4, v17
    v_and_b32 v17, 15, v17
    v_mul_u32_u24 v5, 14336, v5
    v_lshl_add_u32 v17, v17, 4, v5
    v_lshl_add_u32 v17, v4, 8, v17
    v_add_u32 v21, 18, v3
    v_lshrrev_b32 v5, 4, v21
    v_and_b32 v21, 15, v21
    v_mul_u32_u24 v5, 14336, v5
    v_lshl_add_u32 v21, v21, 4, v5
    v_lshl_add_u32 v21, v4, 8, v21
    v_cmp_gt_u32 vcc, 2, v4
    s_nop 1
    v_cndmask_b32 v24, v16, v15, vcc
    v_cndmask_b32 v25, v21, v17, vcc
    s_mov_b32 s40, 0
    s_add_u32 s68, s40, 0
    s_cmp_ge_u32 s68, 14336
    s_cselect_b32 s41, 14336, 0
    s_sub_u32 s68, s68, s41
    s_add_u32 s69, s40, 1024
    s_cmp_ge_u32 s69, 14336
    s_cselect_b32 s41, 14336, 0
    s_sub_u32 s69, s69, s41
    s_add_u32 s70, s40, 2048
    s_cmp_ge_u32 s70, 14336
    s_cselect_b32 s41, 14336, 0
    s_sub_u32 s70, s70, s41
    s_add_u32 s71, s40, 3072
    s_cmp_ge_u32 s71, 14336
    s_cselect_b32 s41, 14336, 0
    s_sub_u32 s71, s71, s41
    s_add_u32 s72, s40, 4096
    s_cmp_ge_u32 s72, 14336
    s_cselect_b32 s41, 14336, 0
    s_sub_u32 s72, s72, s41
    s_add_u32 s73, s40, 5120
    s_cmp_ge_u32 s73, 14336
    s_cselect_b32 s41, 14336, 0
    s_sub_u32 s73, s73, s41
    s_add_u32 s74, s40, 6144
    s_cmp_ge_u32 s74, 14336
    s_cselect_b32 s41, 14336, 0
    s_sub_u32 s74, s74, s41
    s_add_u32 s75, s40, 7168
    s_cmp_ge_u32 s75, 14336
    s_cselect_b32 s41, 14336, 0
    s_sub_u32 s75, s75, s41
    s_add_u32 s76, s40, 8192
    s_cmp_ge_u32 s76, 14336
    s_cselect_b32 s41, 14336, 0
    s_sub_u32 s76, s76, s41
    s_add_u32 s77, s40, 9216
    s_cmp_ge_u32 s77, 14336
    s_cselect_b32 s41, 14336, 0
    s_sub_u32 s77, s77, s41
    s_add_u32 s78, s40, 10240
    s_cmp_ge_u32 s78, 14336
    s_cselect_b32 s41, 14336, 0
    s_sub_u32 s78, s78, s41
    s_add_u32 s79, s40, 11264
    s_cmp_ge_u32 s79, 14336
    s_cselect_b32 s41, 14336, 0
    s_sub_u32 s79, s79, s41
    s_add_u32 s80, s40, 12288
    s_cmp_ge_u32 s80, 14336
    s_cselect_b32 s41, 14336, 0
    s_sub_u32 s80, s80, s41
    s_add_u32 s81, s40, 13312
    s_cmp_ge_u32 s81, 14336
    s_cselect_b32 s41, 14336, 0
    s_sub_u32 s81, s81, s41
    v_lshlrev_b32 v144, 16, v192
    v_and_b32 v145, s36, v192
    v_lshlrev_b32 v146, 16, v193
    v_and_b32 v147, s36, v193
    v_lshlrev_b32 v148, 16, v194
    v_and_b32 v149, s36, v194
    v_lshlrev_b32 v150, 16, v195
    v_and_b32 v151, s36, v195
    v_lshlrev_b32 v152, 16, v196
    v_and_b32 v153, s36, v196
    v_lshlrev_b32 v154, 16, v197
    v_and_b32 v155, s36, v197
    v_lshlrev_b32 v156, 16, v198
    v_and_b32 v157, s36, v198
    v_lshlrev_b32 v158, 16, v199
    v_and_b32 v159, s36, v199
    v_and_b32 v201, s36, v200
    v_lshlrev_b32 v200, 16, v200
    v_and_b32 v203, s36, v202
    v_lshlrev_b32 v202, 16, v202
    v_and_b32 v205, s36, v204
    v_lshlrev_b32 v204, 16, v204
    v_and_b32 v207, s36, v206
    v_lshlrev_b32 v206, 16, v206
    v_and_b32 v209, s36, v208
    v_lshlrev_b32 v208, 16, v208
    v_and_b32 v211, s36, v210
    v_lshlrev_b32 v210, 16, v210
    v_and_b32 v213, s36, v212
    v_lshlrev_b32 v212, 16, v212
    v_and_b32 v215, s36, v214
    v_lshlrev_b32 v214, 16, v214
    v_and_b32 v217, s36, v216
    v_lshlrev_b32 v216, 16, v216
    v_and_b32 v219, s36, v218
    v_lshlrev_b32 v218, 16, v218
    v_and_b32 v221, s36, v220
    v_lshlrev_b32 v220, 16, v220
    v_and_b32 v223, s36, v222
    v_lshlrev_b32 v222, 16, v222
    s_mov_b32 s40, 0x00003f80
    s_mov_b32 s41, 0x3f800000
    v_mov_b64 v[96:97], 0
    v_mov_b64 v[98:99], 0
    v_mov_b64 v[100:101], 0
    v_mov_b64 v[102:103], 0
    v_mov_b64 v[104:105], 0
    v_mov_b64 v[106:107], 0
    v_mov_b64 v[108:109], 0
    v_mov_b64 v[110:111], 0
    s_cmp_eq_u32 s65, 0
    s_cbranch_scc1 T1_y
    s_waitcnt vmcnt(0)
T1_y:
    s_waitcnt vmcnt(14)
    v_dot2c_f32_bf16 v96, s40, v32
    v_dot2c_f32_bf16 v97, s41, v32
    v_dot2c_f32_bf16 v98, s40, v33
    v_dot2c_f32_bf16 v99, s41, v33
    v_dot2c_f32_bf16 v100, s40, v34
    v_dot2c_f32_bf16 v101, s41, v34
    v_dot2c_f32_bf16 v102, s40, v35
    v_dot2c_f32_bf16 v103, s41, v35
    v_dot2c_f32_bf16 v104, s40, v36
    v_dot2c_f32_bf16 v105, s41, v36
    v_dot2c_f32_bf16 v106, s40, v37
    v_dot2c_f32_bf16 v107, s41, v37
    v_dot2c_f32_bf16 v108, s40, v38
    v_dot2c_f32_bf16 v109, s41, v38
    v_dot2c_f32_bf16 v110, s40, v39
    v_dot2c_f32_bf16 v111, s41, v39
    s_waitcnt vmcnt(12)
    v_dot2c_f32_bf16 v96, s40, v40
    v_dot2c_f32_bf16 v97, s41, v40
    v_dot2c_f32_bf16 v98, s40, v41
    v_dot2c_f32_bf16 v99, s41, v41
    v_dot2c_f32_bf16 v100, s40, v42
    v_dot2c_f32_bf16 v101, s41, v42
    v_dot2c_f32_bf16 v102, s40, v43
    v_dot2c_f32_bf16 v103, s41, v43
    v_dot2c_f32_bf16 v104, s40, v44
    v_dot2c_f32_bf16 v105, s41, v44
    v_dot2c_f32_bf16 v106, s40, v45
    v_dot2c_f32_bf16 v107, s41, v45
    v_dot2c_f32_bf16 v108, s40, v46
    v_dot2c_f32_bf16 v109, s41, v46
    v_dot2c_f32_bf16 v110, s40, v47
    v_dot2c_f32_bf16 v111, s41, v47
    s_waitcnt vmcnt(10)
    v_dot2c_f32_bf16 v96, s40, v48
    v_dot2c_f32_bf16 v97, s41, v48
    v_dot2c_f32_bf16 v98, s40, v49
    v_dot2c_f32_bf16 v99, s41, v49
    v_dot2c_f32_bf16 v100, s40, v50
    v_dot2c_f32_bf16 v101, s41, v50
    v_dot2c_f32_bf16 v102, s40, v51
    v_dot2c_f32_bf16 v103, s41, v51
    v_dot2c_f32_bf16 v104, s40, v52
    v_dot2c_f32_bf16 v105, s41, v52
    v_dot2c_f32_bf16 v106, s40, v53
    v_dot2c_f32_bf16 v107, s41, v53
    v_dot2c_f32_bf16 v108, s40, v54
    v_dot2c_f32_bf16 v109, s41, v54
    v_dot2c_f32_bf16 v110, s40, v55
    v_dot2c_f32_bf16 v111, s41, v55
    s_waitcnt vmcnt(8)
    v_dot2c_f32_bf16 v96, s40, v56
    v_dot2c_f32_bf16 v97, s41, v56
    v_dot2c_f32_bf16 v98, s40, v57
    v_dot2c_f32_bf16 v99, s41, v57
    v_dot2c_f32_bf16 v100, s40, v58
    v_dot2c_f32_bf16 v101, s41, v58
    v_dot2c_f32_bf16 v102, s40, v59
    v_dot2c_f32_bf16 v103, s41, v59
    v_dot2c_f32_bf16 v104, s40, v60
    v_dot2c_f32_bf16 v105, s41, v60
    v_dot2c_f32_bf16 v106, s40, v61
    v_dot2c_f32_bf16 v107, s41, v61
    v_dot2c_f32_bf16 v108, s40, v62
    v_dot2c_f32_bf16 v109, s41, v62
    v_dot2c_f32_bf16 v110, s40, v63
    v_dot2c_f32_bf16 v111, s41, v63
    s_waitcnt vmcnt(6)
    v_dot2c_f32_bf16 v96, s40, v64
    v_dot2c_f32_bf16 v97, s41, v64
    v_dot2c_f32_bf16 v98, s40, v65
    v_dot2c_f32_bf16 v99, s41, v65
    v_dot2c_f32_bf16 v100, s40, v66
    v_dot2c_f32_bf16 v101, s41, v66
    v_dot2c_f32_bf16 v102, s40, v67
    v_dot2c_f32_bf16 v103, s41, v67
    v_dot2c_f32_bf16 v104, s40, v68
    v_dot2c_f32_bf16 v105, s41, v68
    v_dot2c_f32_bf16 v106, s40, v69
    v_dot2c_f32_bf16 v107, s41, v69
    v_dot2c_f32_bf16 v108, s40, v70
    v_dot2c_f32_bf16 v109, s41, v70
    v_dot2c_f32_bf16 v110, s40, v71
    v_dot2c_f32_bf16 v111, s41, v71
    s_waitcnt vmcnt(4)
    v_dot2c_f32_bf16 v96, s40, v72
    v_dot2c_f32_bf16 v97, s41, v72
    v_dot2c_f32_bf16 v98, s40, v73
    v_dot2c_f32_bf16 v99, s41, v73
    v_dot2c_f32_bf16 v100, s40, v74
    v_dot2c_f32_bf16 v101, s41, v74
    v_dot2c_f32_bf16 v102, s40, v75
    v_dot2c_f32_bf16 v103, s41, v75
    v_dot2c_f32_bf16 v104, s40, v76
    v_dot2c_f32_bf16 v105, s41, v76
    v_dot2c_f32_bf16 v106, s40, v77
    v_dot2c_f32_bf16 v107, s41, v77
    v_dot2c_f32_bf16 v108, s40, v78
    v_dot2c_f32_bf16 v109, s41, v78
    v_dot2c_f32_bf16 v110, s40, v79
    v_dot2c_f32_bf16 v111, s41, v79
    s_waitcnt vmcnt(2)
    v_dot2c_f32_bf16 v96, s40, v80
    v_dot2c_f32_bf16 v97, s41, v80
    v_dot2c_f32_bf16 v98, s40, v81
    v_dot2c_f32_bf16 v99, s41, v81
    v_dot2c_f32_bf16 v100, s40, v82
    v_dot2c_f32_bf16 v101, s41, v82
    v_dot2c_f32_bf16 v102, s40, v83
    v_dot2c_f32_bf16 v103, s41, v83
    v_dot2c_f32_bf16 v104, s40, v84
    v_dot2c_f32_bf16 v105, s41, v84
    v_dot2c_f32_bf16 v106, s40, v85
    v_dot2c_f32_bf16 v107, s41, v85
    v_dot2c_f32_bf16 v108, s40, v86
    v_dot2c_f32_bf16 v109, s41, v86
    v_dot2c_f32_bf16 v110, s40, v87
    v_dot2c_f32_bf16 v111, s41, v87
    s_waitcnt vmcnt(0)
    v_dot2c_f32_bf16 v96, s40, v88
    v_dot2c_f32_bf16 v97, s41, v88
    v_dot2c_f32_bf16 v98, s40, v89
    v_dot2c_f32_bf16 v99, s41, v89
    v_dot2c_f32_bf16 v100, s40, v90
    v_dot2c_f32_bf16 v101, s41, v90
    v_dot2c_f32_bf16 v102, s40, v91
    v_dot2c_f32_bf16 v103, s41, v91
    v_dot2c_f32_bf16 v104, s40, v92
    v_dot2c_f32_bf16 v105, s41, v92
    v_dot2c_f32_bf16 v106, s40, v93
    v_dot2c_f32_bf16 v107, s41, v93
    v_dot2c_f32_bf16 v108, s40, v94
    v_dot2c_f32_bf16 v109, s41, v94
    v_dot2c_f32_bf16 v110, s40, v95
    v_dot2c_f32_bf16 v111, s41, v95
    ds_write_b128 v26, v[96:99] offset:0
    ds_write_b128 v26, v[100:103] offset:16
    s_cmp_eq_u32 s24, 3
    s_cbranch_scc1 T1_q
    ds_write_b128 v26, v[104:107] offset:1024
    ds_write_b128 v26, v[108:111] offset:1040
T1_q:
    s_waitcnt lgkmcnt(0)
    s_barrier
    ds_read_b128 v[96:99], v27 offset:0
    ds_read_b128 v[100:103], v27 offset:16
    ds_read_b128 v[104:107], v27 offset:1808
    ds_read_b128 v[108:111], v27 offset:1824
    s_waitcnt lgkmcnt(0)
    v_pk_fma_f32 v[96:97], v[96:97], v[200:201], v[144:145]
    v_pk_fma_f32 v[98:99], v[98:99], v[202:203], v[146:147]
    v_pk_fma_f32 v[100:101], v[100:101], v[204:205], v[148:149]
    v_pk_fma_f32 v[102:103], v[102:103], v[206:207], v[150:151]
    v_pk_fma_f32 v[104:105], v[104:105], v[200:201], v[152:153]
    v_pk_fma_f32 v[106:107], v[106:107], v[202:203], v[154:155]
    v_pk_fma_f32 v[108:109], v[108:109], v[204:205], v[156:157]
    v_pk_fma_f32 v[110:111], v[110:111], v[206:207], v[158:159]
    v_cvt_pk_bf16_f32 v32, v96, v97
    v_cvt_pk_bf16_f32 v33, v98, v99
    v_cvt_pk_bf16_f32 v34, v100, v101
    v_cvt_pk_bf16_f32 v35, v102, v103
    v_cvt_pk_bf16_f32 v36, v104, v105
    v_cvt_pk_bf16_f32 v37, v106, v107
    v_cvt_pk_bf16_f32 v38, v108, v109
    v_cvt_pk_bf16_f32 v39, v110, v111
    s_mov_b64 exec, s[34:35]
    ds_write_b128 v30, v[32:35] offset:0
    ds_write_b128 v31, v[36:39] offset:0
    s_mov_b64 exec, -1
    v_pk_add_f32 v[112:113], v[96:97], v[98:99]
    v_pk_add_f32 v[114:115], v[100:101], v[102:103]
    v_pk_add_f32 v[116:117], v[104:105], v[106:107]
    v_pk_add_f32 v[118:119], v[108:109], v[110:111]
    v_pk_add_f32 v[112:113], v[112:113], v[114:115]
    v_pk_add_f32 v[116:117], v[116:117], v[118:119]
    v_add_f32 v112, v112, v113
    v_add_f32 v116, v116, v117
    v_cndmask_b32 v112, 0, v112, s[34:35]
    v_cndmask_b32 v116, 0, v116, s[34:35]
    s_nop 1
    v_permlane32_swap_b32 v112, v116
    v_add_f32 v112, v112, v116
    s_nop 1
    v_add_f32_dpp v112, v112, v112 row_ror:8 row_mask:0xf bank_mask:0xf
    s_nop 1
    v_add_f32_dpp v112, v112, v112 row_ror:4 row_mask:0xf bank_mask:0xf
    s_nop 1
    v_add_f32_dpp v112, v112, v112 row_ror:2 row_mask:0xf bank_mask:0xf
    s_nop 1
    v_add_f32_dpp v112, v112, v112 row_ror:1 row_mask:0xf bank_mask:0xf
    v_mov_b32 v116, v112
    s_nop 1
    v_permlane16_swap_b32 v112, v116
    v_add_f32 v112, v112, v116
    v_mul_f32 v112, s38, v112
    s_nop 0
    v_readlane_b32 s40, v112, 0
    v_readlane_b32 s41, v112, 32
    s_nop 1
    v_pk_add_f32 v[96:97], v[96:97], s[40:41] op_sel_hi:[1,0]
    v_pk_add_f32 v[98:99], v[98:99], s[40:41] op_sel_hi:[1,0]
    v_pk_add_f32 v[100:101], v[100:101], s[40:41] op_sel_hi:[1,0]
    v_pk_add_f32 v[102:103], v[102:103], s[40:41] op_sel_hi:[1,0]
    v_pk_add_f32 v[104:105], v[104:105], s[40:41] op_sel:[0,1] op_sel_hi:[1,1]
    v_pk_add_f32 v[106:107], v[106:107], s[40:41] op_sel:[0,1] op_sel_hi:[1,1]
    v_pk_add_f32 v[108:109], v[108:109], s[40:41] op_sel:[0,1] op_sel_hi:[1,1]
    v_pk_add_f32 v[110:111], v[110:111], s[40:41] op_sel:[0,1] op_sel_hi:[1,1]
    v_pk_mul_f32 v[112:113], v[96:97], v[96:97]
    v_pk_mul_f32 v[116:117], v[104:105], v[104:105]
    v_pk_fma_f32 v[112:113], v[98:99], v[98:99], v[112:113]
    v_pk_fma_f32 v[116:117], v[106:107], v[106:107], v[116:117]
    v_pk_fma_f32 v[112:113], v[100:101], v[100:101], v[112:113]
    v_pk_fma_f32 v[116:117], v[108:109], v[108:109], v[116:117]
    v_pk_fma_f32 v[112:113], v[102:103], v[102:103], v[112:113]
    v_pk_fma_f32 v[116:117], v[110:111], v[110:111], v[116:117]
    v_add_f32 v112, v112, v113
    v_add_f32 v116, v116, v117
    v_cndmask_b32 v112, 0, v112, s[34:35]
    v_cndmask_b32 v116, 0, v116, s[34:35]
    s_nop 1
    v_permlane32_swap_b32 v112, v116
    v_add_f32 v112, v112, v116
    s_nop 1
    v_add_f32_dpp v112, v112, v112 row_ror:8 row_mask:0xf bank_mask:0xf
    s_nop 1
    v_add_f32_dpp v112, v112, v112 row_ror:4 row_mask:0xf bank_mask:0xf
    s_nop 1
    v_add_f32_dpp v112, v112, v112 row_ror:2 row_mask:0xf bank_mask:0xf
    s_nop 1
    v_add_f32_dpp v112, v112, v112 row_ror:1 row_mask:0xf bank_mask:0xf
    v_mov_b32 v116, v112
    s_nop 1
    v_permlane16_swap_b32 v112, v116
    v_add_f32 v112, v112, v116
    v_fma_f32 v112, v112, s37, v9
    v_rsq_f32 v112, v112
    s_nop 0
    v_readlane_b32 s40, v112, 0
    v_readlane_b32 s41, v112, 32
    s_nop 1
    v_pk_mul_f32 v[96:97], v[96:97], s[40:41] op_sel_hi:[1,0]
    v_pk_mul_f32 v[98:99], v[98:99], s[40:41] op_sel_hi:[1,0]
    v_pk_mul_f32 v[100:101], v[100:101], s[40:41] op_sel_hi:[1,0]
    v_pk_mul_f32 v[102:103], v[102:103], s[40:41] op_sel_hi:[1,0]
    v_pk_mul_f32 v[104:105], v[104:105], s[40:41] op_sel:[0,1] op_sel_hi:[1,1]
    v_pk_mul_f32 v[106:107], v[106:107], s[40:41] op_sel:[0,1] op_sel_hi:[1,1]
    v_pk_mul_f32 v[108:109], v[108:109], s[40:41] op_sel:[0,1] op_sel_hi:[1,1]
    v_pk_mul_f32 v[110:111], v[110:111], s[40:41] op_sel:[0,1] op_sel_hi:[1,1]
    v_pk_fma_f32 v[96:97], v[96:97], v[208:209], v[216:217]
    v_pk_fma_f32 v[98:99], v[98:99], v[210:211], v[218:219]
    v_pk_fma_f32 v[100:101], v[100:101], v[212:213], v[220:221]
    v_pk_fma_f32 v[102:103], v[102:103], v[214:215], v[222:223]
    v_pk_fma_f32 v[104:105], v[104:105], v[208:209], v[216:217]
    v_pk_fma_f32 v[106:107], v[106:107], v[210:211], v[218:219]
    v_pk_fma_f32 v[108:109], v[108:109], v[212:213], v[220:221]
    v_pk_fma_f32 v[110:111], v[110:111], v[214:215], v[222:223]
    v_cvt_pk_bf16_f32 v40, v96, v97
    v_cvt_pk_bf16_f32 v41, v98, v99
    v_cvt_pk_bf16_f32 v42, v100, v101
    v_cvt_pk_bf16_f32 v43, v102, v103
    v_cvt_pk_bf16_f32 v44, v104, v105
    v_cvt_pk_bf16_f32 v45, v106, v107
    v_cvt_pk_bf16_f32 v46, v108, v109
    v_cvt_pk_bf16_f32 v47, v110, v111
    s_mov_b64 exec, s[34:35]
    ds_write_b128 v30, v[40:43] offset:7168
    ds_write_b128 v31, v[44:47] offset:7168
    s_mov_b64 exec, -1
    v_pk_add_f32 v[112:113], v[96:97], v[98:99]
    v_pk_add_f32 v[114:115], v[100:101], v[102:103]
    v_pk_add_f32 v[116:117], v[104:105], v[106:107]
    v_pk_add_f32 v[118:119], v[108:109], v[110:111]
    v_pk_add_f32 v[112:113], v[112:113], v[114:115]
    v_pk_add_f32 v[116:117], v[116:117], v[118:119]
    v_add_f32 v112, v112, v113
    v_add_f32 v116, v116, v117
    v_cndmask_b32 v112, 0, v112, s[34:35]
    v_cndmask_b32 v116, 0, v116, s[34:35]
    s_nop 1
    v_permlane32_swap_b32 v112, v116
    v_add_f32 v112, v112, v116
    s_nop 1
    v_add_f32_dpp v112, v112, v112 row_ror:8 row_mask:0xf bank_mask:0xf
    s_nop 1
    v_add_f32_dpp v112, v112, v112 row_ror:4 row_mask:0xf bank_mask:0xf
    s_nop 1
    v_add_f32_dpp v112, v112, v112 row_ror:2 row_mask:0xf bank_mask:0xf
    s_nop 1
    v_add_f32_dpp v112, v112, v112 row_ror:1 row_mask:0xf bank_mask:0xf
    v_mov_b32 v116, v112
    s_nop 1
    v_permlane16_swap_b32 v112, v116
    v_add_f32 v112, v112, v116
    v_mul_f32 v112, s38, v112
    s_nop 0
    v_readlane_b32 s40, v112, 0
    v_readlane_b32 s41, v112, 32
    s_nop 1
    v_pk_add_f32 v[96:97], v[96:97], s[40:41] op_sel_hi:[1,0]
    v_pk_add_f32 v[98:99], v[98:99], s[40:41] op_sel_hi:[1,0]
    v_pk_add_f32 v[100:101], v[100:101], s[40:41] op_sel_hi:[1,0]
    v_pk_add_f32 v[102:103], v[102:103], s[40:41] op_sel_hi:[1,0]
    v_pk_add_f32 v[104:105], v[104:105], s[40:41] op_sel:[0,1] op_sel_hi:[1,1]
    v_pk_add_f32 v[106:107], v[106:107], s[40:41] op_sel:[0,1] op_sel_hi:[1,1]
    v_pk_add_f32 v[108:109], v[108:109], s[40:41] op_sel:[0,1] op_sel_hi:[1,1]
    v_pk_add_f32 v[110:111], v[110:111], s[40:41] op_sel:[0,1] op_sel_hi:[1,1]
    v_pk_mul_f32 v[112:113], v[96:97], v[96:97]
    v_pk_mul_f32 v[116:117], v[104:105], v[104:105]
    v_pk_fma_f32 v[112:113], v[98:99], v[98:99], v[112:113]
    v_pk_fma_f32 v[116:117], v[106:107], v[106:107], v[116:117]
    v_pk_fma_f32 v[112:113], v[100:101], v[100:101], v[112:113]
    v_pk_fma_f32 v[116:117], v[108:109], v[108:109], v[116:117]
    v_pk_fma_f32 v[112:113], v[102:103], v[102:103], v[112:113]
    v_pk_fma_f32 v[116:117], v[110:111], v[110:111], v[116:117]
    v_add_f32 v112, v112, v113
    v_add_f32 v116, v116, v117
    v_cndmask_b32 v112, 0, v112, s[34:35]
    v_cndmask_b32 v116, 0, v116, s[34:35]
    s_nop 1
    v_permlane32_swap_b32 v112, v116
    v_add_f32 v112, v112, v116
    s_nop 1
    v_add_f32_dpp v112, v112, v112 row_ror:8 row_mask:0xf bank_mask:0xf
    s_nop 1
    v_add_f32_dpp v112, v112, v112 row_ror:4 row_mask:0xf bank_mask:0xf
    s_nop 1
    v_add_f32_dpp v112, v112, v112 row_ror:2 row_mask:0xf bank_mask:0xf
    s_nop 1
    v_add_f32_dpp v112, v112, v112 row_ror:1 row_mask:0xf bank_mask:0xf
    v_mov_b32 v116, v112
    s_nop 1
    v_permlane16_swap_b32 v112, v116
    v_add_f32 v112, v112, v116
    v_fma_f32 v112, v112, s37, v9
    v_rsq_f32 v112, v112
    s_nop 0
    v_readlane_b32 s40, v112, 0
    v_readlane_b32 s41, v112, 32
    s_nop 1
    v_pk_mul_f32 v[96:97], v[96:97], s[40:41] op_sel_hi:[1,0]
    v_pk_mul_f32 v[98:99], v[98:99], s[40:41] op_sel_hi:[1,0]
    v_pk_mul_f32 v[100:101], v[100:101], s[40:41] op_sel_hi:[1,0]
    v_pk_mul_f32 v[102:103], v[102:103], s[40:41] op_sel_hi:[1,0]
    v_pk_mul_f32 v[104:105], v[104:105], s[40:41] op_sel:[0,1] op_sel_hi:[1,1]
    v_pk_mul_f32 v[106:107], v[106:107], s[40:41] op_sel:[0,1] op_sel_hi:[1,1]
    v_pk_mul_f32 v[108:109], v[108:109], s[40:41] op_sel:[0,1] op_sel_hi:[1,1]
    v_pk_mul_f32 v[110:111], v[110:111], s[40:41] op_sel:[0,1] op_sel_hi:[1,1]
    v_cvt_pk_bf16_f32 v48, v96, v97
    v_cvt_pk_bf16_f32 v49, v98, v99
    v_cvt_pk_bf16_f32 v50, v100, v101
    v_cvt_pk_bf16_f32 v51, v102, v103
    v_cvt_pk_bf16_f32 v52, v104, v105
    v_cvt_pk_bf16_f32 v53, v106, v107
    v_cvt_pk_bf16_f32 v54, v108, v109
    v_cvt_pk_bf16_f32 v55, v110, v111
    s_mov_b64 exec, s[34:35]
    ds_write_b128 v30, v[48:51] offset:14336
    ds_write_b128 v31, v[52:55] offset:14336
    s_mov_b64 exec, -1
    s_waitcnt vmcnt(0) lgkmcnt(0)
    s_barrier
    ds_read_b128 v[56:59], v20 offset:14336
    ds_read_b128 v[60:63], v20 offset:7168
    ds_read_b128 v[64:67], v20 offset:0
    s_cmp_eq_u32 s24, 3
    s_cbranch_scc1 T1_s1
    ds_read_b128 v[68:71], v20 offset:18432
    ds_read_b128 v[72:75], v20 offset:11264
    ds_read_b128 v[76:79], v20 offset:4096
    s_waitcnt lgkmcnt(0)
    s_add_u32 s40, s28, 6299648
    buffer_store_dwordx4 v[68:71], v29, s[20:23], s40 offen sc1
    s_add_u32 s40, s28, 4202496
    buffer_store_dwordx4 v[72:75], v29, s[20:23], s40 offen sc1
    s_add_u32 s40, s28, 2105344
    buffer_store_dwordx4 v[76:79], v29, s[20:23], s40 offen sc1
T1_s1:
    s_waitcnt lgkmcnt(0)
    s_add_u32 s40, s28, 6291456
    buffer_store_dwordx4 v[56:59], v29, s[20:23], s40 offen sc1
    s_add_u32 s40, s28, 4194304
    buffer_store_dwordx4 v[60:63], v29, s[20:23], s40 offen sc1
    s_add_u32 s40, s28, 2097152
    buffer_store_dwordx4 v[64:67], v29, s[20:23], s40 offen sc1
    s_lshl_b32 s40, s25, 7
    s_lshl_b32 s41, s26, 2
    s_add_u32 s40, s40, s41
    s_add_u32 s40, s40, 36864
    v_mov_b32 v7, s3
    s_waitcnt vmcnt(0)
    s_barrier
    s_cmp_lg_u32 s24, 0
    s_cbranch_scc1 H1_a
    s_mov_b64 exec, 1
    buffer_store_dword v7, off, s[20:23], s40 sc1
    s_mov_b64 exec, -1
H1_a:
    ds_read_b64_tr_b16 a[0:1], v18 offset:0
    ds_read_b64_tr_b16 a[2:3], v18 offset:256
    ds_read_b64_tr_b16 a[4:5], v18 offset:32
    ds_read_b64_tr_b16 a[6:7], v18 offset:288
    ds_read_b64_tr_b16 a[8:9], v18 offset:64
    ds_read_b64_tr_b16 a[10:11], v18 offset:320
    ds_read_b64_tr_b16 a[12:13], v18 offset:96
    ds_read_b64_tr_b16 a[14:15], v18 offset:352
    ds_read_b64_tr_b16 a[16:17], v18 offset:4224
    ds_read_b64_tr_b16 a[18:19], v18 offset:4480
    ds_read_b64_tr_b16 a[20:21], v18 offset:4256
    ds_read_b64_tr_b16 a[22:23], v18 offset:4512
    ds_read_b64_tr_b16 a[24:25], v18 offset:4288
    ds_read_b64_tr_b16 a[26:27], v18 offset:4544
    ds_read_b64_tr_b16 a[28:29], v18 offset:4320
    ds_read_b64_tr_b16 a[30:31], v18 offset:4576
    ds_read_b64_tr_b16 a[32:33], v18 offset:8448
    ds_read_b64_tr_b16 a[34:35], v18 offset:8704
    ds_read_b64_tr_b16 a[36:37], v18 offset:8480
    ds_read_b64_tr_b16 a[38:39], v18 offset:8736
    ds_read_b64_tr_b16 a[40:41], v18 offset:8512
    ds_read_b64_tr_b16 a[42:43], v18 offset:8768
    ds_read_b64_tr_b16 a[44:45], v18 offset:8544
    ds_read_b64_tr_b16 a[46:47], v18 offset:8800
    ds_read_b64_tr_b16 a[48:49], v18 offset:12672
    ds_read_b64_tr_b16 a[50:51], v18 offset:12928
    ds_read_b64_tr_b16 a[52:53], v18 offset:12704
    ds_read_b64_tr_b16 a[54:55], v18 offset:12960
    ds_read_b64_tr_b16 a[56:57], v18 offset:12736
    ds_read_b64_tr_b16 a[58:59], v18 offset:12992
    ds_read_b64_tr_b16 a[60:61], v18 offset:12768
    ds_read_b64_tr_b16 a[62:63], v18 offset:13024
    ds_read_b64_tr_b16 a[64:65], v18 offset:16896
    ds_read_b64_tr_b16 a[66:67], v18 offset:17152
    ds_read_b64_tr_b16 a[68:69], v18 offset:16928
    ds_read_b64_tr_b16 a[70:71], v18 offset:17184
    ds_read_b64_tr_b16 a[72:73], v18 offset:16960
    ds_read_b64_tr_b16 a[74:75], v18 offset:17216
    ds_read_b64_tr_b16 a[76:77], v18 offset:16992
    ds_read_b64_tr_b16 a[78:79], v18 offset:17248
    ds_read_b64_tr_b16 a[80:81], v18 offset:21120
    ds_read_b64_tr_b16 a[82:83], v18 offset:21376
    ds_read_b64_tr_b16 a[84:85], v18 offset:21152
    ds_read_b64_tr_b16 a[86:87], v18 offset:21408
    ds_read_b64_tr_b16 a[88:89], v18 offset:21184
    ds_read_b64_tr_b16 a[90:91], v18 offset:21440
    ds_read_b64_tr_b16 a[92:93], v18 offset:21216
    ds_read_b64_tr_b16 a[94:95], v18 offset:21472
    ds_read_b64_tr_b16 a[96:97], v18 offset:25344
    ds_read_b64_tr_b16 a[98:99], v18 offset:25600
    ds_read_b64_tr_b16 a[100:101], v18 offset:25376
    ds_read_b64_tr_b16 a[102:103], v18 offset:25632
    ds_read_b64_tr_b16 a[104:105], v18 offset:25408
    ds_read_b64_tr_b16 a[106:107], v18 offset:25664
    ds_read_b64_tr_b16 a[108:109], v18 offset:25440
    ds_read_b64_tr_b16 a[110:111], v18 offset:25696
    ds_read_b64_tr_b16 a[112:113], v18 offset:29568
    ds_read_b64_tr_b16 a[114:115], v18 offset:29824
    ds_read_b64_tr_b16 a[116:117], v18 offset:29600
    ds_read_b64_tr_b16 a[118:119], v18 offset:29856
    ds_read_b64_tr_b16 a[120:121], v18 offset:29632
    ds_read_b64_tr_b16 a[122:123], v18 offset:29888
    ds_read_b64_tr_b16 a[124:125], v18 offset:29664
    ds_read_b64_tr_b16 a[126:127], v18 offset:29920
    ds_read_b64_tr_b16 a[128:129], v18 offset:33792
    ds_read_b64_tr_b16 a[130:131], v18 offset:34048
    ds_read_b64_tr_b16 a[132:133], v18 offset:33824
    ds_read_b64_tr_b16 a[134:135], v18 offset:34080
    ds_read_b64_tr_b16 a[136:137], v18 offset:33856
    ds_read_b64_tr_b16 a[138:139], v18 offset:34112
    ds_read_b64_tr_b16 a[140:141], v18 offset:33888
    ds_read_b64_tr_b16 a[142:143], v18 offset:34144
    ds_read_b64_tr_b16 a[144:145], v18 offset:38016
    ds_read_b64_tr_b16 a[146:147], v18 offset:38272
    ds_read_b64_tr_b16 a[148:149], v18 offset:38048
    ds_read_b64_tr_b16 a[150:151], v18 offset:38304
    ds_read_b64_tr_b16 a[152:153], v18 offset:38080
    ds_read_b64_tr_b16 a[154:155], v18 offset:38336
    ds_read_b64_tr_b16 a[156:157], v18 offset:38112
    ds_read_b64_tr_b16 a[158:159], v18 offset:38368
    ds_read_b64_tr_b16 a[160:161], v18 offset:42240
    ds_read_b64_tr_b16 a[162:163], v18 offset:42496
    ds_read_b64_tr_b16 a[164:165], v18 offset:42272
    ds_read_b64_tr_b16 a[166:167], v18 offset:42528
    ds_read_b64_tr_b16 a[168:169], v18 offset:42304
    ds_read_b64_tr_b16 a[170:171], v18 offset:42560
    ds_read_b64_tr_b16 a[172:173], v18 offset:42336
    ds_read_b64_tr_b16 a[174:175], v18 offset:42592
    ds_read_b64_tr_b16 a[176:177], v18 offset:46464
    ds_read_b64_tr_b16 a[178:179], v18 offset:46720
    ds_read_b64_tr_b16 a[180:181], v18 offset:46496
    ds_read_b64_tr_b16 a[182:183], v18 offset:46752
    ds_read_b64_tr_b16 a[184:185], v18 offset:46528
    ds_read_b64_tr_b16 a[186:187], v18 offset:46784
    ds_read_b64_tr_b16 a[188:189], v18 offset:46560
    ds_read_b64_tr_b16 a[190:191], v18 offset:46816
    ds_read_b64_tr_b16 a[192:193], v18 offset:50688
    ds_read_b64_tr_b16 a[194:195], v18 offset:50944
    ds_read_b64_tr_b16 a[196:197], v18 offset:50720
    ds_read_b64_tr_b16 a[198:199], v18 offset:50976
    ds_read_b64_tr_b16 a[200:201], v18 offset:50752
    ds_read_b64_tr_b16 a[202:203], v18 offset:51008
    ds_read_b64_tr_b16 a[204:205], v18 offset:50784
    ds_read_b64_tr_b16 a[206:207], v18 offset:51040
    ds_read_b64_tr_b16 a[208:209], v18 offset:54912
    ds_read_b64_tr_b16 a[210:211], v18 offset:55168
    ds_read_b64_tr_b16 a[212:213], v18 offset:54944
    ds_read_b64_tr_b16 a[214:215], v18 offset:55200
    ds_read_b64_tr_b16 a[216:217], v18 offset:54976
    ds_read_b64_tr_b16 a[218:219], v18 offset:55232
    ds_read_b64_tr_b16 a[220:221], v18 offset:55008
    ds_read_b64_tr_b16 a[222:223], v18 offset:55264
    s_cmp_eq_u32 s24, 0
    s_cbranch_scc1 T1_d1
    s_add_u32 m0, s60, 104704
    s_add_u32 s39, s61, 0
    buffer_load_dwordx4 v10, s[16:19], s39 offen offset:0 lds
    buffer_load_dwordx4 v11, s[16:19], s39 offen offset:1056 lds
    buffer_load_dwordx4 v12, s[16:19], s39 offen offset:2112 lds
    buffer_load_dwordx4 v13, s[16:19], s39 offen offset:3168 lds
    s_add_u32 m0, s60, 117376
    s_add_u32 s39, s61, 86016
    buffer_load_dwordx4 v10, s[16:19], s39 offen offset:0 lds
    buffer_load_dwordx4 v11, s[16:19], s39 offen offset:1056 lds
    buffer_load_dwordx4 v12, s[16:19], s39 offen offset:2112 lds
    buffer_load_dwordx4 v13, s[16:19], s39 offen offset:3168 lds
    s_add_u32 m0, s60, 130048
    s_add_u32 s39, s61, 172032
    buffer_load_dwordx4 v10, s[16:19], s39 offen offset:0 lds
    buffer_load_dwordx4 v11, s[16:19], s39 offen offset:1056 lds
    buffer_load_dwordx4 v12, s[16:19], s39 offen offset:2112 lds
    buffer_load_dwordx4 v13, s[16:19], s39 offen offset:3168 lds
    s_add_u32 m0, s60, 142720
    s_add_u32 s39, s61, 258048
    buffer_load_dwordx4 v10, s[16:19], s39 offen offset:0 lds
    buffer_load_dwordx4 v11, s[16:19], s39 offen offset:1056 lds
    buffer_load_dwordx4 v12, s[16:19], s39 offen offset:2112 lds
    buffer_load_dwordx4 v13, s[16:19], s39 offen offset:3168 lds
    s_cmp_eq_u32 s24, 3
    s_cbranch_scc1 T1_d1
    s_add_u32 m0, s60, 155392
    s_add_u32 s39, s61, 344064
    buffer_load_dwordx4 v10, s[16:19], s39 offen offset:0 lds
    buffer_load_dwordx4 v11, s[16:19], s39 offen offset:1056 lds
    buffer_load_dwordx4 v12, s[16:19], s39 offen offset:2112 lds
    buffer_load_dwordx4 v13, s[16:19], s39 offen offset:3168 lds
T1_d1:
    s_cmp_lg_u32 s24, 0
    s_cbranch_scc1 H1_out
    s_lshl_b32 s41, s25, 7
    s_add_u32 s41, s41, 36864
    v_and_b32 v6, 7, v2
    v_lshlrev_b32 v6, 2, v6
    s_mov_b64 exec, 0xff
    s_mov_b32 s43, 0x8000
H1_poll:
    buffer_load_dword v8, v6, s[20:23], s41 offen sc1
    s_sub_u32 s43, s43, 1
    s_waitcnt vmcnt(0)
    v_cmp_ne_u32 vcc, s3, v8
    s_cmp_eq_u32 s43, 0
    s_cbranch_scc1 H1_x
    s_cbranch_vccnz H1_poll
H1_x:
    s_mov_b64 exec, -1
H1_out:
    s_waitcnt lgkmcnt(0)
    s_barrier
    s_add_u32 s42, s33, 6291456
    buffer_load_dwordx4 v[32:35], v14, s[20:23], s42 offen offset:0 sc1
    buffer_load_dwordx4 v[36:39], v14, s[20:23], s42 offen offset:1024 sc1
    buffer_load_dwordx4 v[40:43], v14, s[20:23], s42 offen offset:2048 sc1
    buffer_load_dwordx4 v[44:47], v14, s[20:23], s42 offen offset:3072 sc1
    s_add_u32 s42, s42, 4096
    buffer_load_dwordx4 v[48:51], v14, s[20:23], s42 offen offset:0 sc1
    buffer_load_dwordx4 v[52:55], v14, s[20:23], s42 offen offset:1024 sc1
    buffer_load_dwordx4 v[56:59], v14, s[20:23], s42 offen offset:2048 sc1
    buffer_load_dwordx4 v[60:63], v14, s[20:23], s42 offen offset:3072 sc1
    s_add_u32 s42, s42, 4096
    buffer_load_dwordx4 v[64:67], v14, s[20:23], s42 offen offset:0 sc1
    buffer_load_dwordx4 v[68:71], v14, s[20:23], s42 offen offset:1024 sc1
    buffer_load_dwordx4 v[72:75], v14, s[20:23], s42 offen offset:2048 sc1
    buffer_load_dwordx4 v[76:79], v14, s[20:23], s42 offen offset:3072 sc1
    s_add_u32 s42, s42, 4096
    buffer_load_dwordx4 v[80:83], v14, s[20:23], s42 offen offset:0 sc1
    buffer_load_dwordx4 v[84:87], v14, s[20:23], s42 offen offset:1024 sc1
    s_add_u32 s38, s62, 4194304
    buffer_load_dwordx4 v[88:91], v23, s[20:23], s38 offen offset:0 sc1
    buffer_load_dwordx4 v[92:95], v23, s[20:23], s38 offen offset:1024 sc1
    s_mov_b32 s56, 0xbdd2d3e8
    v_mov_b32 v26, 0xc0135761
    v_mov_b32 v27, 0xc0135761
    v_lshrrev_b32 v5, 3, v2
    v_and_b32 v6, 1, v5
    v_mul_u32_u24 v6, 28672, v6
    v_bfe_u32 v7, v5, 1, 1
    v_mul_u32_u24 v7, 14336, v7
    v_lshrrev_b32 v5, 2, v5
    v_mul_u32_u24 v5, 57344, v5
    v_add3_u32 v5, v5, v6, v7
    v_and_b32 v6, 7, v2
    v_lshl_add_u32 v5, v6, 4, v5
    v_add_u32 v10, 0, v5
    v_add_u32 v11, 2528, v5
    v_add_u32 v12, 5056, v5
    v_add_u32 v13, 7584, v5
    s_sub_u32 s16, s48, 0
    s_subb_u32 s17, s49, 0
    s_mov_b32 s18, 1605632
    s_mov_b32 s19, 0x20000
    s_mul_i32 s63, s26, 448
    s_mul_i32 s40, s30, 224
    s_mul_i32 s41, s29, 96
    s_add_u32 s40, s40, s41
    s_add_u32 s61, s63, s40
    s_mul_i32 s60, s24, 26176
    s_mul_i32 s57, s24, 14784
    s_add_u32 s57, s57, 104704
    s_waitcnt vmcnt(15)
    v_mfma_f32_16x16x32_bf16 v[96:99], a[0:3], v[32:35], 0
    s_add_u32 m0, s60, 0
    s_add_u32 s39, s61, 0
    v_mfma_f32_16x16x32_bf16 v[100:103], a[4:7], v[32:35], 0
    buffer_load_dwordx4 v10, s[16:19], s39 offen offset:0 lds
    v_mfma_f32_16x16x32_bf16 v[104:107], a[8:11], v[32:35], 0
    v_mfma_f32_16x16x32_bf16 v[108:111], a[12:15], v[32:35], 0
    s_waitcnt vmcnt(15)
    v_mfma_f32_16x16x32_bf16 v[96:99], a[16:19], v[36:39], v[96:99]
    v_mfma_f32_16x16x32_bf16 v[100:103], a[20:23], v[36:39], v[100:103]
    buffer_load_dwordx4 v11, s[16:19], s39 offen offset:1056 lds
    v_mfma_f32_16x16x32_bf16 v[104:107], a[24:27], v[36:39], v[104:107]
    v_mfma_f32_16x16x32_bf16 v[108:111], a[28:31], v[36:39], v[108:111]
    s_waitcnt vmcnt(15)
    v_mfma_f32_16x16x32_bf16 v[96:99], a[32:35], v[40:43], v[96:99]
    v_mfma_f32_16x16x32_bf16 v[100:103], a[36:39], v[40:43], v[100:103]
    buffer_load_dwordx4 v12, s[16:19], s39 offen offset:2112 lds
    v_mfma_f32_16x16x32_bf16 v[104:107], a[40:43], v[40:43], v[104:107]
    v_mfma_f32_16x16x32_bf16 v[108:111], a[44:47], v[40:43], v[108:111]
    s_waitcnt vmcnt(15)
    v_mfma_f32_16x16x32_bf16 v[96:99], a[48:51], v[44:47], v[96:99]
    v_mfma_f32_16x16x32_bf16 v[100:103], a[52:55], v[44:47], v[100:103]
    buffer_load_dwordx4 v13, s[16:19], s39 offen offset:3168 lds
    v_mfma_f32_16x16x32_bf16 v[104:107], a[56:59], v[44:47], v[104:107]
    s_add_u32 m0, s60, 4224
    s_add_u32 s39, s61, 114688
    v_mfma_f32_16x16x32_bf16 v[108:111], a[60:63], v[44:47], v[108:111]
    s_waitcnt vmcnt(15)
    v_mfma_f32_16x16x32_bf16 v[96:99], a[64:67], v[48:51], v[96:99]
    v_mfma_f32_16x16x32_bf16 v[100:103], a[68:71], v[48:51], v[100:103]
    buffer_load_dwordx4 v10, s[16:19], s39 offen offset:0 lds
    v_mfma_f32_16x16x32_bf16 v[104:107], a[72:75], v[48:51], v[104:107]
    v_mfma_f32_16x16x32_bf16 v[108:111], a[76:79], v[48:51], v[108:111]
    s_waitcnt vmcnt(15)
    v_mfma_f32_16x16x32_bf16 v[96:99], a[80:83], v[52:55], v[96:99]
    v_mfma_f32_16x16x32_bf16 v[100:103], a[84:87], v[52:55], v[100:103]
    buffer_load_dwordx4 v11, s[16:19], s39 offen offset:1056 lds
    v_mfma_f32_16x16x32_bf16 v[104:107], a[88:91], v[52:55], v[104:107]
    v_mfma_f32_16x16x32_bf16 v[108:111], a[92:95], v[52:55], v[108:111]
    s_waitcnt vmcnt(15)
    v_mfma_f32_16x16x32_bf16 v[96:99], a[96:99], v[56:59], v[96:99]
    v_mfma_f32_16x16x32_bf16 v[100:103], a[100:103], v[56:59], v[100:103]
    buffer_load_dwordx4 v12, s[16:19], s39 offen offset:2112 lds
    v_mfma_f32_16x16x32_bf16 v[104:107], a[104:107], v[56:59], v[104:107]
    v_mfma_f32_16x16x32_bf16 v[108:111], a[108:111], v[56:59], v[108:111]
    s_waitcnt vmcnt(15)
    v_mfma_f32_16x16x32_bf16 v[96:99], a[112:115], v[60:63], v[96:99]
    v_mfma_f32_16x16x32_bf16 v[100:103], a[116:119], v[60:63], v[100:103]
    buffer_load_dwordx4 v13, s[16:19], s39 offen offset:3168 lds
    v_mfma_f32_16x16x32_bf16 v[104:107], a[120:123], v[60:63], v[104:107]
    s_add_u32 m0, s60, 8448
    s_add_u32 s39, s61, 229376
    v_mfma_f32_16x16x32_bf16 v[108:111], a[124:127], v[60:63], v[108:111]
    s_waitcnt vmcnt(15)
    v_mfma_f32_16x16x32_bf16 v[96:99], a[128:131], v[64:67], v[96:99]
    v_mfma_f32_16x16x32_bf16 v[100:103], a[132:135], v[64:67], v[100:103]
    buffer_load_dwordx4 v10, s[16:19], s39 offen offset:0 lds
    v_mfma_f32_16x16x32_bf16 v[104:107], a[136:139], v[64:67], v[104:107]
    v_mfma_f32_16x16x32_bf16 v[108:111], a[140:143], v[64:67], v[108:111]
    s_waitcnt vmcnt(15)
    v_mfma_f32_16x16x32_bf16 v[96:99], a[144:147], v[68:71], v[96:99]
    v_mfma_f32_16x16x32_bf16 v[100:103], a[148:151], v[68:71], v[100:103]
    buffer_load_dwordx4 v11, s[16:19], s39 offen offset:1056 lds
    v_mfma_f32_16x16x32_bf16 v[104:107], a[152:155], v[68:71], v[104:107]
    v_mfma_f32_16x16x32_bf16 v[108:111], a[156:159], v[68:71], v[108:111]
    s_waitcnt vmcnt(15)
    v_mfma_f32_16x16x32_bf16 v[96:99], a[160:163], v[72:75], v[96:99]
    v_mfma_f32_16x16x32_bf16 v[100:103], a[164:167], v[72:75], v[100:103]
    buffer_load_dwordx4 v12, s[16:19], s39 offen offset:2112 lds
    v_mfma_f32_16x16x32_bf16 v[104:107], a[168:171], v[72:75], v[104:107]
    v_mfma_f32_16x16x32_bf16 v[108:111], a[172:175], v[72:75], v[108:111]
    s_waitcnt vmcnt(15)
    v_mfma_f32_16x16x32_bf16 v[96:99], a[176:179], v[76:79], v[96:99]
    v_mfma_f32_16x16x32_bf16 v[100:103], a[180:183], v[76:79], v[100:103]
    buffer_load_dwordx4 v13, s[16:19], s39 offen offset:3168 lds
    v_mfma_f32_16x16x32_bf16 v[104:107], a[184:187], v[76:79], v[104:107]
    v_mfma_f32_16x16x32_bf16 v[108:111], a[188:191], v[76:79], v[108:111]
    s_waitcnt vmcnt(15)
    v_mfma_f32_16x16x32_bf16 v[96:99], a[192:195], v[80:83], v[96:99]
    v_mfma_f32_16x16x32_bf16 v[100:103], a[196:199], v[80:83], v[100:103]
    v_mfma_f32_16x16x32_bf16 v[104:107], a[200:203], v[80:83], v[104:107]
    v_mfma_f32_16x16x32_bf16 v[108:111], a[204:207], v[80:83], v[108:111]
    s_waitcnt vmcnt(14)
    v_mfma_f32_16x16x32_bf16 v[96:99], a[208:211], v[84:87], v[96:99]
    v_mfma_f32_16x16x32_bf16 v[100:103], a[212:215], v[84:87], v[100:103]
    v_mfma_f32_16x16x32_bf16 v[104:107], a[216:219], v[84:87], v[104:107]
    v_mfma_f32_16x16x32_bf16 v[108:111], a[220:223], v[84:87], v[108:111]
    s_mov_b32 s38, 0xbb124925
    s_barrier
    s_nop 2
    v_pk_mul_f32 v[112:113], v[96:97], v[96:97]
    v_pk_mul_f32 v[114:115], v[98:99], v[98:99]
    v_pk_mul_f32 v[116:117], v[100:101], v[100:101]
    v_pk_mul_f32 v[118:119], v[102:103], v[102:103]
    v_pk_mul_f32 v[120:121], v[104:105], v[104:105]
    v_pk_mul_f32 v[122:123], v[106:107], v[106:107]
    v_pk_mul_f32 v[124:125], v[108:109], v[108:109]
    v_pk_mul_f32 v[126:127], v[110:111], v[110:111]
    v_pk_fma_f32 v[112:113], v[112:113], s[56:57], v[26:27] op_sel_hi:[1,0,1]
    v_pk_fma_f32 v[114:115], v[114:115], s[56:57], v[26:27] op_sel_hi:[1,0,1]
    v_pk_fma_f32 v[116:117], v[116:117], s[56:57], v[26:27] op_sel_hi:[1,0,1]
    v_pk_fma_f32 v[118:119], v[118:119], s[56:57], v[26:27] op_sel_hi:[1,0,1]
    v_pk_fma_f32 v[120:121], v[120:121], s[56:57], v[26:27] op_sel_hi:[1,0,1]
    v_pk_fma_f32 v[122:123], v[122:123], s[56:57], v[26:27] op_sel_hi:[1,0,1]
    v_pk_fma_f32 v[124:125], v[124:125], s[56:57], v[26:27] op_sel_hi:[1,0,1]
    v_pk_fma_f32 v[126:127], v[126:127], s[56:57], v[26:27] op_sel_hi:[1,0,1]
    v_pk_mul_f32 v[112:113], v[112:113], v[96:97]
    v_pk_mul_f32 v[114:115], v[114:115], v[98:99]
    v_pk_mul_f32 v[116:117], v[116:117], v[100:101]
    v_pk_mul_f32 v[118:119], v[118:119], v[102:103]
    v_pk_mul_f32 v[120:121], v[120:121], v[104:105]
    v_pk_mul_f32 v[122:123], v[122:123], v[106:107]
    v_pk_mul_f32 v[124:125], v[124:125], v[108:109]
    v_pk_mul_f32 v[126:127], v[126:127], v[110:111]
    v_exp_f32 v112, v112
    v_exp_f32 v113, v113
    v_exp_f32 v114, v114
    v_exp_f32 v115, v115
    v_exp_f32 v116, v116
    v_exp_f32 v117, v117
    v_exp_f32 v118, v118
    v_exp_f32 v119, v119
    v_exp_f32 v120, v120
    v_exp_f32 v121, v121
    v_exp_f32 v122, v122
    v_exp_f32 v123, v123
    v_exp_f32 v124, v124
    v_exp_f32 v125, v125
    v_exp_f32 v126, v126
    v_exp_f32 v127, v127
    v_pk_add_f32 v[112:113], v[112:113], 1.0 op_sel_hi:[1,0]
    v_pk_add_f32 v[114:115], v[114:115], 1.0 op_sel_hi:[1,0]
    v_pk_add_f32 v[116:117], v[116:117], 1.0 op_sel_hi:[1,0]
    v_pk_add_f32 v[118:119], v[118:119], 1.0 op_sel_hi:[1,0]
    v_pk_add_f32 v[120:121], v[120:121], 1.0 op_sel_hi:[1,0]
    v_pk_add_f32 v[122:123], v[122:123], 1.0 op_sel_hi:[1,0]
    v_pk_add_f32 v[124:125], v[124:125], 1.0 op_sel_hi:[1,0]
    v_pk_add_f32 v[126:127], v[126:127], 1.0 op_sel_hi:[1,0]
    v_rcp_f32 v112, v112
    v_rcp_f32 v113, v113
    v_rcp_f32 v114, v114
    v_rcp_f32 v115, v115
    v_rcp_f32 v116, v116
    v_rcp_f32 v117, v117
    v_rcp_f32 v118, v118
    v_rcp_f32 v119, v119
    v_rcp_f32 v120, v120
    v_rcp_f32 v121, v121
    v_rcp_f32 v122, v122
    v_rcp_f32 v123, v123
    v_rcp_f32 v124, v124
    v_rcp_f32 v125, v125
    v_rcp_f32 v126, v126
    v_rcp_f32 v127, v127
    v_pk_mul_f32 v[96:97], v[96:97], v[112:113]
    v_pk_mul_f32 v[98:99], v[98:99], v[114:115]
    v_pk_mul_f32 v[100:101], v[100:101], v[116:117]
    v_pk_mul_f32 v[102:103], v[102:103], v[118:119]
    v_pk_mul_f32 v[104:105], v[104:105], v[120:121]
    v_pk_mul_f32 v[106:107], v[106:107], v[122:123]
    v_pk_mul_f32 v[108:109], v[108:109], v[124:125]
    v_pk_mul_f32 v[110:111], v[110:111], v[126:127]
    v_cvt_pk_bf16_f32 v128, v96, v97
    v_cvt_pk_bf16_f32 v129, v98, v99
    v_cvt_pk_bf16_f32 v130, v100, v101
    v_cvt_pk_bf16_f32 v131, v102, v103
    v_cvt_pk_bf16_f32 v132, v104, v105
    v_cvt_pk_bf16_f32 v133, v106, v107
    v_cvt_pk_bf16_f32 v134, v108, v109
    v_cvt_pk_bf16_f32 v135, v110, v111
    v_permlane16_swap_b32 v128, v130
    v_permlane16_swap_b32 v129, v131
    v_permlane16_swap_b32 v132, v134
    v_permlane16_swap_b32 v133, v135
    s_add_u32 s40, s62, 8402944
    buffer_store_dwordx4 v[128:131], v23, s[20:23], s40 offen offset:0 sc1
    buffer_store_dwordx4 v[132:135], v23, s[20:23], s40 offen offset:1024 sc1
    s_waitcnt vmcnt(2)
    ds_read_b64_tr_b16 a[0:1], v19 offset:0
    ds_read_b64_tr_b16 a[2:3], v19 offset:256
    ds_read_b64_tr_b16 a[4:5], v19 offset:32
    ds_read_b64_tr_b16 a[6:7], v19 offset:288
    ds_read_b64_tr_b16 a[8:9], v19 offset:64
    s_add_u32 m0, s60, 12672
    ds_read_b64_tr_b16 a[10:11], v19 offset:320
    ds_read_b64_tr_b16 a[12:13], v19 offset:96
    ds_read_b64_tr_b16 a[14:15], v19 offset:352
    ds_read_b64_tr_b16 a[16:17], v19 offset:4224
    ds_read_b64_tr_b16 a[18:19], v19 offset:4480
    s_add_u32 s39, s61, 344064
    ds_read_b64_tr_b16 a[20:21], v19 offset:4256
    ds_read_b64_tr_b16 a[22:23], v19 offset:4512
    ds_read_b64_tr_b16 a[24:25], v19 offset:4288
    ds_read_b64_tr_b16 a[26:27], v19 offset:4544
    ds_read_b64_tr_b16 a[28:29], v19 offset:4320
    buffer_load_dwordx4 v10, s[16:19], s39 offen offset:0 lds
    ds_read_b64_tr_b16 a[30:31], v19 offset:4576
    ds_read_b64_tr_b16 a[32:33], v19 offset:8448
    ds_read_b64_tr_b16 a[34:35], v19 offset:8704
    ds_read_b64_tr_b16 a[36:37], v19 offset:8480
    ds_read_b64_tr_b16 a[38:39], v19 offset:8736
    buffer_load_dwordx4 v11, s[16:19], s39 offen offset:1056 lds
    ds_read_b64_tr_b16 a[40:41], v19 offset:8512
    ds_read_b64_tr_b16 a[42:43], v19 offset:8768
    ds_read_b64_tr_b16 a[44:45], v19 offset:8544
    ds_read_b64_tr_b16 a[46:47], v19 offset:8800
    ds_read_b64_tr_b16 a[48:49], v19 offset:12672
    buffer_load_dwordx4 v12, s[16:19], s39 offen offset:2112 lds
    ds_read_b64_tr_b16 a[50:51], v19 offset:12928
    ds_read_b64_tr_b16 a[52:53], v19 offset:12704
    ds_read_b64_tr_b16 a[54:55], v19 offset:12960
    ds_read_b64_tr_b16 a[56:57], v19 offset:12736
    ds_read_b64_tr_b16 a[58:59], v19 offset:12992
    buffer_load_dwordx4 v13, s[16:19], s39 offen offset:3168 lds
    ds_read_b64_tr_b16 a[60:61], v19 offset:12768
    ds_read_b64_tr_b16 a[62:63], v19 offset:13024
    ds_read_b64_tr_b16 a[64:65], v19 offset:16896
    ds_read_b64_tr_b16 a[66:67], v19 offset:17152
    ds_read_b64_tr_b16 a[68:69], v19 offset:16928
    s_add_u32 m0, s60, 16896
    ds_read_b64_tr_b16 a[70:71], v19 offset:17184
    ds_read_b64_tr_b16 a[72:73], v19 offset:16960
    ds_read_b64_tr_b16 a[74:75], v19 offset:17216
    ds_read_b64_tr_b16 a[76:77], v19 offset:16992
    ds_read_b64_tr_b16 a[78:79], v19 offset:17248
    s_add_u32 s39, s61, 458752
    ds_read_b64_tr_b16 a[80:81], v19 offset:21120
    ds_read_b64_tr_b16 a[82:83], v19 offset:21376
    ds_read_b64_tr_b16 a[84:85], v19 offset:21152
    ds_read_b64_tr_b16 a[86:87], v19 offset:21408
    ds_read_b64_tr_b16 a[88:89], v19 offset:21184
    buffer_load_dwordx4 v10, s[16:19], s39 offen offset:0 lds
    ds_read_b64_tr_b16 a[90:91], v19 offset:21440
    ds_read_b64_tr_b16 a[92:93], v19 offset:21216
    ds_read_b64_tr_b16 a[94:95], v19 offset:21472
    ds_read_b64_tr_b16 a[96:97], v19 offset:25344
    ds_read_b64_tr_b16 a[98:99], v19 offset:25600
    buffer_load_dwordx4 v11, s[16:19], s39 offen offset:1056 lds
    ds_read_b64_tr_b16 a[100:101], v19 offset:25376
    ds_read_b64_tr_b16 a[102:103], v19 offset:25632
    ds_read_b64_tr_b16 a[104:105], v19 offset:25408
    ds_read_b64_tr_b16 a[106:107], v19 offset:25664
    ds_read_b64_tr_b16 a[108:109], v19 offset:25440
    buffer_load_dwordx4 v12, s[16:19], s39 offen offset:2112 lds
    ds_read_b64_tr_b16 a[110:111], v19 offset:25696
    ds_read_b64_tr_b16 a[112:113], v19 offset:29568
    ds_read_b64_tr_b16 a[114:115], v19 offset:29824
    ds_read_b64_tr_b16 a[116:117], v19 offset:29600
    ds_read_b64_tr_b16 a[118:119], v19 offset:29856
    buffer_load_dwordx4 v13, s[16:19], s39 offen offset:3168 lds
    ds_read_b64_tr_b16 a[120:121], v19 offset:29632
    ds_read_b64_tr_b16 a[122:123], v19 offset:29888
    ds_read_b64_tr_b16 a[124:125], v19 offset:29664
    ds_read_b64_tr_b16 a[126:127], v19 offset:29920
    ds_read_b64_tr_b16 a[128:129], v19 offset:33792
    s_add_u32 m0, s60, 21120
    ds_read_b64_tr_b16 a[130:131], v19 offset:34048
    ds_read_b64_tr_b16 a[132:133], v19 offset:33824
    ds_read_b64_tr_b16 a[134:135], v19 offset:34080
    ds_read_b64_tr_b16 a[136:137], v19 offset:33856
    ds_read_b64_tr_b16 a[138:139], v19 offset:34112
    s_add_u32 s39, s61, 573440
    ds_read_b64_tr_b16 a[140:141], v19 offset:33888
    ds_read_b64_tr_b16 a[142:143], v19 offset:34144
    ds_read_b64_tr_b16 a[144:145], v19 offset:38016
    ds_read_b64_tr_b16 a[146:147], v19 offset:38272
    ds_read_b64_tr_b16 a[148:149], v19 offset:38048
    buffer_load_dwordx4 v10, s[16:19], s39 offen offset:0 lds
    ds_read_b64_tr_b16 a[150:151], v19 offset:38304
    ds_read_b64_tr_b16 a[152:153], v19 offset:38080
    ds_read_b64_tr_b16 a[154:155], v19 offset:38336
    ds_read_b64_tr_b16 a[156:157], v19 offset:38112
    ds_read_b64_tr_b16 a[158:159], v19 offset:38368
    buffer_load_dwordx4 v11, s[16:19], s39 offen offset:1056 lds
    ds_read_b64_tr_b16 a[160:161], v19 offset:42240
    ds_read_b64_tr_b16 a[162:163], v19 offset:42496
    ds_read_b64_tr_b16 a[164:165], v19 offset:42272
    ds_read_b64_tr_b16 a[166:167], v19 offset:42528
    ds_read_b64_tr_b16 a[168:169], v19 offset:42304
    buffer_load_dwordx4 v12, s[16:19], s39 offen offset:2112 lds
    ds_read_b64_tr_b16 a[170:171], v19 offset:42560
    ds_read_b64_tr_b16 a[172:173], v19 offset:42336
    ds_read_b64_tr_b16 a[174:175], v19 offset:42592
    ds_read_b64_tr_b16 a[176:177], v19 offset:46464
    ds_read_b64_tr_b16 a[178:179], v19 offset:46720
    buffer_load_dwordx4 v13, s[16:19], s39 offen offset:3168 lds
    ds_read_b64_tr_b16 a[180:181], v19 offset:46496
    ds_read_b64_tr_b16 a[182:183], v19 offset:46752
    ds_read_b64_tr_b16 a[184:185], v19 offset:46528
    ds_read_b64_tr_b16 a[186:187], v19 offset:46784
    ds_read_b64_tr_b16 a[188:189], v19 offset:46560
    ds_read_b64_tr_b16 a[190:191], v19 offset:46816
    ds_read_b64_tr_b16 a[192:193], v19 offset:50688
    ds_read_b64_tr_b16 a[194:195], v19 offset:50944
    ds_read_b64_tr_b16 a[196:197], v19 offset:50720
    ds_read_b64_tr_b16 a[198:199], v19 offset:50976
    ds_read_b64_tr_b16 a[200:201], v19 offset:50752
    ds_read_b64_tr_b16 a[202:203], v19 offset:51008
    ds_read_b64_tr_b16 a[204:205], v19 offset:50784
    ds_read_b64_tr_b16 a[206:207], v19 offset:51040
    ds_read_b64_tr_b16 a[208:209], v19 offset:54912
    ds_read_b64_tr_b16 a[210:211], v19 offset:55168
    ds_read_b64_tr_b16 a[212:213], v19 offset:54944
    ds_read_b64_tr_b16 a[214:215], v19 offset:55200
    ds_read_b64_tr_b16 a[216:217], v19 offset:54976
    ds_read_b64_tr_b16 a[218:219], v19 offset:55232
    ds_read_b64_tr_b16 a[220:221], v19 offset:55008
    ds_read_b64_tr_b16 a[222:223], v19 offset:55264
    s_mov_b32 s43, 0x8000
    s_waitcnt lgkmcnt(0)
    s_barrier
    s_lshl_b32 s40, s29, 5
    s_xor_b32 s41, s29, 1
    s_mul_i32 s41, s41, 96
    v_add_u32 v5, s40, v18
    v_add_u32 v6, s41, v18
    v_add_u32 v28, s60, v6
    v_add_u32 v29, s60, v5
    v_add_u32 v30, s57, v6
    v_add_u32 v31, s57, v5
    v_permlane16_swap_b32 v88, v90
    v_permlane16_swap_b32 v89, v91
    v_permlane16_swap_b32 v92, v94
    v_permlane16_swap_b32 v93, v95
    v_lshlrev_b32 v136, 16, v88
    v_and_b32 v137, s36, v88
    v_lshlrev_b32 v138, 16, v89
    v_and_b32 v139, s36, v89
    v_lshlrev_b32 v140, 16, v90
    v_and_b32 v141, s36, v90
    v_lshlrev_b32 v142, 16, v91
    v_and_b32 v143, s36, v91
    v_lshlrev_b32 v144, 16, v92
    v_and_b32 v145, s36, v92
    v_lshlrev_b32 v146, 16, v93
    v_and_b32 v147, s36, v93
    v_lshlrev_b32 v148, 16, v94
    v_and_b32 v149, s36, v94
    v_lshlrev_b32 v150, 16, v95
    v_and_b32 v151, s36, v95
    s_add_u32 s42, s33, 8388608
    buffer_load_dwordx4 v[32:35], v15, s[20:23], s42 offen offset:0 sc1
    buffer_load_dwordx4 v[36:39], v15, s[20:23], s42 offen offset:1024 sc1
    buffer_load_dwordx4 v[40:43], v15, s[20:23], s42 offen offset:2048 sc1
    buffer_load_dwordx4 v[44:47], v24, s[20:23], s42 offen offset:3072 sc1
    s_add_u32 s42, s42, 4096
    buffer_load_dwordx4 v[48:51], v16, s[20:23], s42 offen offset:0 sc1
    buffer_load_dwordx4 v[52:55], v16, s[20:23], s42 offen offset:1024 sc1
    buffer_load_dwordx4 v[56:59], v16, s[20:23], s42 offen offset:2048 sc1
    buffer_load_dwordx4 v[60:63], v17, s[20:23], s42 offen offset:3072 sc1
    s_add_u32 s42, s42, 4096
    buffer_load_dwordx4 v[64:67], v17, s[20:23], s42 offen offset:0 sc1
    buffer_load_dwordx4 v[68:71], v17, s[20:23], s42 offen offset:1024 sc1
    buffer_load_dwordx4 v[72:75], v25, s[20:23], s42 offen offset:2048 sc1
    buffer_load_dwordx4 v[76:79], v21, s[20:23], s42 offen offset:3072 sc1
    s_add_u32 s42, s42, 4096
    buffer_load_dwordx4 v[80:83], v21, s[20:23], s42 offen offset:0 sc1
    buffer_load_dwordx4 v[84:87], v21, s[20:23], s42 offen offset:1024 sc1
    s_waitcnt vmcnt(13)
    v_mfma_f32_16x16x32_bf16 v[96:99], a[0:3], v[32:35], 0
    s_add_u32 m0, s57, 0
    s_add_u32 s39, s61, 688128
    v_max3_u32 v8, v32, v33, v33
    v_mfma_f32_16x16x32_bf16 v[100:103], a[4:7], v[32:35], 0
    buffer_load_dwordx4 v10, s[16:19], s39 offen offset:0 lds
    v_mfma_f32_16x16x32_bf16 v[104:107], a[8:11], v[32:35], 0
    v_max3_u32 v8, v34, v35, v8
    v_mfma_f32_16x16x32_bf16 v[108:111], a[12:15], v[32:35], 0
    s_waitcnt vmcnt(13)
    v_mfma_f32_16x16x32_bf16 v[96:99], a[16:19], v[36:39], v[96:99]
    v_max3_u32 v8, v36, v37, v8
    v_mfma_f32_16x16x32_bf16 v[100:103], a[20:23], v[36:39], v[100:103]
    buffer_load_dwordx4 v11, s[16:19], s39 offen offset:1056 lds
    v_mfma_f32_16x16x32_bf16 v[104:107], a[24:27], v[36:39], v[104:107]
    v_max3_u32 v8, v38, v39, v8
    v_mfma_f32_16x16x32_bf16 v[108:111], a[28:31], v[36:39], v[108:111]
    s_waitcnt vmcnt(13)
    v_mfma_f32_16x16x32_bf16 v[96:99], a[32:35], v[40:43], v[96:99]
    v_max3_u32 v8, v40, v41, v8
    v_mfma_f32_16x16x32_bf16 v[100:103], a[36:39], v[40:43], v[100:103]
    buffer_load_dwordx4 v12, s[16:19], s39 offen offset:2112 lds
    v_mfma_f32_16x16x32_bf16 v[104:107], a[40:43], v[40:43], v[104:107]
    v_max3_u32 v8, v42, v43, v8
    v_mfma_f32_16x16x32_bf16 v[108:111], a[44:47], v[40:43], v[108:111]
    s_waitcnt vmcnt(13)
    v_mfma_f32_16x16x32_bf16 v[96:99], a[48:51], v[44:47], v[96:99]
    v_max3_u32 v8, v44, v45, v8
    v_mfma_f32_16x16x32_bf16 v[100:103], a[52:55], v[44:47], v[100:103]
    buffer_load_dwordx4 v13, s[16:19], s39 offen offset:3168 lds
    v_mfma_f32_16x16x32_bf16 v[104:107], a[56:59], v[44:47], v[104:107]
    s_add_u32 m0, s57, 4224
    s_add_u32 s39, s61, 802816
    v_max3_u32 v8, v46, v47, v8
    v_mfma_f32_16x16x32_bf16 v[108:111], a[60:63], v[44:47], v[108:111]
    s_waitcnt vmcnt(13)
    v_mfma_f32_16x16x32_bf16 v[96:99], a[64:67], v[48:51], v[96:99]
    v_max3_u32 v8, v48, v49, v8
    v_mfma_f32_16x16x32_bf16 v[100:103], a[68:71], v[48:51], v[100:103]
    buffer_load_dwordx4 v10, s[16:19], s39 offen offset:0 lds
    v_mfma_f32_16x16x32_bf16 v[104:107], a[72:75], v[48:51], v[104:107]
    v_max3_u32 v8, v50, v51, v8
    v_mfma_f32_16x16x32_bf16 v[108:111], a[76:79], v[48:51], v[108:111]
    s_waitcnt vmcnt(13)
    v_mfma_f32_16x16x32_bf16 v[96:99], a[80:83], v[52:55], v[96:99]
    v_max3_u32 v8, v52, v53, v8
    v_mfma_f32_16x16x32_bf16 v[100:103], a[84:87], v[52:55], v[100:103]
    buffer_load_dwordx4 v11, s[16:19], s39 offen offset:1056 lds
    v_mfma_f32_16x16x32_bf16 v[104:107], a[88:91], v[52:55], v[104:107]
    v_max3_u32 v8, v54, v55, v8
    v_mfma_f32_16x16x32_bf16 v[108:111], a[92:95], v[52:55], v[108:111]
    s_waitcnt vmcnt(13)
    v_mfma_f32_16x16x32_bf16 v[96:99], a[96:99], v[56:59], v[96:99]
    v_max3_u32 v8, v56, v57, v8
    v_mfma_f32_16x16x32_bf16 v[100:103], a[100:103], v[56:59], v[100:103]
    buffer_load_dwordx4 v12, s[16:19], s39 offen offset:2112 lds
    v_mfma_f32_16x16x32_bf16 v[104:107], a[104:107], v[56:59], v[104:107]
    v_max3_u32 v8, v58, v59, v8
    v_mfma_f32_16x16x32_bf16 v[108:111], a[108:111], v[56:59], v[108:111]
    s_waitcnt vmcnt(13)
    v_mfma_f32_16x16x32_bf16 v[96:99], a[112:115], v[60:63], v[96:99]
    v_max3_u32 v8, v60, v61, v8
    v_mfma_f32_16x16x32_bf16 v[100:103], a[116:119], v[60:63], v[100:103]
    buffer_load_dwordx4 v13, s[16:19], s39 offen offset:3168 lds
    v_mfma_f32_16x16x32_bf16 v[104:107], a[120:123], v[60:63], v[104:107]
    s_add_u32 m0, s57, 8448
    s_add_u32 s39, s61, 917504
    v_max3_u32 v8, v62, v63, v8
    v_mfma_f32_16x16x32_bf16 v[108:111], a[124:127], v[60:63], v[108:111]
    s_waitcnt vmcnt(13)
    v_mfma_f32_16x16x32_bf16 v[96:99], a[128:131], v[64:67], v[96:99]
    v_max3_u32 v8, v64, v65, v8
    v_mfma_f32_16x16x32_bf16 v[100:103], a[132:135], v[64:67], v[100:103]
    buffer_load_dwordx4 v10, s[16:19], s39 offen offset:0 lds
    v_mfma_f32_16x16x32_bf16 v[104:107], a[136:139], v[64:67], v[104:107]
    v_max3_u32 v8, v66, v67, v8
    v_mfma_f32_16x16x32_bf16 v[108:111], a[140:143], v[64:67], v[108:111]
    s_waitcnt vmcnt(13)
    v_mfma_f32_16x16x32_bf16 v[96:99], a[144:147], v[68:71], v[96:99]
    v_max3_u32 v8, v68, v69, v8
    v_mfma_f32_16x16x32_bf16 v[100:103], a[148:151], v[68:71], v[100:103]
    buffer_load_dwordx4 v11, s[16:19], s39 offen offset:1056 lds
    v_mfma_f32_16x16x32_bf16 v[104:107], a[152:155], v[68:71], v[104:107]
    v_max3_u32 v8, v70, v71, v8
    v_mfma_f32_16x16x32_bf16 v[108:111], a[156:159], v[68:71], v[108:111]
    s_waitcnt vmcnt(13)
    v_mfma_f32_16x16x32_bf16 v[96:99], a[160:163], v[72:75], v[96:99]
    v_max3_u32 v8, v72, v73, v8
    v_mfma_f32_16x16x32_bf16 v[100:103], a[164:167], v[72:75], v[100:103]
    buffer_load_dwordx4 v12, s[16:19], s39 offen offset:2112 lds
    v_mfma_f32_16x16x32_bf16 v[104:107], a[168:171], v[72:75], v[104:107]
    v_max3_u32 v8, v74, v75, v8
    v_mfma_f32_16x16x32_bf16 v[108:111], a[172:175], v[72:75], v[108:111]
    s_waitcnt vmcnt(13)
    v_mfma_f32_16x16x32_bf16 v[96:99], a[176:179], v[76:79], v[96:99]
    v_max3_u32 v8, v76, v77, v8
    v_mfma_f32_16x16x32_bf16 v[100:103], a[180:183], v[76:79], v[100:103]
    buffer_load_dwordx4 v13, s[16:19], s39 offen offset:3168 lds
    v_mfma_f32_16x16x32_bf16 v[104:107], a[184:187], v[76:79], v[104:107]
    v_max3_u32 v8, v78, v79, v8
    v_mfma_f32_16x16x32_bf16 v[108:111], a[188:191], v[76:79], v[108:111]
    s_waitcnt vmcnt(13)
    v_mfma_f32_16x16x32_bf16 v[96:99], a[192:195], v[80:83], v[96:99]
    v_max3_u32 v8, v80, v81, v8
    v_mfma_f32_16x16x32_bf16 v[100:103], a[196:199], v[80:83], v[100:103]
    v_mfma_f32_16x16x32_bf16 v[104:107], a[200:203], v[80:83], v[104:107]
    v_max3_u32 v8, v82, v83, v8
    v_mfma_f32_16x16x32_bf16 v[108:111], a[204:207], v[80:83], v[108:111]
    s_waitcnt vmcnt(12)
    v_mfma_f32_16x16x32_bf16 v[96:99], a[208:211], v[84:87], v[96:99]
    v_max3_u32 v8, v84, v85, v8
    v_mfma_f32_16x16x32_bf16 v[100:103], a[212:215], v[84:87], v[100:103]
    v_mfma_f32_16x16x32_bf16 v[104:107], a[216:219], v[84:87], v[104:107]
    v_max3_u32 v8, v86, v87, v8
    v_mfma_f32_16x16x32_bf16 v[108:111], a[220:223], v[84:87], v[108:111]
    v_cmp_le_u32 vcc, 0xff810000, v8
    s_nop 0
    s_cbranch_vccnz T3_r
T3_c:
    v_pk_add_f32 v[96:97], v[96:97], v[136:137]
    v_pk_add_f32 v[98:99], v[98:99], v[138:139]
    v_pk_add_f32 v[100:101], v[100:101], v[140:141]
    v_pk_add_f32 v[102:103], v[102:103], v[142:143]
    v_pk_add_f32 v[104:105], v[104:105], v[144:145]
    v_pk_add_f32 v[106:107], v[106:107], v[146:147]
    v_pk_add_f32 v[108:109], v[108:109], v[148:149]
    v_pk_add_f32 v[110:111], v[110:111], v[150:151]
    v_cvt_pk_bf16_f32 v128, v96, v97
    v_cvt_pk_bf16_f32 v129, v98, v99
    v_cvt_pk_bf16_f32 v130, v100, v101
    v_cvt_pk_bf16_f32 v131, v102, v103
    v_cvt_pk_bf16_f32 v132, v104, v105
    v_cvt_pk_bf16_f32 v133, v106, v107
    v_cvt_pk_bf16_f32 v134, v108, v109
    v_cvt_pk_bf16_f32 v135, v110, v111
    v_accvgpr_write_b32 a232, v128
    v_accvgpr_write_b32 a233, v129
    v_accvgpr_write_b32 a234, v130
    v_accvgpr_write_b32 a235, v131
    v_accvgpr_write_b32 a236, v132
    v_accvgpr_write_b32 a237, v133
    v_accvgpr_write_b32 a238, v134
    v_accvgpr_write_b32 a239, v135
    v_permlane16_swap_b32 v128, v130
    v_permlane16_swap_b32 v129, v131
    v_permlane16_swap_b32 v132, v134
    v_permlane16_swap_b32 v133, v135
    s_add_u32 s40, s62, 10485760
    buffer_store_dwordx4 v[128:131], v23, s[20:23], s40 offen offset:0 sc1
    buffer_store_dwordx4 v[132:135], v23, s[20:23], s40 offen offset:1024 sc1
    s_waitcnt vmcnt(2)
    ds_read_b64_tr_b16 a[0:1], v28 offset:0
    ds_read_b64_tr_b16 a[2:3], v28 offset:256
    ds_read_b64_tr_b16 a[4:5], v29 offset:0
    ds_read_b64_tr_b16 a[6:7], v29 offset:256
    ds_read_b64_tr_b16 a[8:9], v29 offset:32
    ds_read_b64_tr_b16 a[10:11], v29 offset:288
    ds_read_b64_tr_b16 a[12:13], v29 offset:64
    ds_read_b64_tr_b16 a[14:15], v29 offset:320
    ds_read_b64_tr_b16 a[16:17], v28 offset:4224
    ds_read_b64_tr_b16 a[18:19], v28 offset:4480
    ds_read_b64_tr_b16 a[20:21], v29 offset:4224
    ds_read_b64_tr_b16 a[22:23], v29 offset:4480
    ds_read_b64_tr_b16 a[24:25], v29 offset:4256
    ds_read_b64_tr_b16 a[26:27], v29 offset:4512
    ds_read_b64_tr_b16 a[28:29], v29 offset:4288
    ds_read_b64_tr_b16 a[30:31], v29 offset:4544
    ds_read_b64_tr_b16 a[32:33], v28 offset:8448
    ds_read_b64_tr_b16 a[34:35], v28 offset:8704
    ds_read_b64_tr_b16 a[36:37], v29 offset:8448
    ds_read_b64_tr_b16 a[38:39], v29 offset:8704
    ds_read_b64_tr_b16 a[40:41], v29 offset:8480
    ds_read_b64_tr_b16 a[42:43], v29 offset:8736
    ds_read_b64_tr_b16 a[44:45], v29 offset:8512
    ds_read_b64_tr_b16 a[46:47], v29 offset:8768
    s_waitcnt lgkmcnt(15)
    ds_read_b64_tr_b16 a[48:49], v28 offset:12672
    ds_read_b64_tr_b16 a[50:51], v28 offset:12928
    s_add_u32 m0, s60, 0
    ds_read_b64_tr_b16 a[52:53], v29 offset:12672
    s_add_u32 s39, s61, 1032192
    ds_read_b64_tr_b16 a[54:55], v29 offset:12928
    buffer_load_dwordx4 v10, s[16:19], s39 offen offset:0 lds
    ds_read_b64_tr_b16 a[56:57], v29 offset:12704
    ds_read_b64_tr_b16 a[58:59], v29 offset:12960
    buffer_load_dwordx4 v11, s[16:19], s39 offen offset:1056 lds
    ds_read_b64_tr_b16 a[60:61], v29 offset:12736
    buffer_load_dwordx4 v12, s[16:19], s39 offen offset:2112 lds
    ds_read_b64_tr_b16 a[62:63], v29 offset:12992
    buffer_load_dwordx4 v13, s[16:19], s39 offen offset:3168 lds
    s_waitcnt lgkmcnt(15)
    ds_read_b64_tr_b16 a[64:65], v28 offset:16896
    ds_read_b64_tr_b16 a[66:67], v28 offset:17152
    s_add_u32 m0, s60, 4224
    ds_read_b64_tr_b16 a[68:69], v29 offset:16896
    s_add_u32 s39, s61, 1146880
    ds_read_b64_tr_b16 a[70:71], v29 offset:17152
    buffer_load_dwordx4 v10, s[16:19], s39 offen offset:0 lds
    ds_read_b64_tr_b16 a[72:73], v29 offset:16928
    ds_read_b64_tr_b16 a[74:75], v29 offset:17184
    buffer_load_dwordx4 v11, s[16:19], s39 offen offset:1056 lds
    ds_read_b64_tr_b16 a[76:77], v29 offset:16960
    buffer_load_dwordx4 v12, s[16:19], s39 offen offset:2112 lds
    ds_read_b64_tr_b16 a[78:79], v29 offset:17216
    buffer_load_dwordx4 v13, s[16:19], s39 offen offset:3168 lds
    ds_read_b64_tr_b16 a[80:81], v28 offset:21120
    ds_read_b64_tr_b16 a[82:83], v28 offset:21376
    ds_read_b64_tr_b16 a[84:85], v29 offset:21120
    ds_read_b64_tr_b16 a[86:87], v29 offset:21376
    ds_read_b64_tr_b16 a[88:89], v29 offset:21152
    ds_read_b64_tr_b16 a[90:91], v29 offset:21408
    ds_read_b64_tr_b16 a[92:93], v29 offset:21184
    ds_read_b64_tr_b16 a[94:95], v29 offset:21440
    ds_read_b64_tr_b16 a[96:97], v30 offset:0
    ds_read_b64_tr_b16 a[98:99], v30 offset:256
    ds_read_b64_tr_b16 a[100:101], v31 offset:0
    ds_read_b64_tr_b16 a[102:103], v31 offset:256
    ds_read_b64_tr_b16 a[104:105], v31 offset:32
    ds_read_b64_tr_b16 a[106:107], v31 offset:288
    ds_read_b64_tr_b16 a[108:109], v31 offset:64
    ds_read_b64_tr_b16 a[110:111], v31 offset:320
    ds_read_b64_tr_b16 a[112:113], v30 offset:4224
    ds_read_b64_tr_b16 a[114:115], v30 offset:4480
    ds_read_b64_tr_b16 a[116:117], v31 offset:4224
    ds_read_b64_tr_b16 a[118:119], v31 offset:4480
    ds_read_b64_tr_b16 a[120:121], v31 offset:4256
    ds_read_b64_tr_b16 a[122:123], v31 offset:4512
    ds_read_b64_tr_b16 a[124:125], v31 offset:4288
    ds_read_b64_tr_b16 a[126:127], v31 offset:4544
    ds_read_b64_tr_b16 a[128:129], v30 offset:8448
    ds_read_b64_tr_b16 a[130:131], v30 offset:8704
    ds_read_b64_tr_b16 a[132:133], v31 offset:8448
    ds_read_b64_tr_b16 a[134:135], v31 offset:8704
    ds_read_b64_tr_b16 a[136:137], v31 offset:8480
    ds_read_b64_tr_b16 a[138:139], v31 offset:8736
    ds_read_b64_tr_b16 a[140:141], v31 offset:8512
    ds_read_b64_tr_b16 a[142:143], v31 offset:8768
    s_mov_b32 s43, 0x8000
    s_waitcnt lgkmcnt(0)
    s_barrier
    s_mul_i32 s40, s24, 14336
    s_add_u32 s40, s40, 104704
    v_add_u32 v30, s40, v14
    s_mul_i32 s40, s29, 28672
    s_add_u32 s40, s40, 104704
    v_add_u32 v31, s40, v14
    s_xor_b32 s40, s29, 1
    s_mul_i32 s40, s40, 28672
    s_add_u32 s40, s40, 104704
    v_add_u32 v19, s40, v14
    v_and_b32 v5, 1, v4
    v_mul_u32_u24 v5, 57344, v5
    v_lshrrev_b32 v6, 1, v4
    v_lshl_add_u32 v5, v6, 8, v5
    v_lshl_add_u32 v24, v3, 4, v5
    s_mul_i32 s40, s31, 57344
    s_mul_i32 s41, s26, 28*256
    s_add_u32 s40, s40, s41
    s_mul_i32 s41, s30, 7*512
    s_add_u32 s40, s40, s41
    s_add_u32 s40, s40, 12582912
    s_mul_i32 s41, s29, 114688
    s_add_u32 s52, s40, s41
    s_add_u32 s52, s52, 3*512
    s_lshl_b32 s42, s29, 11
    s_add_u32 s40, s40, s42
    s_add_u32 s58, s40, s41
    s_xor_b32 s41, s29, 1
    s_mul_i32 s41, s41, 114688
    s_add_u32 s59, s40, s41
T4_r:
    s_add_u32 s40, s33, 10485760
    buffer_load_dwordx4 v[32:35], v14, s[20:23], s40 offen offset:0 sc1
    buffer_load_dwordx4 v[36:39], v14, s[20:23], s40 offen offset:1024 sc1
    buffer_load_dwordx4 v[40:43], v14, s[20:23], s40 offen offset:2048 sc1
    buffer_load_dwordx4 v[44:47], v14, s[20:23], s40 offen offset:3072 sc1
    s_add_u32 s40, s40, 4096
    buffer_load_dwordx4 v[48:51], v14, s[20:23], s40 offen offset:0 sc1
    buffer_load_dwordx4 v[52:55], v14, s[20:23], s40 offen offset:1024 sc1
    buffer_load_dwordx4 v[56:59], v14, s[20:23], s40 offen offset:2048 sc1
    buffer_load_dwordx4 v[60:63], v14, s[20:23], s40 offen offset:3072 sc1
    s_add_u32 s40, s40, 4096
    buffer_load_dwordx4 v[64:67], v14, s[20:23], s40 offen offset:0 sc1
    buffer_load_dwordx4 v[68:71], v14, s[20:23], s40 offen offset:1024 sc1
    buffer_load_dwordx4 v[72:75], v14, s[20:23], s40 offen offset:2048 sc1
    buffer_load_dwordx4 v[76:79], v14, s[20:23], s40 offen offset:3072 sc1
    s_add_u32 s40, s40, 4096
    buffer_load_dwordx4 v[80:83], v14, s[20:23], s40 offen offset:0 sc1
    buffer_load_dwordx4 v[84:87], v14, s[20:23], s40 offen offset:1024 sc1
    s_waitcnt vmcnt(13)
    v_max3_u32 v8, v32, v33, v33
    v_max3_u32 v8, v34, v35, v8
    v_lshlrev_b32 v96, 16, v32
    v_and_b32 v97, s36, v32
    v_lshlrev_b32 v98, 16, v33
    v_and_b32 v99, s36, v33
    v_lshlrev_b32 v100, 16, v34
    v_and_b32 v101, s36, v34
    v_lshlrev_b32 v102, 16, v35
    v_and_b32 v103, s36, v35
    v_pk_add_f32 v[208:209], v[96:97], v[98:99]
    v_pk_add_f32 v[210:211], v[100:101], v[102:103]
    s_waitcnt vmcnt(12)
    v_max3_u32 v8, v36, v37, v8
    v_max3_u32 v8, v38, v39, v8
    v_lshlrev_b32 v104, 16, v36
    v_and_b32 v105, s36, v36
    v_lshlrev_b32 v106, 16, v37
    v_and_b32 v107, s36, v37
    v_lshlrev_b32 v108, 16, v38
    v_and_b32 v109, s36, v38
    v_lshlrev_b32 v110, 16, v39
    v_and_b32 v111, s36, v39
    v_pk_add_f32 v[208:209], v[208:209], v[104:105]
    v_pk_add_f32 v[210:211], v[210:211], v[106:107]
    v_pk_add_f32 v[208:209], v[208:209], v[108:109]
    v_pk_add_f32 v[210:211], v[210:211], v[110:111]
    s_waitcnt vmcnt(11)
    v_max3_u32 v8, v40, v41, v8
    v_max3_u32 v8, v42, v43, v8
    v_lshlrev_b32 v112, 16, v40
    v_and_b32 v113, s36, v40
    v_lshlrev_b32 v114, 16, v41
    v_and_b32 v115, s36, v41
    v_lshlrev_b32 v116, 16, v42
    v_and_b32 v117, s36, v42
    v_lshlrev_b32 v118, 16, v43
    v_and_b32 v119, s36, v43
    v_pk_add_f32 v[208:209], v[208:209], v[112:113]
    v_pk_add_f32 v[210:211], v[210:211], v[114:115]
    v_pk_add_f32 v[208:209], v[208:209], v[116:117]
    v_pk_add_f32 v[210:211], v[210:211], v[118:119]
    s_waitcnt vmcnt(10)
    v_max3_u32 v8, v44, v45, v8
    v_max3_u32 v8, v46, v47, v8
    v_lshlrev_b32 v120, 16, v44
    v_and_b32 v121, s36, v44
    v_lshlrev_b32 v122, 16, v45
    v_and_b32 v123, s36, v45
    v_lshlrev_b32 v124, 16, v46
    v_and_b32 v125, s36, v46
    v_lshlrev_b32 v126, 16, v47
    v_and_b32 v127, s36, v47
    v_pk_add_f32 v[208:209], v[208:209], v[120:121]
    v_pk_add_f32 v[210:211], v[210:211], v[122:123]
    v_pk_add_f32 v[208:209], v[208:209], v[124:125]
    v_pk_add_f32 v[210:211], v[210:211], v[126:127]
    s_waitcnt vmcnt(9)
    v_max3_u32 v8, v48, v49, v8
    v_max3_u32 v8, v50, v51, v8
    v_lshlrev_b32 v128, 16, v48
    v_and_b32 v129, s36, v48
    v_lshlrev_b32 v130, 16, v49
    v_and_b32 v131, s36, v49
    v_lshlrev_b32 v132, 16, v50
    v_and_b32 v133, s36, v50
    v_lshlrev_b32 v134, 16, v51
    v_and_b32 v135, s36, v51
    v_pk_add_f32 v[208:209], v[208:209], v[128:129]
    v_pk_add_f32 v[210:211], v[210:211], v[130:131]
    v_pk_add_f32 v[208:209], v[208:209], v[132:133]
    v_pk_add_f32 v[210:211], v[210:211], v[134:135]
    s_waitcnt vmcnt(8)
    v_max3_u32 v8, v52, v53, v8
    v_max3_u32 v8, v54, v55, v8
    v_lshlrev_b32 v136, 16, v52
    v_and_b32 v137, s36, v52
    v_lshlrev_b32 v138, 16, v53
    v_and_b32 v139, s36, v53
    v_lshlrev_b32 v140, 16, v54
    v_and_b32 v141, s36, v54
    v_lshlrev_b32 v142, 16, v55
    v_and_b32 v143, s36, v55
    v_pk_add_f32 v[208:209], v[208:209], v[136:137]
    v_pk_add_f32 v[210:211], v[210:211], v[138:139]
    v_pk_add_f32 v[208:209], v[208:209], v[140:141]
    v_pk_add_f32 v[210:211], v[210:211], v[142:143]
    s_waitcnt vmcnt(7)
    v_max3_u32 v8, v56, v57, v8
    v_max3_u32 v8, v58, v59, v8
    v_lshlrev_b32 v144, 16, v56
    v_and_b32 v145, s36, v56
    v_lshlrev_b32 v146, 16, v57
    v_and_b32 v147, s36, v57
    v_lshlrev_b32 v148, 16, v58
    v_and_b32 v149, s36, v58
    v_lshlrev_b32 v150, 16, v59
    v_and_b32 v151, s36, v59
    v_pk_add_f32 v[208:209], v[208:209], v[144:145]
    v_pk_add_f32 v[210:211], v[210:211], v[146:147]
    v_pk_add_f32 v[208:209], v[208:209], v[148:149]
    v_pk_add_f32 v[210:211], v[210:211], v[150:151]
    s_waitcnt vmcnt(6)
    v_max3_u32 v8, v60, v61, v8
    v_max3_u32 v8, v62, v63, v8
    v_lshlrev_b32 v152, 16, v60
    v_and_b32 v153, s36, v60
    v_lshlrev_b32 v154, 16, v61
    v_and_b32 v155, s36, v61
    v_lshlrev_b32 v156, 16, v62
    v_and_b32 v157, s36, v62
    v_lshlrev_b32 v158, 16, v63
    v_and_b32 v159, s36, v63
    v_pk_add_f32 v[208:209], v[208:209], v[152:153]
    v_pk_add_f32 v[210:211], v[210:211], v[154:155]
    v_pk_add_f32 v[208:209], v[208:209], v[156:157]
    v_pk_add_f32 v[210:211], v[210:211], v[158:159]
    s_waitcnt vmcnt(5)
    v_max3_u32 v8, v64, v65, v8
    v_max3_u32 v8, v66, v67, v8
    v_lshlrev_b32 v160, 16, v64
    v_and_b32 v161, s36, v64
    v_lshlrev_b32 v162, 16, v65
    v_and_b32 v163, s36, v65
    v_lshlrev_b32 v164, 16, v66
    v_and_b32 v165, s36, v66
    v_lshlrev_b32 v166, 16, v67
    v_and_b32 v167, s36, v67
    v_pk_add_f32 v[208:209], v[208:209], v[160:161]
    v_pk_add_f32 v[210:211], v[210:211], v[162:163]
    v_pk_add_f32 v[208:209], v[208:209], v[164:165]
    v_pk_add_f32 v[210:211], v[210:211], v[166:167]
    s_waitcnt vmcnt(4)
    v_max3_u32 v8, v68, v69, v8
    v_max3_u32 v8, v70, v71, v8
    v_lshlrev_b32 v168, 16, v68
    v_and_b32 v169, s36, v68
    v_lshlrev_b32 v170, 16, v69
    v_and_b32 v171, s36, v69
    v_lshlrev_b32 v172, 16, v70
    v_and_b32 v173, s36, v70
    v_lshlrev_b32 v174, 16, v71
    v_and_b32 v175, s36, v71
    v_pk_add_f32 v[208:209], v[208:209], v[168:169]
    v_pk_add_f32 v[210:211], v[210:211], v[170:171]
    v_pk_add_f32 v[208:209], v[208:209], v[172:173]
    v_pk_add_f32 v[210:211], v[210:211], v[174:175]
    s_waitcnt vmcnt(3)
    v_max3_u32 v8, v72, v73, v8
    v_max3_u32 v8, v74, v75, v8
    v_lshlrev_b32 v176, 16, v72
    v_and_b32 v177, s36, v72
    v_lshlrev_b32 v178, 16, v73
    v_and_b32 v179, s36, v73
    v_lshlrev_b32 v180, 16, v74
    v_and_b32 v181, s36, v74
    v_lshlrev_b32 v182, 16, v75
    v_and_b32 v183, s36, v75
    v_pk_add_f32 v[208:209], v[208:209], v[176:177]
    v_pk_add_f32 v[210:211], v[210:211], v[178:179]
    v_pk_add_f32 v[208:209], v[208:209], v[180:181]
    v_pk_add_f32 v[210:211], v[210:211], v[182:183]
    s_waitcnt vmcnt(2)
    v_max3_u32 v8, v76, v77, v8
    v_max3_u32 v8, v78, v79, v8
    v_lshlrev_b32 v184, 16, v76
    v_and_b32 v185, s36, v76
    v_lshlrev_b32 v186, 16, v77
    v_and_b32 v187, s36, v77
    v_lshlrev_b32 v188, 16, v78
    v_and_b32 v189, s36, v78
    v_lshlrev_b32 v190, 16, v79
    v_and_b32 v191, s36, v79
    v_pk_add_f32 v[208:209], v[208:209], v[184:185]
    v_pk_add_f32 v[210:211], v[210:211], v[186:187]
    v_pk_add_f32 v[208:209], v[208:209], v[188:189]
    v_pk_add_f32 v[210:211], v[210:211], v[190:191]
    s_waitcnt vmcnt(1)
    v_max3_u32 v8, v80, v81, v8
    v_max3_u32 v8, v82, v83, v8
    v_lshlrev_b32 v192, 16, v80
    v_and_b32 v193, s36, v80
    v_lshlrev_b32 v194, 16, v81
    v_and_b32 v195, s36, v81
    v_lshlrev_b32 v196, 16, v82
    v_and_b32 v197, s36, v82
    v_lshlrev_b32 v198, 16, v83
    v_and_b32 v199, s36, v83
    v_pk_add_f32 v[208:209], v[208:209], v[192:193]
    v_pk_add_f32 v[210:211], v[210:211], v[194:195]
    v_pk_add_f32 v[208:209], v[208:209], v[196:197]
    v_pk_add_f32 v[210:211], v[210:211], v[198:199]
    s_waitcnt vmcnt(0)
    v_max3_u32 v8, v84, v85, v8
    v_max3_u32 v8, v86, v87, v8
    v_lshlrev_b32 v200, 16, v84
    v_and_b32 v201, s36, v84
    v_lshlrev_b32 v202, 16, v85
    v_and_b32 v203, s36, v85
    v_lshlrev_b32 v204, 16, v86
    v_and_b32 v205, s36, v86
    v_lshlrev_b32 v206, 16, v87
    v_and_b32 v207, s36, v87
    v_pk_add_f32 v[208:209], v[208:209], v[200:201]
    v_pk_add_f32 v[210:211], v[210:211], v[202:203]
    v_pk_add_f32 v[208:209], v[208:209], v[204:205]
    v_pk_add_f32 v[210:211], v[210:211], v[206:207]
    v_cmp_le_u32 vcc, 0xff810000, v8
    s_sub_u32 s43, s43, 1
    s_cbranch_vccz T4_r_ok
    s_cmp_lg_u32 s43, 0
    s_cbranch_scc1 T4_r
T4_r_ok:
    ds_read_b64_tr_b16 a[144:145], v28 offset:0
    ds_read_b64_tr_b16 a[146:147], v28 offset:256
    ds_read_b64_tr_b16 a[148:149], v29 offset:0
    ds_read_b64_tr_b16 a[150:151], v29 offset:256
    ds_read_b64_tr_b16 a[152:153], v29 offset:32
    ds_read_b64_tr_b16 a[154:155], v29 offset:288
    ds_read_b64_tr_b16 a[156:157], v29 offset:64
    ds_read_b64_tr_b16 a[158:159], v29 offset:320
    ds_read_b64_tr_b16 a[160:161], v28 offset:4224
    ds_read_b64_tr_b16 a[162:163], v28 offset:4480
    ds_read_b64_tr_b16 a[164:165], v29 offset:4224
    ds_read_b64_tr_b16 a[166:167], v29 offset:4480
    ds_read_b64_tr_b16 a[168:169], v29 offset:4256
    ds_read_b64_tr_b16 a[170:171], v29 offset:4512
    ds_read_b64_tr_b16 a[172:173], v29 offset:4288
    ds_read_b64_tr_b16 a[174:175], v29 offset:4544
    v_pk_add_f32 v[208:209], v[208:209], v[210:211]
    v_add_f32 v208, v208, v209
    v_mov_b32 v212, v208
    s_nop 1
    v_permlane16_swap_b32 v208, v212
    v_add_f32 v208, v208, v212
    v_mov_b32 v212, v208
    s_nop 1
    v_permlane32_swap_b32 v208, v212
    v_add_f32 v208, v208, v212
    v_mul_f32 v208, s38, v208
    v_pk_add_f32 v[96:97], v[96:97], v[208:209] op_sel_hi:[1,0]
    v_pk_add_f32 v[98:99], v[98:99], v[208:209] op_sel_hi:[1,0]
    v_pk_mul_f32 v[214:215], v[96:97], v[96:97]
    v_pk_mul_f32 v[216:217], v[98:99], v[98:99]
    s_add_u32 m0, s60, 8448
    v_pk_add_f32 v[100:101], v[100:101], v[208:209] op_sel_hi:[1,0]
    v_pk_add_f32 v[102:103], v[102:103], v[208:209] op_sel_hi:[1,0]
    v_pk_fma_f32 v[214:215], v[100:101], v[100:101], v[214:215]
    v_pk_fma_f32 v[216:217], v[102:103], v[102:103], v[216:217]
    v_pk_add_f32 v[104:105], v[104:105], v[208:209] op_sel_hi:[1,0]
    v_pk_add_f32 v[106:107], v[106:107], v[208:209] op_sel_hi:[1,0]
    v_pk_fma_f32 v[214:215], v[104:105], v[104:105], v[214:215]
    v_pk_fma_f32 v[216:217], v[106:107], v[106:107], v[216:217]
    v_pk_add_f32 v[108:109], v[108:109], v[208:209] op_sel_hi:[1,0]
    v_pk_add_f32 v[110:111], v[110:111], v[208:209] op_sel_hi:[1,0]
    v_pk_fma_f32 v[214:215], v[108:109], v[108:109], v[214:215]
    v_pk_fma_f32 v[216:217], v[110:111], v[110:111], v[216:217]
    v_pk_add_f32 v[112:113], v[112:113], v[208:209] op_sel_hi:[1,0]
    s_add_u32 s39, s61, 1261568
    v_pk_add_f32 v[114:115], v[114:115], v[208:209] op_sel_hi:[1,0]
    v_pk_fma_f32 v[214:215], v[112:113], v[112:113], v[214:215]
    v_pk_fma_f32 v[216:217], v[114:115], v[114:115], v[216:217]
    v_pk_add_f32 v[116:117], v[116:117], v[208:209] op_sel_hi:[1,0]
    v_pk_add_f32 v[118:119], v[118:119], v[208:209] op_sel_hi:[1,0]
    v_pk_fma_f32 v[214:215], v[116:117], v[116:117], v[214:215]
    v_pk_fma_f32 v[216:217], v[118:119], v[118:119], v[216:217]
    v_pk_add_f32 v[120:121], v[120:121], v[208:209] op_sel_hi:[1,0]
    v_pk_add_f32 v[122:123], v[122:123], v[208:209] op_sel_hi:[1,0]
    v_pk_fma_f32 v[214:215], v[120:121], v[120:121], v[214:215]
    v_pk_fma_f32 v[216:217], v[122:123], v[122:123], v[216:217]
    v_pk_add_f32 v[124:125], v[124:125], v[208:209] op_sel_hi:[1,0]
    buffer_load_dwordx4 v10, s[16:19], s39 offen offset:0 lds
    v_pk_add_f32 v[126:127], v[126:127], v[208:209] op_sel_hi:[1,0]
    v_pk_fma_f32 v[214:215], v[124:125], v[124:125], v[214:215]
    v_pk_fma_f32 v[216:217], v[126:127], v[126:127], v[216:217]
    v_pk_add_f32 v[128:129], v[128:129], v[208:209] op_sel_hi:[1,0]
    v_pk_add_f32 v[130:131], v[130:131], v[208:209] op_sel_hi:[1,0]
    v_pk_fma_f32 v[214:215], v[128:129], v[128:129], v[214:215]
    v_pk_fma_f32 v[216:217], v[130:131], v[130:131], v[216:217]
    v_pk_add_f32 v[132:133], v[132:133], v[208:209] op_sel_hi:[1,0]
    v_pk_add_f32 v[134:135], v[134:135], v[208:209] op_sel_hi:[1,0]
    v_pk_fma_f32 v[214:215], v[132:133], v[132:133], v[214:215]
    v_pk_fma_f32 v[216:217], v[134:135], v[134:135], v[216:217]
    v_pk_add_f32 v[136:137], v[136:137], v[208:209] op_sel_hi:[1,0]
    v_pk_add_f32 v[138:139], v[138:139], v[208:209] op_sel_hi:[1,0]
    buffer_load_dwordx4 v11, s[16:19], s39 offen offset:1056 lds
    v_pk_fma_f32 v[214:215], v[136:137], v[136:137], v[214:215]
    v_pk_fma_f32 v[216:217], v[138:139], v[138:139], v[216:217]
    v_pk_add_f32 v[140:141], v[140:141], v[208:209] op_sel_hi:[1,0]
    v_pk_add_f32 v[142:143], v[142:143], v[208:209] op_sel_hi:[1,0]
    v_pk_fma_f32 v[214:215], v[140:141], v[140:141], v[214:215]
    v_pk_fma_f32 v[216:217], v[142:143], v[142:143], v[216:217]
    v_pk_add_f32 v[144:145], v[144:145], v[208:209] op_sel_hi:[1,0]
    v_pk_add_f32 v[146:147], v[146:147], v[208:209] op_sel_hi:[1,0]
    v_pk_fma_f32 v[214:215], v[144:145], v[144:145], v[214:215]
    v_pk_fma_f32 v[216:217], v[146:147], v[146:147], v[216:217]
    v_pk_add_f32 v[148:149], v[148:149], v[208:209] op_sel_hi:[1,0]
    v_pk_add_f32 v[150:151], v[150:151], v[208:209] op_sel_hi:[1,0]
    v_pk_fma_f32 v[214:215], v[148:149], v[148:149], v[214:215]
    buffer_load_dwordx4 v12, s[16:19], s39 offen offset:2112 lds
    v_pk_fma_f32 v[216:217], v[150:151], v[150:151], v[216:217]
    v_pk_add_f32 v[152:153], v[152:153], v[208:209] op_sel_hi:[1,0]
    v_pk_add_f32 v[154:155], v[154:155], v[208:209] op_sel_hi:[1,0]
    v_pk_fma_f32 v[214:215], v[152:153], v[152:153], v[214:215]
    v_pk_fma_f32 v[216:217], v[154:155], v[154:155], v[216:217]
    v_pk_add_f32 v[156:157], v[156:157], v[208:209] op_sel_hi:[1,0]
    v_pk_add_f32 v[158:159], v[158:159], v[208:209] op_sel_hi:[1,0]
    v_pk_fma_f32 v[214:215], v[156:157], v[156:157], v[214:215]
    v_pk_fma_f32 v[216:217], v[158:159], v[158:159], v[216:217]
    v_pk_add_f32 v[160:161], v[160:161], v[208:209] op_sel_hi:[1,0]
    v_pk_add_f32 v[162:163], v[162:163], v[208:209] op_sel_hi:[1,0]
    v_pk_fma_f32 v[214:215], v[160:161], v[160:161], v[214:215]
    buffer_load_dwordx4 v13, s[16:19], s39 offen offset:3168 lds
    v_pk_fma_f32 v[216:217], v[162:163], v[162:163], v[216:217]
    v_pk_add_f32 v[164:165], v[164:165], v[208:209] op_sel_hi:[1,0]
    v_pk_add_f32 v[166:167], v[166:167], v[208:209] op_sel_hi:[1,0]
    v_pk_fma_f32 v[214:215], v[164:165], v[164:165], v[214:215]
    v_pk_fma_f32 v[216:217], v[166:167], v[166:167], v[216:217]
    v_pk_add_f32 v[168:169], v[168:169], v[208:209] op_sel_hi:[1,0]
    v_pk_add_f32 v[170:171], v[170:171], v[208:209] op_sel_hi:[1,0]
    v_pk_fma_f32 v[214:215], v[168:169], v[168:169], v[214:215]
    v_pk_fma_f32 v[216:217], v[170:171], v[170:171], v[216:217]
    v_pk_add_f32 v[172:173], v[172:173], v[208:209] op_sel_hi:[1,0]
    v_pk_add_f32 v[174:175], v[174:175], v[208:209] op_sel_hi:[1,0]
    v_pk_fma_f32 v[214:215], v[172:173], v[172:173], v[214:215]
    v_pk_fma_f32 v[216:217], v[174:175], v[174:175], v[216:217]
    s_add_u32 m0, s60, 12672
    v_pk_add_f32 v[176:177], v[176:177], v[208:209] op_sel_hi:[1,0]
    v_pk_add_f32 v[178:179], v[178:179], v[208:209] op_sel_hi:[1,0]
    v_pk_fma_f32 v[214:215], v[176:177], v[176:177], v[214:215]
    v_pk_fma_f32 v[216:217], v[178:179], v[178:179], v[216:217]
    v_pk_add_f32 v[180:181], v[180:181], v[208:209] op_sel_hi:[1,0]
    v_pk_add_f32 v[182:183], v[182:183], v[208:209] op_sel_hi:[1,0]
    v_pk_fma_f32 v[214:215], v[180:181], v[180:181], v[214:215]
    v_pk_fma_f32 v[216:217], v[182:183], v[182:183], v[216:217]
    v_pk_add_f32 v[184:185], v[184:185], v[208:209] op_sel_hi:[1,0]
    v_pk_add_f32 v[186:187], v[186:187], v[208:209] op_sel_hi:[1,0]
    v_pk_fma_f32 v[214:215], v[184:185], v[184:185], v[214:215]
    v_pk_fma_f32 v[216:217], v[186:187], v[186:187], v[216:217]
    s_add_u32 s39, s61, 1376256
    v_pk_add_f32 v[188:189], v[188:189], v[208:209] op_sel_hi:[1,0]
    v_pk_add_f32 v[190:191], v[190:191], v[208:209] op_sel_hi:[1,0]
    v_pk_fma_f32 v[214:215], v[188:189], v[188:189], v[214:215]
    v_pk_fma_f32 v[216:217], v[190:191], v[190:191], v[216:217]
    v_pk_add_f32 v[192:193], v[192:193], v[208:209] op_sel_hi:[1,0]
    v_pk_add_f32 v[194:195], v[194:195], v[208:209] op_sel_hi:[1,0]
    v_pk_fma_f32 v[214:215], v[192:193], v[192:193], v[214:215]
    v_pk_fma_f32 v[216:217], v[194:195], v[194:195], v[216:217]
    v_pk_add_f32 v[196:197], v[196:197], v[208:209] op_sel_hi:[1,0]
    v_pk_add_f32 v[198:199], v[198:199], v[208:209] op_sel_hi:[1,0]
    v_pk_fma_f32 v[214:215], v[196:197], v[196:197], v[214:215]
    v_pk_fma_f32 v[216:217], v[198:199], v[198:199], v[216:217]
    v_pk_add_f32 v[200:201], v[200:201], v[208:209] op_sel_hi:[1,0]
    buffer_load_dwordx4 v10, s[16:19], s39 offen offset:0 lds
    v_pk_add_f32 v[202:203], v[202:203], v[208:209] op_sel_hi:[1,0]
    v_pk_fma_f32 v[214:215], v[200:201], v[200:201], v[214:215]
    v_pk_fma_f32 v[216:217], v[202:203], v[202:203], v[216:217]
    v_pk_add_f32 v[204:205], v[204:205], v[208:209] op_sel_hi:[1,0]
    v_pk_add_f32 v[206:207], v[206:207], v[208:209] op_sel_hi:[1,0]
    v_pk_fma_f32 v[214:215], v[204:205], v[204:205], v[214:215]
    v_pk_fma_f32 v[216:217], v[206:207], v[206:207], v[216:217]
    v_pk_add_f32 v[210:211], v[214:215], v[216:217]
    v_add_f32 v210, v210, v211
    v_mov_b32 v212, v210
    s_nop 1
    v_permlane16_swap_b32 v210, v212
    v_add_f32 v210, v210, v212
    v_mov_b32 v212, v210
    buffer_load_dwordx4 v11, s[16:19], s39 offen offset:1056 lds
    s_nop 0
    v_permlane32_swap_b32 v210, v212
    v_add_f32 v210, v210, v212
    v_fma_f32 v210, v210, s37, v9
    v_rsq_f32 v210, v210
    s_nop 0
    v_pk_mul_f32 v[96:97], v[96:97], v[210:211] op_sel_hi:[1,0]
    v_pk_mul_f32 v[98:99], v[98:99], v[210:211] op_sel_hi:[1,0]
    v_pk_mul_f32 v[100:101], v[100:101], v[210:211] op_sel_hi:[1,0]
    v_pk_mul_f32 v[102:103], v[102:103], v[210:211] op_sel_hi:[1,0]
    v_cvt_pk_bf16_f32 v32, v96, v97
    v_cvt_pk_bf16_f32 v33, v98, v99
    v_cvt_pk_bf16_f32 v34, v100, v101
    v_cvt_pk_bf16_f32 v35, v102, v103
    buffer_load_dwordx4 v12, s[16:19], s39 offen offset:2112 lds
    ds_write_b128 v30, v[32:35] offset:0
    v_pk_mul_f32 v[104:105], v[104:105], v[210:211] op_sel_hi:[1,0]
    v_pk_mul_f32 v[106:107], v[106:107], v[210:211] op_sel_hi:[1,0]
    v_pk_mul_f32 v[108:109], v[108:109], v[210:211] op_sel_hi:[1,0]
    v_pk_mul_f32 v[110:111], v[110:111], v[210:211] op_sel_hi:[1,0]
    v_cvt_pk_bf16_f32 v36, v104, v105
    v_cvt_pk_bf16_f32 v37, v106, v107
    v_cvt_pk_bf16_f32 v38, v108, v109
    v_cvt_pk_bf16_f32 v39, v110, v111
    ds_write_b128 v30, v[36:39] offset:1024
    v_pk_mul_f32 v[112:113], v[112:113], v[210:211] op_sel_hi:[1,0]
    v_pk_mul_f32 v[114:115], v[114:115], v[210:211] op_sel_hi:[1,0]
    v_pk_mul_f32 v[116:117], v[116:117], v[210:211] op_sel_hi:[1,0]
    buffer_load_dwordx4 v13, s[16:19], s39 offen offset:3168 lds
    v_pk_mul_f32 v[118:119], v[118:119], v[210:211] op_sel_hi:[1,0]
    v_cvt_pk_bf16_f32 v40, v112, v113
    v_cvt_pk_bf16_f32 v41, v114, v115
    v_cvt_pk_bf16_f32 v42, v116, v117
    v_cvt_pk_bf16_f32 v43, v118, v119
    ds_write_b128 v30, v[40:43] offset:2048
    v_pk_mul_f32 v[120:121], v[120:121], v[210:211] op_sel_hi:[1,0]
    v_pk_mul_f32 v[122:123], v[122:123], v[210:211] op_sel_hi:[1,0]
    v_pk_mul_f32 v[124:125], v[124:125], v[210:211] op_sel_hi:[1,0]
    v_pk_mul_f32 v[126:127], v[126:127], v[210:211] op_sel_hi:[1,0]
    v_cvt_pk_bf16_f32 v44, v120, v121
    v_cvt_pk_bf16_f32 v45, v122, v123
    s_add_u32 m0, s60, 16896
    v_cvt_pk_bf16_f32 v46, v124, v125
    v_cvt_pk_bf16_f32 v47, v126, v127
    ds_write_b128 v30, v[44:47] offset:3072
    v_pk_mul_f32 v[128:129], v[128:129], v[210:211] op_sel_hi:[1,0]
    v_pk_mul_f32 v[130:131], v[130:131], v[210:211] op_sel_hi:[1,0]
    v_pk_mul_f32 v[132:133], v[132:133], v[210:211] op_sel_hi:[1,0]
    v_pk_mul_f32 v[134:135], v[134:135], v[210:211] op_sel_hi:[1,0]
    v_cvt_pk_bf16_f32 v48, v128, v129
    v_cvt_pk_bf16_f32 v49, v130, v131
    v_cvt_pk_bf16_f32 v50, v132, v133
    v_cvt_pk_bf16_f32 v51, v134, v135
    ds_write_b128 v30, v[48:51] offset:4096
    v_pk_mul_f32 v[136:137], v[136:137], v[210:211] op_sel_hi:[1,0]
    s_add_u32 s39, s61, 1490944
    v_pk_mul_f32 v[138:139], v[138:139], v[210:211] op_sel_hi:[1,0]
    v_pk_mul_f32 v[140:141], v[140:141], v[210:211] op_sel_hi:[1,0]
    v_pk_mul_f32 v[142:143], v[142:143], v[210:211] op_sel_hi:[1,0]
    v_cvt_pk_bf16_f32 v52, v136, v137
    v_cvt_pk_bf16_f32 v53, v138, v139
    v_cvt_pk_bf16_f32 v54, v140, v141
    v_cvt_pk_bf16_f32 v55, v142, v143
    ds_write_b128 v30, v[52:55] offset:5120
    v_pk_mul_f32 v[144:145], v[144:145], v[210:211] op_sel_hi:[1,0]
    v_pk_mul_f32 v[146:147], v[146:147], v[210:211] op_sel_hi:[1,0]
    v_pk_mul_f32 v[148:149], v[148:149], v[210:211] op_sel_hi:[1,0]
    v_pk_mul_f32 v[150:151], v[150:151], v[210:211] op_sel_hi:[1,0]
    v_cvt_pk_bf16_f32 v56, v144, v145
    buffer_load_dwordx4 v10, s[16:19], s39 offen offset:0 lds
    v_cvt_pk_bf16_f32 v57, v146, v147
    v_cvt_pk_bf16_f32 v58, v148, v149
    v_cvt_pk_bf16_f32 v59, v150, v151
    ds_write_b128 v30, v[56:59] offset:6144
    v_pk_mul_f32 v[152:153], v[152:153], v[210:211] op_sel_hi:[1,0]
    v_pk_mul_f32 v[154:155], v[154:155], v[210:211] op_sel_hi:[1,0]
    v_pk_mul_f32 v[156:157], v[156:157], v[210:211] op_sel_hi:[1,0]
    v_pk_mul_f32 v[158:159], v[158:159], v[210:211] op_sel_hi:[1,0]
    v_cvt_pk_bf16_f32 v60, v152, v153
    v_cvt_pk_bf16_f32 v61, v154, v155
    v_cvt_pk_bf16_f32 v62, v156, v157
    v_cvt_pk_bf16_f32 v63, v158, v159
    buffer_load_dwordx4 v11, s[16:19], s39 offen offset:1056 lds
    ds_write_b128 v30, v[60:63] offset:7168
    v_pk_mul_f32 v[160:161], v[160:161], v[210:211] op_sel_hi:[1,0]
    v_pk_mul_f32 v[162:163], v[162:163], v[210:211] op_sel_hi:[1,0]
    v_pk_mul_f32 v[164:165], v[164:165], v[210:211] op_sel_hi:[1,0]
    v_pk_mul_f32 v[166:167], v[166:167], v[210:211] op_sel_hi:[1,0]
    v_cvt_pk_bf16_f32 v64, v160, v161
    v_cvt_pk_bf16_f32 v65, v162, v163
    v_cvt_pk_bf16_f32 v66, v164, v165
    v_cvt_pk_bf16_f32 v67, v166, v167
    ds_write_b128 v30, v[64:67] offset:8192
    v_pk_mul_f32 v[168:169], v[168:169], v[210:211] op_sel_hi:[1,0]
    v_pk_mul_f32 v[170:171], v[170:171], v[210:211] op_sel_hi:[1,0]
    v_pk_mul_f32 v[172:173], v[172:173], v[210:211] op_sel_hi:[1,0]
    buffer_load_dwordx4 v12, s[16:19], s39 offen offset:2112 lds
    v_pk_mul_f32 v[174:175], v[174:175], v[210:211] op_sel_hi:[1,0]
    v_cvt_pk_bf16_f32 v68, v168, v169
    v_cvt_pk_bf16_f32 v69, v170, v171
    v_cvt_pk_bf16_f32 v70, v172, v173
    v_cvt_pk_bf16_f32 v71, v174, v175
    ds_write_b128 v30, v[68:71] offset:9216
    v_pk_mul_f32 v[176:177], v[176:177], v[210:211] op_sel_hi:[1,0]
    v_pk_mul_f32 v[178:179], v[178:179], v[210:211] op_sel_hi:[1,0]
    v_pk_mul_f32 v[180:181], v[180:181], v[210:211] op_sel_hi:[1,0]
    v_pk_mul_f32 v[182:183], v[182:183], v[210:211] op_sel_hi:[1,0]
    v_cvt_pk_bf16_f32 v72, v176, v177
    v_cvt_pk_bf16_f32 v73, v178, v179
    buffer_load_dwordx4 v13, s[16:19], s39 offen offset:3168 lds
    v_cvt_pk_bf16_f32 v74, v180, v181
    v_cvt_pk_bf16_f32 v75, v182, v183
    ds_write_b128 v30, v[72:75] offset:10240
    v_pk_mul_f32 v[184:185], v[184:185], v[210:211] op_sel_hi:[1,0]
    v_pk_mul_f32 v[186:187], v[186:187], v[210:211] op_sel_hi:[1,0]
    v_pk_mul_f32 v[188:189], v[188:189], v[210:211] op_sel_hi:[1,0]
    v_pk_mul_f32 v[190:191], v[190:191], v[210:211] op_sel_hi:[1,0]
    v_cvt_pk_bf16_f32 v76, v184, v185
    v_cvt_pk_bf16_f32 v77, v186, v187
    v_cvt_pk_bf16_f32 v78, v188, v189
    v_cvt_pk_bf16_f32 v79, v190, v191
    ds_write_b128 v30, v[76:79] offset:11264
    v_pk_mul_f32 v[192:193], v[192:193], v[210:211] op_sel_hi:[1,0]
    v_pk_mul_f32 v[194:195], v[194:195], v[210:211] op_sel_hi:[1,0]
    v_pk_mul_f32 v[196:197], v[196:197], v[210:211] op_sel_hi:[1,0]
    v_pk_mul_f32 v[198:199], v[198:199], v[210:211] op_sel_hi:[1,0]
    v_cvt_pk_bf16_f32 v80, v192, v193
    v_cvt_pk_bf16_f32 v81, v194, v195
    v_cvt_pk_bf16_f32 v82, v196, v197
    v_cvt_pk_bf16_f32 v83, v198, v199
    ds_write_b128 v30, v[80:83] offset:12288
    v_pk_mul_f32 v[200:201], v[200:201], v[210:211] op_sel_hi:[1,0]
    v_pk_mul_f32 v[202:203], v[202:203], v[210:211] op_sel_hi:[1,0]
    v_pk_mul_f32 v[204:205], v[204:205], v[210:211] op_sel_hi:[1,0]
    v_pk_mul_f32 v[206:207], v[206:207], v[210:211] op_sel_hi:[1,0]
    v_cvt_pk_bf16_f32 v84, v200, v201
    v_cvt_pk_bf16_f32 v85, v202, v203
    v_cvt_pk_bf16_f32 v86, v204, v205
    v_cvt_pk_bf16_f32 v87, v206, v207
    ds_write_b128 v30, v[84:87] offset:13312
    v_lshrrev_b32 v5, 3, v2
    v_and_b32 v6, 1, v5
    v_mul_u32_u24 v6, 7168, v6
    v_bfe_u32 v7, v5, 1, 1
    v_mul_u32_u24 v7, 3584, v7
    v_lshrrev_b32 v5, 2, v5
    v_mul_u32_u24 v5, 14336, v5
    v_add3_u32 v5, v5, v6, v7
    v_and_b32 v6, 7, v2
    v_lshl_add_u32 v5, v6, 4, v5
    v_add_u32 v10, 480, v5
    v_add_u32 v11, 320, v5
    v_add_u32 v12, 160, v5
    v_add_u32 v13, 0, v5
    s_sub_u32 s16, s50, 480
    s_subb_u32 s17, s51, 0
    s_mov_b32 s18, 1606112
    s_mov_b32 s19, 0x20000
    s_mul_i32 s61, s24, 401408
    s_add_u32 s61, s61, s32
    s_waitcnt vmcnt(0) lgkmcnt(0)
    s_barrier
    ds_read_b128 v[32:35], v31 offset:0
    ds_read_b128 v[36:39], v31 offset:14336
    ds_read_b128 v[40:43], v19 offset:0
    ds_read_b128 v[44:47], v19 offset:14336
    ds_read_b128 v[48:51], v31 offset:1024
    ds_read_b128 v[52:55], v31 offset:15360
    ds_read_b128 v[56:59], v19 offset:1024
    ds_read_b128 v[60:63], v19 offset:15360
    v_add_u32 v30, s60, v18
    s_waitcnt lgkmcnt(4)
    v_mfma_f32_16x16x32_bf16 v[96:99], a[0:3], v[32:35], 0
    ds_read_b128 v[64:67], v31 offset:2048
    v_mfma_f32_16x16x32_bf16 v[100:103], a[0:3], v[36:39], 0
    ds_read_b128 v[68:71], v31 offset:16384
    v_mfma_f32_16x16x32_bf16 v[104:107], a[4:7], v[32:35], 0
    ds_read_b128 v[72:75], v19 offset:2048
    v_mfma_f32_16x16x32_bf16 v[108:111], a[4:7], v[36:39], 0
    ds_read_b128 v[76:79], v19 offset:16384
    s_mul_i32 s39, s68, 28
    s_add_u32 s39, s39, s61
    s_add_u32 m0, s60, 21120
    v_mfma_f32_16x16x32_bf16 v[112:115], a[4:7], v[40:43], 0
    ds_read_b64_tr_b16 a[176:177], v28 offset:8448
    ds_read_b64_tr_b16 a[178:179], v28 offset:8704
    v_mfma_f32_16x16x32_bf16 v[116:119], a[4:7], v[44:47], 0
    buffer_load_dwordx4 v10, s[16:19], s39 offen offset:0 lds
    v_mfma_f32_16x16x32_bf16 v[120:123], a[8:11], v[32:35], 0
    ds_read_b64_tr_b16 a[180:181], v29 offset:8448
    ds_read_b64_tr_b16 a[182:183], v29 offset:8704
    v_mfma_f32_16x16x32_bf16 v[124:127], a[8:11], v[36:39], 0
    ds_read_b64_tr_b16 a[184:185], v29 offset:8480
    ds_read_b64_tr_b16 a[186:187], v29 offset:8736
    v_mfma_f32_16x16x32_bf16 v[128:131], a[8:11], v[40:43], 0
    buffer_load_dwordx4 v11, s[16:19], s39 offen offset:1056 lds
    v_mfma_f32_16x16x32_bf16 v[132:135], a[8:11], v[44:47], 0
    ds_read_b64_tr_b16 a[188:189], v29 offset:8512
    ds_read_b64_tr_b16 a[190:191], v29 offset:8768
    v_mfma_f32_16x16x32_bf16 v[136:139], a[12:15], v[32:35], 0
    buffer_load_dwordx4 v12, s[16:19], s39 offen offset:2112 lds
    v_mfma_f32_16x16x32_bf16 v[140:143], a[12:15], v[36:39], 0
    ds_read_b64_tr_b16 a[192:193], v28 offset:12672
    ds_read_b64_tr_b16 a[194:195], v28 offset:12928
    v_mfma_f32_16x16x32_bf16 v[144:147], a[12:15], v[40:43], 0
    ds_read_b64_tr_b16 a[196:197], v29 offset:12672
    ds_read_b64_tr_b16 a[198:199], v29 offset:12928
    v_mfma_f32_16x16x32_bf16 v[148:151], a[12:15], v[44:47], 0
    ds_read_b64_tr_b16 a[200:201], v29 offset:12704
    ds_read_b64_tr_b16 a[202:203], v29 offset:12960
    s_waitcnt lgkmcnt(15)
    v_mfma_f32_16x16x32_bf16 v[96:99], a[16:19], v[48:51], v[96:99]
    ds_read_b128 v[32:35], v31 offset:3072
    v_mfma_f32_16x16x32_bf16 v[100:103], a[16:19], v[52:55], v[100:103]
    ds_read_b128 v[36:39], v31 offset:17408
    v_mfma_f32_16x16x32_bf16 v[104:107], a[20:23], v[48:51], v[104:107]
    ds_read_b128 v[40:43], v19 offset:3072
    v_mfma_f32_16x16x32_bf16 v[108:111], a[20:23], v[52:55], v[108:111]
    ds_read_b128 v[44:47], v19 offset:17408
    v_mfma_f32_16x16x32_bf16 v[112:115], a[20:23], v[56:59], v[112:115]
    ds_read_b64_tr_b16 a[204:205], v29 offset:12736
    ds_read_b64_tr_b16 a[206:207], v29 offset:12992
    v_mfma_f32_16x16x32_bf16 v[116:119], a[20:23], v[60:63], v[116:119]
    buffer_load_dwordx4 v13, s[16:19], s39 offen offset:3168 lds
    v_mfma_f32_16x16x32_bf16 v[120:123], a[24:27], v[48:51], v[120:123]
    ds_read_b64_tr_b16 a[208:209], v28 offset:16896
    ds_read_b64_tr_b16 a[210:211], v28 offset:17152
    v_mfma_f32_16x16x32_bf16 v[124:127], a[24:27], v[52:55], v[124:127]
    ds_read_b64_tr_b16 a[212:213], v29 offset:16896
    ds_read_b64_tr_b16 a[214:215], v29 offset:17152
    s_mul_i32 s39, s69, 28
    s_add_u32 s39, s39, s61
    s_add_u32 m0, s60, 0
    v_mfma_f32_16x16x32_bf16 v[128:131], a[24:27], v[56:59], v[128:131]
    buffer_load_dwordx4 v10, s[16:19], s39 offen offset:0 lds
    v_mfma_f32_16x16x32_bf16 v[132:135], a[24:27], v[60:63], v[132:135]
    ds_read_b64_tr_b16 a[216:217], v29 offset:16928
    ds_read_b64_tr_b16 a[218:219], v29 offset:17184
    v_mfma_f32_16x16x32_bf16 v[136:139], a[28:31], v[48:51], v[136:139]
    buffer_load_dwordx4 v11, s[16:19], s39 offen offset:1056 lds
    v_mfma_f32_16x16x32_bf16 v[140:143], a[28:31], v[52:55], v[140:143]
    ds_read_b64_tr_b16 a[220:221], v29 offset:16960
    ds_read_b64_tr_b16 a[222:223], v29 offset:17216
    v_mfma_f32_16x16x32_bf16 v[144:147], a[28:31], v[56:59], v[144:147]
    v_mfma_f32_16x16x32_bf16 v[148:151], a[28:31], v[60:63], v[148:151]
    buffer_load_dwordx4 v12, s[16:19], s39 offen offset:2112 lds
    s_waitcnt lgkmcnt(10)
    v_mfma_f32_16x16x32_bf16 v[96:99], a[32:35], v[64:67], v[96:99]
    ds_read_b128 v[48:51], v31 offset:4096
    v_mfma_f32_16x16x32_bf16 v[100:103], a[32:35], v[68:71], v[100:103]
    ds_read_b128 v[52:55], v31 offset:18432
    v_mfma_f32_16x16x32_bf16 v[104:107], a[36:39], v[64:67], v[104:107]
    ds_read_b128 v[56:59], v19 offset:4096
    v_mfma_f32_16x16x32_bf16 v[108:111], a[36:39], v[68:71], v[108:111]
    ds_read_b128 v[60:63], v19 offset:18432
    v_mfma_f32_16x16x32_bf16 v[112:115], a[36:39], v[72:75], v[112:115]
    v_mfma_f32_16x16x32_bf16 v[116:119], a[36:39], v[76:79], v[116:119]
    buffer_load_dwordx4 v13, s[16:19], s39 offen offset:3168 lds
    v_mfma_f32_16x16x32_bf16 v[120:123], a[40:43], v[64:67], v[120:123]
    v_mfma_f32_16x16x32_bf16 v[124:127], a[40:43], v[68:71], v[124:127]
    s_mul_i32 s39, s70, 28
    s_add_u32 s39, s39, s61
    s_add_u32 m0, s60, 4224
    v_mfma_f32_16x16x32_bf16 v[128:131], a[40:43], v[72:75], v[128:131]
    buffer_load_dwordx4 v10, s[16:19], s39 offen offset:0 lds
    v_mfma_f32_16x16x32_bf16 v[132:135], a[40:43], v[76:79], v[132:135]
    v_mfma_f32_16x16x32_bf16 v[136:139], a[44:47], v[64:67], v[136:139]
    v_mfma_f32_16x16x32_bf16 v[140:143], a[44:47], v[68:71], v[140:143]
    v_mfma_f32_16x16x32_bf16 v[144:147], a[44:47], v[72:75], v[144:147]
    v_mfma_f32_16x16x32_bf16 v[148:151], a[44:47], v[76:79], v[148:151]
    buffer_load_dwordx4 v11, s[16:19], s39 offen offset:1056 lds
    s_waitcnt lgkmcnt(4)
    v_mfma_f32_16x16x32_bf16 v[96:99], a[48:51], v[32:35], v[96:99]
    ds_read_b128 v[64:67], v31 offset:5120
    v_mfma_f32_16x16x32_bf16 v[100:103], a[48:51], v[36:39], v[100:103]
    ds_read_b128 v[68:71], v31 offset:19456
    v_mfma_f32_16x16x32_bf16 v[104:107], a[52:55], v[32:35], v[104:107]
    ds_read_b128 v[72:75], v19 offset:5120
    v_mfma_f32_16x16x32_bf16 v[108:111], a[52:55], v[36:39], v[108:111]
    ds_read_b128 v[76:79], v19 offset:19456
    v_mfma_f32_16x16x32_bf16 v[112:115], a[52:55], v[40:43], v[112:115]
    v_mfma_f32_16x16x32_bf16 v[116:119], a[52:55], v[44:47], v[116:119]
    buffer_load_dwordx4 v12, s[16:19], s39 offen offset:2112 lds
    v_mfma_f32_16x16x32_bf16 v[120:123], a[56:59], v[32:35], v[120:123]
    v_mfma_f32_16x16x32_bf16 v[124:127], a[56:59], v[36:39], v[124:127]
    v_mfma_f32_16x16x32_bf16 v[128:131], a[56:59], v[40:43], v[128:131]
    buffer_load_dwordx4 v13, s[16:19], s39 offen offset:3168 lds
    v_mfma_f32_16x16x32_bf16 v[132:135], a[56:59], v[44:47], v[132:135]
    s_mul_i32 s39, s71, 28
    s_add_u32 s39, s39, s61
    s_add_u32 m0, s60, 8448
    v_mfma_f32_16x16x32_bf16 v[136:139], a[60:63], v[32:35], v[136:139]
    v_mfma_f32_16x16x32_bf16 v[140:143], a[60:63], v[36:39], v[140:143]
    v_mfma_f32_16x16x32_bf16 v[144:147], a[60:63], v[40:43], v[144:147]
    v_mfma_f32_16x16x32_bf16 v[148:151], a[60:63], v[44:47], v[148:151]
    buffer_load_dwordx4 v10, s[16:19], s39 offen offset:0 lds
    s_waitcnt lgkmcnt(4)
    v_mfma_f32_16x16x32_bf16 v[96:99], a[64:67], v[48:51], v[96:99]
    ds_read_b128 v[32:35], v31 offset:6144
    v_mfma_f32_16x16x32_bf16 v[100:103], a[64:67], v[52:55], v[100:103]
    ds_read_b128 v[36:39], v31 offset:20480
    v_mfma_f32_16x16x32_bf16 v[104:107], a[68:71], v[48:51], v[104:107]
    ds_read_b128 v[40:43], v19 offset:6144
    v_mfma_f32_16x16x32_bf16 v[108:111], a[68:71], v[52:55], v[108:111]
    ds_read_b128 v[44:47], v19 offset:20480
    v_mfma_f32_16x16x32_bf16 v[112:115], a[68:71], v[56:59], v[112:115]
    s_waitcnt vmcnt(9)
    v_mfma_f32_16x16x32_bf16 v[116:119], a[68:71], v[60:63], v[116:119]
    buffer_load_dwordx4 v11, s[16:19], s39 offen offset:1056 lds
    v_mfma_f32_16x16x32_bf16 v[120:123], a[72:75], v[48:51], v[120:123]
    ds_read_b64_tr_b16 a[0:1], v30 offset:21120
    ds_read_b64_tr_b16 a[2:3], v30 offset:21376
    v_mfma_f32_16x16x32_bf16 v[124:127], a[72:75], v[52:55], v[124:127]
    ds_read_b64_tr_b16 a[4:5], v30 offset:21152
    ds_read_b64_tr_b16 a[6:7], v30 offset:21408
    v_mfma_f32_16x16x32_bf16 v[128:131], a[72:75], v[56:59], v[128:131]
    buffer_load_dwordx4 v12, s[16:19], s39 offen offset:2112 lds
    v_mfma_f32_16x16x32_bf16 v[132:135], a[72:75], v[60:63], v[132:135]
    ds_read_b64_tr_b16 a[8:9], v30 offset:21184
    ds_read_b64_tr_b16 a[10:11], v30 offset:21440
    v_mfma_f32_16x16x32_bf16 v[136:139], a[76:79], v[48:51], v[136:139]
    v_mfma_f32_16x16x32_bf16 v[140:143], a[76:79], v[52:55], v[140:143]
    ds_read_b64_tr_b16 a[12:13], v30 offset:21216
    ds_read_b64_tr_b16 a[14:15], v30 offset:21472
    v_mfma_f32_16x16x32_bf16 v[144:147], a[76:79], v[56:59], v[144:147]
    v_mfma_f32_16x16x32_bf16 v[148:151], a[76:79], v[60:63], v[148:151]
    buffer_load_dwordx4 v13, s[16:19], s39 offen offset:3168 lds
    s_waitcnt lgkmcnt(12)
    v_mfma_f32_16x16x32_bf16 v[96:99], a[80:83], v[64:67], v[96:99]
    ds_read_b128 v[48:51], v31 offset:7168
    v_mfma_f32_16x16x32_bf16 v[100:103], a[80:83], v[68:71], v[100:103]
    ds_read_b128 v[52:55], v31 offset:21504
    v_mfma_f32_16x16x32_bf16 v[104:107], a[84:87], v[64:67], v[104:107]
    ds_read_b128 v[56:59], v19 offset:7168
    v_mfma_f32_16x16x32_bf16 v[108:111], a[84:87], v[68:71], v[108:111]
    ds_read_b128 v[60:63], v19 offset:21504
    s_mul_i32 s39, s72, 28
    s_add_u32 s39, s39, s61
    s_add_u32 m0, s60, 12672
    v_mfma_f32_16x16x32_bf16 v[112:115], a[84:87], v[72:75], v[112:115]
    s_waitcnt vmcnt(8)
    v_mfma_f32_16x16x32_bf16 v[116:119], a[84:87], v[76:79], v[116:119]
    buffer_load_dwordx4 v10, s[16:19], s39 offen offset:0 lds
    v_mfma_f32_16x16x32_bf16 v[120:123], a[88:91], v[64:67], v[120:123]
    ds_read_b64_tr_b16 a[16:17], v30 offset:0
    ds_read_b64_tr_b16 a[18:19], v30 offset:256
    v_mfma_f32_16x16x32_bf16 v[124:127], a[88:91], v[68:71], v[124:127]
    ds_read_b64_tr_b16 a[20:21], v30 offset:32
    ds_read_b64_tr_b16 a[22:23], v30 offset:288
    v_mfma_f32_16x16x32_bf16 v[128:131], a[88:91], v[72:75], v[128:131]
    buffer_load_dwordx4 v11, s[16:19], s39 offen offset:1056 lds
    v_mfma_f32_16x16x32_bf16 v[132:135], a[88:91], v[76:79], v[132:135]
    ds_read_b64_tr_b16 a[24:25], v30 offset:64
    ds_read_b64_tr_b16 a[26:27], v30 offset:320
    v_mfma_f32_16x16x32_bf16 v[136:139], a[92:95], v[64:67], v[136:139]
    buffer_load_dwordx4 v12, s[16:19], s39 offen offset:2112 lds
    v_mfma_f32_16x16x32_bf16 v[140:143], a[92:95], v[68:71], v[140:143]
    ds_read_b64_tr_b16 a[28:29], v30 offset:96
    ds_read_b64_tr_b16 a[30:31], v30 offset:352
    v_mfma_f32_16x16x32_bf16 v[144:147], a[92:95], v[72:75], v[144:147]
    v_mfma_f32_16x16x32_bf16 v[148:151], a[92:95], v[76:79], v[148:151]
    s_waitcnt lgkmcnt(15)
    v_mfma_f32_16x16x32_bf16 v[96:99], a[96:99], v[32:35], v[96:99]
    ds_read_b128 v[64:67], v31 offset:8192
    v_mfma_f32_16x16x32_bf16 v[100:103], a[96:99], v[36:39], v[100:103]
    ds_read_b128 v[68:71], v31 offset:22528
    v_mfma_f32_16x16x32_bf16 v[104:107], a[100:103], v[32:35], v[104:107]
    ds_read_b128 v[72:75], v19 offset:8192
    v_mfma_f32_16x16x32_bf16 v[108:111], a[100:103], v[36:39], v[108:111]
    ds_read_b128 v[76:79], v19 offset:22528
    v_mfma_f32_16x16x32_bf16 v[112:115], a[100:103], v[40:43], v[112:115]
    s_waitcnt vmcnt(7)
    v_mfma_f32_16x16x32_bf16 v[116:119], a[100:103], v[44:47], v[116:119]
    buffer_load_dwordx4 v13, s[16:19], s39 offen offset:3168 lds
    v_mfma_f32_16x16x32_bf16 v[120:123], a[104:107], v[32:35], v[120:123]
    ds_read_b64_tr_b16 a[32:33], v30 offset:4224
    ds_read_b64_tr_b16 a[34:35], v30 offset:4480
    v_mfma_f32_16x16x32_bf16 v[124:127], a[104:107], v[36:39], v[124:127]
    ds_read_b64_tr_b16 a[36:37], v30 offset:4256
    ds_read_b64_tr_b16 a[38:39], v30 offset:4512
    s_mul_i32 s39, s73, 28
    s_add_u32 s39, s39, s61
    s_add_u32 m0, s60, 16896
    v_mfma_f32_16x16x32_bf16 v[128:131], a[104:107], v[40:43], v[128:131]
    buffer_load_dwordx4 v10, s[16:19], s39 offen offset:0 lds
    v_mfma_f32_16x16x32_bf16 v[132:135], a[104:107], v[44:47], v[132:135]
    ds_read_b64_tr_b16 a[40:41], v30 offset:4288
    ds_read_b64_tr_b16 a[42:43], v30 offset:4544
    v_mfma_f32_16x16x32_bf16 v[136:139], a[108:111], v[32:35], v[136:139]
    buffer_load_dwordx4 v11, s[16:19], s39 offen offset:1056 lds
    v_mfma_f32_16x16x32_bf16 v[140:143], a[108:111], v[36:39], v[140:143]
    ds_read_b64_tr_b16 a[44:45], v30 offset:4320
    ds_read_b64_tr_b16 a[46:47], v30 offset:4576
    v_mfma_f32_16x16x32_bf16 v[144:147], a[108:111], v[40:43], v[144:147]
    v_mfma_f32_16x16x32_bf16 v[148:151], a[108:111], v[44:47], v[148:151]
    buffer_load_dwordx4 v12, s[16:19], s39 offen offset:2112 lds
    s_waitcnt lgkmcnt(15)
    v_mfma_f32_16x16x32_bf16 v[96:99], a[112:115], v[48:51], v[96:99]
    ds_read_b128 v[32:35], v31 offset:9216
    v_mfma_f32_16x16x32_bf16 v[100:103], a[112:115], v[52:55], v[100:103]
    ds_read_b128 v[36:39], v31 offset:23552
    v_mfma_f32_16x16x32_bf16 v[104:107], a[116:119], v[48:51], v[104:107]
    ds_read_b128 v[40:43], v19 offset:9216
    v_mfma_f32_16x16x32_bf16 v[108:111], a[116:119], v[52:55], v[108:111]
    ds_read_b128 v[44:47], v19 offset:23552
    v_mfma_f32_16x16x32_bf16 v[112:115], a[116:119], v[56:59], v[112:115]
    v_mfma_f32_16x16x32_bf16 v[116:119], a[116:119], v[60:63], v[116:119]
    buffer_load_dwordx4 v13, s[16:19], s39 offen offset:3168 lds
    v_mfma_f32_16x16x32_bf16 v[120:123], a[120:123], v[48:51], v[120:123]
    v_mfma_f32_16x16x32_bf16 v[124:127], a[120:123], v[52:55], v[124:127]
    s_mul_i32 s39, s74, 28
    s_add_u32 s39, s39, s61
    s_add_u32 m0, s60, 21120
    v_mfma_f32_16x16x32_bf16 v[128:131], a[120:123], v[56:59], v[128:131]
    buffer_load_dwordx4 v10, s[16:19], s39 offen offset:0 lds
    v_mfma_f32_16x16x32_bf16 v[132:135], a[120:123], v[60:63], v[132:135]
    v_mfma_f32_16x16x32_bf16 v[136:139], a[124:127], v[48:51], v[136:139]
    v_mfma_f32_16x16x32_bf16 v[140:143], a[124:127], v[52:55], v[140:143]
    v_mfma_f32_16x16x32_bf16 v[144:147], a[124:127], v[56:59], v[144:147]
    v_mfma_f32_16x16x32_bf16 v[148:151], a[124:127], v[60:63], v[148:151]
    buffer_load_dwordx4 v11, s[16:19], s39 offen offset:1056 lds
    s_waitcnt lgkmcnt(12)
    v_mfma_f32_16x16x32_bf16 v[96:99], a[128:131], v[64:67], v[96:99]
    ds_read_b128 v[48:51], v31 offset:10240
    v_mfma_f32_16x16x32_bf16 v[100:103], a[128:131], v[68:71], v[100:103]
    ds_read_b128 v[52:55], v31 offset:24576
    v_mfma_f32_16x16x32_bf16 v[104:107], a[132:135], v[64:67], v[104:107]
    ds_read_b128 v[56:59], v19 offset:10240
    v_mfma_f32_16x16x32_bf16 v[108:111], a[132:135], v[68:71], v[108:111]
    ds_read_b128 v[60:63], v19 offset:24576
    v_mfma_f32_16x16x32_bf16 v[112:115], a[132:135], v[72:75], v[112:115]
    s_waitcnt vmcnt(10)
    v_mfma_f32_16x16x32_bf16 v[116:119], a[132:135], v[76:79], v[116:119]
    buffer_load_dwordx4 v12, s[16:19], s39 offen offset:2112 lds
    v_mfma_f32_16x16x32_bf16 v[120:123], a[136:139], v[64:67], v[120:123]
    ds_read_b64_tr_b16 a[48:49], v30 offset:8448
    ds_read_b64_tr_b16 a[50:51], v30 offset:8704
    v_mfma_f32_16x16x32_bf16 v[124:127], a[136:139], v[68:71], v[124:127]
    ds_read_b64_tr_b16 a[52:53], v30 offset:8480
    ds_read_b64_tr_b16 a[54:55], v30 offset:8736
    v_mfma_f32_16x16x32_bf16 v[128:131], a[136:139], v[72:75], v[128:131]
    buffer_load_dwordx4 v13, s[16:19], s39 offen offset:3168 lds
    v_mfma_f32_16x16x32_bf16 v[132:135], a[136:139], v[76:79], v[132:135]
    ds_read_b64_tr_b16 a[56:57], v30 offset:8512
    ds_read_b64_tr_b16 a[58:59], v30 offset:8768
    s_mul_i32 s39, s75, 28
    s_add_u32 s39, s39, s61
    s_add_u32 m0, s60, 0
    v_mfma_f32_16x16x32_bf16 v[136:139], a[140:143], v[64:67], v[136:139]
    v_mfma_f32_16x16x32_bf16 v[140:143], a[140:143], v[68:71], v[140:143]
    ds_read_b64_tr_b16 a[60:61], v30 offset:8544
    ds_read_b64_tr_b16 a[62:63], v30 offset:8800
    v_mfma_f32_16x16x32_bf16 v[144:147], a[140:143], v[72:75], v[144:147]
    v_mfma_f32_16x16x32_bf16 v[148:151], a[140:143], v[76:79], v[148:151]
    buffer_load_dwordx4 v10, s[16:19], s39 offen offset:0 lds
    s_waitcnt lgkmcnt(12)
    v_mfma_f32_16x16x32_bf16 v[96:99], a[144:147], v[32:35], v[96:99]
    ds_read_b128 v[64:67], v31 offset:11264
    v_mfma_f32_16x16x32_bf16 v[100:103], a[144:147], v[36:39], v[100:103]
    ds_read_b128 v[68:71], v31 offset:25600
    v_mfma_f32_16x16x32_bf16 v[104:107], a[148:151], v[32:35], v[104:107]
    ds_read_b128 v[72:75], v19 offset:11264
    v_mfma_f32_16x16x32_bf16 v[108:111], a[148:151], v[36:39], v[108:111]
    ds_read_b128 v[76:79], v19 offset:25600
    v_mfma_f32_16x16x32_bf16 v[112:115], a[148:151], v[40:43], v[112:115]
    s_waitcnt vmcnt(9)
    v_mfma_f32_16x16x32_bf16 v[116:119], a[148:151], v[44:47], v[116:119]
    buffer_load_dwordx4 v11, s[16:19], s39 offen offset:1056 lds
    v_mfma_f32_16x16x32_bf16 v[120:123], a[152:155], v[32:35], v[120:123]
    ds_read_b64_tr_b16 a[64:65], v30 offset:12672
    ds_read_b64_tr_b16 a[66:67], v30 offset:12928
    v_mfma_f32_16x16x32_bf16 v[124:127], a[152:155], v[36:39], v[124:127]
    ds_read_b64_tr_b16 a[68:69], v30 offset:12704
    ds_read_b64_tr_b16 a[70:71], v30 offset:12960
    v_mfma_f32_16x16x32_bf16 v[128:131], a[152:155], v[40:43], v[128:131]
    buffer_load_dwordx4 v12, s[16:19], s39 offen offset:2112 lds
    v_mfma_f32_16x16x32_bf16 v[132:135], a[152:155], v[44:47], v[132:135]
    ds_read_b64_tr_b16 a[72:73], v30 offset:12736
    ds_read_b64_tr_b16 a[74:75], v30 offset:12992
    v_mfma_f32_16x16x32_bf16 v[136:139], a[156:159], v[32:35], v[136:139]
    v_mfma_f32_16x16x32_bf16 v[140:143], a[156:159], v[36:39], v[140:143]
    ds_read_b64_tr_b16 a[76:77], v30 offset:12768
    ds_read_b64_tr_b16 a[78:79], v30 offset:13024
    v_mfma_f32_16x16x32_bf16 v[144:147], a[156:159], v[40:43], v[144:147]
    v_mfma_f32_16x16x32_bf16 v[148:151], a[156:159], v[44:47], v[148:151]
    buffer_load_dwordx4 v13, s[16:19], s39 offen offset:3168 lds
    s_waitcnt lgkmcnt(15)
    v_mfma_f32_16x16x32_bf16 v[96:99], a[160:163], v[48:51], v[96:99]
    ds_read_b128 v[32:35], v31 offset:12288
    v_mfma_f32_16x16x32_bf16 v[100:103], a[160:163], v[52:55], v[100:103]
    ds_read_b128 v[36:39], v31 offset:26624
    v_mfma_f32_16x16x32_bf16 v[104:107], a[164:167], v[48:51], v[104:107]
    ds_read_b128 v[40:43], v19 offset:12288
    v_mfma_f32_16x16x32_bf16 v[108:111], a[164:167], v[52:55], v[108:111]
    ds_read_b128 v[44:47], v19 offset:26624
    s_mul_i32 s39, s76, 28
    s_add_u32 s39, s39, s61
    s_add_u32 m0, s60, 4224
    v_mfma_f32_16x16x32_bf16 v[112:115], a[164:167], v[56:59], v[112:115]
    v_mfma_f32_16x16x32_bf16 v[116:119], a[164:167], v[60:63], v[116:119]
    buffer_load_dwordx4 v10, s[16:19], s39 offen offset:0 lds
    v_mfma_f32_16x16x32_bf16 v[120:123], a[168:171], v[48:51], v[120:123]
    v_mfma_f32_16x16x32_bf16 v[124:127], a[168:171], v[52:55], v[124:127]
    v_mfma_f32_16x16x32_bf16 v[128:131], a[168:171], v[56:59], v[128:131]
    buffer_load_dwordx4 v11, s[16:19], s39 offen offset:1056 lds
    v_mfma_f32_16x16x32_bf16 v[132:135], a[168:171], v[60:63], v[132:135]
    v_mfma_f32_16x16x32_bf16 v[136:139], a[172:175], v[48:51], v[136:139]
    buffer_load_dwordx4 v12, s[16:19], s39 offen offset:2112 lds
    v_mfma_f32_16x16x32_bf16 v[140:143], a[172:175], v[52:55], v[140:143]
    v_mfma_f32_16x16x32_bf16 v[144:147], a[172:175], v[56:59], v[144:147]
    v_mfma_f32_16x16x32_bf16 v[148:151], a[172:175], v[60:63], v[148:151]
    s_waitcnt lgkmcnt(12)
    v_mfma_f32_16x16x32_bf16 v[96:99], a[176:179], v[64:67], v[96:99]
    ds_read_b128 v[48:51], v31 offset:13312
    v_mfma_f32_16x16x32_bf16 v[100:103], a[176:179], v[68:71], v[100:103]
    ds_read_b128 v[52:55], v31 offset:27648
    v_mfma_f32_16x16x32_bf16 v[104:107], a[180:183], v[64:67], v[104:107]
    ds_read_b128 v[56:59], v19 offset:13312
    v_mfma_f32_16x16x32_bf16 v[108:111], a[180:183], v[68:71], v[108:111]
    ds_read_b128 v[60:63], v19 offset:27648
    v_mfma_f32_16x16x32_bf16 v[112:115], a[180:183], v[72:75], v[112:115]
    v_mfma_f32_16x16x32_bf16 v[116:119], a[180:183], v[76:79], v[116:119]
    buffer_load_dwordx4 v13, s[16:19], s39 offen offset:3168 lds
    v_mfma_f32_16x16x32_bf16 v[120:123], a[184:187], v[64:67], v[120:123]
    v_mfma_f32_16x16x32_bf16 v[124:127], a[184:187], v[68:71], v[124:127]
    s_mul_i32 s39, s77, 28
    s_add_u32 s39, s39, s61
    s_add_u32 m0, s60, 8448
    v_mfma_f32_16x16x32_bf16 v[128:131], a[184:187], v[72:75], v[128:131]
    buffer_load_dwordx4 v10, s[16:19], s39 offen offset:0 lds
    v_mfma_f32_16x16x32_bf16 v[132:135], a[184:187], v[76:79], v[132:135]
    v_mfma_f32_16x16x32_bf16 v[136:139], a[188:191], v[64:67], v[136:139]
    buffer_load_dwordx4 v11, s[16:19], s39 offen offset:1056 lds
    v_mfma_f32_16x16x32_bf16 v[140:143], a[188:191], v[68:71], v[140:143]
    v_mfma_f32_16x16x32_bf16 v[144:147], a[188:191], v[72:75], v[144:147]
    v_mfma_f32_16x16x32_bf16 v[148:151], a[188:191], v[76:79], v[148:151]
    s_waitcnt lgkmcnt(4)
    v_mfma_f32_16x16x32_bf16 v[96:99], a[192:195], v[32:35], v[96:99]
    v_mfma_f32_16x16x32_bf16 v[100:103], a[192:195], v[36:39], v[100:103]
    v_mfma_f32_16x16x32_bf16 v[104:107], a[196:199], v[32:35], v[104:107]
    v_mfma_f32_16x16x32_bf16 v[108:111], a[196:199], v[36:39], v[108:111]
    v_mfma_f32_16x16x32_bf16 v[112:115], a[196:199], v[40:43], v[112:115]
    v_mfma_f32_16x16x32_bf16 v[116:119], a[196:199], v[44:47], v[116:119]
    buffer_load_dwordx4 v12, s[16:19], s39 offen offset:2112 lds
    v_mfma_f32_16x16x32_bf16 v[120:123], a[200:203], v[32:35], v[120:123]
    v_mfma_f32_16x16x32_bf16 v[124:127], a[200:203], v[36:39], v[124:127]
    v_mfma_f32_16x16x32_bf16 v[128:131], a[200:203], v[40:43], v[128:131]
    buffer_load_dwordx4 v13, s[16:19], s39 offen offset:3168 lds
    v_mfma_f32_16x16x32_bf16 v[132:135], a[200:203], v[44:47], v[132:135]
    s_mul_i32 s39, s78, 28
    s_add_u32 s39, s39, s61
    s_add_u32 m0, s60, 12672
    v_mfma_f32_16x16x32_bf16 v[136:139], a[204:207], v[32:35], v[136:139]
    buffer_load_dwordx4 v10, s[16:19], s39 offen offset:0 lds
    v_mfma_f32_16x16x32_bf16 v[140:143], a[204:207], v[36:39], v[140:143]
    v_mfma_f32_16x16x32_bf16 v[144:147], a[204:207], v[40:43], v[144:147]
    v_mfma_f32_16x16x32_bf16 v[148:151], a[204:207], v[44:47], v[148:151]
    buffer_load_dwordx4 v11, s[16:19], s39 offen offset:1056 lds
    s_waitcnt lgkmcnt(0)
    v_mfma_f32_16x16x32_bf16 v[96:99], a[208:211], v[48:51], v[96:99]
    v_mfma_f32_16x16x32_bf16 v[100:103], a[208:211], v[52:55], v[100:103]
    v_mfma_f32_16x16x32_bf16 v[104:107], a[212:215], v[48:51], v[104:107]
    v_mfma_f32_16x16x32_bf16 v[108:111], a[212:215], v[52:55], v[108:111]
    v_mfma_f32_16x16x32_bf16 v[112:115], a[212:215], v[56:59], v[112:115]
    v_mfma_f32_16x16x32_bf16 v[116:119], a[212:215], v[60:63], v[116:119]
    buffer_load_dwordx4 v12, s[16:19], s39 offen offset:2112 lds
    v_mfma_f32_16x16x32_bf16 v[120:123], a[216:219], v[48:51], v[120:123]
    v_mfma_f32_16x16x32_bf16 v[124:127], a[216:219], v[52:55], v[124:127]
    v_mfma_f32_16x16x32_bf16 v[128:131], a[216:219], v[56:59], v[128:131]
    buffer_load_dwordx4 v13, s[16:19], s39 offen offset:3168 lds
    v_mfma_f32_16x16x32_bf16 v[132:135], a[216:219], v[60:63], v[132:135]
    v_mfma_f32_16x16x32_bf16 v[136:139], a[220:223], v[48:51], v[136:139]
    v_mfma_f32_16x16x32_bf16 v[140:143], a[220:223], v[52:55], v[140:143]
    v_mfma_f32_16x16x32_bf16 v[144:147], a[220:223], v[56:59], v[144:147]
    v_mfma_f32_16x16x32_bf16 v[148:151], a[220:223], v[60:63], v[148:151]
    v_add_u32 v28, s60, v18
    v_add_u32 v29, s57, v18
    s_barrier
    v_pk_mul_f32 v[32:33], v[96:97], v[96:97]
    v_pk_mul_f32 v[34:35], v[98:99], v[98:99]
    v_pk_mul_f32 v[36:37], v[100:101], v[100:101]
    v_pk_mul_f32 v[38:39], v[102:103], v[102:103]
    v_pk_fma_f32 v[32:33], v[32:33], s[56:57], v[26:27] op_sel_hi:[1,0,1]
    v_pk_fma_f32 v[34:35], v[34:35], s[56:57], v[26:27] op_sel_hi:[1,0,1]
    v_pk_fma_f32 v[36:37], v[36:37], s[56:57], v[26:27] op_sel_hi:[1,0,1]
    v_pk_fma_f32 v[38:39], v[38:39], s[56:57], v[26:27] op_sel_hi:[1,0,1]
    v_pk_mul_f32 v[32:33], v[32:33], v[96:97]
    v_pk_mul_f32 v[34:35], v[34:35], v[98:99]
    v_pk_mul_f32 v[36:37], v[36:37], v[100:101]
    v_pk_mul_f32 v[38:39], v[38:39], v[102:103]
    v_exp_f32 v32, v32
    v_exp_f32 v33, v33
    v_exp_f32 v34, v34
    v_exp_f32 v35, v35
    v_exp_f32 v36, v36
    v_exp_f32 v37, v37
    v_exp_f32 v38, v38
    s_mul_i32 s39, s79, 28
    s_add_u32 s39, s39, s61
    s_add_u32 m0, s57, 0
    v_exp_f32 v39, v39
    v_pk_add_f32 v[32:33], v[32:33], 1.0 op_sel_hi:[1,0]
    v_pk_add_f32 v[34:35], v[34:35], 1.0 op_sel_hi:[1,0]
    v_pk_add_f32 v[36:37], v[36:37], 1.0 op_sel_hi:[1,0]
    v_pk_add_f32 v[38:39], v[38:39], 1.0 op_sel_hi:[1,0]
    v_rcp_f32 v32, v32
    v_rcp_f32 v33, v33
    v_rcp_f32 v34, v34
    v_rcp_f32 v35, v35
    v_rcp_f32 v36, v36
    v_rcp_f32 v37, v37
    v_rcp_f32 v38, v38
    v_rcp_f32 v39, v39
    v_pk_mul_f32 v[96:97], v[96:97], v[32:33]
    v_pk_mul_f32 v[98:99], v[98:99], v[34:35]
    v_pk_mul_f32 v[100:101], v[100:101], v[36:37]
    v_pk_mul_f32 v[102:103], v[102:103], v[38:39]
    v_cvt_pk_bf16_f32 v160, v96, v97
    buffer_load_dwordx4 v10, s[16:19], s39 offen offset:0 lds
    v_cvt_pk_bf16_f32 v161, v98, v99
    v_cvt_pk_bf16_f32 v162, v100, v101
    v_cvt_pk_bf16_f32 v163, v102, v103
    s_nop 0
    v_permlane16_swap_b32 v160, v162
    v_permlane16_swap_b32 v161, v163
    buffer_store_dwordx4 v[160:163], v24, s[20:23], s52 offen offset:0 sc1
    v_pk_mul_f32 v[32:33], v[104:105], v[104:105]
    v_pk_mul_f32 v[34:35], v[106:107], v[106:107]
    v_pk_mul_f32 v[36:37], v[108:109], v[108:109]
    v_pk_mul_f32 v[38:39], v[110:111], v[110:111]
    v_pk_fma_f32 v[32:33], v[32:33], s[56:57], v[26:27] op_sel_hi:[1,0,1]
    v_pk_fma_f32 v[34:35], v[34:35], s[56:57], v[26:27] op_sel_hi:[1,0,1]
    v_pk_fma_f32 v[36:37], v[36:37], s[56:57], v[26:27] op_sel_hi:[1,0,1]
    v_pk_fma_f32 v[38:39], v[38:39], s[56:57], v[26:27] op_sel_hi:[1,0,1]
    v_pk_mul_f32 v[32:33], v[32:33], v[104:105]
    v_pk_mul_f32 v[34:35], v[34:35], v[106:107]
    v_pk_mul_f32 v[36:37], v[36:37], v[108:109]
    v_pk_mul_f32 v[38:39], v[38:39], v[110:111]
    buffer_load_dwordx4 v11, s[16:19], s39 offen offset:1056 lds
    v_exp_f32 v32, v32
    v_exp_f32 v33, v33
    v_exp_f32 v34, v34
    v_exp_f32 v35, v35
    v_exp_f32 v36, v36
    v_exp_f32 v37, v37
    v_exp_f32 v38, v38
    v_exp_f32 v39, v39
    v_pk_add_f32 v[32:33], v[32:33], 1.0 op_sel_hi:[1,0]
    v_pk_add_f32 v[34:35], v[34:35], 1.0 op_sel_hi:[1,0]
    v_pk_add_f32 v[36:37], v[36:37], 1.0 op_sel_hi:[1,0]
    v_pk_add_f32 v[38:39], v[38:39], 1.0 op_sel_hi:[1,0]
    v_rcp_f32 v32, v32
    v_rcp_f32 v33, v33
    v_rcp_f32 v34, v34
    v_rcp_f32 v35, v35
    v_rcp_f32 v36, v36
    v_rcp_f32 v37, v37
    buffer_load_dwordx4 v12, s[16:19], s39 offen offset:2112 lds
    v_rcp_f32 v38, v38
    v_rcp_f32 v39, v39
    v_pk_mul_f32 v[104:105], v[104:105], v[32:33]
    v_pk_mul_f32 v[106:107], v[106:107], v[34:35]
    v_pk_mul_f32 v[108:109], v[108:109], v[36:37]
    v_pk_mul_f32 v[110:111], v[110:111], v[38:39]
    v_cvt_pk_bf16_f32 v164, v104, v105
    v_cvt_pk_bf16_f32 v165, v106, v107
    v_cvt_pk_bf16_f32 v166, v108, v109
    v_cvt_pk_bf16_f32 v167, v110, v111
    s_nop 0
    v_permlane16_swap_b32 v164, v166
    v_permlane16_swap_b32 v165, v167
    buffer_store_dwordx4 v[164:167], v24, s[20:23], s58 offen offset:0 sc1
    v_pk_mul_f32 v[32:33], v[112:113], v[112:113]
    v_pk_mul_f32 v[34:35], v[114:115], v[114:115]
    v_pk_mul_f32 v[36:37], v[116:117], v[116:117]
    v_pk_mul_f32 v[38:39], v[118:119], v[118:119]
    v_pk_fma_f32 v[32:33], v[32:33], s[56:57], v[26:27] op_sel_hi:[1,0,1]
    buffer_load_dwordx4 v13, s[16:19], s39 offen offset:3168 lds
    v_pk_fma_f32 v[34:35], v[34:35], s[56:57], v[26:27] op_sel_hi:[1,0,1]
    v_pk_fma_f32 v[36:37], v[36:37], s[56:57], v[26:27] op_sel_hi:[1,0,1]
    v_pk_fma_f32 v[38:39], v[38:39], s[56:57], v[26:27] op_sel_hi:[1,0,1]
    v_pk_mul_f32 v[32:33], v[32:33], v[112:113]
    v_pk_mul_f32 v[34:35], v[34:35], v[114:115]
    v_pk_mul_f32 v[36:37], v[36:37], v[116:117]
    v_pk_mul_f32 v[38:39], v[38:39], v[118:119]
    v_exp_f32 v32, v32
    v_exp_f32 v33, v33
    v_exp_f32 v34, v34
    v_exp_f32 v35, v35
    v_exp_f32 v36, v36
    v_exp_f32 v37, v37
    v_exp_f32 v38, v38
    v_exp_f32 v39, v39
    v_pk_add_f32 v[32:33], v[32:33], 1.0 op_sel_hi:[1,0]
    v_pk_add_f32 v[34:35], v[34:35], 1.0 op_sel_hi:[1,0]
    v_pk_add_f32 v[36:37], v[36:37], 1.0 op_sel_hi:[1,0]
    s_mul_i32 s39, s80, 28
    s_add_u32 s39, s39, s61
    s_add_u32 m0, s57, 4224
    v_pk_add_f32 v[38:39], v[38:39], 1.0 op_sel_hi:[1,0]
    v_rcp_f32 v32, v32
    v_rcp_f32 v33, v33
    v_rcp_f32 v34, v34
    v_rcp_f32 v35, v35
    v_rcp_f32 v36, v36
    v_rcp_f32 v37, v37
    v_rcp_f32 v38, v38
    v_rcp_f32 v39, v39
    v_pk_mul_f32 v[112:113], v[112:113], v[32:33]
    v_pk_mul_f32 v[114:115], v[114:115], v[34:35]
    v_pk_mul_f32 v[116:117], v[116:117], v[36:37]
    v_pk_mul_f32 v[118:119], v[118:119], v[38:39]
    v_cvt_pk_bf16_f32 v168, v112, v113
    v_cvt_pk_bf16_f32 v169, v114, v115
    v_cvt_pk_bf16_f32 v170, v116, v117
    v_cvt_pk_bf16_f32 v171, v118, v119
    s_nop 0
    v_permlane16_swap_b32 v168, v170
    buffer_load_dwordx4 v10, s[16:19], s39 offen offset:0 lds
    v_permlane16_swap_b32 v169, v171
    buffer_store_dwordx4 v[168:171], v24, s[20:23], s59 offen offset:0 sc1
    v_pk_mul_f32 v[32:33], v[120:121], v[120:121]
    v_pk_mul_f32 v[34:35], v[122:123], v[122:123]
    v_pk_mul_f32 v[36:37], v[124:125], v[124:125]
    v_pk_mul_f32 v[38:39], v[126:127], v[126:127]
    v_pk_fma_f32 v[32:33], v[32:33], s[56:57], v[26:27] op_sel_hi:[1,0,1]
    v_pk_fma_f32 v[34:35], v[34:35], s[56:57], v[26:27] op_sel_hi:[1,0,1]
    v_pk_fma_f32 v[36:37], v[36:37], s[56:57], v[26:27] op_sel_hi:[1,0,1]
    v_pk_fma_f32 v[38:39], v[38:39], s[56:57], v[26:27] op_sel_hi:[1,0,1]
    v_pk_mul_f32 v[32:33], v[32:33], v[120:121]
    v_pk_mul_f32 v[34:35], v[34:35], v[122:123]
    v_pk_mul_f32 v[36:37], v[36:37], v[124:125]
    v_pk_mul_f32 v[38:39], v[38:39], v[126:127]
    v_exp_f32 v32, v32
    v_exp_f32 v33, v33
    v_exp_f32 v34, v34
    v_exp_f32 v35, v35
    buffer_load_dwordx4 v11, s[16:19], s39 offen offset:1056 lds
    v_exp_f32 v36, v36
    v_exp_f32 v37, v37
    v_exp_f32 v38, v38
    v_exp_f32 v39, v39
    v_pk_add_f32 v[32:33], v[32:33], 1.0 op_sel_hi:[1,0]
    v_pk_add_f32 v[34:35], v[34:35], 1.0 op_sel_hi:[1,0]
    v_pk_add_f32 v[36:37], v[36:37], 1.0 op_sel_hi:[1,0]
    v_pk_add_f32 v[38:39], v[38:39], 1.0 op_sel_hi:[1,0]
    v_rcp_f32 v32, v32
    v_rcp_f32 v33, v33
    v_rcp_f32 v34, v34
    v_rcp_f32 v35, v35
    v_rcp_f32 v36, v36
    v_rcp_f32 v37, v37
    v_rcp_f32 v38, v38
    v_rcp_f32 v39, v39
    v_pk_mul_f32 v[120:121], v[120:121], v[32:33]
    v_pk_mul_f32 v[122:123], v[122:123], v[34:35]
    buffer_load_dwordx4 v12, s[16:19], s39 offen offset:2112 lds
    v_pk_mul_f32 v[124:125], v[124:125], v[36:37]
    v_pk_mul_f32 v[126:127], v[126:127], v[38:39]
    v_cvt_pk_bf16_f32 v172, v120, v121
    v_cvt_pk_bf16_f32 v173, v122, v123
    v_cvt_pk_bf16_f32 v174, v124, v125
    v_cvt_pk_bf16_f32 v175, v126, v127
    s_nop 0
    v_permlane16_swap_b32 v172, v174
    v_permlane16_swap_b32 v173, v175
    buffer_store_dwordx4 v[172:175], v24, s[20:23], s58 offen offset:512 sc1
    v_pk_mul_f32 v[32:33], v[128:129], v[128:129]
    v_pk_mul_f32 v[34:35], v[130:131], v[130:131]
    v_pk_mul_f32 v[36:37], v[132:133], v[132:133]
    v_pk_mul_f32 v[38:39], v[134:135], v[134:135]
    v_pk_fma_f32 v[32:33], v[32:33], s[56:57], v[26:27] op_sel_hi:[1,0,1]
    v_pk_fma_f32 v[34:35], v[34:35], s[56:57], v[26:27] op_sel_hi:[1,0,1]
    v_pk_fma_f32 v[36:37], v[36:37], s[56:57], v[26:27] op_sel_hi:[1,0,1]
    v_pk_fma_f32 v[38:39], v[38:39], s[56:57], v[26:27] op_sel_hi:[1,0,1]
    v_pk_mul_f32 v[32:33], v[32:33], v[128:129]
    buffer_load_dwordx4 v13, s[16:19], s39 offen offset:3168 lds
    v_pk_mul_f32 v[34:35], v[34:35], v[130:131]
    v_pk_mul_f32 v[36:37], v[36:37], v[132:133]
    v_pk_mul_f32 v[38:39], v[38:39], v[134:135]
    v_exp_f32 v32, v32
    v_exp_f32 v33, v33
    v_exp_f32 v34, v34
    v_exp_f32 v35, v35
    v_exp_f32 v36, v36
    v_exp_f32 v37, v37
    v_exp_f32 v38, v38
    v_exp_f32 v39, v39
    v_pk_add_f32 v[32:33], v[32:33], 1.0 op_sel_hi:[1,0]
    v_pk_add_f32 v[34:35], v[34:35], 1.0 op_sel_hi:[1,0]
    v_pk_add_f32 v[36:37], v[36:37], 1.0 op_sel_hi:[1,0]
    v_pk_add_f32 v[38:39], v[38:39], 1.0 op_sel_hi:[1,0]
    v_rcp_f32 v32, v32
    v_rcp_f32 v33, v33
    v_rcp_f32 v34, v34
    s_mul_i32 s39, s81, 28
    s_add_u32 s39, s39, s61
    s_add_u32 m0, s57, 8448
    v_rcp_f32 v35, v35
    v_rcp_f32 v36, v36
    v_rcp_f32 v37, v37
    v_rcp_f32 v38, v38
    v_rcp_f32 v39, v39
    v_pk_mul_f32 v[128:129], v[128:129], v[32:33]
    v_pk_mul_f32 v[130:131], v[130:131], v[34:35]
    v_pk_mul_f32 v[132:133], v[132:133], v[36:37]
    v_pk_mul_f32 v[134:135], v[134:135], v[38:39]
    v_cvt_pk_bf16_f32 v176, v128, v129
    v_cvt_pk_bf16_f32 v177, v130, v131
    v_cvt_pk_bf16_f32 v178, v132, v133
    v_cvt_pk_bf16_f32 v179, v134, v135
    s_nop 0
    v_permlane16_swap_b32 v176, v178
    v_permlane16_swap_b32 v177, v179
    buffer_store_dwordx4 v[176:179], v24, s[20:23], s59 offen offset:512 sc1
    v_pk_mul_f32 v[32:33], v[136:137], v[136:137]
    v_pk_mul_f32 v[34:35], v[138:139], v[138:139]
    buffer_load_dwordx4 v10, s[16:19], s39 offen offset:0 lds
    v_pk_mul_f32 v[36:37], v[140:141], v[140:141]
    v_pk_mul_f32 v[38:39], v[142:143], v[142:143]
    v_pk_fma_f32 v[32:33], v[32:33], s[56:57], v[26:27] op_sel_hi:[1,0,1]
    v_pk_fma_f32 v[34:35], v[34:35], s[56:57], v[26:27] op_sel_hi:[1,0,1]
    v_pk_fma_f32 v[36:37], v[36:37], s[56:57], v[26:27] op_sel_hi:[1,0,1]
    v_pk_fma_f32 v[38:39], v[38:39], s[56:57], v[26:27] op_sel_hi:[1,0,1]
    v_pk_mul_f32 v[32:33], v[32:33], v[136:137]
    v_pk_mul_f32 v[34:35], v[34:35], v[138:139]
    v_pk_mul_f32 v[36:37], v[36:37], v[140:141]
    v_pk_mul_f32 v[38:39], v[38:39], v[142:143]
    v_exp_f32 v32, v32
    v_exp_f32 v33, v33
    v_exp_f32 v34, v34
    v_exp_f32 v35, v35
    v_exp_f32 v36, v36
    v_exp_f32 v37, v37
    v_exp_f32 v38, v38
    v_exp_f32 v39, v39
    buffer_load_dwordx4 v11, s[16:19], s39 offen offset:1056 lds
    v_pk_add_f32 v[32:33], v[32:33], 1.0 op_sel_hi:[1,0]
    v_pk_add_f32 v[34:35], v[34:35], 1.0 op_sel_hi:[1,0]
    v_pk_add_f32 v[36:37], v[36:37], 1.0 op_sel_hi:[1,0]
    v_pk_add_f32 v[38:39], v[38:39], 1.0 op_sel_hi:[1,0]
    v_rcp_f32 v32, v32
    v_rcp_f32 v33, v33
    v_rcp_f32 v34, v34
    v_rcp_f32 v35, v35
    v_rcp_f32 v36, v36
    v_rcp_f32 v37, v37
    v_rcp_f32 v38, v38
    v_rcp_f32 v39, v39
    v_pk_mul_f32 v[136:137], v[136:137], v[32:33]
    v_pk_mul_f32 v[138:139], v[138:139], v[34:35]
    v_pk_mul_f32 v[140:141], v[140:141], v[36:37]
    v_pk_mul_f32 v[142:143], v[142:143], v[38:39]
    v_cvt_pk_bf16_f32 v180, v136, v137
    v_cvt_pk_bf16_f32 v181, v138, v139
    buffer_load_dwordx4 v12, s[16:19], s39 offen offset:2112 lds
    v_cvt_pk_bf16_f32 v182, v140, v141
    v_cvt_pk_bf16_f32 v183, v142, v143
    s_nop 0
    v_permlane16_swap_b32 v180, v182
    v_permlane16_swap_b32 v181, v183
    buffer_store_dwordx4 v[180:183], v24, s[20:23], s58 offen offset:1024 sc1
    v_pk_mul_f32 v[32:33], v[144:145], v[144:145]
    v_pk_mul_f32 v[34:35], v[146:147], v[146:147]
    v_pk_mul_f32 v[36:37], v[148:149], v[148:149]
    v_pk_mul_f32 v[38:39], v[150:151], v[150:151]
    v_pk_fma_f32 v[32:33], v[32:33], s[56:57], v[26:27] op_sel_hi:[1,0,1]
    v_pk_fma_f32 v[34:35], v[34:35], s[56:57], v[26:27] op_sel_hi:[1,0,1]
    v_pk_fma_f32 v[36:37], v[36:37], s[56:57], v[26:27] op_sel_hi:[1,0,1]
    v_pk_fma_f32 v[38:39], v[38:39], s[56:57], v[26:27] op_sel_hi:[1,0,1]
    v_pk_mul_f32 v[32:33], v[32:33], v[144:145]
    v_pk_mul_f32 v[34:35], v[34:35], v[146:147]
    v_pk_mul_f32 v[36:37], v[36:37], v[148:149]
    v_pk_mul_f32 v[38:39], v[38:39], v[150:151]
    v_exp_f32 v32, v32
    buffer_load_dwordx4 v13, s[16:19], s39 offen offset:3168 lds
    v_exp_f32 v33, v33
    v_exp_f32 v34, v34
    v_exp_f32 v35, v35
    v_exp_f32 v36, v36
    v_exp_f32 v37, v37
    v_exp_f32 v38, v38
    v_exp_f32 v39, v39
    v_pk_add_f32 v[32:33], v[32:33], 1.0 op_sel_hi:[1,0]
    v_pk_add_f32 v[34:35], v[34:35], 1.0 op_sel_hi:[1,0]
    v_pk_add_f32 v[36:37], v[36:37], 1.0 op_sel_hi:[1,0]
    v_pk_add_f32 v[38:39], v[38:39], 1.0 op_sel_hi:[1,0]
    v_rcp_f32 v32, v32
    v_rcp_f32 v33, v33
    v_rcp_f32 v34, v34
    v_rcp_f32 v35, v35
    v_rcp_f32 v36, v36
    v_rcp_f32 v37, v37
    v_rcp_f32 v38, v38
    v_rcp_f32 v39, v39
    v_pk_mul_f32 v[144:145], v[144:145], v[32:33]
    v_pk_mul_f32 v[146:147], v[146:147], v[34:35]
    v_pk_mul_f32 v[148:149], v[148:149], v[36:37]
    v_pk_mul_f32 v[150:151], v[150:151], v[38:39]
    v_cvt_pk_bf16_f32 v184, v144, v145
    v_cvt_pk_bf16_f32 v185, v146, v147
    v_cvt_pk_bf16_f32 v186, v148, v149
    v_cvt_pk_bf16_f32 v187, v150, v151
    s_nop 0
    v_permlane16_swap_b32 v184, v186
    v_permlane16_swap_b32 v185, v187
    buffer_store_dwordx4 v[184:187], v24, s[20:23], s59 offen offset:1024 sc1
    s_lshl_b32 s40, s25, 7
    s_lshl_b32 s41, s26, 2
    s_add_u32 s40, s40, s41
    s_add_u32 s40, s40, 49152
    v_mov_b32 v7, s3
    s_waitcnt vmcnt(0)
    s_barrier
    s_cmp_lg_u32 s24, 0
    s_cbranch_scc1 H4_a
    s_mov_b64 exec, 1
    buffer_store_dword v7, off, s[20:23], s40 sc1
    s_mov_b64 exec, -1
H4_a:
    s_add_u32 s40, s62, 2097152
    buffer_load_dwordx4 a[224:227], v23, s[20:23], s40 offen offset:0 sc1
    buffer_load_dwordx4 a[228:231], v23, s[20:23], s40 offen offset:1024 sc1
    s_lshl_b32 s40, s27, 7
    s_add_u32 s40, s40, 8960
    v_and_b32 v8, 1, v4
    v_mul_u32_u24 v8, 896, v8
    v_lshrrev_b32 v7, 1, v4
    v_lshl_add_u32 v8, v7, 4, v8
    buffer_load_dwordx4 a[240:243], v8, s[20:23], s40 offen offset:0 sc1
    buffer_load_dwordx4 a[244:247], v8, s[20:23], s40 offen offset:32 sc1
    buffer_load_dwordx4 a[248:251], v8, s[20:23], s40 offen offset:64 sc1
    buffer_load_dwordx4 a[252:255], v8, s[20:23], s40 offen offset:96 sc1
    ds_read_b64_tr_b16 a[80:81], v28 offset:16896
    ds_read_b64_tr_b16 a[82:83], v28 offset:17152
    ds_read_b64_tr_b16 a[84:85], v28 offset:16928
    ds_read_b64_tr_b16 a[86:87], v28 offset:17184
    ds_read_b64_tr_b16 a[88:89], v28 offset:16960
    ds_read_b64_tr_b16 a[90:91], v28 offset:17216
    ds_read_b64_tr_b16 a[92:93], v28 offset:16992
    ds_read_b64_tr_b16 a[94:95], v28 offset:17248
    ds_read_b64_tr_b16 a[96:97], v28 offset:21120
    ds_read_b64_tr_b16 a[98:99], v28 offset:21376
    ds_read_b64_tr_b16 a[100:101], v28 offset:21152
    ds_read_b64_tr_b16 a[102:103], v28 offset:21408
    ds_read_b64_tr_b16 a[104:105], v28 offset:21184
    ds_read_b64_tr_b16 a[106:107], v28 offset:21440
    ds_read_b64_tr_b16 a[108:109], v28 offset:21216
    ds_read_b64_tr_b16 a[110:111], v28 offset:21472
    ds_read_b64_tr_b16 a[112:113], v28 offset:0
    ds_read_b64_tr_b16 a[114:115], v28 offset:256
    ds_read_b64_tr_b16 a[116:117], v28 offset:32
    ds_read_b64_tr_b16 a[118:119], v28 offset:288
    ds_read_b64_tr_b16 a[120:121], v28 offset:64
    ds_read_b64_tr_b16 a[122:123], v28 offset:320
    ds_read_b64_tr_b16 a[124:125], v28 offset:96
    ds_read_b64_tr_b16 a[126:127], v28 offset:352
    ds_read_b64_tr_b16 a[128:129], v28 offset:4224
    ds_read_b64_tr_b16 a[130:131], v28 offset:4480
    ds_read_b64_tr_b16 a[132:133], v28 offset:4256
    ds_read_b64_tr_b16 a[134:135], v28 offset:4512
    ds_read_b64_tr_b16 a[136:137], v28 offset:4288
    ds_read_b64_tr_b16 a[138:139], v28 offset:4544
    ds_read_b64_tr_b16 a[140:141], v28 offset:4320
    ds_read_b64_tr_b16 a[142:143], v28 offset:4576
    ds_read_b64_tr_b16 a[144:145], v28 offset:8448
    ds_read_b64_tr_b16 a[146:147], v28 offset:8704
    ds_read_b64_tr_b16 a[148:149], v28 offset:8480
    ds_read_b64_tr_b16 a[150:151], v28 offset:8736
    ds_read_b64_tr_b16 a[152:153], v28 offset:8512
    ds_read_b64_tr_b16 a[154:155], v28 offset:8768
    ds_read_b64_tr_b16 a[156:157], v28 offset:8544
    ds_read_b64_tr_b16 a[158:159], v28 offset:8800
    ds_read_b64_tr_b16 a[160:161], v28 offset:12672
    ds_read_b64_tr_b16 a[162:163], v28 offset:12928
    ds_read_b64_tr_b16 a[164:165], v28 offset:12704
    ds_read_b64_tr_b16 a[166:167], v28 offset:12960
    ds_read_b64_tr_b16 a[168:169], v28 offset:12736
    ds_read_b64_tr_b16 a[170:171], v28 offset:12992
    ds_read_b64_tr_b16 a[172:173], v28 offset:12768
    ds_read_b64_tr_b16 a[174:175], v28 offset:13024
    ds_read_b64_tr_b16 a[176:177], v29 offset:0
    ds_read_b64_tr_b16 a[178:179], v29 offset:256
    ds_read_b64_tr_b16 a[180:181], v29 offset:32
    ds_read_b64_tr_b16 a[182:183], v29 offset:288
    ds_read_b64_tr_b16 a[184:185], v29 offset:64
    ds_read_b64_tr_b16 a[186:187], v29 offset:320
    ds_read_b64_tr_b16 a[188:189], v29 offset:96
    ds_read_b64_tr_b16 a[190:191], v29 offset:352
    ds_read_b64_tr_b16 a[192:193], v29 offset:4224
    ds_read_b64_tr_b16 a[194:195], v29 offset:4480
    ds_read_b64_tr_b16 a[196:197], v29 offset:4256
    ds_read_b64_tr_b16 a[198:199], v29 offset:4512
    ds_read_b64_tr_b16 a[200:201], v29 offset:4288
    ds_read_b64_tr_b16 a[202:203], v29 offset:4544
    ds_read_b64_tr_b16 a[204:205], v29 offset:4320
    ds_read_b64_tr_b16 a[206:207], v29 offset:4576
    ds_read_b64_tr_b16 a[208:209], v29 offset:8448
    ds_read_b64_tr_b16 a[210:211], v29 offset:8704
    ds_read_b64_tr_b16 a[212:213], v29 offset:8480
    ds_read_b64_tr_b16 a[214:215], v29 offset:8736
    ds_read_b64_tr_b16 a[216:217], v29 offset:8512
    ds_read_b64_tr_b16 a[218:219], v29 offset:8768
    ds_read_b64_tr_b16 a[220:221], v29 offset:8544
    ds_read_b64_tr_b16 a[222:223], v29 offset:8800
    s_cmp_lg_u32 s24, 0
    s_cbranch_scc1 H4_out
    s_lshl_b32 s41, s25, 7
    s_add_u32 s41, s41, 49152
    v_and_b32 v6, 7, v2
    v_lshlrev_b32 v6, 2, v6
    s_mov_b64 exec, 0xff
    s_mov_b32 s43, 0x8000
H4_poll:
    buffer_load_dword v8, v6, s[20:23], s41 offen sc1
    s_sub_u32 s43, s43, 1
    s_waitcnt vmcnt(0)
    v_cmp_ne_u32 vcc, s3, v8
    s_cmp_eq_u32 s43, 0
    s_cbranch_scc1 H4_x
    s_cbranch_vccnz H4_poll
H4_x:
    s_mov_b64 exec, -1
H4_out:
    s_waitcnt lgkmcnt(0)
    s_barrier
    s_mul_i32 s40, s31, 57344
    s_mul_i32 s41, s24, 14*1024
    s_add_u32 s40, s40, s41
    s_add_u32 s40, s40, 12582912
    v_mov_b32 v18, v14
    s_add_u32 s41, s24, 0
    s_and_b32 s41, s41, 3
    s_mul_i32 s41, s41, 57344
    s_add_u32 s41, s41, s40
    v_add_u32 v14, s41, v18
    s_add_u32 s41, s24, 1
    s_and_b32 s41, s41, 3
    s_mul_i32 s41, s41, 57344
    s_add_u32 s41, s41, s40
    v_add_u32 v15, s41, v18
    s_add_u32 s41, s24, 2
    s_and_b32 s41, s41, 3
    s_mul_i32 s41, s41, 57344
    s_add_u32 s41, s41, s40
    v_add_u32 v16, s41, v18
    s_add_u32 s41, s24, 3
    s_and_b32 s41, s41, 3
    s_mul_i32 s41, s41, 57344
    s_add_u32 s41, s41, s40
    v_add_u32 v17, s41, v18
    buffer_load_dwordx4 v[32:35], v14, s[20:23], s68 offen sc1
    buffer_load_dwordx4 v[36:39], v15, s[20:23], s68 offen sc1
    buffer_load_dwordx4 v[40:43], v16, s[20:23], s68 offen sc1
    buffer_load_dwordx4 v[44:47], v17, s[20:23], s68 offen sc1
    buffer_load_dwordx4 v[48:51], v14, s[20:23], s69 offen sc1
    buffer_load_dwordx4 v[52:55], v15, s[20:23], s69 offen sc1
    buffer_load_dwordx4 v[56:59], v16, s[20:23], s69 offen sc1
    buffer_load_dwordx4 v[60:63], v17, s[20:23], s69 offen sc1
    buffer_load_dwordx4 v[64:67], v14, s[20:23], s70 offen sc1
    buffer_load_dwordx4 v[68:71], v15, s[20:23], s70 offen sc1
    buffer_load_dwordx4 v[72:75], v16, s[20:23], s70 offen sc1
    buffer_load_dwordx4 v[76:79], v17, s[20:23], s70 offen sc1
    s_waitcnt vmcnt(8)
    v_mfma_f32_16x16x32_bf16 v[192:195], a[0:3], v[32:35], 0
    v_mfma_f32_16x16x32_bf16 v[196:199], a[4:7], v[32:35], 0
    buffer_load_dwordx4 v[80:83], v14, s[20:23], s71 offen sc1
    v_mfma_f32_16x16x32_bf16 v[200:203], a[8:11], v[32:35], 0
    v_mfma_f32_16x16x32_bf16 v[204:207], a[12:15], v[32:35], 0
    v_mfma_f32_16x16x32_bf16 v[208:211], a[0:3], v[36:39], 0
    v_mfma_f32_16x16x32_bf16 v[212:215], a[4:7], v[36:39], 0
    buffer_load_dwordx4 v[84:87], v15, s[20:23], s71 offen sc1
    v_mfma_f32_16x16x32_bf16 v[216:219], a[8:11], v[36:39], 0
    v_mfma_f32_16x16x32_bf16 v[220:223], a[12:15], v[36:39], 0
    v_mfma_f32_16x16x32_bf16 v[224:227], a[0:3], v[40:43], 0
    v_mfma_f32_16x16x32_bf16 v[228:231], a[4:7], v[40:43], 0
    buffer_load_dwordx4 v[88:91], v16, s[20:23], s71 offen sc1
    v_mfma_f32_16x16x32_bf16 v[232:235], a[8:11], v[40:43], 0
    v_mfma_f32_16x16x32_bf16 v[236:239], a[12:15], v[40:43], 0
    v_mfma_f32_16x16x32_bf16 v[240:243], a[0:3], v[44:47], 0
    v_mfma_f32_16x16x32_bf16 v[244:247], a[4:7], v[44:47], 0
    buffer_load_dwordx4 v[92:95], v17, s[20:23], s71 offen sc1
    v_mfma_f32_16x16x32_bf16 v[248:251], a[8:11], v[44:47], 0
    v_mfma_f32_16x16x32_bf16 v[252:255], a[12:15], v[44:47], 0
    s_waitcnt vmcnt(8)
    v_mfma_f32_16x16x32_bf16 v[192:195], a[16:19], v[48:51], v[192:195]
    v_mfma_f32_16x16x32_bf16 v[196:199], a[20:23], v[48:51], v[196:199]
    buffer_load_dwordx4 v[96:99], v14, s[20:23], s72 offen sc1
    v_mfma_f32_16x16x32_bf16 v[200:203], a[24:27], v[48:51], v[200:203]
    v_mfma_f32_16x16x32_bf16 v[204:207], a[28:31], v[48:51], v[204:207]
    v_mfma_f32_16x16x32_bf16 v[208:211], a[16:19], v[52:55], v[208:211]
    v_mfma_f32_16x16x32_bf16 v[212:215], a[20:23], v[52:55], v[212:215]
    buffer_load_dwordx4 v[100:103], v15, s[20:23], s72 offen sc1
    v_mfma_f32_16x16x32_bf16 v[216:219], a[24:27], v[52:55], v[216:219]
    v_mfma_f32_16x16x32_bf16 v[220:223], a[28:31], v[52:55], v[220:223]
    v_mfma_f32_16x16x32_bf16 v[224:227], a[16:19], v[56:59], v[224:227]
    v_mfma_f32_16x16x32_bf16 v[228:231], a[20:23], v[56:59], v[228:231]
    buffer_load_dwordx4 v[104:107], v16, s[20:23], s72 offen sc1
    v_mfma_f32_16x16x32_bf16 v[232:235], a[24:27], v[56:59], v[232:235]
    v_mfma_f32_16x16x32_bf16 v[236:239], a[28:31], v[56:59], v[236:239]
    v_mfma_f32_16x16x32_bf16 v[240:243], a[16:19], v[60:63], v[240:243]
    v_mfma_f32_16x16x32_bf16 v[244:247], a[20:23], v[60:63], v[244:247]
    buffer_load_dwordx4 v[108:111], v17, s[20:23], s72 offen sc1
    v_mfma_f32_16x16x32_bf16 v[248:251], a[24:27], v[60:63], v[248:251]
    v_mfma_f32_16x16x32_bf16 v[252:255], a[28:31], v[60:63], v[252:255]
    s_waitcnt vmcnt(8)
    v_mfma_f32_16x16x32_bf16 v[192:195], a[32:35], v[64:67], v[192:195]
    v_mfma_f32_16x16x32_bf16 v[196:199], a[36:39], v[64:67], v[196:199]
    buffer_load_dwordx4 v[112:115], v14, s[20:23], s73 offen sc1
    v_mfma_f32_16x16x32_bf16 v[200:203], a[40:43], v[64:67], v[200:203]
    v_mfma_f32_16x16x32_bf16 v[204:207], a[44:47], v[64:67], v[204:207]
    v_mfma_f32_16x16x32_bf16 v[208:211], a[32:35], v[68:71], v[208:211]
    v_mfma_f32_16x16x32_bf16 v[212:215], a[36:39], v[68:71], v[212:215]
    buffer_load_dwordx4 v[116:119], v15, s[20:23], s73 offen sc1
    v_mfma_f32_16x16x32_bf16 v[216:219], a[40:43], v[68:71], v[216:219]
    v_mfma_f32_16x16x32_bf16 v[220:223], a[44:47], v[68:71], v[220:223]
    v_mfma_f32_16x16x32_bf16 v[224:227], a[32:35], v[72:75], v[224:227]
    v_mfma_f32_16x16x32_bf16 v[228:231], a[36:39], v[72:75], v[228:231]
    buffer_load_dwordx4 v[120:123], v16, s[20:23], s73 offen sc1
    v_mfma_f32_16x16x32_bf16 v[232:235], a[40:43], v[72:75], v[232:235]
    v_mfma_f32_16x16x32_bf16 v[236:239], a[44:47], v[72:75], v[236:239]
    v_mfma_f32_16x16x32_bf16 v[240:243], a[32:35], v[76:79], v[240:243]
    v_mfma_f32_16x16x32_bf16 v[244:247], a[36:39], v[76:79], v[244:247]
    buffer_load_dwordx4 v[124:127], v17, s[20:23], s73 offen sc1
    v_mfma_f32_16x16x32_bf16 v[248:251], a[40:43], v[76:79], v[248:251]
    v_mfma_f32_16x16x32_bf16 v[252:255], a[44:47], v[76:79], v[252:255]
    s_waitcnt vmcnt(8)
    v_mfma_f32_16x16x32_bf16 v[192:195], a[48:51], v[80:83], v[192:195]
    v_mfma_f32_16x16x32_bf16 v[196:199], a[52:55], v[80:83], v[196:199]
    buffer_load_dwordx4 v[128:131], v14, s[20:23], s74 offen sc1
    v_mfma_f32_16x16x32_bf16 v[200:203], a[56:59], v[80:83], v[200:203]
    v_mfma_f32_16x16x32_bf16 v[204:207], a[60:63], v[80:83], v[204:207]
    v_mfma_f32_16x16x32_bf16 v[208:211], a[48:51], v[84:87], v[208:211]
    v_mfma_f32_16x16x32_bf16 v[212:215], a[52:55], v[84:87], v[212:215]
    buffer_load_dwordx4 v[132:135], v15, s[20:23], s74 offen sc1
    v_mfma_f32_16x16x32_bf16 v[216:219], a[56:59], v[84:87], v[216:219]
    v_mfma_f32_16x16x32_bf16 v[220:223], a[60:63], v[84:87], v[220:223]
    v_mfma_f32_16x16x32_bf16 v[224:227], a[48:51], v[88:91], v[224:227]
    v_mfma_f32_16x16x32_bf16 v[228:231], a[52:55], v[88:91], v[228:231]
    buffer_load_dwordx4 v[136:139], v16, s[20:23], s74 offen sc1
    v_mfma_f32_16x16x32_bf16 v[232:235], a[56:59], v[88:91], v[232:235]
    v_mfma_f32_16x16x32_bf16 v[236:239], a[60:63], v[88:91], v[236:239]
    v_mfma_f32_16x16x32_bf16 v[240:243], a[48:51], v[92:95], v[240:243]
    v_mfma_f32_16x16x32_bf16 v[244:247], a[52:55], v[92:95], v[244:247]
    buffer_load_dwordx4 v[140:143], v17, s[20:23], s74 offen sc1
    v_mfma_f32_16x16x32_bf16 v[248:251], a[56:59], v[92:95], v[248:251]
    v_mfma_f32_16x16x32_bf16 v[252:255], a[60:63], v[92:95], v[252:255]
    s_waitcnt vmcnt(8)
    v_mfma_f32_16x16x32_bf16 v[192:195], a[64:67], v[96:99], v[192:195]
    v_mfma_f32_16x16x32_bf16 v[196:199], a[68:71], v[96:99], v[196:199]
    buffer_load_dwordx4 v[144:147], v14, s[20:23], s75 offen sc1
    v_mfma_f32_16x16x32_bf16 v[200:203], a[72:75], v[96:99], v[200:203]
    v_mfma_f32_16x16x32_bf16 v[204:207], a[76:79], v[96:99], v[204:207]
    v_mfma_f32_16x16x32_bf16 v[208:211], a[64:67], v[100:103], v[208:211]
    v_mfma_f32_16x16x32_bf16 v[212:215], a[68:71], v[100:103], v[212:215]
    buffer_load_dwordx4 v[148:151], v15, s[20:23], s75 offen sc1
    v_mfma_f32_16x16x32_bf16 v[216:219], a[72:75], v[100:103], v[216:219]
    v_mfma_f32_16x16x32_bf16 v[220:223], a[76:79], v[100:103], v[220:223]
    v_mfma_f32_16x16x32_bf16 v[224:227], a[64:67], v[104:107], v[224:227]
    v_mfma_f32_16x16x32_bf16 v[228:231], a[68:71], v[104:107], v[228:231]
    buffer_load_dwordx4 v[152:155], v16, s[20:23], s75 offen sc1
    v_mfma_f32_16x16x32_bf16 v[232:235], a[72:75], v[104:107], v[232:235]
    v_mfma_f32_16x16x32_bf16 v[236:239], a[76:79], v[104:107], v[236:239]
    v_mfma_f32_16x16x32_bf16 v[240:243], a[64:67], v[108:111], v[240:243]
    v_mfma_f32_16x16x32_bf16 v[244:247], a[68:71], v[108:111], v[244:247]
    buffer_load_dwordx4 v[156:159], v17, s[20:23], s75 offen sc1
    v_mfma_f32_16x16x32_bf16 v[248:251], a[72:75], v[108:111], v[248:251]
    v_mfma_f32_16x16x32_bf16 v[252:255], a[76:79], v[108:111], v[252:255]
    s_waitcnt vmcnt(8)
    v_mfma_f32_16x16x32_bf16 v[192:195], a[80:83], v[112:115], v[192:195]
    v_mfma_f32_16x16x32_bf16 v[196:199], a[84:87], v[112:115], v[196:199]
    buffer_load_dwordx4 v[160:163], v14, s[20:23], s76 offen sc1
    v_mfma_f32_16x16x32_bf16 v[200:203], a[88:91], v[112:115], v[200:203]
    v_mfma_f32_16x16x32_bf16 v[204:207], a[92:95], v[112:115], v[204:207]
    v_mfma_f32_16x16x32_bf16 v[208:211], a[80:83], v[116:119], v[208:211]
    v_mfma_f32_16x16x32_bf16 v[212:215], a[84:87], v[116:119], v[212:215]
    buffer_load_dwordx4 v[164:167], v15, s[20:23], s76 offen sc1
    v_mfma_f32_16x16x32_bf16 v[216:219], a[88:91], v[116:119], v[216:219]
    v_mfma_f32_16x16x32_bf16 v[220:223], a[92:95], v[116:119], v[220:223]
    v_mfma_f32_16x16x32_bf16 v[224:227], a[80:83], v[120:123], v[224:227]
    v_mfma_f32_16x16x32_bf16 v[228:231], a[84:87], v[120:123], v[228:231]
    buffer_load_dwordx4 v[168:171], v16, s[20:23], s76 offen sc1
    v_mfma_f32_16x16x32_bf16 v[232:235], a[88:91], v[120:123], v[232:235]
    v_mfma_f32_16x16x32_bf16 v[236:239], a[92:95], v[120:123], v[236:239]
    v_mfma_f32_16x16x32_bf16 v[240:243], a[80:83], v[124:127], v[240:243]
    v_mfma_f32_16x16x32_bf16 v[244:247], a[84:87], v[124:127], v[244:247]
    buffer_load_dwordx4 v[172:175], v17, s[20:23], s76 offen sc1
    v_mfma_f32_16x16x32_bf16 v[248:251], a[88:91], v[124:127], v[248:251]
    v_mfma_f32_16x16x32_bf16 v[252:255], a[92:95], v[124:127], v[252:255]
    s_waitcnt vmcnt(8)
    v_mfma_f32_16x16x32_bf16 v[192:195], a[96:99], v[128:131], v[192:195]
    v_mfma_f32_16x16x32_bf16 v[196:199], a[100:103], v[128:131], v[196:199]
    buffer_load_dwordx4 v[176:179], v14, s[20:23], s77 offen sc1
    v_mfma_f32_16x16x32_bf16 v[200:203], a[104:107], v[128:131], v[200:203]
    v_mfma_f32_16x16x32_bf16 v[204:207], a[108:111], v[128:131], v[204:207]
    v_mfma_f32_16x16x32_bf16 v[208:211], a[96:99], v[132:135], v[208:211]
    v_mfma_f32_16x16x32_bf16 v[212:215], a[100:103], v[132:135], v[212:215]
    buffer_load_dwordx4 v[180:183], v15, s[20:23], s77 offen sc1
    v_mfma_f32_16x16x32_bf16 v[216:219], a[104:107], v[132:135], v[216:219]
    v_mfma_f32_16x16x32_bf16 v[220:223], a[108:111], v[132:135], v[220:223]
    v_mfma_f32_16x16x32_bf16 v[224:227], a[96:99], v[136:139], v[224:227]
    v_mfma_f32_16x16x32_bf16 v[228:231], a[100:103], v[136:139], v[228:231]
    buffer_load_dwordx4 v[184:187], v16, s[20:23], s77 offen sc1
    v_mfma_f32_16x16x32_bf16 v[232:235], a[104:107], v[136:139], v[232:235]
    v_mfma_f32_16x16x32_bf16 v[236:239], a[108:111], v[136:139], v[236:239]
    v_mfma_f32_16x16x32_bf16 v[240:243], a[96:99], v[140:143], v[240:243]
    v_mfma_f32_16x16x32_bf16 v[244:247], a[100:103], v[140:143], v[244:247]
    buffer_load_dwordx4 v[188:191], v17, s[20:23], s77 offen sc1
    v_mfma_f32_16x16x32_bf16 v[248:251], a[104:107], v[140:143], v[248:251]
    v_mfma_f32_16x16x32_bf16 v[252:255], a[108:111], v[140:143], v[252:255]
    s_waitcnt vmcnt(8)
    v_mfma_f32_16x16x32_bf16 v[192:195], a[112:115], v[144:147], v[192:195]
    v_mfma_f32_16x16x32_bf16 v[196:199], a[116:119], v[144:147], v[196:199]
    buffer_load_dwordx4 v[32:35], v14, s[20:23], s78 offen sc1
    v_mfma_f32_16x16x32_bf16 v[200:203], a[120:123], v[144:147], v[200:203]
    v_mfma_f32_16x16x32_bf16 v[204:207], a[124:127], v[144:147], v[204:207]
    v_mfma_f32_16x16x32_bf16 v[208:211], a[112:115], v[148:151], v[208:211]
    v_mfma_f32_16x16x32_bf16 v[212:215], a[116:119], v[148:151], v[212:215]
    buffer_load_dwordx4 v[36:39], v15, s[20:23], s78 offen sc1
    v_mfma_f32_16x16x32_bf16 v[216:219], a[120:123], v[148:151], v[216:219]
    v_mfma_f32_16x16x32_bf16 v[220:223], a[124:127], v[148:151], v[220:223]
    v_mfma_f32_16x16x32_bf16 v[224:227], a[112:115], v[152:155], v[224:227]
    v_mfma_f32_16x16x32_bf16 v[228:231], a[116:119], v[152:155], v[228:231]
    buffer_load_dwordx4 v[40:43], v16, s[20:23], s78 offen sc1
    v_mfma_f32_16x16x32_bf16 v[232:235], a[120:123], v[152:155], v[232:235]
    v_mfma_f32_16x16x32_bf16 v[236:239], a[124:127], v[152:155], v[236:239]
    v_mfma_f32_16x16x32_bf16 v[240:243], a[112:115], v[156:159], v[240:243]
    v_mfma_f32_16x16x32_bf16 v[244:247], a[116:119], v[156:159], v[244:247]
    buffer_load_dwordx4 v[44:47], v17, s[20:23], s78 offen sc1
    v_mfma_f32_16x16x32_bf16 v[248:251], a[120:123], v[156:159], v[248:251]
    v_mfma_f32_16x16x32_bf16 v[252:255], a[124:127], v[156:159], v[252:255]
    s_waitcnt vmcnt(8)
    v_mfma_f32_16x16x32_bf16 v[192:195], a[128:131], v[160:163], v[192:195]
    v_mfma_f32_16x16x32_bf16 v[196:199], a[132:135], v[160:163], v[196:199]
    buffer_load_dwordx4 v[48:51], v14, s[20:23], s79 offen sc1
    v_mfma_f32_16x16x32_bf16 v[200:203], a[136:139], v[160:163], v[200:203]
    v_mfma_f32_16x16x32_bf16 v[204:207], a[140:143], v[160:163], v[204:207]
    v_mfma_f32_16x16x32_bf16 v[208:211], a[128:131], v[164:167], v[208:211]
    v_mfma_f32_16x16x32_bf16 v[212:215], a[132:135], v[164:167], v[212:215]
    buffer_load_dwordx4 v[52:55], v15, s[20:23], s79 offen sc1
    v_mfma_f32_16x16x32_bf16 v[216:219], a[136:139], v[164:167], v[216:219]
    v_mfma_f32_16x16x32_bf16 v[220:223], a[140:143], v[164:167], v[220:223]
    v_mfma_f32_16x16x32_bf16 v[224:227], a[128:131], v[168:171], v[224:227]
    v_mfma_f32_16x16x32_bf16 v[228:231], a[132:135], v[168:171], v[228:231]
    buffer_load_dwordx4 v[56:59], v16, s[20:23], s79 offen sc1
    v_mfma_f32_16x16x32_bf16 v[232:235], a[136:139], v[168:171], v[232:235]
    v_mfma_f32_16x16x32_bf16 v[236:239], a[140:143], v[168:171], v[236:239]
    v_mfma_f32_16x16x32_bf16 v[240:243], a[128:131], v[172:175], v[240:243]
    v_mfma_f32_16x16x32_bf16 v[244:247], a[132:135], v[172:175], v[244:247]
    buffer_load_dwordx4 v[60:63], v17, s[20:23], s79 offen sc1
    v_mfma_f32_16x16x32_bf16 v[248:251], a[136:139], v[172:175], v[248:251]
    v_mfma_f32_16x16x32_bf16 v[252:255], a[140:143], v[172:175], v[252:255]
    s_waitcnt vmcnt(8)
    v_mfma_f32_16x16x32_bf16 v[192:195], a[144:147], v[176:179], v[192:195]
    v_mfma_f32_16x16x32_bf16 v[196:199], a[148:151], v[176:179], v[196:199]
    buffer_load_dwordx4 v[64:67], v14, s[20:23], s80 offen sc1
    v_mfma_f32_16x16x32_bf16 v[200:203], a[152:155], v[176:179], v[200:203]
    v_mfma_f32_16x16x32_bf16 v[204:207], a[156:159], v[176:179], v[204:207]
    v_mfma_f32_16x16x32_bf16 v[208:211], a[144:147], v[180:183], v[208:211]
    v_mfma_f32_16x16x32_bf16 v[212:215], a[148:151], v[180:183], v[212:215]
    buffer_load_dwordx4 v[68:71], v15, s[20:23], s80 offen sc1
    v_mfma_f32_16x16x32_bf16 v[216:219], a[152:155], v[180:183], v[216:219]
    v_mfma_f32_16x16x32_bf16 v[220:223], a[156:159], v[180:183], v[220:223]
    v_mfma_f32_16x16x32_bf16 v[224:227], a[144:147], v[184:187], v[224:227]
    v_mfma_f32_16x16x32_bf16 v[228:231], a[148:151], v[184:187], v[228:231]
    buffer_load_dwordx4 v[72:75], v16, s[20:23], s80 offen sc1
    v_mfma_f32_16x16x32_bf16 v[232:235], a[152:155], v[184:187], v[232:235]
    v_mfma_f32_16x16x32_bf16 v[236:239], a[156:159], v[184:187], v[236:239]
    v_mfma_f32_16x16x32_bf16 v[240:243], a[144:147], v[188:191], v[240:243]
    v_mfma_f32_16x16x32_bf16 v[244:247], a[148:151], v[188:191], v[244:247]
    buffer_load_dwordx4 v[76:79], v17, s[20:23], s80 offen sc1
    v_mfma_f32_16x16x32_bf16 v[248:251], a[152:155], v[188:191], v[248:251]
    v_mfma_f32_16x16x32_bf16 v[252:255], a[156:159], v[188:191], v[252:255]
    s_waitcnt vmcnt(8)
    v_mfma_f32_16x16x32_bf16 v[192:195], a[160:163], v[32:35], v[192:195]
    v_mfma_f32_16x16x32_bf16 v[196:199], a[164:167], v[32:35], v[196:199]
    buffer_load_dwordx4 v[80:83], v14, s[20:23], s81 offen sc1
    v_mfma_f32_16x16x32_bf16 v[200:203], a[168:171], v[32:35], v[200:203]
    v_mfma_f32_16x16x32_bf16 v[204:207], a[172:175], v[32:35], v[204:207]
    v_mfma_f32_16x16x32_bf16 v[208:211], a[160:163], v[36:39], v[208:211]
    v_mfma_f32_16x16x32_bf16 v[212:215], a[164:167], v[36:39], v[212:215]
    buffer_load_dwordx4 v[84:87], v15, s[20:23], s81 offen sc1
    v_mfma_f32_16x16x32_bf16 v[216:219], a[168:171], v[36:39], v[216:219]
    v_mfma_f32_16x16x32_bf16 v[220:223], a[172:175], v[36:39], v[220:223]
    v_mfma_f32_16x16x32_bf16 v[224:227], a[160:163], v[40:43], v[224:227]
    v_mfma_f32_16x16x32_bf16 v[228:231], a[164:167], v[40:43], v[228:231]
    buffer_load_dwordx4 v[88:91], v16, s[20:23], s81 offen sc1
    v_mfma_f32_16x16x32_bf16 v[232:235], a[168:171], v[40:43], v[232:235]
    v_mfma_f32_16x16x32_bf16 v[236:239], a[172:175], v[40:43], v[236:239]
    v_mfma_f32_16x16x32_bf16 v[240:243], a[160:163], v[44:47], v[240:243]
    v_mfma_f32_16x16x32_bf16 v[244:247], a[164:167], v[44:47], v[244:247]
    buffer_load_dwordx4 v[92:95], v17, s[20:23], s81 offen sc1
    v_mfma_f32_16x16x32_bf16 v[248:251], a[168:171], v[44:47], v[248:251]
    v_mfma_f32_16x16x32_bf16 v[252:255], a[172:175], v[44:47], v[252:255]
    s_waitcnt vmcnt(8)
    v_mfma_f32_16x16x32_bf16 v[192:195], a[176:179], v[48:51], v[192:195]
    v_mfma_f32_16x16x32_bf16 v[196:199], a[180:183], v[48:51], v[196:199]
    v_mfma_f32_16x16x32_bf16 v[200:203], a[184:187], v[48:51], v[200:203]
    v_mfma_f32_16x16x32_bf16 v[204:207], a[188:191], v[48:51], v[204:207]
    v_mfma_f32_16x16x32_bf16 v[208:211], a[176:179], v[52:55], v[208:211]
    v_mfma_f32_16x16x32_bf16 v[212:215], a[180:183], v[52:55], v[212:215]
    v_mfma_f32_16x16x32_bf16 v[216:219], a[184:187], v[52:55], v[216:219]
    v_mfma_f32_16x16x32_bf16 v[220:223], a[188:191], v[52:55], v[220:223]
    v_mfma_f32_16x16x32_bf16 v[224:227], a[176:179], v[56:59], v[224:227]
    v_mfma_f32_16x16x32_bf16 v[228:231], a[180:183], v[56:59], v[228:231]
    v_mfma_f32_16x16x32_bf16 v[232:235], a[184:187], v[56:59], v[232:235]
    v_mfma_f32_16x16x32_bf16 v[236:239], a[188:191], v[56:59], v[236:239]
    v_mfma_f32_16x16x32_bf16 v[240:243], a[176:179], v[60:63], v[240:243]
    v_mfma_f32_16x16x32_bf16 v[244:247], a[180:183], v[60:63], v[244:247]
    v_mfma_f32_16x16x32_bf16 v[248:251], a[184:187], v[60:63], v[248:251]
    v_mfma_f32_16x16x32_bf16 v[252:255], a[188:191], v[60:63], v[252:255]
    s_waitcnt vmcnt(4)
    v_mfma_f32_16x16x32_bf16 v[192:195], a[192:195], v[64:67], v[192:195]
    v_mfma_f32_16x16x32_bf16 v[196:199], a[196:199], v[64:67], v[196:199]
    v_mfma_f32_16x16x32_bf16 v[200:203], a[200:203], v[64:67], v[200:203]
    v_mfma_f32_16x16x32_bf16 v[204:207], a[204:207], v[64:67], v[204:207]
    v_mfma_f32_16x16x32_bf16 v[208:211], a[192:195], v[68:71], v[208:211]
    v_mfma_f32_16x16x32_bf16 v[212:215], a[196:199], v[68:71], v[212:215]
    v_mfma_f32_16x16x32_bf16 v[216:219], a[200:203], v[68:71], v[216:219]
    v_mfma_f32_16x16x32_bf16 v[220:223], a[204:207], v[68:71], v[220:223]
    v_mfma_f32_16x16x32_bf16 v[224:227], a[192:195], v[72:75], v[224:227]
    v_mfma_f32_16x16x32_bf16 v[228:231], a[196:199], v[72:75], v[228:231]
    v_mfma_f32_16x16x32_bf16 v[232:235], a[200:203], v[72:75], v[232:235]
    v_mfma_f32_16x16x32_bf16 v[236:239], a[204:207], v[72:75], v[236:239]
    v_mfma_f32_16x16x32_bf16 v[240:243], a[192:195], v[76:79], v[240:243]
    v_mfma_f32_16x16x32_bf16 v[244:247], a[196:199], v[76:79], v[244:247]
    v_mfma_f32_16x16x32_bf16 v[248:251], a[200:203], v[76:79], v[248:251]
    v_mfma_f32_16x16x32_bf16 v[252:255], a[204:207], v[76:79], v[252:255]
    s_waitcnt vmcnt(0)
    v_mfma_f32_16x16x32_bf16 v[208:211], a[208:211], v[84:87], v[208:211]
    v_mfma_f32_16x16x32_bf16 v[212:215], a[212:215], v[84:87], v[212:215]
    v_mfma_f32_16x16x32_bf16 v[216:219], a[216:219], v[84:87], v[216:219]
    v_mfma_f32_16x16x32_bf16 v[220:223], a[220:223], v[84:87], v[220:223]
    v_mfma_f32_16x16x32_bf16 v[224:227], a[208:211], v[88:91], v[224:227]
    v_mfma_f32_16x16x32_bf16 v[228:231], a[212:215], v[88:91], v[228:231]
    v_mfma_f32_16x16x32_bf16 v[232:235], a[216:219], v[88:91], v[232:235]
    v_mfma_f32_16x16x32_bf16 v[236:239], a[220:223], v[88:91], v[236:239]
    v_mfma_f32_16x16x32_bf16 v[240:243], a[208:211], v[92:95], v[240:243]
    v_mfma_f32_16x16x32_bf16 v[244:247], a[212:215], v[92:95], v[244:247]
    v_mfma_f32_16x16x32_bf16 v[248:251], a[216:219], v[92:95], v[248:251]
    v_mfma_f32_16x16x32_bf16 v[252:255], a[220:223], v[92:95], v[252:255]
    v_mfma_f32_16x16x32_bf16 v[192:195], a[208:211], v[80:83], v[192:195]
    v_mfma_f32_16x16x32_bf16 v[196:199], a[212:215], v[80:83], v[196:199]
    v_mfma_f32_16x16x32_bf16 v[200:203], a[216:219], v[80:83], v[200:203]
    v_mfma_f32_16x16x32_bf16 v[204:207], a[220:223], v[80:83], v[204:207]
    s_lshl_b32 s40, s24, 12
    v_add_u32 v5, s40, v18
    s_lshl_b32 s40, s24, 14
    v_add_u32 v6, s40, v18
    s_add_u32 s41, s24, 1
    s_and_b32 s41, s41, 3
    s_lshl_b32 s41, s41, 14
    v_add_u32 v15, s41, v18
    s_add_u32 s41, s24, 2
    s_and_b32 s41, s41, 3
    s_lshl_b32 s41, s41, 14
    v_add_u32 v16, s41, v18
    s_add_u32 s41, s24, 3
    s_and_b32 s41, s41, 3
    s_lshl_b32 s41, s41, 14
    v_add_u32 v17, s41, v18
    ds_write_b128 v15, v[208:211] offset:0
    v_accvgpr_read_b32 v112, a232
    v_accvgpr_read_b32 v113, a233
    v_accvgpr_read_b32 v114, a234
    v_accvgpr_read_b32 v115, a235
    v_accvgpr_read_b32 v116, a236
    v_accvgpr_read_b32 v117, a237
    ds_write_b128 v15, v[212:215] offset:1024
    v_accvgpr_read_b32 v118, a238
    v_accvgpr_read_b32 v119, a239
    v_accvgpr_read_b32 v120, a224
    v_accvgpr_read_b32 v121, a225
    v_accvgpr_read_b32 v122, a226
    v_accvgpr_read_b32 v123, a227
    ds_write_b128 v15, v[216:219] offset:2048
    v_accvgpr_read_b32 v124, a228
    v_accvgpr_read_b32 v125, a229
    v_accvgpr_read_b32 v126, a230
    v_accvgpr_read_b32 v127, a231
    v_accvgpr_read_b32 v144, a240
    v_accvgpr_read_b32 v146, a242
    v_accvgpr_read_b32 v148, a244
    ds_write_b128 v15, v[220:223] offset:3072
    v_accvgpr_read_b32 v150, a246
    v_accvgpr_read_b32 v152, a248
    v_accvgpr_read_b32 v154, a250
    v_accvgpr_read_b32 v156, a252
    v_accvgpr_read_b32 v158, a254
    v_and_b32 v145, s36, v144
    ds_write_b128 v16, v[224:227] offset:4096
    v_lshlrev_b32 v144, 16, v144
    v_and_b32 v147, s36, v146
    v_lshlrev_b32 v146, 16, v146
    v_and_b32 v149, s36, v148
    v_lshlrev_b32 v148, 16, v148
    v_and_b32 v151, s36, v150
    ds_write_b128 v16, v[228:231] offset:5120
    v_lshlrev_b32 v150, 16, v150
    v_and_b32 v153, s36, v152
    v_lshlrev_b32 v152, 16, v152
    v_and_b32 v155, s36, v154
    v_lshlrev_b32 v154, 16, v154
    v_and_b32 v157, s36, v156
    v_lshlrev_b32 v156, 16, v156
    ds_write_b128 v16, v[232:235] offset:6144
    v_and_b32 v159, s36, v158
    v_lshlrev_b32 v158, 16, v158
    v_permlane16_swap_b32 v120, v122
    v_permlane16_swap_b32 v121, v123
    v_permlane16_swap_b32 v124, v126
    v_permlane16_swap_b32 v125, v127
    ds_write_b128 v16, v[236:239] offset:7168
    v_lshlrev_b32 v160, 16, v112
    v_and_b32 v161, s36, v112
    v_lshlrev_b32 v162, 16, v113
    v_and_b32 v163, s36, v113
    v_lshlrev_b32 v164, 16, v114
    v_and_b32 v165, s36, v114
    ds_write_b128 v17, v[240:243] offset:8192
    v_lshlrev_b32 v166, 16, v115
    v_and_b32 v167, s36, v115
    v_lshlrev_b32 v168, 16, v116
    v_and_b32 v169, s36, v116
    v_lshlrev_b32 v170, 16, v117
    v_and_b32 v171, s36, v117
    v_lshlrev_b32 v172, 16, v118
    ds_write_b128 v17, v[244:247] offset:9216
    v_and_b32 v173, s36, v118
    v_lshlrev_b32 v174, 16, v119
    v_and_b32 v175, s36, v119
    v_lshlrev_b32 v176, 16, v120
    v_and_b32 v177, s36, v120
    v_lshlrev_b32 v178, 16, v121
    ds_write_b128 v17, v[248:251] offset:10240
    v_and_b32 v179, s36, v121
    v_lshlrev_b32 v180, 16, v122
    v_and_b32 v181, s36, v122
    v_lshlrev_b32 v182, 16, v123
    v_and_b32 v183, s36, v123
    v_lshlrev_b32 v184, 16, v124
    ds_write_b128 v17, v[252:255] offset:11264
    v_and_b32 v185, s36, v124
    v_lshlrev_b32 v186, 16, v125
    v_and_b32 v187, s36, v125
    v_lshlrev_b32 v188, 16, v126
    v_and_b32 v189, s36, v126
    v_lshlrev_b32 v190, 16, v127
    v_and_b32 v191, s36, v127
    v_pk_add_f32 v[96:97], v[192:193], v[160:161]
    v_pk_add_f32 v[98:99], v[194:195], v[162:163]
    v_pk_add_f32 v[100:101], v[196:197], v[164:165]
    v_pk_add_f32 v[102:103], v[198:199], v[166:167]
    v_pk_add_f32 v[104:105], v[200:201], v[168:169]
    v_pk_add_f32 v[106:107], v[202:203], v[170:171]
    v_pk_add_f32 v[108:109], v[204:205], v[172:173]
    v_pk_add_f32 v[110:111], v[206:207], v[174:175]
    s_add_u32 s61, s31, s24
    s_mul_i32 s61, s61, 14336
    s_add_u32 s61, s61, s32
    v_cmp_gt_u32 vcc, 8, v3
    v_add_u32 v7, -7104, v22
    s_nop 0
    v_cndmask_b32 v22, v7, v22, vcc
    s_waitcnt lgkmcnt(0)
    s_barrier
    ds_read_b128 v[32:35], v6 offset:0
    ds_read_b128 v[36:39], v6 offset:1024
    ds_read_b128 v[40:43], v6 offset:2048
    ds_read_b128 v[44:47], v6 offset:3072
    ds_read_b128 v[48:51], v6 offset:4096
    ds_read_b128 v[52:55], v6 offset:5120
    ds_read_b128 v[56:59], v6 offset:6144
    ds_read_b128 v[60:63], v6 offset:7168
    ds_read_b128 v[64:67], v6 offset:8192
    ds_read_b128 v[68:71], v6 offset:9216
    ds_read_b128 v[72:75], v6 offset:10240
    ds_read_b128 v[76:79], v6 offset:11264
    s_waitcnt lgkmcnt(8)
    v_pk_add_f32 v[96:97], v[32:33], v[96:97]
    v_pk_add_f32 v[98:99], v[34:35], v[98:99]
    v_pk_add_f32 v[100:101], v[36:37], v[100:101]
    v_pk_add_f32 v[102:103], v[38:39], v[102:103]
    v_pk_add_f32 v[104:105], v[40:41], v[104:105]
    v_pk_add_f32 v[106:107], v[42:43], v[106:107]
    v_pk_add_f32 v[108:109], v[44:45], v[108:109]
    v_pk_add_f32 v[110:111], v[46:47], v[110:111]
    s_waitcnt lgkmcnt(4)
    v_pk_add_f32 v[96:97], v[48:49], v[96:97]
    v_pk_add_f32 v[98:99], v[50:51], v[98:99]
    v_pk_add_f32 v[100:101], v[52:53], v[100:101]
    v_pk_add_f32 v[102:103], v[54:55], v[102:103]
    v_pk_add_f32 v[104:105], v[56:57], v[104:105]
    v_pk_add_f32 v[106:107], v[58:59], v[106:107]
    v_pk_add_f32 v[108:109], v[60:61], v[108:109]
    v_pk_add_f32 v[110:111], v[62:63], v[110:111]
    s_waitcnt lgkmcnt(0)
    v_pk_add_f32 v[96:97], v[64:65], v[96:97]
    v_pk_add_f32 v[98:99], v[66:67], v[98:99]
    v_pk_add_f32 v[100:101], v[68:69], v[100:101]
    v_pk_add_f32 v[102:103], v[70:71], v[102:103]
    v_pk_add_f32 v[104:105], v[72:73], v[104:105]
    v_pk_add_f32 v[106:107], v[74:75], v[106:107]
    v_pk_add_f32 v[108:109], v[76:77], v[108:109]
    v_pk_add_f32 v[110:111], v[78:79], v[110:111]
    v_pk_fma_f32 v[96:97], v[96:97], v[144:145], v[176:177]
    v_pk_fma_f32 v[98:99], v[98:99], v[146:147], v[178:179]
    v_pk_fma_f32 v[100:101], v[100:101], v[148:149], v[180:181]
    v_pk_fma_f32 v[102:103], v[102:103], v[150:151], v[182:183]
    v_pk_fma_f32 v[104:105], v[104:105], v[152:153], v[184:185]
    v_pk_fma_f32 v[106:107], v[106:107], v[154:155], v[186:187]
    v_pk_fma_f32 v[108:109], v[108:109], v[156:157], v[188:189]
    v_pk_fma_f32 v[110:111], v[110:111], v[158:159], v[190:191]
    v_cvt_pk_bf16_f32 v128, v96, v97
    v_cvt_pk_bf16_f32 v129, v98, v99
    v_cvt_pk_bf16_f32 v130, v100, v101
    v_cvt_pk_bf16_f32 v131, v102, v103
    v_cvt_pk_bf16_f32 v132, v104, v105
    v_cvt_pk_bf16_f32 v133, v106, v107
    v_cvt_pk_bf16_f32 v134, v108, v109
    v_cvt_pk_bf16_f32 v135, v110, v111
    v_permlane16_swap_b32 v128, v130
    v_permlane16_swap_b32 v129, v131
    v_permlane16_swap_b32 v132, v134
    v_permlane16_swap_b32 v133, v135
    v_cndmask_b32 v136, v128, v132, vcc
    v_cndmask_b32 v137, v129, v133, vcc
    v_cndmask_b32 v138, v130, v134, vcc
    v_cndmask_b32 v139, v131, v135, vcc
    v_mov_b32_dpp v140, v136 row_ror:8 row_mask:0xf bank_mask:0xf
    v_mov_b32_dpp v141, v137 row_ror:8 row_mask:0xf bank_mask:0xf
    v_mov_b32_dpp v142, v138 row_ror:8 row_mask:0xf bank_mask:0xf
    v_mov_b32_dpp v143, v139 row_ror:8 row_mask:0xf bank_mask:0xf
    v_cndmask_b32 v128, v140, v128, vcc
    v_cndmask_b32 v132, v132, v140, vcc
    v_cndmask_b32 v129, v141, v129, vcc
    v_cndmask_b32 v133, v133, v141, vcc
    v_cndmask_b32 v130, v142, v130, vcc
    v_cndmask_b32 v134, v134, v142, vcc
    v_cndmask_b32 v131, v143, v131, vcc
    v_cndmask_b32 v135, v135, v143, vcc
    buffer_store_dwordx4 v[128:131], v22, s[12:15], s61 offen sc1
    s_add_u32 s61, s61, 7168
    buffer_store_dwordx4 v[132:135], v22, s[12:15], s61 offen sc1
T5_end:
    s_endpgm
T3_r:
    s_add_u32 s42, s33, 8388608
    buffer_load_dwordx4 v[32:35], v15, s[20:23], s42 offen offset:0 sc1
    buffer_load_dwordx4 v[36:39], v15, s[20:23], s42 offen offset:1024 sc1
    buffer_load_dwordx4 v[40:43], v15, s[20:23], s42 offen offset:2048 sc1
    buffer_load_dwordx4 v[44:47], v24, s[20:23], s42 offen offset:3072 sc1
    s_add_u32 s42, s42, 4096
    buffer_load_dwordx4 v[48:51], v16, s[20:23], s42 offen offset:0 sc1
    buffer_load_dwordx4 v[52:55], v16, s[20:23], s42 offen offset:1024 sc1
    buffer_load_dwordx4 v[56:59], v16, s[20:23], s42 offen offset:2048 sc1
    buffer_load_dwordx4 v[60:63], v17, s[20:23], s42 offen offset:3072 sc1
    s_add_u32 s42, s42, 4096
    buffer_load_dwordx4 v[64:67], v17, s[20:23], s42 offen offset:0 sc1
    buffer_load_dwordx4 v[68:71], v17, s[20:23], s42 offen offset:1024 sc1
    buffer_load_dwordx4 v[72:75], v25, s[20:23], s42 offen offset:2048 sc1
    buffer_load_dwordx4 v[76:79], v21, s[20:23], s42 offen offset:3072 sc1
    s_add_u32 s42, s42, 4096
    buffer_load_dwordx4 v[80:83], v21, s[20:23], s42 offen offset:0 sc1
    buffer_load_dwordx4 v[84:87], v21, s[20:23], s42 offen offset:1024 sc1
    s_waitcnt vmcnt(0)
    v_max3_u32 v8, v32, v33, v33
    v_max3_u32 v8, v34, v35, v8
    v_max3_u32 v8, v36, v37, v8
    v_max3_u32 v8, v38, v39, v8
    v_max3_u32 v8, v40, v41, v8
    v_max3_u32 v8, v42, v43, v8
    v_max3_u32 v8, v44, v45, v8
    v_max3_u32 v8, v46, v47, v8
    v_max3_u32 v8, v48, v49, v8
    v_max3_u32 v8, v50, v51, v8
    v_max3_u32 v8, v52, v53, v8
    v_max3_u32 v8, v54, v55, v8
    v_max3_u32 v8, v56, v57, v8
    v_max3_u32 v8, v58, v59, v8
    v_max3_u32 v8, v60, v61, v8
    v_max3_u32 v8, v62, v63, v8
    v_max3_u32 v8, v64, v65, v8
    v_max3_u32 v8, v66, v67, v8
    v_max3_u32 v8, v68, v69, v8
    v_max3_u32 v8, v70, v71, v8
    v_max3_u32 v8, v72, v73, v8
    v_max3_u32 v8, v74, v75, v8
    v_max3_u32 v8, v76, v77, v8
    v_max3_u32 v8, v78, v79, v8
    v_max3_u32 v8, v80, v81, v8
    v_max3_u32 v8, v82, v83, v8
    v_max3_u32 v8, v84, v85, v8
    v_max3_u32 v8, v86, v87, v8
    v_cmp_le_u32 vcc, 0xff810000, v8
    s_sub_u32 s43, s43, 1
    s_cbranch_vccz T3_r_ok
    s_cmp_lg_u32 s43, 0
    s_cbranch_scc1 T3_r
T3_r_ok:
    v_mfma_f32_16x16x32_bf16 v[96:99], a[0:3], v[32:35], 0
    v_mfma_f32_16x16x32_bf16 v[100:103], a[4:7], v[32:35], 0
    v_mfma_f32_16x16x32_bf16 v[104:107], a[8:11], v[32:35], 0
    v_mfma_f32_16x16x32_bf16 v[108:111], a[12:15], v[32:35], 0
    v_mfma_f32_16x16x32_bf16 v[96:99], a[16:19], v[36:39], v[96:99]
    v_mfma_f32_16x16x32_bf16 v[100:103], a[20:23], v[36:39], v[100:103]
    v_mfma_f32_16x16x32_bf16 v[104:107], a[24:27], v[36:39], v[104:107]
    v_mfma_f32_16x16x32_bf16 v[108:111], a[28:31], v[36:39], v[108:111]
    v_mfma_f32_16x16x32_bf16 v[96:99], a[32:35], v[40:43], v[96:99]
    v_mfma_f32_16x16x32_bf16 v[100:103], a[36:39], v[40:43], v[100:103]
    v_mfma_f32_16x16x32_bf16 v[104:107], a[40:43], v[40:43], v[104:107]
    v_mfma_f32_16x16x32_bf16 v[108:111], a[44:47], v[40:43], v[108:111]
    v_mfma_f32_16x16x32_bf16 v[96:99], a[48:51], v[44:47], v[96:99]
    v_mfma_f32_16x16x32_bf16 v[100:103], a[52:55], v[44:47], v[100:103]
    v_mfma_f32_16x16x32_bf16 v[104:107], a[56:59], v[44:47], v[104:107]
    v_mfma_f32_16x16x32_bf16 v[108:111], a[60:63], v[44:47], v[108:111]
    v_mfma_f32_16x16x32_bf16 v[96:99], a[64:67], v[48:51], v[96:99]
    v_mfma_f32_16x16x32_bf16 v[100:103], a[68:71], v[48:51], v[100:103]
    v_mfma_f32_16x16x32_bf16 v[104:107], a[72:75], v[48:51], v[104:107]
    v_mfma_f32_16x16x32_bf16 v[108:111], a[76:79], v[48:51], v[108:111]
    v_mfma_f32_16x16x32_bf16 v[96:99], a[80:83], v[52:55], v[96:99]
    v_mfma_f32_16x16x32_bf16 v[100:103], a[84:87], v[52:55], v[100:103]
    v_mfma_f32_16x16x32_bf16 v[104:107], a[88:91], v[52:55], v[104:107]
    v_mfma_f32_16x16x32_bf16 v[108:111], a[92:95], v[52:55], v[108:111]
    v_mfma_f32_16x16x32_bf16 v[96:99], a[96:99], v[56:59], v[96:99]
    v_mfma_f32_16x16x32_bf16 v[100:103], a[100:103], v[56:59], v[100:103]
    v_mfma_f32_16x16x32_bf16 v[104:107], a[104:107], v[56:59], v[104:107]
    v_mfma_f32_16x16x32_bf16 v[108:111], a[108:111], v[56:59], v[108:111]
    v_mfma_f32_16x16x32_bf16 v[96:99], a[112:115], v[60:63], v[96:99]
    v_mfma_f32_16x16x32_bf16 v[100:103], a[116:119], v[60:63], v[100:103]
    v_mfma_f32_16x16x32_bf16 v[104:107], a[120:123], v[60:63], v[104:107]
    v_mfma_f32_16x16x32_bf16 v[108:111], a[124:127], v[60:63], v[108:111]
    v_mfma_f32_16x16x32_bf16 v[96:99], a[128:131], v[64:67], v[96:99]
    v_mfma_f32_16x16x32_bf16 v[100:103], a[132:135], v[64:67], v[100:103]
    v_mfma_f32_16x16x32_bf16 v[104:107], a[136:139], v[64:67], v[104:107]
    v_mfma_f32_16x16x32_bf16 v[108:111], a[140:143], v[64:67], v[108:111]
    v_mfma_f32_16x16x32_bf16 v[96:99], a[144:147], v[68:71], v[96:99]
    v_mfma_f32_16x16x32_bf16 v[100:103], a[148:151], v[68:71], v[100:103]
    v_mfma_f32_16x16x32_bf16 v[104:107], a[152:155], v[68:71], v[104:107]
    v_mfma_f32_16x16x32_bf16 v[108:111], a[156:159], v[68:71], v[108:111]
    v_mfma_f32_16x16x32_bf16 v[96:99], a[160:163], v[72:75], v[96:99]
    v_mfma_f32_16x16x32_bf16 v[100:103], a[164:167], v[72:75], v[100:103]
    v_mfma_f32_16x16x32_bf16 v[104:107], a[168:171], v[72:75], v[104:107]
    v_mfma_f32_16x16x32_bf16 v[108:111], a[172:175], v[72:75], v[108:111]
    v_mfma_f32_16x16x32_bf16 v[96:99], a[176:179], v[76:79], v[96:99]
    v_mfma_f32_16x16x32_bf16 v[100:103], a[180:183], v[76:79], v[100:103]
    v_mfma_f32_16x16x32_bf16 v[104:107], a[184:187], v[76:79], v[104:107]
    v_mfma_f32_16x16x32_bf16 v[108:111], a[188:191], v[76:79], v[108:111]
    v_mfma_f32_16x16x32_bf16 v[96:99], a[192:195], v[80:83], v[96:99]
    v_mfma_f32_16x16x32_bf16 v[100:103], a[196:199], v[80:83], v[100:103]
    v_mfma_f32_16x16x32_bf16 v[104:107], a[200:203], v[80:83], v[104:107]
    v_mfma_f32_16x16x32_bf16 v[108:111], a[204:207], v[80:83], v[108:111]
    v_mfma_f32_16x16x32_bf16 v[96:99], a[208:211], v[84:87], v[96:99]
    v_mfma_f32_16x16x32_bf16 v[100:103], a[212:215], v[84:87], v[100:103]
    v_mfma_f32_16x16x32_bf16 v[104:107], a[216:219], v[84:87], v[104:107]
    v_mfma_f32_16x16x32_bf16 v[108:111], a[220:223], v[84:87], v[108:111]
    s_nop 7
    s_branch T3_c
KB_redo:
    s_mov_b32 s38, 1
    s_mov_b32 s36, 0
    s_mov_b32 s34, 32
    s_mov_b32 s6, 0
    s_mov_b32 s47, 0
    s_mov_b32 s91, 0
    v_and_b32 v230, 63, v255
    v_lshrrev_b32 v231, 5, v230
    v_and_b32 v230, 31, v230
    v_lshlrev_b32 v230, 4, v230
    v_lshl_add_u32 v233, v231, 13, v230
    v_add_u32 v230, 1584, v233
    v_add_u32 v231, 1056, v233
    v_add_u32 v232, 528, v233
    s_lshl_b32 s43, s27, 12
    s_lshr_b32 s28, s24, 1
    s_lshl_b32 s28, s28, 14
    s_add_u32 s28, s28, s43
    s_add_u32 s29, s28, 2048
    s_add_u32 s37, s28, 1015808
    s_mul_i32 s32, s24, 8320
    s_lshl_b32 s30, s24, 13
    s_add_u32 s31, s30, 2048
    v_mov_b32 v240, 0xff800000
    v_mov_b32 v241, 0xff800000
    v_mov_b32 v242, 0xff800000
    v_mov_b32 v243, 0xff800000
    s_waitcnt vmcnt(0)
KB_rl:
    s_barrier
    s_add_u32 m0, s32, 0
    s_nop 0
    buffer_load_dwordx4 v230, s[8:11], s28 offen offset:0 lds
    buffer_load_dwordx4 v231, s[8:11], s28 offen offset:1040 lds
    buffer_load_dwordx4 v232, s[8:11], s28 offen offset:2080 lds
    buffer_load_dwordx4 v233, s[8:11], s28 offen offset:3120 lds
    s_add_u32 m0, s32, 4160
    s_nop 0
    buffer_load_dwordx4 v230, s[8:11], s29 offen offset:0 lds
    buffer_load_dwordx4 v231, s[8:11], s29 offen offset:1040 lds
    buffer_load_dwordx4 v232, s[8:11], s29 offen offset:2080 lds
    buffer_load_dwordx4 v233, s[8:11], s29 offen offset:3120 lds
    s_add_u32 s28, s28, 0x8000
    s_min_u32 s28, s28, s37
    s_add_u32 s29, s28, 2048
    s_waitcnt vmcnt(0)
    s_barrier
    ds_read_b128 a[128:131], v224 offset:0
    ds_read_b128 a[132:135], v224 offset:512
    ds_read_b128 a[136:139], v224 offset:32
    ds_read_b128 a[140:143], v224 offset:544
    s_waitcnt lgkmcnt(2)
    v_mfma_f32_16x16x32_bf16 v[128:131], a[128:131], a[0:3], 0
    ds_read_b128 a[144:147], v224 offset:64
    v_mfma_f32_16x16x32_bf16 v[132:135], a[128:131], a[32:35], 0
    v_mfma_f32_16x16x32_bf16 v[136:139], a[128:131], a[64:67], 0
    v_mfma_f32_16x16x32_bf16 v[140:143], a[128:131], a[96:99], 0
    v_mfma_f32_16x16x32_bf16 v[144:147], a[132:135], a[0:3], 0
    ds_read_b128 a[148:151], v224 offset:576
    v_mfma_f32_16x16x32_bf16 v[148:151], a[132:135], a[32:35], 0
    v_mfma_f32_16x16x32_bf16 v[152:155], a[132:135], a[64:67], 0
    v_mfma_f32_16x16x32_bf16 v[156:159], a[132:135], a[96:99], 0
    s_waitcnt lgkmcnt(2)
    v_mfma_f32_16x16x32_bf16 v[128:131], a[136:139], a[4:7], v[128:131]
    ds_read_b128 a[152:155], v224 offset:96
    v_mfma_f32_16x16x32_bf16 v[132:135], a[136:139], a[36:39], v[132:135]
    v_mfma_f32_16x16x32_bf16 v[136:139], a[136:139], a[68:71], v[136:139]
    v_mfma_f32_16x16x32_bf16 v[140:143], a[136:139], a[100:103], v[140:143]
    v_mfma_f32_16x16x32_bf16 v[144:147], a[140:143], a[4:7], v[144:147]
    ds_read_b128 a[156:159], v224 offset:608
    v_mfma_f32_16x16x32_bf16 v[148:151], a[140:143], a[36:39], v[148:151]
    v_mfma_f32_16x16x32_bf16 v[152:155], a[140:143], a[68:71], v[152:155]
    v_mfma_f32_16x16x32_bf16 v[156:159], a[140:143], a[100:103], v[156:159]
    s_waitcnt lgkmcnt(2)
    v_mfma_f32_16x16x32_bf16 v[128:131], a[144:147], a[8:11], v[128:131]
    ds_read_b128 a[128:131], v224 offset:128
    v_mfma_f32_16x16x32_bf16 v[132:135], a[144:147], a[40:43], v[132:135]
    v_mfma_f32_16x16x32_bf16 v[136:139], a[144:147], a[72:75], v[136:139]
    v_mfma_f32_16x16x32_bf16 v[140:143], a[144:147], a[104:107], v[140:143]
    v_mfma_f32_16x16x32_bf16 v[144:147], a[148:151], a[8:11], v[144:147]
    ds_read_b128 a[132:135], v224 offset:640
    v_mfma_f32_16x16x32_bf16 v[148:151], a[148:151], a[40:43], v[148:151]
    v_mfma_f32_16x16x32_bf16 v[152:155], a[148:151], a[72:75], v[152:155]
    v_mfma_f32_16x16x32_bf16 v[156:159], a[148:151], a[104:107], v[156:159]
    s_waitcnt lgkmcnt(2)
    v_mfma_f32_16x16x32_bf16 v[128:131], a[152:155], a[12:15], v[128:131]
    ds_read_b128 a[136:139], v224 offset:160
    v_mfma_f32_16x16x32_bf16 v[132:135], a[152:155], a[44:47], v[132:135]
    v_mfma_f32_16x16x32_bf16 v[136:139], a[152:155], a[76:79], v[136:139]
    v_mfma_f32_16x16x32_bf16 v[140:143], a[152:155], a[108:111], v[140:143]
    v_mfma_f32_16x16x32_bf16 v[144:147], a[156:159], a[12:15], v[144:147]
    ds_read_b128 a[140:143], v224 offset:672
    v_mfma_f32_16x16x32_bf16 v[148:151], a[156:159], a[44:47], v[148:151]
    v_mfma_f32_16x16x32_bf16 v[152:155], a[156:159], a[76:79], v[152:155]
    v_mfma_f32_16x16x32_bf16 v[156:159], a[156:159], a[108:111], v[156:159]
    s_waitcnt lgkmcnt(2)
    v_mfma_f32_16x16x32_bf16 v[128:131], a[128:131], a[16:19], v[128:131]
    ds_read_b128 a[144:147], v224 offset:192
    v_mfma_f32_16x16x32_bf16 v[132:135], a[128:131], a[48:51], v[132:135]
    v_mfma_f32_16x16x32_bf16 v[136:139], a[128:131], a[80:83], v[136:139]
    v_mfma_f32_16x16x32_bf16 v[140:143], a[128:131], a[112:115], v[140:143]
    v_mfma_f32_16x16x32_bf16 v[144:147], a[132:135], a[16:19], v[144:147]
    ds_read_b128 a[148:151], v224 offset:704
    v_mfma_f32_16x16x32_bf16 v[148:151], a[132:135], a[48:51], v[148:151]
    v_mfma_f32_16x16x32_bf16 v[152:155], a[132:135], a[80:83], v[152:155]
    v_mfma_f32_16x16x32_bf16 v[156:159], a[132:135], a[112:115], v[156:159]
    s_waitcnt lgkmcnt(2)
    v_mfma_f32_16x16x32_bf16 v[128:131], a[136:139], a[20:23], v[128:131]
    ds_read_b128 a[152:155], v224 offset:224
    v_mfma_f32_16x16x32_bf16 v[132:135], a[136:139], a[52:55], v[132:135]
    v_mfma_f32_16x16x32_bf16 v[136:139], a[136:139], a[84:87], v[136:139]
    v_mfma_f32_16x16x32_bf16 v[140:143], a[136:139], a[116:119], v[140:143]
    v_mfma_f32_16x16x32_bf16 v[144:147], a[140:143], a[20:23], v[144:147]
    ds_read_b128 a[156:159], v224 offset:736
    v_mfma_f32_16x16x32_bf16 v[148:151], a[140:143], a[52:55], v[148:151]
    v_mfma_f32_16x16x32_bf16 v[152:155], a[140:143], a[84:87], v[152:155]
    v_mfma_f32_16x16x32_bf16 v[156:159], a[140:143], a[116:119], v[156:159]
    s_waitcnt lgkmcnt(2)
    v_mfma_f32_16x16x32_bf16 v[128:131], a[144:147], a[24:27], v[128:131]
    v_mfma_f32_16x16x32_bf16 v[132:135], a[144:147], a[56:59], v[132:135]
    v_mfma_f32_16x16x32_bf16 v[136:139], a[144:147], a[88:91], v[136:139]
    v_mfma_f32_16x16x32_bf16 v[140:143], a[144:147], a[120:123], v[140:143]
    v_mfma_f32_16x16x32_bf16 v[144:147], a[148:151], a[24:27], v[144:147]
    v_mfma_f32_16x16x32_bf16 v[148:151], a[148:151], a[56:59], v[148:151]
    v_mfma_f32_16x16x32_bf16 v[152:155], a[148:151], a[88:91], v[152:155]
    v_mfma_f32_16x16x32_bf16 v[156:159], a[148:151], a[120:123], v[156:159]
    s_waitcnt lgkmcnt(0)
    v_mfma_f32_16x16x32_bf16 v[128:131], a[152:155], a[28:31], v[128:131]
    v_mfma_f32_16x16x32_bf16 v[132:135], a[152:155], a[60:63], v[132:135]
    v_mfma_f32_16x16x32_bf16 v[136:139], a[152:155], a[92:95], v[136:139]
    v_mfma_f32_16x16x32_bf16 v[140:143], a[152:155], a[124:127], v[140:143]
    v_mfma_f32_16x16x32_bf16 v[144:147], a[156:159], a[28:31], v[144:147]
    v_mfma_f32_16x16x32_bf16 v[148:151], a[156:159], a[60:63], v[148:151]
    v_mfma_f32_16x16x32_bf16 v[152:155], a[156:159], a[92:95], v[152:155]
    v_mfma_f32_16x16x32_bf16 v[156:159], a[156:159], a[124:127], v[156:159]
    s_nop 7
    v_max3_f32 v240, v240, v128, v129
    v_max3_f32 v240, v240, v130, v131
    v_max3_f32 v240, v240, v144, v145
    v_max3_f32 v240, v240, v146, v147
    v_max3_f32 v241, v241, v132, v133
    v_max3_f32 v241, v241, v134, v135
    v_max3_f32 v241, v241, v148, v149
    v_max3_f32 v241, v241, v150, v151
    v_max3_f32 v242, v242, v136, v137
    v_max3_f32 v242, v242, v138, v139
    v_max3_f32 v242, v242, v152, v153
    v_max3_f32 v242, v242, v154, v155
    v_max3_f32 v243, v243, v140, v141
    v_max3_f32 v243, v243, v142, v143
    v_max3_f32 v243, v243, v156, v157
    v_max3_f32 v243, v243, v158, v159
    s_sub_u32 s34, s34, 1
    s_cmp_lg_u32 s34, 0
    s_cbranch_scc1 KB_rl
    v_and_b32 v230, 63, v255
    v_lshrrev_b32 v231, 5, v230
    v_and_b32 v230, 31, v230
    v_lshlrev_b32 v230, 4, v230
    v_lshl_add_u32 v233, v231, 13, v230
    v_add_u32 v230, 1584, v233
    v_add_u32 v231, 1056, v233
    v_add_u32 v232, 528, v233
    s_lshl_b32 s43, s27, 12
    s_lshr_b32 s28, s24, 1
    s_lshl_b32 s28, s28, 14
    s_add_u32 s28, s28, s43
    s_add_u32 s29, s28, 2048
    s_add_u32 s37, s28, 1015808
    s_mul_i32 s32, s24, 8320
    s_lshl_b32 s30, s24, 13
    s_add_u32 s31, s30, 2048
    s_barrier
    s_add_u32 m0, s32, 0
    s_nop 0
    buffer_load_dwordx4 v230, s[8:11], s28 offen offset:0 lds
    buffer_load_dwordx4 v231, s[8:11], s28 offen offset:1040 lds
    buffer_load_dwordx4 v232, s[8:11], s28 offen offset:2080 lds
    buffer_load_dwordx4 v233, s[8:11], s28 offen offset:3120 lds
    s_add_u32 m0, s32, 4160
    s_nop 0
    buffer_load_dwordx4 v230, s[8:11], s29 offen offset:0 lds
    buffer_load_dwordx4 v231, s[8:11], s29 offen offset:1040 lds
    buffer_load_dwordx4 v232, s[8:11], s29 offen offset:2080 lds
    buffer_load_dwordx4 v233, s[8:11], s29 offen offset:3120 lds
    s_add_u32 s28, s28, 0x8000
    s_min_u32 s28, s28, s37
    s_add_u32 s29, s28, 2048
    s_waitcnt vmcnt(0)
    s_barrier
    s_branch KB_restart
KB_done:
    s_endpgm
.section .rodata,"a"
.p2align 6
.amdhsa_kernel adaLN_cond__gqa_block_cached__mixer_s_mlp__prompt_kernel
  .amdhsa_next_free_vgpr 512
  .amdhsa_next_free_sgpr 102
  .amdhsa_accum_offset 256
  .amdhsa_group_segment_fixed_size 0
  .amdhsa_kernarg_size 120
  .amdhsa_user_sgpr_count 2
  .amdhsa_user_sgpr_kernarg_segment_ptr 1
  .amdhsa_system_sgpr_workgroup_id_x 1
.end_amdhsa_kernel
```
